```python
import torch

def _softmax(x, axis=-1):
    return torch.softmax(x, dim=axis)
def _gelu(x):
    return torch.nn.functional.gelu(x, approximate="tanh")
def _silu(x):
    return torch.nn.functional.silu(x)
def _sigmoid(x):
    return torch.sigmoid(x)
def _layernorm(x, axis=-1, eps=1e-5):
    m = x.mean(dim=axis, keepdim=True)
    v = x.var(dim=axis, keepdim=True, unbiased=False)
    return (x - m) / torch.sqrt(v + eps)
def _scatter_add(tgt, idx, src, axis=0):
    return tgt.clone().index_add_(axis, idx, src)
def _segment_sum(src, seg, n):
    out = torch.zeros((n,) + src.shape[1:], dtype=src.dtype)
    return out.index_add_(0, seg, src)
def _pad(x, pw):
    flat = tuple(v for pair in reversed(pw) for v in pair)
    return torch.nn.functional.pad(x, flat)

kernel_name = 'interleave_layers__sliding_block__glu_gated_geglu__prompt'

def setup_inputs():

    _w = (lambda a: (lambda t: t.to(torch.bfloat16) if t.is_floating_point() else t)(torch.as_tensor(a)))
    def _A_setup():
        B, S, D = 1, 2048, 640
        return {
            "x": _w((lambda *s: torch.randn(*s, dtype=torch.bfloat16) * 0.05)(B, S, D)),
            "wqkv": _w((lambda *s: torch.randn(*s, dtype=torch.bfloat16) * 0.05)(D, 3 * D)),
            "wo": _w((lambda *s: torch.randn(*s, dtype=torch.bfloat16) * 0.05)(D, D)),
        }
    _A_in = _A_setup()

    def _B_setup():
        B, S, Dm, Df = 1, 2048, 640, 1536
        return {
            "x": _w((lambda *s: torch.randn(*s, dtype=torch.bfloat16) * 0.05)(B, S, Dm)),
            "w_gate": _w((lambda *s: torch.randn(*s, dtype=torch.bfloat16) * 0.8)(Dm, Df) * (Dm ** -0.5)),
            "w_up": _w((lambda *s: torch.randn(*s, dtype=torch.bfloat16) * 0.8)(Dm, Df) * (Dm ** -0.5)),
            "w_down": _w((lambda *s: torch.randn(*s, dtype=torch.bfloat16) * 0.8)(Df, Dm) * (Df ** -0.5)),
        }
    _B_in = _B_setup()

    return {
        "A_x": _A_in["x"],
        "A_wqkv": _A_in["wqkv"],
        "A_wo": _A_in["wo"],
        "B_x": _B_in["x"],
        "B_w_gate": _B_in["w_gate"],
        "B_w_up": _B_in["w_up"],
        "B_w_down": _B_in["w_down"],
    }

def reference(A_x, A_wqkv, A_wo, B_x, B_w_gate, B_w_up, B_w_down):
    def _A_ref(x, wqkv, wo):
        B, S, D = x.shape
        H = 32; Dh = D // H; W = 256
        qkv = (lambda x, *d: x.permute(*d))((x @ wqkv).reshape(B, S, 3, H, Dh), 2, 0, 3, 1, 4)
        q, k, v = qkv[0], qkv[1], qkv[2]
        scores = torch.einsum("bhqd,bhkd->bhqk", q, k) * (Dh ** -0.5)
        idx = torch.arange(S)
        mask = (idx[:, None] - idx[None, :] >= 0) & (idx[:, None] - idx[None, :] < W)
        scores = torch.where(mask[None, None], scores, -1e9)
        p = _softmax(scores, axis=-1)
        o = torch.einsum("bhqk,bhkd->bhqd", p, v)
        return (lambda x, *d: x.permute(*d))(o, 0, 2, 1, 3).reshape(B, S, D) @ wo

    def _B_ref(x, w_gate, w_up, w_down):
        g = torch.einsum("bsd,df->bsf", x, w_gate)
        u = torch.einsum("bsd,df->bsf", x, w_up)
        h = _gelu(g) * u
        return torch.einsum("bsf,fd->bsd", h, w_down)

    x = A_x
    x = x + _A_ref(_layernorm(x, axis=-1), A_wqkv, A_wo)
    x = x + _B_ref(_layernorm(x, axis=-1), B_w_gate, B_w_up, B_w_down)
    x = x + _A_ref(_layernorm(x, axis=-1), A_wqkv, A_wo)
    x = x + _B_ref(_layernorm(x, axis=-1), B_w_gate, B_w_up, B_w_down)
    return x
```

```asm
; @launch grid=(256,1,1) block=(256,1,1) lds=163840
.amdgcn_target "amdgcn-amd-amdhsa--gfx950"
.text
.globl interleave_layers__sliding_block__glu_gated_geglu__prompt_kernel
.p2align 8
.type interleave_layers__sliding_block__glu_gated_geglu__prompt_kernel,@function
interleave_layers__sliding_block__glu_gated_geglu__prompt_kernel:
s_load_dwordx2 s[4:5], s[0:1], 72
s_load_dwordx2 s[8:9], s[0:1], 56
s_load_dwordx2 s[12:13], s[0:1], 0
s_load_dwordx2 s[32:33], s[0:1], 8
s_load_dwordx2 s[82:83], s[0:1], 16
s_load_dwordx4 s[84:87], s[0:1], 32
s_load_dwordx2 s[88:89], s[0:1], 48
s_cmp_ge_u32 s2, 256
s_cbranch_scc1 EXIT
s_getpc_b64 s[64:65]
PC1:
s_lshr_b32 s74, s2, 3
v_lshl_add_u32 v19, v0, 5, s74
v_lshlrev_b32 v19, 7, v19
v_min_u32 v19, main_end-PC1-4, v19
global_load_dword v247, v19, s[64:65]
s_mov_b32 s6, 266338304
s_mov_b32 s7, 0x00020000
s_mov_b32 s10, 2621440
s_mov_b32 s11, 0x00020000
s_mov_b32 s14, 2621440
s_mov_b32 s15, 0x00020000
v_lshrrev_b32 v19, 6, v0
v_and_b32 v0, 63, v0
v_readfirstlane_b32 s18, v19
s_and_b32 s74, s2, 7
s_lshr_b32 s75, s2, 3
s_lshr_b32 s76, s74, 1
s_lshl_b32 s76, s76, 2
s_lshr_b32 s16, s75, 3
s_add_u32 s16, s16, s76
s_and_b32 s76, s74, 1
s_lshl_b32 s76, s76, 3
s_and_b32 s17, s75, 7
s_add_u32 s17, s17, s76
s_and_b32 s19, s17, 1
s_lshr_b32 s20, s17, 1
s_lshl_b32 s25, s18, 12
v_lshlrev_b32 v1, 4, v0
s_add_u32 s58, s16, s17
s_and_b32 s58, s58, 15
s_add_u32 s59, s58, 1
s_and_b32 s59, s59, 15
s_mov_b32 s34, 2457600
s_mov_b32 s35, 0x00020000
v_mul_u32_u24 v48, 6554, v0
v_lshrrev_b32 v48, 16, v48
v_mul_u32_u24 v49, 10, v48
v_sub_u32 v49, v0, v49
v_mul_u32_u24 v48, 3840, v48
v_lshl_add_u32 v50, v49, 4, v48
s_lshr_b32 s42, s58, 2
s_and_b32 s43, s58, 3
s_lshl_b32 s43, s43, 1
s_add_u32 s43, s43, s19
s_mul_i32 s44, s42, 1280
s_mul_i32 s45, s20, 160
s_add_u32 s44, s44, s45
s_lshl_b32 s45, s43, 2
s_add_u32 s45, s45, s18
s_mul_i32 s45, s45, 76800
s_add_u32 s44, s44, s45
s_cmp_ge_u32 s58, 12
s_cselect_b32 s45, 268435456, 0
v_add_u32 v50, s45, v50
s_mul_i32 s45, s18, 3200
s_mov_b32 exec_hi, 0x3ffff
s_add_u32 m0, s45, 0
s_waitcnt lgkmcnt(0)
buffer_load_dwordx4 v50, s[32:35], s44 offen nt lds
s_add_u32 m0, s45, 800
s_add_u32 s44, s44, 19200
buffer_load_dwordx4 v50, s[32:35], s44 offen nt lds
s_add_u32 m0, s45, 1600
s_add_u32 s44, s44, 19200
buffer_load_dwordx4 v50, s[32:35], s44 offen nt lds
s_add_u32 m0, s45, 2400
s_add_u32 s44, s44, 19200
buffer_load_dwordx4 v50, s[32:35], s44 offen nt lds
s_mov_b32 exec_hi, -1
s_lshl_b32 s45, s16, 4
s_add_u32 s45, s45, s17
s_lshl_b32 s45, s45, 2
s_add_u32 s45, s45, s18
s_mul_i32 s45, s45, 2560
v_min_u32 v51, 19, v0
v_lshlrev_b32 v51, 7, v51
buffer_load_dword v246, v51, s[12:15], s45 offen
s_sub_u32 s74, 0, s4
s_and_b32 s74, s74, 0x1fffff
s_add_u32 s4, s4, s74
s_addc_u32 s5, s5, 0
s_cmp_lg_u32 s58, 15
s_cbranch_scc1 LC2
v_mov_b32 v60, 0
v_mov_b32 v61, 0
v_mov_b32 v62, 0
v_mov_b32 v63, 0
s_mul_i32 s44, s16, 4243456
s_add_u32 s44, s44, 84918272
s_lshl_b32 s45, s18, 13
s_add_u32 s45, s45, s44
s_lshr_b32 s57, s18, 1
v_lshrrev_b32 v64, s57, v0
v_and_b32 v65, s57, v0
v_lshlrev_b32 v65, 4, v65
v_lshl_add_u32 v64, v64, 7, v65
buffer_store_dwordx4 v[60:63], v64, s[4:7], s45 offen sc1
s_lshl_b32 s45, s18, 8
s_add_u32 s44, s44, s45
s_add_u32 s44, s44, 20480
s_load_dword s57, s[4:5], s44 offset:0 glc
s_load_dword s57, s[4:5], s44 offset:8192 glc
LC2:
s_nop 1
v_mov_b32 v249, 983040
buffer_load_dword v248, v249, s[4:7], 0 offen sc1
s_branch PG_al
.p2align 12
PG_al:
s_cmp_ge_u32 s59, 4
s_cselect_b64 s[36:37], s[86:87], s[84:85]
s_cmp_ge_u32 s59, 8
s_cselect_b64 s[36:37], s[88:89], s[36:37]
s_cmp_ge_u32 s59, 14
s_cselect_b64 s[36:37], s[82:83], s[36:37]
s_cselect_b32 s38, 819200, 0
s_cselect_b32 s41, 0, 1966080
s_add_u32 s38, s38, s41
s_mov_b32 s39, 0x00020000
s_mov_b32 s40, 0x3f803f80
s_mov_b32 s47, 6554
s_cmp_lt_u32 s59, 8
s_cselect_b32 s46, 24, 10
s_cselect_b32 s47, 2731, s47
s_cselect_b32 s49, s18, 0
v_mov_b32 v55, 268435456
s_mov_b32 s50, 1280
s_cselect_b32 s48, 3072, s50
s_lshl_b32 s49, s49, 9
s_cmp_ge_u32 s59, 14
s_cselect_b32 s50, 50, 40
s_lshl_b32 s50, s50, 3
s_cmp_lt_u32 s59, 8
s_cselect_b32 s50, 1920, s50
v_add_u32 v52, s49, v0
v_mul_u32_u24 v53, s47, v52
v_lshrrev_b32 v53, 16, v53
v_mul_u32_u24 v54, s46, v53
v_sub_u32 v54, v52, v54
v_mul_u32_u24 v53, s48, v53
v_lshl_add_u32 v53, v54, 4, v53
v_cmp_gt_u32 vcc, s50, v52
s_nop 1
v_cndmask_b32 v232, v55, v53, vcc
s_add_u32 s49, s49, 64
v_add_u32 v52, s49, v0
v_mul_u32_u24 v53, s47, v52
v_lshrrev_b32 v53, 16, v53
v_mul_u32_u24 v54, s46, v53
v_sub_u32 v54, v52, v54
v_mul_u32_u24 v53, s48, v53
v_lshl_add_u32 v53, v54, 4, v53
v_cmp_gt_u32 vcc, s50, v52
s_nop 1
v_cndmask_b32 v233, v55, v53, vcc
s_add_u32 s49, s49, 64
v_add_u32 v52, s49, v0
v_mul_u32_u24 v53, s47, v52
v_lshrrev_b32 v53, 16, v53
v_mul_u32_u24 v54, s46, v53
v_sub_u32 v54, v52, v54
v_mul_u32_u24 v53, s48, v53
v_lshl_add_u32 v53, v54, 4, v53
v_cmp_gt_u32 vcc, s50, v52
s_nop 1
v_cndmask_b32 v234, v55, v53, vcc
s_add_u32 s49, s49, 64
v_add_u32 v52, s49, v0
v_mul_u32_u24 v53, s47, v52
v_lshrrev_b32 v53, 16, v53
v_mul_u32_u24 v54, s46, v53
v_sub_u32 v54, v52, v54
v_mul_u32_u24 v53, s48, v53
v_lshl_add_u32 v53, v54, 4, v53
v_cmp_gt_u32 vcc, s50, v52
s_nop 1
v_cndmask_b32 v235, v55, v53, vcc
s_add_u32 s49, s49, 64
v_add_u32 v52, s49, v0
v_mul_u32_u24 v53, s47, v52
v_lshrrev_b32 v53, 16, v53
v_mul_u32_u24 v54, s46, v53
v_sub_u32 v54, v52, v54
v_mul_u32_u24 v53, s48, v53
v_lshl_add_u32 v53, v54, 4, v53
v_cmp_gt_u32 vcc, s50, v52
s_nop 1
v_cndmask_b32 v236, v55, v53, vcc
s_add_u32 s49, s49, 64
v_add_u32 v52, s49, v0
v_mul_u32_u24 v53, s47, v52
v_lshrrev_b32 v53, 16, v53
v_mul_u32_u24 v54, s46, v53
v_sub_u32 v54, v52, v54
v_mul_u32_u24 v53, s48, v53
v_lshl_add_u32 v53, v54, 4, v53
v_cmp_gt_u32 vcc, s50, v52
s_nop 1
v_cndmask_b32 v237, v55, v53, vcc
s_add_u32 s49, s49, 64
v_add_u32 v52, s49, v0
v_mul_u32_u24 v53, s47, v52
v_lshrrev_b32 v53, 16, v53
v_mul_u32_u24 v54, s46, v53
v_sub_u32 v54, v52, v54
v_mul_u32_u24 v53, s48, v53
v_lshl_add_u32 v53, v54, 4, v53
v_cmp_gt_u32 vcc, s50, v52
s_nop 1
v_cndmask_b32 v238, v55, v53, vcc
s_add_u32 s49, s49, 64
v_add_u32 v52, s49, v0
v_mul_u32_u24 v53, s47, v52
v_lshrrev_b32 v53, 16, v53
v_mul_u32_u24 v54, s46, v53
v_sub_u32 v54, v52, v54
v_mul_u32_u24 v53, s48, v53
v_lshl_add_u32 v53, v54, 4, v53
v_cmp_gt_u32 vcc, s50, v52
s_nop 1
v_cndmask_b32 v239, v55, v53, vcc
s_add_u32 s49, s49, 64
s_and_b32 s46, s59, 3
s_lshl_b32 s46, s46, 1
s_add_u32 s46, s46, s19
s_mul_i32 s46, s46, 245760
s_mul_i32 s47, s20, 384
s_add_u32 s46, s46, s47
s_cmp_ge_u32 s59, 14
s_cselect_b32 s47, 2, 6
s_cselect_b32 s48, 14, 8
s_cselect_b32 s49, 40, 32
s_mul_i32 s47, s47, s19
s_add_u32 s47, s47, s59
s_sub_u32 s47, s47, s48
s_lshl_b32 s47, s47, 2
s_add_u32 s60, s47, s18
s_mul_i32 s47, s60, s49
s_mul_i32 s47, s47, 1280
s_mul_i32 s48, s20, 160
s_add_u32 s47, s47, s48
s_cmp_lt_u32 s59, 8
s_cselect_b32 s61, s46, s47
s_lshl_b32 s74, s16, 2
s_add_u32 s74, s74, s18
s_mul_i32 s62, s74, 40960
v_lshrrev_b32 v48, 3, v0
v_mul_u32_u24 v48, 1280, v48
v_and_b32 v49, 7, v0
v_lshrrev_b32 v50, 4, v0
v_xor_b32 v49, v49, v50
v_lshl_add_u32 v96, v49, 4, v48
v_xor_b32 v97, 64, v96
v_add_u32 v98, 18432, v96
v_add_u32 v99, 27648, v97
v_add_u32 v97, 9216, v97
s_mul_i32 s21, s17, 163840
s_add_u32 s21, s21, s25
s_add_u32 s21, s21, 1048576
v_min_u32 v8, 1, v0
v_lshlrev_b32 v8, 28, v8
v_mov_b32 v9, 1
v_and_b32 v48, 31, v0
v_lshrrev_b32 v49, 5, v0
v_bfe_u32 v50, v0, 1, 3
v_xor_b32 v49, v49, v50
v_lshlrev_b32 v49, 4, v49
v_lshl_add_u32 v48, v48, 7, v49
v_and_b32 v48, 15, v0
v_lshrrev_b32 v49, 4, v0
v_xor_b32 v49, v49, v50
v_lshlrev_b32 v49, 4, v49
v_lshl_add_u32 v48, v48, 7, v49
s_add_u32 s74, s25, 65536
v_add_u32 v100, s74, v48
v_xor_b32 v101, 64, v100
v_xor_b32 v102, 2048, v100
v_xor_b32 v103, 2112, v100
v_mov_b32 v152, 0
v_mov_b32 v153, 0
v_mov_b32 v156, 0
v_mov_b32 v157, 0
s_lshl_b32 s74, s20, 12
s_add_u32 s74, s74, 917504
s_sub_u32 s75, 15, s16
s_mov_b32 s76, 919424
v_and_b32 v49, 3, v0
v_min_u32 v49, 2, v49
v_add_u32 v49, s75, v49
v_min_u32 v49, 15, v49
v_lshl_add_u32 v49, v49, 11, s76
v_lshlrev_b32 v174, 2, v0
v_add_u32 v174, 987136, v174
v_lshl_add_u32 v48, v0, 7, s74
v_cmp_gt_u32 vcc, 32, v0
s_nop 1
v_cndmask_b32 v240, v49, v48, vcc
s_lshl_b32 s74, s20, 12
s_add_u32 s74, s74, 950272
v_and_b32 v48, 31, v0
v_lshl_add_u32 v241, v48, 7, s74
s_mul_i32 s22, s17, 245760
s_add_u32 s22, s22, s25
s_add_u32 s22, s22, 4194304
s_mul_i32 s23, s20, 102400
s_mul_i32 s74, s18, 25600
s_add_u32 s23, s23, s74
s_add_u32 s23, s23, 8388608
s_mul_i32 s24, s20, 245760
s_mul_i32 s74, s18, 61440
s_add_u32 s24, s24, s74
s_add_u32 s24, s24, 9437184
s_lshl_b32 s74, s16, 2
s_add_u32 s74, s74, s18
s_cmp_lt_u32 s74, 8
s_cselect_b32 s80, 0x3f80, 0
s_or_b32 s80, s80, 1.0
s_cmp_lt_u32 s74, 7
s_cselect_b32 s81, 0x3f80, 0
s_or_b32 s81, s81, 1.0
s_cmp_lt_u32 s74, 6
s_cselect_b32 s82, 0x3f80, 0
s_or_b32 s82, s82, 1.0
s_cmp_lt_u32 s74, 5
s_cselect_b32 s83, 0x3f80, 0
s_or_b32 s83, s83, 1.0
s_cmp_lt_u32 s74, 4
s_cselect_b32 s84, 0x3f80, 0
s_or_b32 s84, s84, 1.0
s_cmp_lt_u32 s74, 3
s_cselect_b32 s85, 0x3f80, 0
s_or_b32 s85, s85, 1.0
s_cmp_lt_u32 s74, 2
s_cselect_b32 s86, 0x3f80, 0
s_or_b32 s86, s86, 1.0
s_cmp_lt_u32 s74, 1
s_cselect_b32 s87, 0x3f80, 0
s_or_b32 s87, s87, 1.0
s_cmp_lt_u32 s74, 0
s_cselect_b32 s88, 0x3f80, 0
s_or_b32 s88, s88, 1.0
v_lshlrev_b32 v255, 10, v0
v_mov_b32 v48, 268435456
v_cmp_gt_u32 vcc, 4, v0
s_nop 1
v_cndmask_b32 v255, v48, v255, vcc
s_add_u32 s74, s18, 1
s_and_b32 s74, s74, 3
s_mul_i32 s74, s74, 15360
s_add_u32 s74, s74, 0
v_add_u32 v10, s74, v1
s_add_u32 s74, s18, 2
s_and_b32 s74, s74, 3
s_mul_i32 s74, s74, 15360
s_add_u32 s74, s74, 5120
v_add_u32 v11, s74, v1
s_add_u32 s74, s18, 3
s_and_b32 s74, s74, 3
s_mul_i32 s74, s74, 15360
s_add_u32 s74, s74, 10240
v_add_u32 v12, s74, v1
s_mul_i32 s74, s18, 15360
v_add_u32 v13, s74, v1
v_add_u32 v2, 0x10000, v1
v_add_u32 v3, 0x20000, v1
v_lshrrev_b32 v48, 4, v0
v_and_b32 v49, 15, v0
v_lshlrev_b32 v50, 9, v48
v_lshl_add_u32 v4, v49, 4, v50
v_lshlrev_b32 v50, 10, v48
v_lshl_add_u32 v14, v49, 4, v50
v_lshrrev_b32 v50, 1, v48
v_lshlrev_b32 v50, 9, v50
v_lshl_add_u32 v15, v49, 4, v50
v_and_b32 v50, 1, v48
v_lshl_add_u32 v15, v50, 3, v15
s_mul_i32 s74, s20, 5120
v_add_u32 v14, s74, v14
s_add_u32 s74, s74, 4096
v_add_u32 v15, s74, v15
v_and_b32 v50, 0xffffe000, v14
v_add_u32 v14, v50, v14
v_and_b32 v50, 0xffffe000, v15
v_add_u32 v15, v50, v15
v_lshlrev_b32 v7, 7, v49
v_lshl_add_u32 v7, v48, 28, v7
v_lshlrev_b32 v17, 3, v49
v_lshl_add_u32 v17, v48, 28, v17
v_mul_u32_u24 v50, 160, v49
v_add_u32 v50, s25, v50
v_lshl_add_u32 v250, v48, 5, v50
v_lshl_add_u32 v251, v48, 3, v50
s_lshl_b32 s74, s16, 1
s_add_u32 s74, s74, s19
s_lshl_b32 s74, s74, 2
s_add_u32 s74, s74, s18
s_mul_i32 s74, s74, 20480
s_mul_i32 s75, s20, 160
s_add_u32 s93, s74, s75
v_lshrrev_b32 v48, 5, v0
v_and_b32 v49, 31, v0
v_lshlrev_b32 v50, 2, v48
v_xor_b32 v50, v50, v49
v_lshlrev_b32 v50, 4, v50
v_lshl_add_u32 v5, v48, 9, v50
v_lshlrev_b32 v50, 3, v49
s_lshl_b32 s74, s18, 8
v_lshl_add_u32 v6, v48, 12, v50
v_add_u32 v6, s74, v6
v_lshlrev_b32 v50, 4, v49
v_lshl_add_u32 v16, v48, 3, v50
s_mul_i32 s74, s18, 5248
v_add_u32 v47, s74, v5
s_mul_i32 s1, s16, 4243456
s_add_u32 s1, s1, 16777216
s_lshr_b32 s75, s18, 1
s_mul_i32 s74, s75, 4243456
s_add_u32 s74, s74, s1
s_sub_u32 s74, s74, 8486912
s_mul_i32 s26, s18, 81920
s_add_u32 s26, s26, s1
s_lshl_b32 s76, s17, 14
s_and_b32 s77, s17, 3
s_lshl_b32 s77, s77, 10
s_add_u32 s76, s76, s77
s_lshl_b32 s29, s18, 18
s_add_u32 s29, s29, s76
s_add_u32 s29, s29, s1
s_and_b32 s77, s18, 1
s_lshl_b32 s89, s77, 19
s_add_u32 s89, s89, s76
s_add_u32 s89, s89, s74
s_add_u32 s89, s89, 134217728
s_lshl_b32 s76, s17, 1
s_add_u32 s92, s76, s77
s_lshl_b32 s92, s92, 7
s_add_u32 s92, s92, s74
s_add_u32 s92, s92, 68157440
s_add_u32 s91, s76, s75
s_lshl_b32 s91, s91, 7
s_add_u32 s91, s91, s1
s_add_u32 s91, s91, 68157440
s_add_u32 s27, s91, 32
s_add_u32 s76, s16, s75
s_mov_b32 s90, 262144
s_cmp_lt_u32 s76, 2
s_cselect_b32 s89, s21, s89
s_cselect_b32 s90, 5120, s90
s_cselect_b32 s27, s27, s92
s_cselect_b32 s92, s91, s92
s_cselect_b32 s3, 0, 2
s_lshr_b32 s77, s17, 2
s_lshl_b32 s28, s77, 14
s_add_u32 s28, s28, s26
s_add_u32 s74, s1, 68141056
s_lshl_b32 s76, s75, 2
s_add_u32 s76, s76, s77
s_lshl_b32 s76, s76, 7
s_add_u32 s98, s74, s76
s_lshl_b32 s76, s19, 2
s_add_u32 s76, s76, s18
s_lshl_b32 s76, s76, 7
s_add_u32 s99, s74, s76
s_and_b32 s77, s20, 3
s_lshl_b32 s77, s77, 10
s_add_u32 s74, s74, 4096
s_lshl_b32 s76, s19, 1
s_add_u32 s76, s76, s75
s_lshl_b32 s76, s76, 7
s_add_u32 s100, s74, s76
s_lshl_b32 s76, s18, 7
s_add_u32 s101, s74, s76
s_add_u32 s101, s101, s77
s_add_u32 s74, s18, 1
s_bfe_u32 s75, s74, 0x10001
s_and_b32 s76, s74, 1
s_lshl_b32 s76, s76, 8
s_add_u32 s76, s76, s1
s_lshl_b32 s77, s19, 1
s_add_u32 s75, s75, s77
s_mul_i32 s66, s75, 81920
s_add_u32 s66, s66, s76
s_lshl_b32 s75, s75, 2
s_add_u32 s75, s75, s18
s_lshl_b32 s75, s75, 16
s_add_u32 s70, s75, s76
s_add_u32 s74, s18, 2
s_bfe_u32 s75, s74, 0x10001
s_and_b32 s76, s74, 1
s_lshl_b32 s76, s76, 8
s_add_u32 s76, s76, s1
s_lshl_b32 s77, s19, 1
s_add_u32 s75, s75, s77
s_mul_i32 s67, s75, 81920
s_add_u32 s67, s67, s76
s_lshl_b32 s75, s75, 2
s_add_u32 s75, s75, s18
s_lshl_b32 s75, s75, 16
s_add_u32 s71, s75, s76
s_add_u32 s74, s18, 3
s_bfe_u32 s75, s74, 0x10001
s_and_b32 s76, s74, 1
s_lshl_b32 s76, s76, 8
s_add_u32 s76, s76, s1
s_lshl_b32 s77, s19, 1
s_add_u32 s75, s75, s77
s_mul_i32 s68, s75, 81920
s_add_u32 s68, s68, s76
s_lshl_b32 s75, s75, 2
s_add_u32 s75, s75, s18
s_lshl_b32 s75, s75, 16
s_add_u32 s72, s75, s76
s_add_u32 s74, s18, 4
s_bfe_u32 s75, s74, 0x10001
s_and_b32 s76, s74, 1
s_lshl_b32 s76, s76, 8
s_add_u32 s76, s76, s1
s_lshl_b32 s77, s19, 1
s_add_u32 s75, s75, s77
s_mul_i32 s69, s75, 81920
s_add_u32 s69, s69, s76
s_lshl_b32 s75, s75, 2
s_add_u32 s75, s75, s18
s_lshl_b32 s75, s75, 16
s_add_u32 s73, s75, s76
s_mov_b64 exec, 0
s_cmp_eq_u32 s18, 0
s_cbranch_scc1 PG_s5
s_cmp_eq_u32 s18, 1
s_cbranch_scc1 PG_b0
s_cmp_eq_u32 s18, 2
s_cbranch_scc1 PG_b0
s_cmp_eq_u32 s18, 3
s_cbranch_scc1 PG_b0
PG_b0:
s_mov_b64 exec, -1
s_cmp_ge_u32 s58, 12
s_cbranch_scc1 WZ3
v_lshrrev_b32 v48, 4, v0
v_bfe_u32 v49, v0, 2, 2
v_lshl_add_u32 v48, v48, 3, v49
v_mul_u32_u24 v48, 160, v48
v_bfe_u32 v49, v0, 1, 1
v_mul_u32_u24 v49, 80, v49
v_add3_u32 v48, v48, v49, 0
v_and_b32 v49, 1, v0
v_bfe_u32 v52, v0, 3, 1
v_mul_u32_u24 v59, 163840, v52
v_lshlrev_b32 v54, 12, v52
v_and_b32 v52, 7, v0
v_lshl_add_u32 v59, v52, 4, v59
v_lshl_add_u32 v54, v52, 4, v54
v_lshrrev_b32 v52, 4, v0
v_lshl_add_u32 v54, v52, 28, v54
s_cmp_eq_u32 s42, 0
s_cselect_b32 s46, 10, 0
s_cmp_eq_u32 s42, 2
s_cselect_b32 s46, 5, s46
s_mul_i32 s47, s20, 327680
s_add_u32 s47, s47, 1048576
s_lshl_b32 s48, s20, 13
s_mul_i32 s49, s43, 0x84
s_and_b32 s49, s49, 772
s_add_u32 s48, s48, s49
s_add_u32 s48, s48, 196608
s_and_b32 s49, s18, 1
s_lshl_b32 s49, s49, 3
s_lshr_b32 s50, s18, 1
s_lshl_b32 s50, s50, 5
s_add_u32 s49, s49, s50
s_cmp_eq_u32 s18, 2
s_cselect_b32 s50, 40, 16
s_add_u32 s51, s46, s18
v_mul_u32_u24 v55, s50, v49
v_add3_u32 v55, v55, v48, s49
s_mov_b32 s54, 0x76431520
s_mov_b32 s55, 0xecdb9a8
s_lshl_b32 s53, s51, 2
s_lshr_b64 s[54:55], s[54:55], s53
s_bfe_u32 s55, s54, 0x20002
s_and_b32 s56, s54, 1
s_lshl_b32 s56, s56, 7
s_bfe_u32 s54, s54, 0x10001
s_lshl_b32 s53, s55, 10
s_add_u32 s53, s53, s56
s_lshl_b32 s52, s54, 3
s_add_u32 s53, s53, s52
s_add_u32 s53, s53, s48
s_lshl_b32 s52, s54, 11
s_add_u32 s52, s52, s56
s_add_u32 s52, s52, s47
s_cmp_ge_u32 s55, 2
s_cselect_b32 s54, 40, 4
s_cselect_b32 s56, 8, 24
s_mul_i32 s54, s54, s55
s_lshl_b32 s54, s54, 10
s_add_u32 s52, s52, s54
s_mul_i32 s54, s43, 10
v_lshrrev_b32 v56, 4, v0
v_add_u32 v56, s54, v56
v_lshrrev_b32 v57, 3, v56
v_mad_u32_u24 v57, v57, s56, v56
v_lshl_add_u32 v51, v57, 8, v59
v_add_u32 v56, 4, v56
v_lshrrev_b32 v57, 3, v56
v_mad_u32_u24 v57, v57, s56, v56
v_lshl_add_u32 v52, v57, 8, v59
v_add_u32 v56, 4, v56
v_lshrrev_b32 v57, 3, v56
v_mad_u32_u24 v57, v57, s56, v56
v_lshl_add_u32 v53, v57, 8, v59
v_add_u32 v56, 4, v56
v_lshrrev_b32 v57, 5, v0
v_lshl_add_u32 v53, v57, 28, v53
s_waitcnt vmcnt(2)
s_barrier
ds_read_b64_tr_b16 v[60:61], v55 offset:0
ds_read_b64_tr_b16 v[62:63], v55 offset:640
ds_read_b64_tr_b16 v[64:65], v55 offset:5120
ds_read_b64_tr_b16 v[66:67], v55 offset:5760
ds_read_b64_tr_b16 v[68:69], v55 offset:10240
ds_read_b64_tr_b16 v[70:71], v55 offset:10880
s_waitcnt lgkmcnt(4)
buffer_store_dwordx4 v[60:63], v51, s[4:7], s52 offen sc1
s_waitcnt lgkmcnt(2)
buffer_store_dwordx4 v[64:67], v52, s[4:7], s52 offen sc1
s_waitcnt lgkmcnt(0)
buffer_store_dwordx4 v[68:71], v53, s[4:7], s52 offen sc1
v_mov_b32 v56, 0
v_dot2c_f32_bf16 v56, s40, v60
v_dot2c_f32_bf16 v56, s40, v61
v_dot2c_f32_bf16 v56, s40, v62
v_dot2c_f32_bf16 v56, s40, v63
v_dot2c_f32_bf16 v56, s40, v64
v_dot2c_f32_bf16 v56, s40, v65
v_dot2c_f32_bf16 v56, s40, v66
v_dot2c_f32_bf16 v56, s40, v67
s_mov_b32 exec_hi, 0
v_dot2c_f32_bf16 v56, s40, v68
v_dot2c_f32_bf16 v56, s40, v69
v_dot2c_f32_bf16 v56, s40, v70
v_dot2c_f32_bf16 v56, s40, v71
s_mov_b32 exec_hi, -1
s_nop 1
v_mov_b32 v57, v56
s_nop 1
v_permlane32_swap_b32 v57, v56
v_add_f32 v56, v57, v56
v_mov_b32 v57, v56
s_nop 1
v_permlane16_swap_b32 v57, v56
v_add_f32 v56, v57, v56
v_cvt_pk_bf16_f32 v73, v56, 0
v_lshlrev_b32 v57, 16, v73
v_sub_f32 v58, v56, v57
v_cvt_pk_bf16_f32 v72, v57, v58
buffer_store_dword v72, v54, s[4:7], s53 offen sc1
s_cmp_lg_u32 s18, 3
s_cbranch_scc1 WQ4
s_mov_b32 s49, 48
s_mov_b32 s50, 16
s_add_u32 s51, s46, 4
v_mul_u32_u24 v55, s50, v49
v_add3_u32 v55, v55, v48, s49
s_mov_b32 s54, 0x76431520
s_mov_b32 s55, 0xecdb9a8
s_lshl_b32 s53, s51, 2
s_lshr_b64 s[54:55], s[54:55], s53
s_bfe_u32 s55, s54, 0x20002
s_and_b32 s56, s54, 1
s_lshl_b32 s56, s56, 7
s_bfe_u32 s54, s54, 0x10001
s_lshl_b32 s53, s55, 10
s_add_u32 s53, s53, s56
s_lshl_b32 s52, s54, 3
s_add_u32 s53, s53, s52
s_add_u32 s53, s53, s48
s_lshl_b32 s52, s54, 11
s_add_u32 s52, s52, s56
s_add_u32 s52, s52, s47
s_cmp_ge_u32 s55, 2
s_cselect_b32 s54, 40, 4
s_cselect_b32 s56, 8, 24
s_mul_i32 s54, s54, s55
s_lshl_b32 s54, s54, 10
s_add_u32 s52, s52, s54
s_mul_i32 s54, s43, 10
v_lshrrev_b32 v56, 4, v0
v_add_u32 v56, s54, v56
v_lshrrev_b32 v57, 3, v56
v_mad_u32_u24 v57, v57, s56, v56
v_lshl_add_u32 v51, v57, 8, v59
v_add_u32 v56, 4, v56
v_lshrrev_b32 v57, 3, v56
v_mad_u32_u24 v57, v57, s56, v56
v_lshl_add_u32 v52, v57, 8, v59
v_add_u32 v56, 4, v56
v_lshrrev_b32 v57, 3, v56
v_mad_u32_u24 v57, v57, s56, v56
v_lshl_add_u32 v53, v57, 8, v59
v_add_u32 v56, 4, v56
v_lshrrev_b32 v57, 5, v0
v_lshl_add_u32 v53, v57, 28, v53
ds_read_b64_tr_b16 v[76:77], v55 offset:0
ds_read_b64_tr_b16 v[78:79], v55 offset:640
ds_read_b64_tr_b16 v[80:81], v55 offset:5120
ds_read_b64_tr_b16 v[82:83], v55 offset:5760
ds_read_b64_tr_b16 v[84:85], v55 offset:10240
ds_read_b64_tr_b16 v[86:87], v55 offset:10880
s_waitcnt lgkmcnt(4)
buffer_store_dwordx4 v[76:79], v51, s[4:7], s52 offen sc1
s_waitcnt lgkmcnt(2)
buffer_store_dwordx4 v[80:83], v52, s[4:7], s52 offen sc1
s_waitcnt lgkmcnt(0)
buffer_store_dwordx4 v[84:87], v53, s[4:7], s52 offen sc1
v_mov_b32 v56, 0
v_dot2c_f32_bf16 v56, s40, v76
v_dot2c_f32_bf16 v56, s40, v77
v_dot2c_f32_bf16 v56, s40, v78
v_dot2c_f32_bf16 v56, s40, v79
v_dot2c_f32_bf16 v56, s40, v80
v_dot2c_f32_bf16 v56, s40, v81
v_dot2c_f32_bf16 v56, s40, v82
v_dot2c_f32_bf16 v56, s40, v83
s_mov_b32 exec_hi, 0
v_dot2c_f32_bf16 v56, s40, v84
v_dot2c_f32_bf16 v56, s40, v85
v_dot2c_f32_bf16 v56, s40, v86
v_dot2c_f32_bf16 v56, s40, v87
s_mov_b32 exec_hi, -1
s_nop 1
v_mov_b32 v57, v56
s_nop 1
v_permlane32_swap_b32 v57, v56
v_add_f32 v56, v57, v56
v_mov_b32 v57, v56
s_nop 1
v_permlane16_swap_b32 v57, v56
v_add_f32 v56, v57, v56
v_cvt_pk_bf16_f32 v89, v56, 0
v_lshlrev_b32 v57, 16, v89
v_sub_f32 v58, v56, v57
v_cvt_pk_bf16_f32 v88, v57, v58
buffer_store_dword v88, v54, s[4:7], s53 offen sc1
WZ3:
WQ4:
s_nop 1
s_add_u32 m0, s25, 65536
s_add_u32 s78, s62, 0
buffer_load_dwordx4 v96, s[12:15], s78 offen offset:0 lds
buffer_load_dwordx4 v97, s[12:15], s78 offen offset:1024 lds
buffer_load_dwordx4 v98, s[12:15], s78 offen offset:2048 lds
buffer_load_dwordx4 v99, s[12:15], s78 offen offset:3072 lds
s_add_u32 m0, s25, 81920
s_add_u32 s78, s62, 128
buffer_load_dwordx4 v96, s[12:15], s78 offen offset:0 lds
buffer_load_dwordx4 v97, s[12:15], s78 offen offset:1024 lds
buffer_load_dwordx4 v98, s[12:15], s78 offen offset:2048 lds
buffer_load_dwordx4 v99, s[12:15], s78 offen offset:3072 lds
s_mov_b32 s74, 0x9e3779b1
s_waitcnt vmcnt(8)
v_mul_lo_u32 v248, v248, s74
v_add_u32 v248, 0x7f4a7c15, v248
v_xor_b32 v249, 0x5bd1e995, v248
v_readfirstlane_b32 s0, v248
s_add_u32 m0, s25, 98304
s_add_u32 s78, s62, 256
buffer_load_dwordx4 v96, s[12:15], s78 offen offset:0 lds
buffer_load_dwordx4 v97, s[12:15], s78 offen offset:1024 lds
buffer_load_dwordx4 v98, s[12:15], s78 offen offset:2048 lds
buffer_load_dwordx4 v99, s[12:15], s78 offen offset:3072 lds
s_cmp_lg_u32 s58, 15
s_cbranch_scc1 LR5
s_getreg_b32 s48, hwreg(HW_REG_XCC_ID)
s_and_b32 s48, s48, 4
s_waitcnt lgkmcnt(0)
s_memtime s[50:51]
s_waitcnt lgkmcnt(0)
s_load_dword s49, s[4:5], s44 offset:0 glc
s_waitcnt lgkmcnt(0)
s_memtime s[52:53]
s_waitcnt lgkmcnt(0)
s_sub_u32 s54, s52, s50
s_load_dword s49, s[4:5], s44 offset:8192 glc
s_waitcnt lgkmcnt(0)
s_memtime s[50:51]
s_waitcnt lgkmcnt(0)
s_sub_u32 s55, s50, s52
s_cmp_lt_u32 s55, s54
s_addc_u32 s48, s48, 0
s_lshl_b32 s46, s16, 2
s_add_u32 s46, s46, s18
s_lshl_b32 s46, s46, 2
s_add_u32 s46, s46, 987136
v_add_u32 v60, s48, v248
v_mov_b32 v61, v60
v_mov_b32 v62, v60
v_mov_b32 v63, v60
buffer_store_dword v60, v8, s[4:7], s46 offen sc1
LR5:
s_mov_b64 exec, 0
s_cmp_eq_u32 s18, 0
s_cbranch_scc1 PG_s1
s_cmp_eq_u32 s18, 1
s_cbranch_scc1 PG_s2
s_cmp_eq_u32 s18, 2
s_cbranch_scc1 PG_s3
s_cmp_eq_u32 s18, 3
s_cbranch_scc1 PG_s4
PG_b1:
s_mov_b64 exec, -1
s_waitcnt vmcnt(11)
s_barrier
s_cmp_lg_u32 s18, 0
s_cbranch_scc1 FG6
s_lshl_b32 s74, s17, 4
s_add_u32 s74, s74, s58
s_lshl_b32 s74, s74, 7
s_add_u32 s74, s74, 917504
buffer_store_dwordx2 v[248:249], v17, s[4:7], s74 offen sc1
FG6:
s_add_u32 m0, s25, 114688
s_add_u32 s78, s62, 384
buffer_load_dwordx4 v96, s[12:15], s78 offen offset:0 lds
buffer_load_dwordx4 v97, s[12:15], s78 offen offset:1024 lds
buffer_load_dwordx4 v98, s[12:15], s78 offen offset:2048 lds
buffer_load_dwordx4 v99, s[12:15], s78 offen offset:3072 lds
s_waitcnt vmcnt(12)
ds_read_b128 v[104:107], v100 offset:0
ds_read_b128 v[108:111], v101 offset:0
ds_read_b128 v[112:115], v102 offset:0
ds_read_b128 v[116:119], v103 offset:0
ds_read_b128 a[0:3], v100 offset:0
ds_read_b128 a[4:7], v101 offset:0
ds_read_b128 a[8:11], v102 offset:0
ds_read_b128 a[12:15], v103 offset:0
s_waitcnt lgkmcnt(0)
s_add_u32 m0, s25, 65536
s_add_u32 s78, s62, 512
buffer_load_dwordx4 v96, s[12:15], s78 offen offset:0 lds
buffer_load_dwordx4 v97, s[12:15], s78 offen offset:1024 lds
buffer_load_dwordx4 v98, s[12:15], s78 offen offset:2048 lds
buffer_load_dwordx4 v99, s[12:15], s78 offen offset:3072 lds
s_waitcnt vmcnt(12)
ds_read_b128 v[120:123], v100 offset:16384
ds_read_b128 v[124:127], v101 offset:16384
ds_read_b128 v[128:131], v102 offset:16384
ds_read_b128 v[132:135], v103 offset:16384
ds_read_b128 a[16:19], v100 offset:16384
ds_read_b128 a[20:23], v101 offset:16384
ds_read_b128 a[24:27], v102 offset:16384
ds_read_b128 a[28:31], v103 offset:16384
v_dot2c_f32_bf16 v152, s40, v104
v_dot2c_f32_bf16 v153, v104, v104
v_dot2c_f32_bf16 v152, s40, v105
v_dot2c_f32_bf16 v153, v105, v105
v_dot2c_f32_bf16 v152, s40, v106
v_dot2c_f32_bf16 v153, v106, v106
v_dot2c_f32_bf16 v152, s40, v107
v_dot2c_f32_bf16 v153, v107, v107
v_dot2c_f32_bf16 v152, s40, v108
v_dot2c_f32_bf16 v153, v108, v108
v_dot2c_f32_bf16 v152, s40, v109
v_dot2c_f32_bf16 v153, v109, v109
v_dot2c_f32_bf16 v152, s40, v110
v_dot2c_f32_bf16 v153, v110, v110
v_dot2c_f32_bf16 v152, s40, v111
v_dot2c_f32_bf16 v153, v111, v111
v_dot2c_f32_bf16 v156, s40, v112
v_dot2c_f32_bf16 v157, v112, v112
v_dot2c_f32_bf16 v156, s40, v113
v_dot2c_f32_bf16 v157, v113, v113
v_dot2c_f32_bf16 v156, s40, v114
v_dot2c_f32_bf16 v157, v114, v114
v_dot2c_f32_bf16 v156, s40, v115
v_dot2c_f32_bf16 v157, v115, v115
v_dot2c_f32_bf16 v156, s40, v116
v_dot2c_f32_bf16 v157, v116, v116
v_dot2c_f32_bf16 v156, s40, v117
v_dot2c_f32_bf16 v157, v117, v117
v_dot2c_f32_bf16 v156, s40, v118
v_dot2c_f32_bf16 v157, v118, v118
v_dot2c_f32_bf16 v156, s40, v119
v_dot2c_f32_bf16 v157, v119, v119
s_waitcnt lgkmcnt(0)
s_add_u32 m0, s25, 81920
s_add_u32 s78, s62, 640
buffer_load_dwordx4 v96, s[12:15], s78 offen offset:0 lds
buffer_load_dwordx4 v97, s[12:15], s78 offen offset:1024 lds
buffer_load_dwordx4 v98, s[12:15], s78 offen offset:2048 lds
buffer_load_dwordx4 v99, s[12:15], s78 offen offset:3072 lds
s_lshl_b32 s41, s25, 1
s_add_u32 m0, s41, 131072
s_nop 0
buffer_load_dwordx4 v232, s[36:39], s61 offen nt lds
s_lshl_b32 s41, s25, 1
s_add_u32 m0, s41, 132096
s_nop 0
buffer_load_dwordx4 v233, s[36:39], s61 offen nt lds
s_lshl_b32 s41, s25, 1
s_add_u32 m0, s41, 133120
s_nop 0
buffer_load_dwordx4 v234, s[36:39], s61 offen nt lds
s_lshl_b32 s41, s25, 1
s_add_u32 m0, s41, 134144
s_nop 0
PG_s1:
s_cbranch_execz PG_b1
buffer_load_dwordx4 v235, s[36:39], s61 offen nt lds
s_lshl_b32 s41, s25, 1
s_add_u32 m0, s41, 135168
s_nop 0
buffer_load_dwordx4 v236, s[36:39], s61 offen nt lds
s_lshl_b32 s41, s25, 1
s_add_u32 m0, s41, 136192
s_nop 0
buffer_load_dwordx4 v237, s[36:39], s61 offen nt lds
s_lshl_b32 s41, s25, 1
s_add_u32 m0, s41, 137216
s_nop 0
buffer_load_dwordx4 v238, s[36:39], s61 offen nt lds
s_lshl_b32 s41, s25, 1
s_add_u32 m0, s41, 138240
s_nop 0
buffer_load_dwordx4 v239, s[36:39], s61 offen nt lds
v_mov_b32 v224, 268435456
v_mov_b32 v225, 268435456
v_mov_b32 v226, 268435456
v_mov_b32 v227, 268435456
v_mov_b32 v228, 268435456
v_mov_b32 v229, 268435456
v_mov_b32 v230, 268435456
v_mov_b32 v231, 268435456
v_mov_b32 v232, 268435456
v_mov_b32 v233, 268435456
v_mov_b32 v234, 268435456
s_lshl_b32 s41, s25, 1
s_add_u32 s41, s41, 131072
s_cmp_ge_u32 s59, 14
s_cbranch_scc1 S28
s_cmp_ge_u32 s59, 8
s_cbranch_scc1 S27
s_cmp_ge_u32 s18, 3
s_cbranch_scc1 S29
v_bfe_u32 v176, v0, 2, 2
v_mul_u32_u24 v176, 384, v176
v_lshrrev_b32 v178, 5, v0
v_mul_u32_u24 v177, 192, v178
v_add_u32 v176, v176, v177
v_bfe_u32 v179, v0, 4, 1
v_lshl_add_u32 v176, v179, 3, v176
v_and_b32 v177, 3, v0
v_lshl_add_u32 v176, v177, 4, v176
s_lshl_b32 s51, s18, 6
s_add_u32 s51, s51, 131072
v_add_u32 v176, s51, v176
v_and_b32 v180, 15, v0
v_lshlrev_b32 v180, 4, v180
v_mul_u32_u24 v177, 6144, v178
v_lshl_add_u32 v177, v179, 3, v177
v_add_u32 v177, v177, v180
v_mul_u32_u24 v178, 245760, v178
v_lshl_add_u32 v178, v179, 11, v178
v_add_u32 v178, v178, v180
s_mul_i32 s51, s20, 6
s_add_u32 s51, s51, s18
s_lshr_b32 s52, s59, 2
s_and_b32 s55, s59, 3
s_lshl_b32 s54, s51, 11
s_lshl_b32 s56, s52, 10
s_add_u32 s54, s54, s56
s_lshl_b32 s56, s55, 8
s_add_u32 s54, s54, s56
s_lshl_b32 s56, s19, 2
s_add_u32 s54, s54, s56
s_add_u32 s54, s54, 262144
v_add_u32 v234, s54, v177
s_mul_i32 s53, s51, 81920
s_lshl_b32 s52, s52, 12
s_add_u32 s53, s53, s52
s_add_u32 s53, s53, 4194304
v_add_u32 v178, s53, v178
s_lshl_b32 s55, s55, 1
s_add_u32 s55, s55, s19
s_mul_i32 s55, s55, 10
s_add_u32 s51, s55, 0
s_lshr_b32 s52, s51, 3
s_mul_i32 s52, s52, 24
s_add_u32 s51, s51, s52
v_lshl_add_u32 v224, s51, 8, v178
s_add_u32 s51, s55, 1
s_lshr_b32 s52, s51, 3
s_mul_i32 s52, s52, 24
s_add_u32 s51, s51, s52
v_lshl_add_u32 v225, s51, 8, v178
s_add_u32 s51, s55, 2
s_lshr_b32 s52, s51, 3
s_mul_i32 s52, s52, 24
s_add_u32 s51, s51, s52
v_lshl_add_u32 v226, s51, 8, v178
s_add_u32 s51, s55, 3
s_lshr_b32 s52, s51, 3
s_mul_i32 s52, s52, 24
s_add_u32 s51, s51, s52
v_lshl_add_u32 v227, s51, 8, v178
s_add_u32 s51, s55, 4
s_lshr_b32 s52, s51, 3
s_mul_i32 s52, s52, 24
s_add_u32 s51, s51, s52
v_lshl_add_u32 v228, s51, 8, v178
s_add_u32 s51, s55, 5
s_lshr_b32 s52, s51, 3
s_mul_i32 s52, s52, 24
s_add_u32 s51, s51, s52
v_lshl_add_u32 v229, s51, 8, v178
s_add_u32 s51, s55, 6
s_lshr_b32 s52, s51, 3
s_mul_i32 s52, s52, 24
s_add_u32 s51, s51, s52
v_lshl_add_u32 v230, s51, 8, v178
s_add_u32 s51, s55, 7
s_lshr_b32 s52, s51, 3
s_mul_i32 s52, s52, 24
s_add_u32 s51, s51, s52
v_lshl_add_u32 v231, s51, 8, v178
s_add_u32 s51, s55, 8
s_lshr_b32 s52, s51, 3
s_mul_i32 s52, s52, 24
s_add_u32 s51, s51, s52
v_lshl_add_u32 v232, s51, 8, v178
s_add_u32 s51, s55, 9
s_lshr_b32 s52, s51, 3
s_mul_i32 s52, s52, 24
s_add_u32 s51, s51, s52
v_lshl_add_u32 v233, s51, 8, v178
s_branch S29
S27:
v_bfe_u32 v176, v0, 2, 2
v_lshrrev_b32 v177, 4, v0
v_lshl_add_u32 v176, v177, 3, v176
v_mul_u32_u24 v176, 160, v176
v_add_u32 v176, s41, v176
v_and_b32 v178, 3, v0
v_lshl_add_u32 v177, v178, 3, v176
v_lshl_add_u32 v176, v178, 5, v176
v_mov_b32 v168, s41
v_mov_b32 v169, s41
s_mul_i32 s51, s60, 21846
s_lshr_b32 s51, s51, 16
s_mul_i32 s53, s51, 3
s_sub_u32 s53, s60, s53
s_lshl_b32 s53, s53, 2
s_and_b32 s54, s51, 3
s_add_u32 s53, s53, s54
s_mul_i32 s53, s53, 5120
s_lshr_b32 s54, s51, 2
s_mul_i32 s54, s54, 61440
s_add_u32 s53, s53, s54
s_mul_i32 s54, s20, 245760
s_add_u32 s53, s53, s54
s_add_u32 s53, s53, 9437184
v_add_u32 v224, s53, v1
v_add_u32 v225, 1024, v224
v_add_u32 v226, 2048, v224
v_add_u32 v227, 3072, v224
v_add_u32 v228, 4096, v224
s_branch S29
S28:
v_lshrrev_b32 v178, 4, v0
v_and_b32 v179, 1, v178
v_lshrrev_b32 v180, 5, v0
v_mul_u32_u24 v181, 20, v180
v_lshl_add_u32 v181, v179, 3, v181
v_bfe_u32 v176, v0, 2, 2
v_add_u32 v181, v181, v176
v_mul_u32_u24 v181, 160, v181
v_add_u32 v181, s41, v181
v_and_b32 v182, 3, v0
v_mul_u32_u24 v176, 160, v176
v_add_u32 v183, s41, v176
v_lshl_add_u32 v176, v182, 5, v181
v_lshl_add_u32 v177, v182, 3, v181
v_lshl_add_u32 v168, v182, 5, v183
v_lshl_add_u32 v168, v178, 3, v168
v_lshl_add_u32 v169, v182, 3, v183
v_and_b32 v170, 15, v0
v_lshlrev_b32 v170, 4, v170
v_mul_u32_u24 v171, 10240, v180
v_lshl_add_u32 v171, v179, 8, v171
v_add_u32 v171, v171, v170
v_lshl_add_u32 v172, v178, 10, v170
v_lshl_add_u32 v173, v178, 28, v170
s_lshr_b32 s51, s60, 2
s_mul_i32 s51, s51, 25600
s_mul_i32 s53, s20, 102400
s_add_u32 s51, s51, s53
s_add_u32 s51, s51, 8388608
s_lshr_b32 s53, s18, 1
s_mul_i32 s53, s53, 5120
s_and_b32 s54, s18, 1
s_lshl_b32 s54, s54, 9
s_add_u32 s53, s53, s54
s_add_u32 s53, s53, s51
s_lshl_b32 s55, s18, 8
s_add_u32 s55, s55, s51
s_add_u32 s55, s55, 20480
s_add_u32 s56, s55, 4096
v_add_u32 v224, s53, v171
v_add_u32 v229, s55, v172
v_add_u32 v230, s56, v173
v_add_u32 v225, 1024, v224
v_add_u32 v226, 2048, v224
v_add_u32 v227, 3072, v224
v_add_u32 v228, 4096, v224
S29:
s_nop 1
s_waitcnt vmcnt(20)
ds_read_b128 v[104:107], v100 offset:32768
ds_read_b128 v[108:111], v101 offset:32768
ds_read_b128 v[112:115], v102 offset:32768
ds_read_b128 v[116:119], v103 offset:32768
ds_read_b128 a[32:35], v100 offset:32768
ds_read_b128 a[36:39], v101 offset:32768
ds_read_b128 a[40:43], v102 offset:32768
ds_read_b128 a[44:47], v103 offset:32768
v_dot2c_f32_bf16 v152, s40, v120
v_dot2c_f32_bf16 v153, v120, v120
v_dot2c_f32_bf16 v152, s40, v121
v_dot2c_f32_bf16 v153, v121, v121
v_dot2c_f32_bf16 v152, s40, v122
v_dot2c_f32_bf16 v153, v122, v122
v_dot2c_f32_bf16 v152, s40, v123
v_dot2c_f32_bf16 v153, v123, v123
v_dot2c_f32_bf16 v152, s40, v124
v_dot2c_f32_bf16 v153, v124, v124
v_dot2c_f32_bf16 v152, s40, v125
v_dot2c_f32_bf16 v153, v125, v125
v_dot2c_f32_bf16 v152, s40, v126
v_dot2c_f32_bf16 v153, v126, v126
v_dot2c_f32_bf16 v152, s40, v127
v_dot2c_f32_bf16 v153, v127, v127
v_dot2c_f32_bf16 v156, s40, v128
v_dot2c_f32_bf16 v157, v128, v128
v_dot2c_f32_bf16 v156, s40, v129
v_dot2c_f32_bf16 v157, v129, v129
v_dot2c_f32_bf16 v156, s40, v130
v_dot2c_f32_bf16 v157, v130, v130
v_dot2c_f32_bf16 v156, s40, v131
v_dot2c_f32_bf16 v157, v131, v131
v_dot2c_f32_bf16 v156, s40, v132
v_dot2c_f32_bf16 v157, v132, v132
v_dot2c_f32_bf16 v156, s40, v133
v_dot2c_f32_bf16 v157, v133, v133
v_dot2c_f32_bf16 v156, s40, v134
v_dot2c_f32_bf16 v157, v134, v134
v_dot2c_f32_bf16 v156, s40, v135
v_dot2c_f32_bf16 v157, v135, v135
s_waitcnt lgkmcnt(0)
s_add_u32 m0, s25, 98304
s_add_u32 s78, s62, 768
buffer_load_dwordx4 v96, s[12:15], s78 offen offset:0 lds
buffer_load_dwordx4 v97, s[12:15], s78 offen offset:1024 lds
buffer_load_dwordx4 v98, s[12:15], s78 offen offset:2048 lds
buffer_load_dwordx4 v99, s[12:15], s78 offen offset:3072 lds
s_waitcnt vmcnt(20)
ds_read_b128 v[120:123], v100 offset:49152
ds_read_b128 v[124:127], v101 offset:49152
ds_read_b128 v[128:131], v102 offset:49152
ds_read_b128 v[132:135], v103 offset:49152
ds_read_b128 a[48:51], v100 offset:49152
ds_read_b128 a[52:55], v101 offset:49152
ds_read_b128 a[56:59], v102 offset:49152
ds_read_b128 a[60:63], v103 offset:49152
v_add_u32 v143, 0, v0
v_mul_u32_u24 v144, 6554, v143
v_lshrrev_b32 v144, 16, v144
v_mul_u32_u24 v144, 1120, v144
v_lshl_add_u32 v140, v143, 4, v144
v_add_u32 v143, 64, v0
v_mul_u32_u24 v144, 6554, v143
v_lshrrev_b32 v144, 16, v144
v_mul_u32_u24 v144, 1120, v144
v_lshl_add_u32 v141, v143, 4, v144
v_add_u32 v143, 128, v0
v_mul_u32_u24 v144, 6554, v143
v_lshrrev_b32 v144, 16, v144
v_mul_u32_u24 v144, 1120, v144
v_lshl_add_u32 v142, v143, 4, v144
v_lshrrev_b32 v143, 5, v0
v_lshl_add_u32 v142, v143, 28, v142
s_add_u32 m0, s25, 16384
s_nop 0
buffer_load_dwordx4 v140, s[12:15], s93 offen lds
s_add_u32 m0, s25, 17408
s_nop 0
buffer_load_dwordx4 v141, s[12:15], s93 offen lds
s_add_u32 m0, s25, 18432
s_nop 0
buffer_load_dwordx4 v142, s[12:15], s93 offen lds
v_dot2c_f32_bf16 v152, s40, v104
v_dot2c_f32_bf16 v153, v104, v104
v_dot2c_f32_bf16 v152, s40, v105
v_dot2c_f32_bf16 v153, v105, v105
v_dot2c_f32_bf16 v152, s40, v106
v_dot2c_f32_bf16 v153, v106, v106
v_dot2c_f32_bf16 v152, s40, v107
v_dot2c_f32_bf16 v153, v107, v107
v_dot2c_f32_bf16 v152, s40, v108
v_dot2c_f32_bf16 v153, v108, v108
v_dot2c_f32_bf16 v152, s40, v109
v_dot2c_f32_bf16 v153, v109, v109
v_dot2c_f32_bf16 v152, s40, v110
v_dot2c_f32_bf16 v153, v110, v110
v_dot2c_f32_bf16 v152, s40, v111
v_dot2c_f32_bf16 v153, v111, v111
v_dot2c_f32_bf16 v156, s40, v112
v_dot2c_f32_bf16 v157, v112, v112
v_dot2c_f32_bf16 v156, s40, v113
v_dot2c_f32_bf16 v157, v113, v113
v_dot2c_f32_bf16 v156, s40, v114
v_dot2c_f32_bf16 v157, v114, v114
v_dot2c_f32_bf16 v156, s40, v115
v_dot2c_f32_bf16 v157, v115, v115
v_dot2c_f32_bf16 v156, s40, v116
v_dot2c_f32_bf16 v157, v116, v116
v_dot2c_f32_bf16 v156, s40, v117
v_dot2c_f32_bf16 v157, v117, v117
v_dot2c_f32_bf16 v156, s40, v118
v_dot2c_f32_bf16 v157, v118, v118
v_dot2c_f32_bf16 v156, s40, v119
v_dot2c_f32_bf16 v157, v119, v119
s_waitcnt lgkmcnt(0)
s_add_u32 m0, s25, 114688
s_add_u32 s78, s62, 896
buffer_load_dwordx4 v96, s[12:15], s78 offen offset:0 lds
buffer_load_dwordx4 v97, s[12:15], s78 offen offset:1024 lds
buffer_load_dwordx4 v98, s[12:15], s78 offen offset:2048 lds
buffer_load_dwordx4 v99, s[12:15], s78 offen offset:3072 lds
s_waitcnt vmcnt(23)
ds_read_b128 v[104:107], v100 offset:0
ds_read_b128 v[108:111], v101 offset:0
ds_read_b128 v[112:115], v102 offset:0
ds_read_b128 v[116:119], v103 offset:0
ds_read_b128 a[64:67], v100 offset:0
ds_read_b128 a[68:71], v101 offset:0
ds_read_b128 a[72:75], v102 offset:0
ds_read_b128 a[76:79], v103 offset:0
v_dot2c_f32_bf16 v152, s40, v120
v_dot2c_f32_bf16 v153, v120, v120
v_dot2c_f32_bf16 v152, s40, v121
v_dot2c_f32_bf16 v153, v121, v121
v_dot2c_f32_bf16 v152, s40, v122
v_dot2c_f32_bf16 v153, v122, v122
v_dot2c_f32_bf16 v152, s40, v123
v_dot2c_f32_bf16 v153, v123, v123
v_dot2c_f32_bf16 v152, s40, v124
v_dot2c_f32_bf16 v153, v124, v124
v_dot2c_f32_bf16 v152, s40, v125
v_dot2c_f32_bf16 v153, v125, v125
v_dot2c_f32_bf16 v152, s40, v126
v_dot2c_f32_bf16 v153, v126, v126
v_dot2c_f32_bf16 v152, s40, v127
v_dot2c_f32_bf16 v153, v127, v127
v_dot2c_f32_bf16 v156, s40, v128
v_dot2c_f32_bf16 v157, v128, v128
v_dot2c_f32_bf16 v156, s40, v129
v_dot2c_f32_bf16 v157, v129, v129
v_dot2c_f32_bf16 v156, s40, v130
v_dot2c_f32_bf16 v157, v130, v130
v_dot2c_f32_bf16 v156, s40, v131
v_dot2c_f32_bf16 v157, v131, v131
v_dot2c_f32_bf16 v156, s40, v132
v_dot2c_f32_bf16 v157, v132, v132
v_dot2c_f32_bf16 v156, s40, v133
v_dot2c_f32_bf16 v157, v133, v133
v_dot2c_f32_bf16 v156, s40, v134
v_dot2c_f32_bf16 v157, v134, v134
v_dot2c_f32_bf16 v156, s40, v135
v_dot2c_f32_bf16 v157, v135, v135
s_waitcnt lgkmcnt(0)
s_add_u32 m0, s25, 65536
s_add_u32 s78, s62, 1024
buffer_load_dwordx4 v96, s[12:15], s78 offen offset:0 lds
buffer_load_dwordx4 v97, s[12:15], s78 offen offset:1024 lds
buffer_load_dwordx4 v98, s[12:15], s78 offen offset:2048 lds
buffer_load_dwordx4 v99, s[12:15], s78 offen offset:3072 lds
s_waitcnt vmcnt(23)
ds_read_b128 v[120:123], v100 offset:16384
ds_read_b128 v[124:127], v101 offset:16384
ds_read_b128 v[128:131], v102 offset:16384
ds_read_b128 v[132:135], v103 offset:16384
ds_read_b128 a[80:83], v100 offset:16384
ds_read_b128 a[84:87], v101 offset:16384
ds_read_b128 a[88:91], v102 offset:16384
ds_read_b128 a[92:95], v103 offset:16384
s_cmp_eq_u32 s18, 0
s_cselect_b32 s74, 0, 268435456
v_add_u32 v240, s74, v240
buffer_load_dwordx2 v[242:243], v240, s[4:7], 0 offen sc1
v_dot2c_f32_bf16 v152, s40, v104
v_dot2c_f32_bf16 v153, v104, v104
v_dot2c_f32_bf16 v152, s40, v105
v_dot2c_f32_bf16 v153, v105, v105
v_dot2c_f32_bf16 v152, s40, v106
v_dot2c_f32_bf16 v153, v106, v106
v_dot2c_f32_bf16 v152, s40, v107
v_dot2c_f32_bf16 v153, v107, v107
v_dot2c_f32_bf16 v152, s40, v108
v_dot2c_f32_bf16 v153, v108, v108
v_dot2c_f32_bf16 v152, s40, v109
v_dot2c_f32_bf16 v153, v109, v109
v_dot2c_f32_bf16 v152, s40, v110
v_dot2c_f32_bf16 v153, v110, v110
v_dot2c_f32_bf16 v152, s40, v111
v_dot2c_f32_bf16 v153, v111, v111
v_dot2c_f32_bf16 v156, s40, v112
v_dot2c_f32_bf16 v157, v112, v112
v_dot2c_f32_bf16 v156, s40, v113
v_dot2c_f32_bf16 v157, v113, v113
v_dot2c_f32_bf16 v156, s40, v114
v_dot2c_f32_bf16 v157, v114, v114
v_dot2c_f32_bf16 v156, s40, v115
v_dot2c_f32_bf16 v157, v115, v115
v_dot2c_f32_bf16 v156, s40, v116
v_dot2c_f32_bf16 v157, v116, v116
v_dot2c_f32_bf16 v156, s40, v117
v_dot2c_f32_bf16 v157, v117, v117
v_dot2c_f32_bf16 v156, s40, v118
v_dot2c_f32_bf16 v157, v118, v118
v_dot2c_f32_bf16 v156, s40, v119
v_dot2c_f32_bf16 v157, v119, v119
s_waitcnt lgkmcnt(0)
s_add_u32 m0, s25, 81920
s_add_u32 s78, s62, 1152
buffer_load_dwordx4 v96, s[12:15], s78 offen offset:0 lds
buffer_load_dwordx4 v97, s[12:15], s78 offen offset:1024 lds
buffer_load_dwordx4 v98, s[12:15], s78 offen offset:2048 lds
buffer_load_dwordx4 v99, s[12:15], s78 offen offset:3072 lds
s_waitcnt vmcnt(16)
ds_read_b128 v[104:107], v100 offset:32768
ds_read_b128 v[108:111], v101 offset:32768
ds_read_b128 v[112:115], v102 offset:32768
ds_read_b128 v[116:119], v103 offset:32768
ds_read_b128 a[96:99], v100 offset:32768
ds_read_b128 a[100:103], v101 offset:32768
ds_read_b128 a[104:107], v102 offset:32768
ds_read_b128 a[108:111], v103 offset:32768
v_dot2c_f32_bf16 v152, s40, v120
v_dot2c_f32_bf16 v153, v120, v120
v_dot2c_f32_bf16 v152, s40, v121
v_dot2c_f32_bf16 v153, v121, v121
v_dot2c_f32_bf16 v152, s40, v122
v_dot2c_f32_bf16 v153, v122, v122
v_dot2c_f32_bf16 v152, s40, v123
v_dot2c_f32_bf16 v153, v123, v123
v_dot2c_f32_bf16 v152, s40, v124
v_dot2c_f32_bf16 v153, v124, v124
v_dot2c_f32_bf16 v152, s40, v125
v_dot2c_f32_bf16 v153, v125, v125
v_dot2c_f32_bf16 v152, s40, v126
v_dot2c_f32_bf16 v153, v126, v126
v_dot2c_f32_bf16 v152, s40, v127
v_dot2c_f32_bf16 v153, v127, v127
v_dot2c_f32_bf16 v156, s40, v128
v_dot2c_f32_bf16 v157, v128, v128
v_dot2c_f32_bf16 v156, s40, v129
v_dot2c_f32_bf16 v157, v129, v129
v_dot2c_f32_bf16 v156, s40, v130
v_dot2c_f32_bf16 v157, v130, v130
v_dot2c_f32_bf16 v156, s40, v131
v_dot2c_f32_bf16 v157, v131, v131
v_dot2c_f32_bf16 v156, s40, v132
v_dot2c_f32_bf16 v157, v132, v132
v_dot2c_f32_bf16 v156, s40, v133
v_dot2c_f32_bf16 v157, v133, v133
v_dot2c_f32_bf16 v156, s40, v134
v_dot2c_f32_bf16 v157, v134, v134
v_dot2c_f32_bf16 v156, s40, v135
v_dot2c_f32_bf16 v157, v135, v135
s_waitcnt lgkmcnt(0)
s_waitcnt vmcnt(9)
ds_read_b128 v[120:123], v100 offset:49152
ds_read_b128 v[124:127], v101 offset:49152
ds_read_b128 v[128:131], v102 offset:49152
ds_read_b128 v[132:135], v103 offset:49152
ds_read_b128 a[112:115], v100 offset:49152
ds_read_b128 a[116:119], v101 offset:49152
ds_read_b128 a[120:123], v102 offset:49152
ds_read_b128 a[124:127], v103 offset:49152
buffer_load_dword v175, v174, s[4:7], 0 offen sc1
ds_read_b128 v[136:139], v250 offset:16384
ds_read_b128 v[140:143], v250 offset:16400
ds_read_b64 v[144:145], v251 offset:16512
v_dot2c_f32_bf16 v152, s40, v104
v_dot2c_f32_bf16 v153, v104, v104
v_dot2c_f32_bf16 v152, s40, v105
v_dot2c_f32_bf16 v153, v105, v105
v_dot2c_f32_bf16 v152, s40, v106
v_dot2c_f32_bf16 v153, v106, v106
v_dot2c_f32_bf16 v152, s40, v107
v_dot2c_f32_bf16 v153, v107, v107
v_dot2c_f32_bf16 v152, s40, v108
v_dot2c_f32_bf16 v153, v108, v108
v_dot2c_f32_bf16 v152, s40, v109
v_dot2c_f32_bf16 v153, v109, v109
v_dot2c_f32_bf16 v152, s40, v110
v_dot2c_f32_bf16 v153, v110, v110
v_dot2c_f32_bf16 v152, s40, v111
v_dot2c_f32_bf16 v153, v111, v111
v_dot2c_f32_bf16 v156, s40, v112
v_dot2c_f32_bf16 v157, v112, v112
v_dot2c_f32_bf16 v156, s40, v113
v_dot2c_f32_bf16 v157, v113, v113
v_dot2c_f32_bf16 v156, s40, v114
v_dot2c_f32_bf16 v157, v114, v114
v_dot2c_f32_bf16 v156, s40, v115
v_dot2c_f32_bf16 v157, v115, v115
v_dot2c_f32_bf16 v156, s40, v116
v_dot2c_f32_bf16 v157, v116, v116
v_dot2c_f32_bf16 v156, s40, v117
v_dot2c_f32_bf16 v157, v117, v117
v_dot2c_f32_bf16 v156, s40, v118
v_dot2c_f32_bf16 v157, v118, v118
v_dot2c_f32_bf16 v156, s40, v119
v_dot2c_f32_bf16 v157, v119, v119
s_waitcnt lgkmcnt(0)
s_waitcnt vmcnt(5)
s_cmp_lg_u32 s18, 0
s_cbranch_scc1 PW10
v_cmp_ne_u64 vcc, v[242:243], v[248:249]
s_nop 0
s_cbranch_vccnz VS11
VB12:
PW10:
s_barrier
s_add_u32 m0, s25, 0
s_add_u32 s30, s21, 0
buffer_load_dwordx4 v1, s[4:7], s30 offen sc1 lds
buffer_load_dwordx4 v1, s[4:7], s30 offen offset:1024 sc1 lds
buffer_load_dwordx4 v1, s[4:7], s30 offen offset:2048 sc1 lds
buffer_load_dwordx4 v1, s[4:7], s30 offen offset:3072 sc1 lds
ds_read_b128 v[104:107], v100 offset:0
ds_read_b128 v[108:111], v101 offset:0
ds_read_b128 v[112:115], v102 offset:0
ds_read_b128 v[116:119], v103 offset:0
ds_read_b128 a[128:131], v100 offset:0
ds_read_b128 a[132:135], v101 offset:0
ds_read_b128 a[136:139], v102 offset:0
ds_read_b128 a[140:143], v103 offset:0
v_lshlrev_b32 v20, 16, v136
v_and_b32 v21, 0xffff0000, v136
v_lshlrev_b32 v22, 16, v137
v_and_b32 v23, 0xffff0000, v137
v_lshlrev_b32 v24, 16, v138
v_and_b32 v25, 0xffff0000, v138
v_lshlrev_b32 v26, 16, v139
v_and_b32 v27, 0xffff0000, v139
v_lshlrev_b32 v28, 16, v140
v_and_b32 v29, 0xffff0000, v140
v_lshlrev_b32 v30, 16, v141
v_and_b32 v31, 0xffff0000, v141
v_lshlrev_b32 v32, 16, v142
v_and_b32 v33, 0xffff0000, v142
v_lshlrev_b32 v34, 16, v143
v_and_b32 v35, 0xffff0000, v143
v_lshlrev_b32 v36, 16, v144
v_and_b32 v37, 0xffff0000, v144
v_lshlrev_b32 v38, 16, v145
v_and_b32 v39, 0xffff0000, v145
v_dot2c_f32_bf16 v152, s40, v120
v_dot2c_f32_bf16 v153, v120, v120
v_dot2c_f32_bf16 v152, s40, v121
v_dot2c_f32_bf16 v153, v121, v121
v_dot2c_f32_bf16 v152, s40, v122
v_dot2c_f32_bf16 v153, v122, v122
v_dot2c_f32_bf16 v152, s40, v123
v_dot2c_f32_bf16 v153, v123, v123
v_dot2c_f32_bf16 v152, s40, v124
v_dot2c_f32_bf16 v153, v124, v124
v_dot2c_f32_bf16 v152, s40, v125
v_dot2c_f32_bf16 v153, v125, v125
v_dot2c_f32_bf16 v152, s40, v126
v_dot2c_f32_bf16 v153, v126, v126
v_dot2c_f32_bf16 v152, s40, v127
v_dot2c_f32_bf16 v153, v127, v127
v_dot2c_f32_bf16 v156, s40, v128
v_dot2c_f32_bf16 v157, v128, v128
v_dot2c_f32_bf16 v156, s40, v129
v_dot2c_f32_bf16 v157, v129, v129
v_dot2c_f32_bf16 v156, s40, v130
v_dot2c_f32_bf16 v157, v130, v130
v_dot2c_f32_bf16 v156, s40, v131
v_dot2c_f32_bf16 v157, v131, v131
v_dot2c_f32_bf16 v156, s40, v132
v_dot2c_f32_bf16 v157, v132, v132
v_dot2c_f32_bf16 v156, s40, v133
v_dot2c_f32_bf16 v157, v133, v133
v_dot2c_f32_bf16 v156, s40, v134
v_dot2c_f32_bf16 v157, v134, v134
v_dot2c_f32_bf16 v156, s40, v135
v_dot2c_f32_bf16 v157, v135, v135
s_waitcnt lgkmcnt(0)
s_add_u32 m0, s25, 16384
s_add_u32 s30, s21, 16384
buffer_load_dwordx4 v1, s[4:7], s30 offen sc1 lds
buffer_load_dwordx4 v1, s[4:7], s30 offen offset:1024 sc1 lds
buffer_load_dwordx4 v1, s[4:7], s30 offen offset:2048 sc1 lds
buffer_load_dwordx4 v1, s[4:7], s30 offen offset:3072 sc1 lds
s_waitcnt vmcnt(9)
ds_read_b128 v[120:123], v100 offset:16384
ds_read_b128 v[124:127], v101 offset:16384
ds_read_b128 v[128:131], v102 offset:16384
ds_read_b128 v[132:135], v103 offset:16384
ds_read_b128 a[144:147], v100 offset:16384
ds_read_b128 a[148:151], v101 offset:16384
ds_read_b128 a[152:155], v102 offset:16384
ds_read_b128 a[156:159], v103 offset:16384
v_dot2c_f32_bf16 v152, s40, v104
v_dot2c_f32_bf16 v153, v104, v104
v_dot2c_f32_bf16 v152, s40, v105
v_dot2c_f32_bf16 v153, v105, v105
v_dot2c_f32_bf16 v152, s40, v106
v_dot2c_f32_bf16 v153, v106, v106
v_dot2c_f32_bf16 v152, s40, v107
v_dot2c_f32_bf16 v153, v107, v107
v_dot2c_f32_bf16 v152, s40, v108
v_dot2c_f32_bf16 v153, v108, v108
v_dot2c_f32_bf16 v152, s40, v109
v_dot2c_f32_bf16 v153, v109, v109
v_dot2c_f32_bf16 v152, s40, v110
v_dot2c_f32_bf16 v153, v110, v110
v_dot2c_f32_bf16 v152, s40, v111
v_dot2c_f32_bf16 v153, v111, v111
v_dot2c_f32_bf16 v156, s40, v112
v_dot2c_f32_bf16 v157, v112, v112
v_dot2c_f32_bf16 v156, s40, v113
v_dot2c_f32_bf16 v157, v113, v113
v_dot2c_f32_bf16 v156, s40, v114
v_dot2c_f32_bf16 v157, v114, v114
v_dot2c_f32_bf16 v156, s40, v115
v_dot2c_f32_bf16 v157, v115, v115
v_dot2c_f32_bf16 v156, s40, v116
v_dot2c_f32_bf16 v157, v116, v116
v_dot2c_f32_bf16 v156, s40, v117
v_dot2c_f32_bf16 v157, v117, v117
v_dot2c_f32_bf16 v156, s40, v118
v_dot2c_f32_bf16 v157, v118, v118
v_dot2c_f32_bf16 v156, s40, v119
v_dot2c_f32_bf16 v157, v119, v119
s_waitcnt lgkmcnt(0)
s_add_u32 m0, s25, 32768
s_add_u32 s30, s21, 32768
buffer_load_dwordx4 v1, s[4:7], s30 offen sc1 lds
buffer_load_dwordx4 v1, s[4:7], s30 offen offset:1024 sc1 lds
buffer_load_dwordx4 v1, s[4:7], s30 offen offset:2048 sc1 lds
buffer_load_dwordx4 v1, s[4:7], s30 offen offset:3072 sc1 lds
v_dot2c_f32_bf16 v152, s40, v120
v_dot2c_f32_bf16 v153, v120, v120
v_dot2c_f32_bf16 v152, s40, v121
v_dot2c_f32_bf16 v153, v121, v121
v_dot2c_f32_bf16 v152, s40, v122
v_dot2c_f32_bf16 v153, v122, v122
v_dot2c_f32_bf16 v152, s40, v123
v_dot2c_f32_bf16 v153, v123, v123
v_dot2c_f32_bf16 v152, s40, v124
v_dot2c_f32_bf16 v153, v124, v124
v_dot2c_f32_bf16 v152, s40, v125
v_dot2c_f32_bf16 v153, v125, v125
v_dot2c_f32_bf16 v152, s40, v126
v_dot2c_f32_bf16 v153, v126, v126
v_dot2c_f32_bf16 v152, s40, v127
v_dot2c_f32_bf16 v153, v127, v127
v_dot2c_f32_bf16 v156, s40, v128
v_dot2c_f32_bf16 v157, v128, v128
v_dot2c_f32_bf16 v156, s40, v129
v_dot2c_f32_bf16 v157, v129, v129
v_dot2c_f32_bf16 v156, s40, v130
v_dot2c_f32_bf16 v157, v130, v130
v_dot2c_f32_bf16 v156, s40, v131
v_dot2c_f32_bf16 v157, v131, v131
v_dot2c_f32_bf16 v156, s40, v132
v_dot2c_f32_bf16 v157, v132, v132
v_dot2c_f32_bf16 v156, s40, v133
v_dot2c_f32_bf16 v157, v133, v133
v_dot2c_f32_bf16 v156, s40, v134
v_dot2c_f32_bf16 v157, v134, v134
v_dot2c_f32_bf16 v156, s40, v135
v_dot2c_f32_bf16 v157, v135, v135
s_barrier
s_cmp_ge_u32 s59, 8
s_cbranch_scc1 S213
s_cmp_eq_u32 s18, 3
s_cbranch_scc1 S214
ds_read_b64_tr_b16 v[184:185], v176 offset:0
ds_read_b64_tr_b16 v[186:187], v176 offset:1536
ds_read_b64_tr_b16 v[188:189], v176 offset:3072
ds_read_b64_tr_b16 v[190:191], v176 offset:4608
ds_read_b64_tr_b16 v[192:193], v176 offset:6144
ds_read_b64_tr_b16 v[194:195], v176 offset:7680
ds_read_b64_tr_b16 v[196:197], v176 offset:9216
ds_read_b64_tr_b16 v[198:199], v176 offset:10752
ds_read_b64_tr_b16 v[200:201], v176 offset:12288
ds_read_b64_tr_b16 v[202:203], v176 offset:13824
ds_read_b64_tr_b16 v[204:205], v176 offset:15360
ds_read_b64_tr_b16 v[206:207], v176 offset:16896
ds_read_b64_tr_b16 v[208:209], v176 offset:18432
ds_read_b64_tr_b16 v[210:211], v176 offset:19968
ds_read_b64_tr_b16 v[212:213], v176 offset:21504
ds_read_b64_tr_b16 v[214:215], v176 offset:23040
ds_read_b64_tr_b16 v[216:217], v176 offset:24576
ds_read_b64_tr_b16 v[218:219], v176 offset:26112
ds_read_b64_tr_b16 v[220:221], v176 offset:27648
ds_read_b64_tr_b16 v[222:223], v176 offset:29184
v_mov_b32 v178, 0
v_mov_b32 v179, 0
s_waitcnt lgkmcnt(15)
v_dot2c_f32_bf16 v178, s40, v184
v_dot2c_f32_bf16 v178, s40, v185
s_waitcnt lgkmcnt(15)
v_dot2c_f32_bf16 v178, s40, v186
v_dot2c_f32_bf16 v178, s40, v187
s_waitcnt lgkmcnt(15)
v_dot2c_f32_bf16 v178, s40, v188
v_dot2c_f32_bf16 v178, s40, v189
s_waitcnt lgkmcnt(15)
v_dot2c_f32_bf16 v178, s40, v190
v_dot2c_f32_bf16 v178, s40, v191
s_waitcnt lgkmcnt(15)
v_dot2c_f32_bf16 v178, s40, v192
v_dot2c_f32_bf16 v178, s40, v193
s_waitcnt lgkmcnt(14)
v_dot2c_f32_bf16 v178, s40, v194
v_dot2c_f32_bf16 v178, s40, v195
s_waitcnt lgkmcnt(13)
v_dot2c_f32_bf16 v178, s40, v196
v_dot2c_f32_bf16 v178, s40, v197
s_waitcnt lgkmcnt(12)
v_dot2c_f32_bf16 v178, s40, v198
v_dot2c_f32_bf16 v178, s40, v199
s_waitcnt lgkmcnt(11)
v_dot2c_f32_bf16 v178, s40, v200
v_dot2c_f32_bf16 v178, s40, v201
s_waitcnt lgkmcnt(10)
v_dot2c_f32_bf16 v178, s40, v202
v_dot2c_f32_bf16 v178, s40, v203
s_waitcnt lgkmcnt(9)
v_dot2c_f32_bf16 v179, s40, v204
v_dot2c_f32_bf16 v179, s40, v205
s_waitcnt lgkmcnt(8)
v_dot2c_f32_bf16 v179, s40, v206
v_dot2c_f32_bf16 v179, s40, v207
s_waitcnt lgkmcnt(7)
v_dot2c_f32_bf16 v179, s40, v208
v_dot2c_f32_bf16 v179, s40, v209
s_waitcnt lgkmcnt(6)
v_dot2c_f32_bf16 v179, s40, v210
v_dot2c_f32_bf16 v179, s40, v211
s_waitcnt lgkmcnt(5)
v_dot2c_f32_bf16 v179, s40, v212
v_dot2c_f32_bf16 v179, s40, v213
s_waitcnt lgkmcnt(4)
v_dot2c_f32_bf16 v179, s40, v214
v_dot2c_f32_bf16 v179, s40, v215
s_waitcnt lgkmcnt(3)
v_dot2c_f32_bf16 v179, s40, v216
v_dot2c_f32_bf16 v179, s40, v217
s_waitcnt lgkmcnt(2)
v_dot2c_f32_bf16 v179, s40, v218
v_dot2c_f32_bf16 v179, s40, v219
s_waitcnt lgkmcnt(1)
v_dot2c_f32_bf16 v179, s40, v220
v_dot2c_f32_bf16 v179, s40, v221
s_waitcnt lgkmcnt(0)
v_dot2c_f32_bf16 v179, s40, v222
v_dot2c_f32_bf16 v179, s40, v223
s_nop 2
s_branch S214
S213:
ds_read_b64_tr_b16 v[184:185], v176 offset:0
ds_read_b64_tr_b16 v[186:187], v176 offset:640
ds_read_b64_tr_b16 v[188:189], v176 offset:8
ds_read_b64_tr_b16 v[190:191], v176 offset:648
ds_read_b64_tr_b16 v[192:193], v176 offset:16
ds_read_b64_tr_b16 v[194:195], v176 offset:656
ds_read_b64_tr_b16 v[196:197], v176 offset:24
ds_read_b64_tr_b16 v[198:199], v176 offset:664
ds_read_b64_tr_b16 v[200:201], v177 offset:128
ds_read_b64_tr_b16 v[202:203], v177 offset:768
PG_s2:
s_cbranch_execz PG_b1
ds_read_b64_tr_b16 v[204:205], v168 offset:2560
ds_read_b64_tr_b16 v[206:207], v168 offset:5760
ds_read_b64_tr_b16 v[208:209], v169 offset:2688
ds_read_b64_tr_b16 v[210:211], v169 offset:5888
S214:
s_waitcnt lgkmcnt(0)
s_waitcnt vmcnt(8)
s_barrier
ds_read_b128 v[112:115], v1 offset:0
ds_read_b128 v[116:119], v1 offset:1024
ds_read_b128 v[120:123], v1 offset:2048
ds_read_b128 v[124:127], v1 offset:3072
ds_read_b128 v[128:131], v1 offset:4096
ds_read_b128 v[132:135], v1 offset:5120
s_waitcnt lgkmcnt(4)
v_mfma_f32_16x16x32_bf16 v[48:51], v[112:115], a[0:3], 0
s_add_u32 m0, s25, 49152
s_add_u32 s30, s21, 49152
v_mfma_f32_16x16x32_bf16 v[48:51], v[116:119], a[4:7], v[48:51]
buffer_load_dwordx4 v1, s[4:7], s30 offen sc1 lds
v_mfma_f32_16x16x32_bf16 v[56:59], v[112:115], a[8:11], 0
ds_read_b128 v[112:115], v1 offset:6144
v_mov_b32 v154, v152
v_mfma_f32_16x16x32_bf16 v[56:59], v[116:119], a[12:15], v[56:59]
ds_read_b128 v[116:119], v1 offset:7168
s_waitcnt lgkmcnt(4)
v_mfma_f32_16x16x32_bf16 v[52:55], v[120:123], a[0:3], 0
buffer_store_dwordx4 v[184:187], v224, s[4:7], 0 offen sc1
v_mfma_f32_16x16x32_bf16 v[52:55], v[124:127], a[4:7], v[52:55]
buffer_load_dwordx4 v1, s[4:7], s30 offen offset:1024 sc1 lds
v_mfma_f32_16x16x32_bf16 v[60:63], v[120:123], a[8:11], 0
ds_read_b128 v[120:123], v1 offset:8192
v_mov_b32 v155, v153
v_mfma_f32_16x16x32_bf16 v[60:63], v[124:127], a[12:15], v[60:63]
ds_read_b128 v[124:127], v1 offset:9216
s_waitcnt lgkmcnt(4)
v_mfma_f32_16x16x32_bf16 v[64:67], v[128:131], a[0:3], 0
buffer_load_dwordx4 v1, s[4:7], s30 offen offset:2048 sc1 lds
v_mfma_f32_16x16x32_bf16 v[64:67], v[132:135], a[4:7], v[64:67]
buffer_store_dwordx4 v[188:191], v225, s[4:7], 0 offen sc1
v_mfma_f32_16x16x32_bf16 v[72:75], v[128:131], a[8:11], 0
ds_read_b128 v[128:131], v1 offset:10240
v_mov_b32 v158, v156
v_mfma_f32_16x16x32_bf16 v[72:75], v[132:135], a[12:15], v[72:75]
ds_read_b128 v[132:135], v1 offset:11264
s_waitcnt lgkmcnt(4)
v_mfma_f32_16x16x32_bf16 v[68:71], v[112:115], a[0:3], 0
v_mov_b32 v159, v157
v_permlane32_swap_b32 v154, v152
v_mfma_f32_16x16x32_bf16 v[68:71], v[116:119], a[4:7], v[68:71]
v_permlane32_swap_b32 v155, v153
v_permlane32_swap_b32 v158, v156
v_mfma_f32_16x16x32_bf16 v[76:79], v[112:115], a[8:11], 0
ds_read_b128 v[112:115], v1 offset:12288
v_permlane32_swap_b32 v159, v157
v_mfma_f32_16x16x32_bf16 v[76:79], v[116:119], a[12:15], v[76:79]
ds_read_b128 v[116:119], v1 offset:13312
s_waitcnt lgkmcnt(4)
v_mfma_f32_16x16x32_bf16 v[48:51], v[120:123], a[16:19], v[48:51]
buffer_load_dwordx4 v1, s[4:7], s30 offen offset:3072 sc1 lds
v_mfma_f32_16x16x32_bf16 v[48:51], v[124:127], a[20:23], v[48:51]
buffer_store_dwordx4 v[192:195], v226, s[4:7], 0 offen sc1
v_mfma_f32_16x16x32_bf16 v[56:59], v[120:123], a[24:27], v[56:59]
ds_read_b128 v[120:123], v1 offset:14336
v_add_f32 v152, v152, v154
v_mfma_f32_16x16x32_bf16 v[56:59], v[124:127], a[28:31], v[56:59]
ds_read_b128 v[124:127], v1 offset:15360
s_waitcnt vmcnt(11)
s_barrier
s_waitcnt lgkmcnt(4)
v_mfma_f32_16x16x32_bf16 v[52:55], v[128:131], a[16:19], v[52:55]
s_add_u32 m0, s25, 65536
s_add_u32 s30, s21, 65536
v_mfma_f32_16x16x32_bf16 v[52:55], v[132:135], a[20:23], v[52:55]
buffer_load_dwordx4 v1, s[4:7], s30 offen sc1 lds
v_mfma_f32_16x16x32_bf16 v[60:63], v[128:131], a[24:27], v[60:63]
ds_read_b128 v[128:131], v1 offset:16384
v_add_f32 v153, v153, v155
v_mfma_f32_16x16x32_bf16 v[60:63], v[132:135], a[28:31], v[60:63]
ds_read_b128 v[132:135], v1 offset:17408
s_waitcnt lgkmcnt(4)
v_mfma_f32_16x16x32_bf16 v[64:67], v[112:115], a[16:19], v[64:67]
buffer_load_dwordx4 v1, s[4:7], s30 offen offset:1024 sc1 lds
v_mfma_f32_16x16x32_bf16 v[64:67], v[116:119], a[20:23], v[64:67]
buffer_store_dwordx4 v[196:199], v227, s[4:7], 0 offen sc1
v_mfma_f32_16x16x32_bf16 v[72:75], v[112:115], a[24:27], v[72:75]
ds_read_b128 v[112:115], v1 offset:18432
v_add_f32 v156, v156, v158
v_mfma_f32_16x16x32_bf16 v[72:75], v[116:119], a[28:31], v[72:75]
ds_read_b128 v[116:119], v1 offset:19456
s_waitcnt lgkmcnt(4)
v_mfma_f32_16x16x32_bf16 v[68:71], v[120:123], a[16:19], v[68:71]
buffer_load_dwordx4 v1, s[4:7], s30 offen offset:2048 sc1 lds
v_mfma_f32_16x16x32_bf16 v[68:71], v[124:127], a[20:23], v[68:71]
v_add_f32 v157, v157, v159
v_mov_b32 v154, v152
v_mfma_f32_16x16x32_bf16 v[76:79], v[120:123], a[24:27], v[76:79]
ds_read_b128 v[120:123], v1 offset:20480
v_mov_b32 v155, v153
v_mfma_f32_16x16x32_bf16 v[76:79], v[124:127], a[28:31], v[76:79]
ds_read_b128 v[124:127], v1 offset:21504
s_waitcnt lgkmcnt(4)
v_mfma_f32_16x16x32_bf16 v[48:51], v[128:131], a[32:35], v[48:51]
buffer_load_dwordx4 v1, s[4:7], s30 offen offset:3072 sc1 lds
v_mfma_f32_16x16x32_bf16 v[48:51], v[132:135], a[36:39], v[48:51]
buffer_store_dwordx4 v[200:203], v228, s[4:7], 0 offen sc1
v_mfma_f32_16x16x32_bf16 v[56:59], v[128:131], a[40:43], v[56:59]
ds_read_b128 v[128:131], v1 offset:22528
v_mov_b32 v158, v156
v_mfma_f32_16x16x32_bf16 v[56:59], v[132:135], a[44:47], v[56:59]
ds_read_b128 v[132:135], v1 offset:23552
s_waitcnt lgkmcnt(4)
v_mfma_f32_16x16x32_bf16 v[52:55], v[112:115], a[32:35], v[52:55]
v_mov_b32 v159, v157
v_permlane16_swap_b32 v154, v152
v_mfma_f32_16x16x32_bf16 v[52:55], v[116:119], a[36:39], v[52:55]
v_permlane16_swap_b32 v155, v153
v_permlane16_swap_b32 v158, v156
v_mfma_f32_16x16x32_bf16 v[60:63], v[112:115], a[40:43], v[60:63]
ds_read_b128 v[112:115], v1 offset:24576
v_permlane16_swap_b32 v159, v157
v_mfma_f32_16x16x32_bf16 v[60:63], v[116:119], a[44:47], v[60:63]
ds_read_b128 v[116:119], v1 offset:25600
s_waitcnt lgkmcnt(4)
v_mfma_f32_16x16x32_bf16 v[64:67], v[120:123], a[32:35], v[64:67]
s_mul_i32 s77, s17, 4096
s_add_u32 s77, s77, 196608
v_mfma_f32_16x16x32_bf16 v[64:67], v[124:127], a[36:39], v[64:67]
buffer_load_dwordx4 v[136:139], v1, s[4:7], s77 offen offset:0 sc1
v_mfma_f32_16x16x32_bf16 v[72:75], v[120:123], a[40:43], v[72:75]
ds_read_b128 v[120:123], v1 offset:26624
v_add_f32 v152, v152, v154
v_mfma_f32_16x16x32_bf16 v[72:75], v[124:127], a[44:47], v[72:75]
ds_read_b128 v[124:127], v1 offset:27648
s_waitcnt lgkmcnt(4)
v_mfma_f32_16x16x32_bf16 v[68:71], v[128:131], a[32:35], v[68:71]
buffer_store_dwordx4 v[204:207], v229, s[4:7], 0 offen sc1
v_mfma_f32_16x16x32_bf16 v[68:71], v[132:135], a[36:39], v[68:71]
buffer_load_dwordx4 v[140:143], v1, s[4:7], s77 offen offset:1024 sc1
v_mfma_f32_16x16x32_bf16 v[76:79], v[128:131], a[40:43], v[76:79]
ds_read_b128 v[128:131], v1 offset:28672
v_add_f32 v153, v153, v155
v_mfma_f32_16x16x32_bf16 v[76:79], v[132:135], a[44:47], v[76:79]
ds_read_b128 v[132:135], v1 offset:29696
s_waitcnt lgkmcnt(4)
v_mfma_f32_16x16x32_bf16 v[48:51], v[112:115], a[48:51], v[48:51]
buffer_load_dwordx4 v[144:147], v1, s[4:7], s77 offen offset:2048 sc1
v_mfma_f32_16x16x32_bf16 v[48:51], v[116:119], a[52:55], v[48:51]
buffer_store_dwordx4 v[208:211], v230, s[4:7], 0 offen sc1
v_mfma_f32_16x16x32_bf16 v[56:59], v[112:115], a[56:59], v[56:59]
ds_read_b128 v[112:115], v1 offset:30720
v_add_f32 v156, v156, v158
v_mfma_f32_16x16x32_bf16 v[56:59], v[116:119], a[60:63], v[56:59]
ds_read_b128 v[116:119], v1 offset:31744
s_waitcnt vmcnt(18)
s_barrier
s_waitcnt lgkmcnt(4)
v_mfma_f32_16x16x32_bf16 v[52:55], v[120:123], a[48:51], v[52:55]
buffer_load_dwordx4 v[148:151], v1, s[4:7], s77 offen offset:3072 sc1
v_mfma_f32_16x16x32_bf16 v[52:55], v[124:127], a[52:55], v[52:55]
v_add_f32 v157, v157, v159
v_mul_f32 v152, 0xbacccccd, v152
v_mfma_f32_16x16x32_bf16 v[60:63], v[120:123], a[56:59], v[60:63]
ds_read_b128 v[120:123], v1 offset:32768
v_cvt_pk_bf16_f32 v40, v152, v152
v_mfma_f32_16x16x32_bf16 v[60:63], v[124:127], a[60:63], v[60:63]
ds_read_b128 v[124:127], v1 offset:33792
s_waitcnt lgkmcnt(4)
v_mfma_f32_16x16x32_bf16 v[64:67], v[128:131], a[48:51], v[64:67]
s_add_u32 m0, s25, 81920
s_add_u32 s30, s21, 81920
v_mfma_f32_16x16x32_bf16 v[64:67], v[132:135], a[52:55], v[64:67]
buffer_load_dwordx4 v1, s[4:7], s30 offen sc1 lds
v_mfma_f32_16x16x32_bf16 v[72:75], v[128:131], a[56:59], v[72:75]
ds_read_b128 v[128:131], v1 offset:34816
v_cvt_pk_bf16_f32 v41, v152, v152
v_mfma_f32_16x16x32_bf16 v[72:75], v[132:135], a[60:63], v[72:75]
ds_read_b128 v[132:135], v1 offset:35840
s_waitcnt lgkmcnt(4)
v_mfma_f32_16x16x32_bf16 v[68:71], v[112:115], a[48:51], v[68:71]
buffer_store_dwordx4 v[212:215], v231, s[4:7], 0 offen sc1
v_mfma_f32_16x16x32_bf16 v[68:71], v[116:119], a[52:55], v[68:71]
v_mul_f32 v156, 0xbacccccd, v156
v_cvt_pk_bf16_f32 v42, v156, v156
v_mfma_f32_16x16x32_bf16 v[76:79], v[112:115], a[56:59], v[76:79]
ds_read_b128 v[112:115], v1 offset:36864
v_cvt_pk_bf16_f32 v43, v156, v156
v_mfma_f32_16x16x32_bf16 v[76:79], v[116:119], a[60:63], v[76:79]
ds_read_b128 v[116:119], v1 offset:37888
s_waitcnt lgkmcnt(4)
v_mfma_f32_16x16x32_bf16 v[48:51], v[120:123], a[64:67], v[48:51]
buffer_load_dwordx4 v1, s[4:7], s30 offen offset:1024 sc1 lds
v_mfma_f32_16x16x32_bf16 v[48:51], v[124:127], a[68:71], v[48:51]
s_mov_b32 s32, 0xffffffff
s_mov_b32 s33, 0xfffffff0
v_mfma_f32_16x16x32_bf16 v[56:59], v[120:123], a[72:75], v[56:59]
ds_read_b128 v[120:123], v1 offset:38912
v_mul_f32 v153, 0x3acccccd, v153
v_mfma_f32_16x16x32_bf16 v[56:59], v[124:127], a[76:79], v[56:59]
ds_read_b128 v[124:127], v1 offset:39936
s_waitcnt lgkmcnt(4)
v_mfma_f32_16x16x32_bf16 v[52:55], v[128:131], a[64:67], v[52:55]
buffer_store_dwordx4 v[216:219], v232, s[4:7], 0 offen sc1
v_mfma_f32_16x16x32_bf16 v[52:55], v[132:135], a[68:71], v[52:55]
buffer_load_dwordx4 v1, s[4:7], s30 offen offset:2048 sc1 lds
v_mfma_f32_16x16x32_bf16 v[60:63], v[128:131], a[72:75], v[60:63]
ds_read_b128 v[128:131], v1 offset:40960
v_fma_f32 v153, -v152, v152, v153
v_mfma_f32_16x16x32_bf16 v[60:63], v[132:135], a[76:79], v[60:63]
ds_read_b128 v[132:135], v1 offset:41984
s_waitcnt lgkmcnt(4)
v_mfma_f32_16x16x32_bf16 v[64:67], v[112:115], a[64:67], v[64:67]
s_mov_b32 s34, 0xfffffffe
s_mov_b32 s35, 0xffffffe0
v_mfma_f32_16x16x32_bf16 v[64:67], v[116:119], a[68:71], v[64:67]
buffer_load_dwordx4 v1, s[4:7], s30 offen offset:3072 sc1 lds
v_mfma_f32_16x16x32_bf16 v[72:75], v[112:115], a[72:75], v[72:75]
ds_read_b128 v[112:115], v1 offset:43008
v_max_f32 v153, 0, v153
v_mfma_f32_16x16x32_bf16 v[72:75], v[116:119], a[76:79], v[72:75]
ds_read_b128 v[116:119], v1 offset:44032
s_waitcnt lgkmcnt(4)
v_mfma_f32_16x16x32_bf16 v[68:71], v[120:123], a[64:67], v[68:71]
buffer_store_dwordx4 v[220:223], v233, s[4:7], 0 offen sc1
v_mfma_f32_16x16x32_bf16 v[68:71], v[124:127], a[68:71], v[68:71]
s_mov_b32 s36, 0xfffffffc
s_mov_b32 s37, 0xffffffc0
v_mfma_f32_16x16x32_bf16 v[76:79], v[120:123], a[72:75], v[76:79]
ds_read_b128 v[120:123], v1 offset:45056
v_add_f32 v153, 0x3727c5ac, v153
v_mfma_f32_16x16x32_bf16 v[76:79], v[124:127], a[76:79], v[76:79]
ds_read_b128 v[124:127], v1 offset:46080
s_waitcnt lgkmcnt(4)
v_mfma_f32_16x16x32_bf16 v[48:51], v[128:131], a[80:83], v[48:51]
s_add_u32 m0, s25, 98304
s_add_u32 s30, s21, 98304
v_mfma_f32_16x16x32_bf16 v[48:51], v[132:135], a[84:87], v[48:51]
buffer_load_dwordx4 v1, s[4:7], s30 offen sc1 lds
v_mfma_f32_16x16x32_bf16 v[56:59], v[128:131], a[88:91], v[56:59]
ds_read_b128 v[128:131], v1 offset:47104
v_mfma_f32_16x16x32_bf16 v[56:59], v[132:135], a[92:95], v[56:59]
ds_read_b128 v[132:135], v1 offset:48128
s_waitcnt vmcnt(21)
s_barrier
s_waitcnt lgkmcnt(4)
v_mfma_f32_16x16x32_bf16 v[52:55], v[112:115], a[80:83], v[52:55]
buffer_load_dwordx4 v1, s[4:7], s30 offen offset:1024 sc1 lds
v_mfma_f32_16x16x32_bf16 v[52:55], v[116:119], a[84:87], v[52:55]
s_mov_b32 s38, 0xfffffff8
s_mov_b32 s39, 0xffffff80
v_mfma_f32_16x16x32_bf16 v[60:63], v[112:115], a[88:91], v[60:63]
ds_read_b128 v[112:115], v1 offset:49152
v_mfma_f32_16x16x32_bf16 v[60:63], v[116:119], a[92:95], v[60:63]
ds_read_b128 v[116:119], v1 offset:50176
s_waitcnt lgkmcnt(4)
v_mfma_f32_16x16x32_bf16 v[64:67], v[120:123], a[80:83], v[64:67]
buffer_load_dwordx4 v1, s[4:7], s30 offen offset:2048 sc1 lds
v_mfma_f32_16x16x32_bf16 v[64:67], v[124:127], a[84:87], v[64:67]
s_mov_b32 s40, 0xffffff00
s_mov_b32 s41, 0xfffff000
v_mfma_f32_16x16x32_bf16 v[72:75], v[120:123], a[88:91], v[72:75]
ds_read_b128 v[120:123], v1 offset:51200
v_mfma_f32_16x16x32_bf16 v[72:75], v[124:127], a[92:95], v[72:75]
ds_read_b128 v[124:127], v1 offset:52224
s_waitcnt lgkmcnt(4)
v_mfma_f32_16x16x32_bf16 v[68:71], v[128:131], a[80:83], v[68:71]
buffer_load_dwordx4 v1, s[4:7], s30 offen offset:3072 sc1 lds
v_mfma_f32_16x16x32_bf16 v[68:71], v[132:135], a[84:87], v[68:71]
s_mov_b32 s42, 0xfffffe00
s_mov_b32 s43, 0xffffe000
v_mfma_f32_16x16x32_bf16 v[76:79], v[128:131], a[88:91], v[76:79]
ds_read_b128 v[128:131], v1 offset:53248
v_mfma_f32_16x16x32_bf16 v[76:79], v[132:135], a[92:95], v[76:79]
ds_read_b128 v[132:135], v1 offset:54272
s_waitcnt lgkmcnt(4)
v_mfma_f32_16x16x32_bf16 v[48:51], v[112:115], a[96:99], v[48:51]
s_add_u32 m0, s25, 114688
s_add_u32 s30, s21, 114688
v_mfma_f32_16x16x32_bf16 v[48:51], v[116:119], a[100:103], v[48:51]
buffer_load_dwordx4 v1, s[4:7], s30 offen sc1 lds
v_mfma_f32_16x16x32_bf16 v[56:59], v[112:115], a[104:107], v[56:59]
ds_read_b128 v[112:115], v1 offset:55296
v_mfma_f32_16x16x32_bf16 v[56:59], v[116:119], a[108:111], v[56:59]
ds_read_b128 v[116:119], v1 offset:56320
s_waitcnt lgkmcnt(4)
v_mfma_f32_16x16x32_bf16 v[52:55], v[120:123], a[96:99], v[52:55]
s_mov_b32 s44, 0xfffffc00
s_mov_b32 s45, 0xffffc000
v_mfma_f32_16x16x32_bf16 v[52:55], v[124:127], a[100:103], v[52:55]
buffer_load_dwordx4 v1, s[4:7], s30 offen offset:1024 sc1 lds
v_mfma_f32_16x16x32_bf16 v[60:63], v[120:123], a[104:107], v[60:63]
ds_read_b128 v[120:123], v1 offset:57344
v_mfma_f32_16x16x32_bf16 v[60:63], v[124:127], a[108:111], v[60:63]
ds_read_b128 v[124:127], v1 offset:58368
s_waitcnt lgkmcnt(4)
v_mfma_f32_16x16x32_bf16 v[64:67], v[128:131], a[96:99], v[64:67]
buffer_load_dwordx4 v1, s[4:7], s30 offen offset:2048 sc1 lds
v_mfma_f32_16x16x32_bf16 v[64:67], v[132:135], a[100:103], v[64:67]
s_mov_b32 s46, 0xfffff800
s_mov_b32 s47, 0xffff8000
v_mfma_f32_16x16x32_bf16 v[72:75], v[128:131], a[104:107], v[72:75]
ds_read_b128 v[128:131], v1 offset:59392
v_mfma_f32_16x16x32_bf16 v[72:75], v[132:135], a[108:111], v[72:75]
ds_read_b128 v[132:135], v1 offset:60416
s_waitcnt lgkmcnt(4)
v_mfma_f32_16x16x32_bf16 v[68:71], v[112:115], a[96:99], v[68:71]
v_rsq_f32 v18, v153
v_mfma_f32_16x16x32_bf16 v[68:71], v[116:119], a[100:103], v[68:71]
v_mul_f32 v157, 0x3acccccd, v157
v_fma_f32 v157, -v156, v156, v157
v_mfma_f32_16x16x32_bf16 v[76:79], v[112:115], a[104:107], v[76:79]
ds_read_b128 v[112:115], v1 offset:61440
v_max_f32 v157, 0, v157
v_mfma_f32_16x16x32_bf16 v[76:79], v[116:119], a[108:111], v[76:79]
ds_read_b128 v[116:119], v1 offset:62464
s_waitcnt lgkmcnt(4)
v_mfma_f32_16x16x32_bf16 v[48:51], v[120:123], a[112:115], v[48:51]
buffer_load_dwordx4 v1, s[4:7], s30 offen offset:3072 sc1 lds
v_mfma_f32_16x16x32_bf16 v[48:51], v[124:127], a[116:119], v[48:51]
s_mov_b32 s48, 0xffff0000
s_mov_b32 s49, 0xfff00000
v_mfma_f32_16x16x32_bf16 v[56:59], v[120:123], a[120:123], v[56:59]
ds_read_b128 v[120:123], v1 offset:63488
v_add_f32 v157, 0x3727c5ac, v157
v_mfma_f32_16x16x32_bf16 v[56:59], v[124:127], a[124:127], v[56:59]
ds_read_b128 v[124:127], v1 offset:64512
s_waitcnt vmcnt(22)
s_barrier
s_waitcnt lgkmcnt(4)
v_mfma_f32_16x16x32_bf16 v[52:55], v[128:131], a[112:115], v[52:55]
s_add_u32 m0, s25, 131072
s_add_u32 s30, s21, 131072
v_mfma_f32_16x16x32_bf16 v[52:55], v[132:135], a[116:119], v[52:55]
buffer_load_dwordx4 v1, s[4:7], s30 offen sc1 lds
v_mfma_f32_16x16x32_bf16 v[60:63], v[128:131], a[120:123], v[60:63]
ds_read_b128 v[128:131], v2 offset:0
v_mfma_f32_16x16x32_bf16 v[60:63], v[132:135], a[124:127], v[60:63]
ds_read_b128 v[132:135], v2 offset:1024
s_waitcnt lgkmcnt(4)
v_mfma_f32_16x16x32_bf16 v[64:67], v[112:115], a[112:115], v[64:67]
s_mov_b32 s50, 0xfffe0000
s_mov_b32 s51, 0xffe00000
v_mfma_f32_16x16x32_bf16 v[64:67], v[116:119], a[116:119], v[64:67]
buffer_load_dwordx4 v1, s[4:7], s30 offen offset:1024 sc1 lds
v_mfma_f32_16x16x32_bf16 v[72:75], v[112:115], a[120:123], v[72:75]
ds_read_b128 v[112:115], v2 offset:2048
v_mfma_f32_16x16x32_bf16 v[72:75], v[116:119], a[124:127], v[72:75]
ds_read_b128 v[116:119], v2 offset:3072
s_waitcnt lgkmcnt(4)
v_mfma_f32_16x16x32_bf16 v[68:71], v[120:123], a[112:115], v[68:71]
s_mov_b32 s52, 0xfffc0000
s_mov_b32 s53, 0xffc00000
v_mfma_f32_16x16x32_bf16 v[68:71], v[124:127], a[116:119], v[68:71]
buffer_load_dwordx4 v1, s[4:7], s30 offen offset:2048 sc1 lds
v_mfma_f32_16x16x32_bf16 v[76:79], v[120:123], a[120:123], v[76:79]
ds_read_b128 v[120:123], v2 offset:4096
v_mfma_f32_16x16x32_bf16 v[76:79], v[124:127], a[124:127], v[76:79]
ds_read_b128 v[124:127], v2 offset:5120
s_waitcnt lgkmcnt(4)
v_mfma_f32_16x16x32_bf16 v[48:51], v[128:131], a[128:131], v[48:51]
buffer_load_dwordx4 v1, s[4:7], s30 offen offset:3072 sc1 lds
v_mfma_f32_16x16x32_bf16 v[48:51], v[132:135], a[132:135], v[48:51]
s_mov_b32 s54, 0xfff80000
s_mov_b32 s55, 0xff800000
v_mfma_f32_16x16x32_bf16 v[56:59], v[128:131], a[136:139], v[56:59]
ds_read_b128 v[128:131], v2 offset:6144
v_mfma_f32_16x16x32_bf16 v[56:59], v[132:135], a[140:143], v[56:59]
ds_read_b128 v[132:135], v2 offset:7168
s_waitcnt lgkmcnt(4)
v_mfma_f32_16x16x32_bf16 v[52:55], v[112:115], a[128:131], v[52:55]
v_rsq_f32 v44, v157
v_mfma_f32_16x16x32_bf16 v[52:55], v[116:119], a[132:135], v[52:55]
v_add_f32 v178, v179, v178
v_cvt_pk_bf16_f32 v183, v178, 0
v_mfma_f32_16x16x32_bf16 v[60:63], v[112:115], a[136:139], v[60:63]
ds_read_b128 v[112:115], v2 offset:8192
v_lshlrev_b32 v179, 16, v183
v_mfma_f32_16x16x32_bf16 v[60:63], v[116:119], a[140:143], v[60:63]
ds_read_b128 v[116:119], v2 offset:9216
s_waitcnt lgkmcnt(4)
v_mfma_f32_16x16x32_bf16 v[64:67], v[120:123], a[128:131], v[64:67]
s_mov_b32 s56, 0xff000000
s_mov_b32 s57, 0xf0000000
v_mfma_f32_16x16x32_bf16 v[64:67], v[124:127], a[132:135], v[64:67]
v_sub_f32 v180, v178, v179
v_cvt_pk_bf16_f32 v182, v179, v180
v_mfma_f32_16x16x32_bf16 v[72:75], v[120:123], a[136:139], v[72:75]
ds_read_b128 v[120:123], v2 offset:10240
v_mfma_f32_16x16x32_bf16 v[72:75], v[124:127], a[140:143], v[72:75]
ds_read_b128 v[124:127], v2 offset:11264
s_waitcnt lgkmcnt(4)
v_mfma_f32_16x16x32_bf16 v[68:71], v[128:131], a[128:131], v[68:71]
buffer_store_dword v182, v234, s[4:7], 0 offen sc1
v_mfma_f32_16x16x32_bf16 v[68:71], v[132:135], a[132:135], v[68:71]
s_mov_b32 s58, 0xfe000000
s_mov_b32 s59, 0xe0000000
v_mfma_f32_16x16x32_bf16 v[76:79], v[128:131], a[136:139], v[76:79]
ds_read_b128 v[128:131], v2 offset:12288
v_mfma_f32_16x16x32_bf16 v[76:79], v[132:135], a[140:143], v[76:79]
ds_read_b128 v[132:135], v2 offset:13312
s_waitcnt lgkmcnt(4)
v_mfma_f32_16x16x32_bf16 v[48:51], v[112:115], a[144:147], v[48:51]
v_sub_u32 v175, v175, v248
v_cmp_lt_u32 vcc, 7, v175
s_nop 0
s_cbranch_vccnz VT15
VB16:
v_mfma_f32_16x16x32_bf16 v[48:51], v[116:119], a[148:151], v[48:51]
v_lshrrev_b32 v174, 2, v175
v_and_b32 v175, 1, v175
v_mfma_f32_16x16x32_bf16 v[56:59], v[112:115], a[152:155], v[56:59]
ds_read_b128 v[112:115], v2 offset:14336
v_mfma_f32_16x16x32_bf16 v[56:59], v[116:119], a[156:159], v[56:59]
ds_read_b128 v[116:119], v2 offset:15360
s_waitcnt vmcnt(14)
s_barrier
s_waitcnt lgkmcnt(4)
v_mfma_f32_16x16x32_bf16 v[52:55], v[120:123], a[144:147], v[52:55]
s_mov_b32 s60, 0xfc000000
s_mov_b32 s61, 0xc0000000
v_mfma_f32_16x16x32_bf16 v[52:55], v[124:127], a[148:151], v[52:55]
v_cmp_ne_u32 vcc, v175, v174
s_nop 0
s_bcnt1_i32_b64 s64, vcc
s_cmp_ge_u32 s64, 32
s_cselect_b32 s64, 1, 0
v_mfma_f32_16x16x32_bf16 v[60:63], v[120:123], a[152:155], v[60:63]
ds_read_b128 v[120:123], v2 offset:16384
v_xor_b32 v175, s64, v174
v_mfma_f32_16x16x32_bf16 v[60:63], v[124:127], a[156:159], v[60:63]
ds_read_b128 v[124:127], v2 offset:17408
v_lshlrev_b32 v175, 13, v175
s_waitcnt lgkmcnt(4)
v_mfma_f32_16x16x32_bf16 v[64:67], v[128:131], a[144:147], v[64:67]
s_mov_b32 s62, 0xf8000000
s_mov_b32 s63, 0x80000000
s_lshr_b32 s65, s18, 1
s_add_u32 s65, s65, s16
s_max_u32 s65, s65, 2
s_sub_u32 s65, s65, 2
v_mfma_f32_16x16x32_bf16 v[64:67], v[132:135], a[148:151], v[64:67]
s_lshl_b32 s65, s65, 2
s_lshl_b32 s64, s16, 2
v_mfma_f32_16x16x32_bf16 v[72:75], v[128:131], a[152:155], v[72:75]
ds_read_b128 v[128:131], v2 offset:18432
v_readlane_b32 s64, v175, s64
v_mfma_f32_16x16x32_bf16 v[72:75], v[132:135], a[156:159], v[72:75]
ds_read_b128 v[132:135], v2 offset:19456
v_readlane_b32 s65, v175, s65
s_waitcnt lgkmcnt(4)
v_mfma_f32_16x16x32_bf16 v[68:71], v[112:115], a[144:147], v[68:71]
s_add_u32 s26, s26, s64
s_add_u32 s29, s29, s64
v_bfe_u32 v238, v0, 4, 1
v_and_b32 v234, 15, v0
v_mfma_f32_16x16x32_bf16 v[68:71], v[116:119], a[148:151], v[68:71]
s_add_u32 s91, s91, s64
s_add_u32 s28, s28, s64
v_lshlrev_b32 v237, 2, v238
v_xor_b32 v234, v234, v237
v_mfma_f32_16x16x32_bf16 v[76:79], v[112:115], a[152:155], v[76:79]
ds_read_b128 v[112:115], v2 offset:20480
s_add_u32 s98, s98, s64
s_add_u32 s99, s99, s64
v_lshlrev_b32 v234, 4, v234
v_lshl_add_u32 v234, v238, 9, v234
v_mfma_f32_16x16x32_bf16 v[76:79], v[116:119], a[156:159], v[76:79]
ds_read_b128 v[116:119], v2 offset:21504
s_add_u32 s100, s100, s64
s_add_u32 s101, s101, s64
v_lshrrev_b32 v239, 5, v0
v_lshl_add_u32 v232, v239, 10, v234
v_mfma_f32_16x16x16_bf16 v[48:51], v[136:137], v[40:41], v[48:51]
s_add_u32 s66, s66, s64
s_add_u32 s67, s67, s64
v_lshl_add_u32 v233, v239, 11, v234
v_sub_u32 v237, v47, v5
v_mfma_f32_16x16x16_bf16 v[56:59], v[136:137], v[42:43], v[56:59]
s_add_u32 s68, s68, s64
s_add_u32 s69, s69, s64
v_add_u32 v237, 41984, v237
v_add_u32 v235, v237, v232
v_mfma_f32_16x16x16_bf16 v[52:55], v[138:139], v[40:41], v[52:55]
s_add_u32 s70, s70, s64
s_add_u32 s71, s71, s64
v_add_u32 v236, v237, v233
v_lshl_add_u32 v236, v239, 7, v236
v_mfma_f32_16x16x16_bf16 v[60:63], v[138:139], v[42:43], v[60:63]
s_add_u32 s72, s72, s64
s_add_u32 s73, s73, s64
v_add_u32 v238, s25, v232
v_add_u32 v238, 66560, v238
v_mfma_f32_16x16x16_bf16 v[64:67], v[140:141], v[40:41], v[64:67]
s_cmp_eq_u32 s3, 0
s_cselect_b32 s64, s64, s65
s_cselect_b32 s65, 0, s65
v_add_u32 v237, 3072, v235
v_lshl_add_u32 v234, v239, 28, v234
v_mfma_f32_16x16x16_bf16 v[72:75], v[140:141], v[42:43], v[72:75]
s_add_u32 s89, s89, s65
s_add_u32 s92, s92, s64
s_add_u32 s27, s27, s64
v_subrev_u32 v239, 2048, v238
s_mov_b32 vcc_lo, -1
s_mov_b32 vcc_hi, 0
v_cndmask_b32 v237, v239, v237, vcc
v_mfma_f32_16x16x16_bf16 v[68:71], v[142:143], v[40:41], v[68:71]
v_add_u32 v239, s25, v5
v_add_u32 v239, 65536, v239
v_mfma_f32_16x16x16_bf16 v[76:79], v[142:143], v[42:43], v[76:79]
s_waitcnt lgkmcnt(4)
v_mfma_f32_16x16x32_bf16 v[80:83], v[120:123], a[0:3], 0
s_add_u32 m0, s25, 147456
s_add_u32 s30, s21, 147456
v_mfma_f32_16x16x32_bf16 v[80:83], v[124:127], a[4:7], v[80:83]
buffer_load_dwordx4 v1, s[4:7], s30 offen sc1 lds
v_mfma_f32_16x16x32_bf16 v[88:91], v[120:123], a[8:11], 0
ds_read_b128 v[120:123], v2 offset:22528
v_mul_f32 v48, v18, v48
v_mul_f32 v49, v18, v49
v_mfma_f32_16x16x32_bf16 v[88:91], v[124:127], a[12:15], v[88:91]
ds_read_b128 v[124:127], v2 offset:23552
v_mul_f32 v50, v18, v50
s_waitcnt lgkmcnt(4)
v_mfma_f32_16x16x32_bf16 v[84:87], v[128:131], a[0:3], 0
s_add_u32 s74, s29, 134217728
v_mul_f32 v51, v18, v51
v_mul_f32 v52, v18, v52
v_mfma_f32_16x16x32_bf16 v[84:87], v[132:135], a[4:7], v[84:87]
buffer_load_dwordx4 v1, s[4:7], s30 offen offset:1024 sc1 lds
v_mul_f32 v53, v18, v53
v_mfma_f32_16x16x32_bf16 v[92:95], v[128:131], a[8:11], 0
ds_read_b128 v[128:131], v2 offset:24576
v_mul_f32 v54, v18, v54
v_mul_f32 v55, v18, v55
v_mfma_f32_16x16x32_bf16 v[92:95], v[132:135], a[12:15], v[92:95]
ds_read_b128 v[132:135], v2 offset:25600
v_cvt_pk_bf16_f32 v152, v48, v49
s_waitcnt lgkmcnt(4)
v_mfma_f32_16x16x32_bf16 v[80:83], v[112:115], a[16:19], v[80:83]
v_cvt_pk_bf16_f32 v153, v50, v51
v_cvt_pk_bf16_f32 v154, v52, v53
v_cvt_pk_bf16_f32 v155, v54, v55
v_mfma_f32_16x16x32_bf16 v[80:83], v[116:119], a[20:23], v[80:83]
buffer_store_dwordx4 v[152:155], v232, s[4:7], s74 offen offset:0 sc1
v_mul_f32 v56, v44, v56
v_mfma_f32_16x16x32_bf16 v[88:91], v[112:115], a[24:27], v[88:91]
ds_read_b128 v[112:115], v2 offset:26624
v_mul_f32 v57, v44, v57
v_mul_f32 v58, v44, v58
v_mfma_f32_16x16x32_bf16 v[88:91], v[116:119], a[28:31], v[88:91]
ds_read_b128 v[116:119], v2 offset:27648
v_mul_f32 v59, v44, v59
s_waitcnt lgkmcnt(4)
v_mfma_f32_16x16x32_bf16 v[84:87], v[120:123], a[16:19], v[84:87]
buffer_load_dwordx4 v1, s[4:7], s30 offen offset:2048 sc1 lds
v_mul_f32 v60, v44, v60
v_mfma_f32_16x16x32_bf16 v[84:87], v[124:127], a[20:23], v[84:87]
v_mul_f32 v61, v44, v61
v_mul_f32 v62, v44, v62
v_mul_f32 v63, v44, v63
v_mfma_f32_16x16x32_bf16 v[92:95], v[120:123], a[24:27], v[92:95]
ds_read_b128 v[120:123], v2 offset:28672
v_cvt_pk_bf16_f32 v156, v56, v57
v_cvt_pk_bf16_f32 v157, v58, v59
v_mfma_f32_16x16x32_bf16 v[92:95], v[124:127], a[28:31], v[92:95]
ds_read_b128 v[124:127], v2 offset:29696
v_cvt_pk_bf16_f32 v158, v60, v61
s_waitcnt lgkmcnt(4)
v_mfma_f32_16x16x32_bf16 v[80:83], v[128:131], a[32:35], v[80:83]
buffer_load_dwordx4 v1, s[4:7], s30 offen offset:3072 sc1 lds
v_cvt_pk_bf16_f32 v159, v62, v63
v_mfma_f32_16x16x32_bf16 v[80:83], v[132:135], a[36:39], v[80:83]
buffer_store_dwordx4 v[156:159], v232, s[4:7], s74 offen offset:256 sc1
v_mul_f32 v64, v18, v64
v_mfma_f32_16x16x32_bf16 v[88:91], v[128:131], a[40:43], v[88:91]
ds_read_b128 v[128:131], v2 offset:30720
v_mul_f32 v65, v18, v65
v_mul_f32 v66, v18, v66
v_mfma_f32_16x16x32_bf16 v[88:91], v[132:135], a[44:47], v[88:91]
ds_read_b128 v[132:135], v2 offset:31744
v_mul_f32 v67, v18, v67
s_waitcnt vmcnt(15)
s_barrier
s_waitcnt lgkmcnt(4)
v_mfma_f32_16x16x32_bf16 v[84:87], v[112:115], a[32:35], v[84:87]
v_mul_f32 v68, v18, v68
v_mul_f32 v69, v18, v69
v_mul_f32 v70, v18, v70
v_mfma_f32_16x16x32_bf16 v[84:87], v[116:119], a[36:39], v[84:87]
v_mul_f32 v71, v18, v71
v_cvt_pk_bf16_f32 v160, v64, v65
v_cvt_pk_bf16_f32 v161, v66, v67
v_mfma_f32_16x16x32_bf16 v[92:95], v[112:115], a[40:43], v[92:95]
ds_read_b128 v[112:115], v2 offset:32768
v_cvt_pk_bf16_f32 v162, v68, v69
v_cvt_pk_bf16_f32 v163, v70, v71
v_mfma_f32_16x16x32_bf16 v[92:95], v[116:119], a[44:47], v[92:95]
ds_read_b128 v[116:119], v2 offset:33792
PG_s3:
s_cbranch_execz PG_b1
v_mul_f32 v72, v44, v72
s_waitcnt lgkmcnt(4)
v_mfma_f32_16x16x32_bf16 v[80:83], v[120:123], a[48:51], v[80:83]
buffer_store_dwordx4 v[160:163], v233, s[4:7], s74 offen offset:2048 sc1
v_mul_f32 v73, v44, v73
v_mfma_f32_16x16x32_bf16 v[80:83], v[124:127], a[52:55], v[80:83]
v_mul_f32 v74, v44, v74
v_mul_f32 v75, v44, v75
v_mul_f32 v76, v44, v76
v_mfma_f32_16x16x32_bf16 v[88:91], v[120:123], a[56:59], v[88:91]
ds_read_b128 v[120:123], v2 offset:34816
v_mul_f32 v77, v44, v77
v_mul_f32 v78, v44, v78
v_mfma_f32_16x16x32_bf16 v[88:91], v[124:127], a[60:63], v[88:91]
ds_read_b128 v[124:127], v2 offset:35840
v_mul_f32 v79, v44, v79
s_waitcnt lgkmcnt(4)
v_mfma_f32_16x16x32_bf16 v[84:87], v[128:131], a[48:51], v[84:87]
v_cvt_pk_bf16_f32 v164, v72, v73
v_cvt_pk_bf16_f32 v165, v74, v75
v_cvt_pk_bf16_f32 v166, v76, v77
v_mfma_f32_16x16x32_bf16 v[84:87], v[132:135], a[52:55], v[84:87]
v_cvt_pk_bf16_f32 v167, v78, v79
v_mul_f32 v214, 0x3ea52b5c, v18
v_mul_f32 v215, 0x3ea52b5c, v44
v_mfma_f32_16x16x32_bf16 v[92:95], v[128:131], a[56:59], v[92:95]
ds_read_b128 v[128:131], v2 offset:36864
v_mfma_f32_16x16x32_bf16 v[92:95], v[132:135], a[60:63], v[92:95]
ds_read_b128 v[132:135], v2 offset:37888
s_waitcnt lgkmcnt(4)
v_mfma_f32_16x16x32_bf16 v[80:83], v[112:115], a[64:67], v[80:83]
buffer_store_dwordx4 v[164:167], v233, s[4:7], s74 offen offset:2304 sc1
v_mfma_f32_16x16x32_bf16 v[80:83], v[116:119], a[68:71], v[80:83]
s_mov_b32 vcc_lo, -1
s_mov_b32 vcc_hi, 0
v_cndmask_b32 v45, v214, v18, vcc
v_cndmask_b32 v46, v215, v44, vcc
v_mfma_f32_16x16x32_bf16 v[88:91], v[112:115], a[72:75], v[88:91]
ds_read_b128 v[112:115], v2 offset:38912
v_mov_b32 v228, 0x3f803f80
v_mov_b32 v229, 0x3f803f80
v_mfma_f32_16x16x32_bf16 v[88:91], v[116:119], a[76:79], v[88:91]
ds_read_b128 v[116:119], v2 offset:39936
v_mov_b32 v230, 0x3f803f80
s_waitcnt lgkmcnt(4)
v_mfma_f32_16x16x32_bf16 v[84:87], v[120:123], a[64:67], v[84:87]
v_mov_b32 v231, 0x3f803f80
v_cndmask_b32 v216, 0, -1, s[32:33]
v_cndmask_b32 v217, 0, -1, s[34:35]
v_mfma_f32_16x16x32_bf16 v[84:87], v[124:127], a[68:71], v[84:87]
v_and_b32 v216, 0xffff, v216
v_lshl_or_b32 v188, v217, 16, v216
v_cndmask_b32 v216, 0, -1, s[36:37]
v_mfma_f32_16x16x32_bf16 v[92:95], v[120:123], a[72:75], v[92:95]
ds_read_b128 v[120:123], v2 offset:40960
v_cndmask_b32 v217, 0, -1, s[38:39]
v_and_b32 v216, 0xffff, v216
v_mfma_f32_16x16x32_bf16 v[92:95], v[124:127], a[76:79], v[92:95]
ds_read_b128 v[124:127], v2 offset:41984
v_lshl_or_b32 v189, v217, 16, v216
s_waitcnt lgkmcnt(4)
v_mfma_f32_16x16x32_bf16 v[80:83], v[128:131], a[80:83], v[80:83]
v_cndmask_b32 v216, 0, -1, s[40:41]
v_cndmask_b32 v217, 0, -1, s[42:43]
v_mfma_f32_16x16x32_bf16 v[80:83], v[132:135], a[84:87], v[80:83]
v_and_b32 v216, 0xffff, v216
v_lshl_or_b32 v190, v217, 16, v216
v_mfma_f32_16x16x32_bf16 v[88:91], v[128:131], a[88:91], v[88:91]
ds_read_b128 v[128:131], v2 offset:43008
v_cndmask_b32 v216, 0, -1, s[44:45]
v_mfma_f32_16x16x32_bf16 v[88:91], v[132:135], a[92:95], v[88:91]
ds_read_b128 v[132:135], v2 offset:44032
s_waitcnt lgkmcnt(4)
v_mfma_f32_16x16x32_bf16 v[84:87], v[112:115], a[80:83], v[84:87]
v_cndmask_b32 v217, 0, -1, s[46:47]
v_and_b32 v216, 0xffff, v216
v_mfma_f32_16x16x32_bf16 v[84:87], v[116:119], a[84:87], v[84:87]
v_lshl_or_b32 v191, v217, 16, v216
v_cndmask_b32 v216, 0, -1, s[48:49]
v_mfma_f32_16x16x32_bf16 v[92:95], v[112:115], a[88:91], v[92:95]
ds_read_b128 v[112:115], v2 offset:45056
v_cndmask_b32 v217, 0, -1, s[50:51]
v_mfma_f32_16x16x32_bf16 v[92:95], v[116:119], a[92:95], v[92:95]
ds_read_b128 v[116:119], v2 offset:46080
s_waitcnt lgkmcnt(4)
v_mfma_f32_16x16x32_bf16 v[80:83], v[120:123], a[96:99], v[80:83]
v_and_b32 v216, 0xffff, v216
v_lshl_or_b32 v192, v217, 16, v216
v_mfma_f32_16x16x32_bf16 v[80:83], v[124:127], a[100:103], v[80:83]
v_cndmask_b32 v216, 0, -1, s[52:53]
v_cndmask_b32 v217, 0, -1, s[54:55]
v_mfma_f32_16x16x32_bf16 v[88:91], v[120:123], a[104:107], v[88:91]
ds_read_b128 v[120:123], v2 offset:47104
v_and_b32 v216, 0xffff, v216
v_mfma_f32_16x16x32_bf16 v[88:91], v[124:127], a[108:111], v[88:91]
ds_read_b128 v[124:127], v2 offset:48128
s_waitcnt vmcnt(8)
s_barrier
s_cmp_lg_u32 s18, 0
s_cbranch_scc1 FG17
s_lshl_b32 s74, s17, 4
s_add_u32 s74, s74, s16
s_lshl_b32 s74, s74, 7
s_add_u32 s74, s74, 950272
buffer_store_dwordx2 v[248:249], v17, s[4:7], s74 offen sc1
FG17:
s_waitcnt lgkmcnt(4)
v_mfma_f32_16x16x32_bf16 v[84:87], v[128:131], a[96:99], v[84:87]
ds_write_b128 v235, v[152:155] offset:0
v_mfma_f32_16x16x32_bf16 v[84:87], v[132:135], a[100:103], v[84:87]
v_lshl_or_b32 v193, v217, 16, v216
v_cndmask_b32 v216, 0, -1, s[56:57]
v_mfma_f32_16x16x32_bf16 v[92:95], v[128:131], a[104:107], v[92:95]
ds_read_b128 v[128:131], v2 offset:49152
v_cndmask_b32 v217, 0, -1, s[58:59]
v_mfma_f32_16x16x32_bf16 v[92:95], v[132:135], a[108:111], v[92:95]
ds_read_b128 v[132:135], v2 offset:50176
s_waitcnt lgkmcnt(5)
v_mfma_f32_16x16x32_bf16 v[80:83], v[112:115], a[112:115], v[80:83]
ds_write_b128 v235, v[156:159] offset:256
v_mfma_f32_16x16x32_bf16 v[80:83], v[116:119], a[116:119], v[80:83]
v_and_b32 v216, 0xffff, v216
v_lshl_or_b32 v194, v217, 16, v216
v_mfma_f32_16x16x32_bf16 v[88:91], v[112:115], a[120:123], v[88:91]
ds_read_b128 v[112:115], v2 offset:51200
v_cndmask_b32 v216, 0, -1, s[60:61]
v_mfma_f32_16x16x32_bf16 v[88:91], v[116:119], a[124:127], v[88:91]
ds_read_b128 v[116:119], v2 offset:52224
s_waitcnt lgkmcnt(6)
v_mfma_f32_16x16x32_bf16 v[84:87], v[120:123], a[112:115], v[84:87]
ds_write_b128 v236, v[160:163] offset:2048
v_mfma_f32_16x16x32_bf16 v[84:87], v[124:127], a[116:119], v[84:87]
v_cndmask_b32 v217, 0, -1, s[62:63]
v_and_b32 v216, 0xffff, v216
v_mfma_f32_16x16x32_bf16 v[92:95], v[120:123], a[120:123], v[92:95]
ds_read_b128 v[120:123], v2 offset:53248
v_lshl_or_b32 v195, v217, 16, v216
v_mfma_f32_16x16x32_bf16 v[92:95], v[124:127], a[124:127], v[92:95]
ds_read_b128 v[124:127], v2 offset:54272
s_waitcnt lgkmcnt(6)
v_mfma_f32_16x16x32_bf16 v[80:83], v[128:131], a[128:131], v[80:83]
ds_write_b128 v236, v[164:167] offset:2304
v_mfma_f32_16x16x32_bf16 v[80:83], v[132:135], a[132:135], v[80:83]
v_lshrrev_b32 v216, 5, v0
v_bfe_u32 v217, v0, 2, 2
v_mfma_f32_16x16x32_bf16 v[88:91], v[128:131], a[136:139], v[88:91]
ds_read_b128 v[128:131], v2 offset:55296
v_lshl_add_u32 v216, v216, 2, v217
v_mfma_f32_16x16x32_bf16 v[88:91], v[132:135], a[140:143], v[88:91]
ds_read_b128 v[132:135], v2 offset:56320
s_waitcnt lgkmcnt(6)
v_mfma_f32_16x16x32_bf16 v[84:87], v[112:115], a[128:131], v[84:87]
ds_write_b128 v1, v[228:231] offset:62976
v_mfma_f32_16x16x32_bf16 v[84:87], v[116:119], a[132:135], v[84:87]
v_bfe_u32 v217, v0, 4, 1
v_and_b32 v218, 3, v0
v_mfma_f32_16x16x32_bf16 v[92:95], v[112:115], a[136:139], v[92:95]
ds_read_b128 v[112:115], v2 offset:57344
v_lshl_add_u32 v217, v217, 2, v218
v_mfma_f32_16x16x32_bf16 v[92:95], v[116:119], a[140:143], v[92:95]
ds_read_b128 v[116:119], v2 offset:58368
s_waitcnt lgkmcnt(6)
v_mfma_f32_16x16x32_bf16 v[80:83], v[120:123], a[144:147], v[80:83]
ds_write_b128 v1, v[228:231] offset:64000
v_mfma_f32_16x16x32_bf16 v[80:83], v[124:127], a[148:151], v[80:83]
v_and_b32 v218, 1, v0
v_lshlrev_b32 v219, 2, v218
v_mfma_f32_16x16x32_bf16 v[88:91], v[120:123], a[152:155], v[88:91]
ds_read_b128 v[120:123], v2 offset:59392
v_mfma_f32_16x16x32_bf16 v[88:91], v[124:127], a[156:159], v[88:91]
ds_read_b128 v[124:127], v2 offset:60416
s_waitcnt lgkmcnt(6)
v_mfma_f32_16x16x32_bf16 v[84:87], v[128:131], a[144:147], v[84:87]
v_mfma_f32_16x16x32_bf16 v[84:87], v[132:135], a[148:151], v[84:87]
v_mfma_f32_16x16x32_bf16 v[92:95], v[128:131], a[152:155], v[92:95]
ds_read_b128 v[128:131], v2 offset:61440
v_mfma_f32_16x16x32_bf16 v[92:95], v[132:135], a[156:159], v[92:95]
ds_read_b128 v[132:135], v2 offset:62464
v_mfma_f32_16x16x16_bf16 v[80:83], v[144:145], v[40:41], v[80:83]
s_waitcnt vmcnt(0)
buffer_atomic_add v9, v8, s[4:7], s91 offen offset:0 sc1
v_mfma_f32_16x16x16_bf16 v[88:91], v[144:145], v[42:43], v[88:91]
v_mfma_f32_16x16x16_bf16 v[84:87], v[146:147], v[40:41], v[84:87]
v_mfma_f32_16x16x16_bf16 v[92:95], v[146:147], v[42:43], v[92:95]
s_waitcnt lgkmcnt(5)
v_mfma_f32_16x16x32_bf16 v[96:99], v[112:115], a[0:3], 0
v_mfma_f32_16x16x32_bf16 v[96:99], v[116:119], a[4:7], v[96:99]
s_barrier
v_mfma_f32_16x16x32_bf16 v[104:107], v[112:115], a[8:11], 0
ds_read_b128 v[112:115], v2 offset:63488
v_mfma_f32_16x16x32_bf16 v[104:107], v[116:119], a[12:15], v[104:107]
ds_read_b128 v[116:119], v2 offset:64512
s_waitcnt lgkmcnt(4)
v_mfma_f32_16x16x32_bf16 v[100:103], v[120:123], a[0:3], 0
v_mul_f32 v80, v45, v80
v_mul_f32 v81, v45, v81
v_mfma_f32_16x16x32_bf16 v[100:103], v[124:127], a[4:7], v[100:103]
v_mul_f32 v82, v45, v82
v_mul_f32 v83, v45, v83
v_mfma_f32_16x16x32_bf16 v[108:111], v[120:123], a[8:11], 0
ds_read_b128 v[120:123], v3 offset:0
v_mul_f32 v84, v45, v84
v_mfma_f32_16x16x32_bf16 v[108:111], v[124:127], a[12:15], v[108:111]
ds_read_b128 v[124:127], v3 offset:1024
s_waitcnt lgkmcnt(4)
v_mfma_f32_16x16x32_bf16 v[96:99], v[128:131], a[16:19], v[96:99]
v_mul_f32 v85, v45, v85
v_mul_f32 v86, v45, v86
v_mfma_f32_16x16x32_bf16 v[96:99], v[132:135], a[20:23], v[96:99]
v_mul_f32 v87, v45, v87
v_cvt_pk_bf16_f32 v48, v80, v81
v_mfma_f32_16x16x32_bf16 v[104:107], v[128:131], a[24:27], v[104:107]
ds_read_b128 v[128:131], v3 offset:2048
v_cvt_pk_bf16_f32 v49, v82, v83
v_mfma_f32_16x16x32_bf16 v[104:107], v[132:135], a[28:31], v[104:107]
ds_read_b128 v[132:135], v3 offset:3072
s_waitcnt lgkmcnt(4)
v_mfma_f32_16x16x32_bf16 v[100:103], v[112:115], a[16:19], v[100:103]
v_cvt_pk_bf16_f32 v50, v84, v85
v_cvt_pk_bf16_f32 v51, v86, v87
v_mfma_f32_16x16x32_bf16 v[100:103], v[116:119], a[20:23], v[100:103]
s_add_u32 s74, s29, 134217728
v_mul_f32 v88, v46, v88
v_mfma_f32_16x16x32_bf16 v[108:111], v[112:115], a[24:27], v[108:111]
ds_read_b128 v[112:115], v3 offset:4096
v_mul_f32 v89, v46, v89
v_mfma_f32_16x16x32_bf16 v[108:111], v[116:119], a[28:31], v[108:111]
ds_read_b128 v[116:119], v3 offset:5120
s_waitcnt lgkmcnt(4)
v_mfma_f32_16x16x32_bf16 v[96:99], v[120:123], a[32:35], v[96:99]
buffer_store_dwordx4 v[48:51], v234, s[4:7], s74 offen offset:3072 sc1
v_mfma_f32_16x16x32_bf16 v[96:99], v[124:127], a[36:39], v[96:99]
ds_write_b128 v237, v[48:51]
v_mfma_f32_16x16x32_bf16 v[104:107], v[120:123], a[40:43], v[104:107]
ds_read_b128 v[120:123], v3 offset:6144
v_mul_f32 v90, v46, v90
v_mfma_f32_16x16x32_bf16 v[104:107], v[124:127], a[44:47], v[104:107]
ds_read_b128 v[124:127], v3 offset:7168
s_waitcnt lgkmcnt(5)
v_mfma_f32_16x16x32_bf16 v[100:103], v[128:131], a[32:35], v[100:103]
s_load_dword s15, s[4:5], s92 offset:0 glc
v_mul_f32 v91, v46, v91
v_mfma_f32_16x16x32_bf16 v[100:103], v[132:135], a[36:39], v[100:103]
v_mul_f32 v92, v46, v92
v_mul_f32 v93, v46, v93
v_mfma_f32_16x16x32_bf16 v[108:111], v[128:131], a[40:43], v[108:111]
ds_read_b128 v[128:131], v3 offset:8192
v_mul_f32 v94, v46, v94
v_mfma_f32_16x16x32_bf16 v[108:111], v[132:135], a[44:47], v[108:111]
ds_read_b128 v[132:135], v3 offset:9216
s_waitcnt lgkmcnt(5)
v_mfma_f32_16x16x32_bf16 v[96:99], v[112:115], a[48:51], v[96:99]
v_mul_f32 v95, v46, v95
v_cvt_pk_bf16_f32 v52, v88, v89
v_mfma_f32_16x16x32_bf16 v[96:99], v[116:119], a[52:55], v[96:99]
v_cvt_pk_bf16_f32 v53, v90, v91
v_cvt_pk_bf16_f32 v54, v92, v93
v_mfma_f32_16x16x32_bf16 v[104:107], v[112:115], a[56:59], v[104:107]
ds_read_b128 v[112:115], v3 offset:10240
v_cvt_pk_bf16_f32 v55, v94, v95
v_mfma_f32_16x16x32_bf16 v[104:107], v[116:119], a[60:63], v[104:107]
ds_read_b128 v[116:119], v3 offset:11264
buffer_store_dwordx4 v[52:55], v234, s[4:7], s74 offen offset:3328 sc1
s_waitcnt lgkmcnt(4)
v_mfma_f32_16x16x32_bf16 v[100:103], v[120:123], a[48:51], v[100:103]
ds_write_b128 v237, v[52:55] offset:256
v_mfma_f32_16x16x32_bf16 v[100:103], v[124:127], a[52:55], v[100:103]
ds_read_b128 v[172:175], v239
v_xor_b32 v219, v219, v216
v_mfma_f32_16x16x32_bf16 v[108:111], v[120:123], a[56:59], v[108:111]
ds_read_b128 v[120:123], v3 offset:12288
v_lshlrev_b32 v219, 4, v219
v_mfma_f32_16x16x32_bf16 v[108:111], v[124:127], a[60:63], v[108:111]
ds_read_b128 v[124:127], v3 offset:13312
s_waitcnt lgkmcnt(6)
v_mfma_f32_16x16x32_bf16 v[96:99], v[128:131], a[64:67], v[96:99]
ds_read_b128 v[64:67], v47 offset:41984
v_lshl_add_u32 v219, v218, 9, v219
v_mfma_f32_16x16x32_bf16 v[96:99], v[132:135], a[68:71], v[96:99]
ds_read_b128 v[68:71], v47 offset:43008
v_bfe_u32 v220, v0, 1, 1
v_mfma_f32_16x16x32_bf16 v[104:107], v[128:131], a[72:75], v[104:107]
ds_read_b128 v[128:131], v3 offset:14336
v_lshl_add_u32 v220, v220, 3, v219
v_mfma_f32_16x16x32_bf16 v[104:107], v[132:135], a[76:79], v[104:107]
ds_read_b128 v[132:135], v3 offset:15360
s_waitcnt lgkmcnt(8)
v_mfma_f32_16x16x32_bf16 v[100:103], v[112:115], a[64:67], v[100:103]
ds_read_b64 v[72:73], v47 offset:46208
v_add_u32 v221, 4232, v219
v_mfma_f32_16x16x32_bf16 v[100:103], v[116:119], a[68:71], v[100:103]
v_mov_b32 v224, 128
v_mov_b32 v225, 5248
v_mfma_f32_16x16x32_bf16 v[108:111], v[112:115], a[72:75], v[108:111]
ds_read_b128 v[112:115], v3 offset:16384
v_subrev_u32 v226, v5, v47
v_mfma_f32_16x16x32_bf16 v[108:111], v[116:119], a[76:79], v[108:111]
ds_read_b128 v[116:119], v3 offset:17408
s_waitcnt lgkmcnt(7)
v_mfma_f32_16x16x32_bf16 v[96:99], v[120:123], a[80:83], v[96:99]
s_lshl_b32 s76, s18, 7
s_add_u32 s76, s76, 63104
v_mov_b32 v227, s76
v_mfma_f32_16x16x32_bf16 v[96:99], v[124:127], a[84:87], v[96:99]
v_add_u32 v222, 2048, v220
v_mfma_f32_16x16x32_bf16 v[104:107], v[120:123], a[88:91], v[104:107]
ds_read_b128 v[120:123], v3 offset:18432
v_mfma_f32_16x16x32_bf16 v[104:107], v[124:127], a[92:95], v[104:107]
ds_read_b128 v[124:127], v3 offset:19456
s_waitcnt lgkmcnt(0)
s_cmp_ge_u32 s15, s3
s_cbranch_scc0 SP18
BK19:
v_mfma_f32_16x16x32_bf16 v[100:103], v[128:131], a[80:83], v[100:103]
s_mul_i32 s75, s18, 10496
s_add_u32 m0, s75, 0
s_add_u32 s78, s89, 0
v_mfma_f32_16x16x32_bf16 v[100:103], v[132:135], a[84:87], v[100:103]
buffer_load_dwordx4 v1, s[4:7], s78 offen sc1 lds
v_mfma_f32_16x16x32_bf16 v[108:111], v[128:131], a[88:91], v[108:111]
ds_read_b128 v[128:131], v3 offset:20480
v_mfma_f32_16x16x32_bf16 v[108:111], v[132:135], a[92:95], v[108:111]
ds_read_b128 v[132:135], v3 offset:21504
v_mfma_f32_16x16x32_bf16 v[96:99], v[112:115], a[96:99], v[96:99]
buffer_load_dwordx4 v1, s[4:7], s78 offen offset:1024 sc1 lds
v_mfma_f32_16x16x32_bf16 v[96:99], v[116:119], a[100:103], v[96:99]
v_cmp_gt_u32 vcc, 4, v217
s_nop 1
v_cndmask_b32 v222, v221, v222, vcc
v_mfma_f32_16x16x32_bf16 v[104:107], v[112:115], a[104:107], v[104:107]
ds_read_b128 v[112:115], v3 offset:22528
v_add_u32 v222, v226, v222
v_mfma_f32_16x16x32_bf16 v[104:107], v[116:119], a[108:111], v[104:107]
ds_read_b128 v[116:119], v3 offset:23552
v_mfma_f32_16x16x32_bf16 v[100:103], v[120:123], a[96:99], v[100:103]
buffer_load_dwordx4 v1, s[4:7], s78 offen offset:2048 sc1 lds
v_mfma_f32_16x16x32_bf16 v[100:103], v[124:127], a[100:103], v[100:103]
v_cmp_gt_u32 s[76:77], 4, v217
v_cmp_eq_u32 vcc, 4, v217
s_nop 0
s_or_b64 vcc, vcc, s[76:77]
v_cndmask_b32 v196, v227, v222, vcc
v_cndmask_b32 v223, v224, v225, vcc
v_mfma_f32_16x16x32_bf16 v[108:111], v[120:123], a[104:107], v[108:111]
ds_read_b128 v[120:123], v3 offset:24576
v_add_u32 v197, v196, v223
v_mfma_f32_16x16x32_bf16 v[108:111], v[124:127], a[108:111], v[108:111]
ds_read_b128 v[124:127], v3 offset:25600
s_waitcnt lgkmcnt(4)
v_mfma_f32_16x16x32_bf16 v[96:99], v[128:131], a[112:115], v[96:99]
s_add_u32 m0, s75, 4224
s_add_u32 s78, s78, 4096
v_mfma_f32_16x16x32_bf16 v[96:99], v[132:135], a[116:119], v[96:99]
buffer_load_dwordx4 v1, s[4:7], s78 offen sc1 lds
v_mfma_f32_16x16x32_bf16 v[104:107], v[128:131], a[120:123], v[104:107]
ds_read_b128 v[128:131], v3 offset:26624
v_add_u32 v198, v197, v223
v_mfma_f32_16x16x32_bf16 v[104:107], v[132:135], a[124:127], v[104:107]
ds_read_b128 v[132:135], v3 offset:27648
s_waitcnt lgkmcnt(4)
v_mfma_f32_16x16x32_bf16 v[100:103], v[112:115], a[112:115], v[100:103]
s_add_u32 m0, s75, 5248
s_add_u32 s78, s89, s90
v_add_u32 v199, v198, v223
v_mfma_f32_16x16x32_bf16 v[100:103], v[116:119], a[116:119], v[100:103]
buffer_load_dwordx4 v1, s[4:7], s78 offen sc1 lds
v_add_u32 v200, v199, v223
v_add_u32 v201, v200, v223
v_mfma_f32_16x16x32_bf16 v[108:111], v[112:115], a[120:123], v[108:111]
ds_read_b128 v[112:115], v3 offset:28672
v_add_u32 v202, v201, v223
v_add_u32 v203, v202, v223
v_mfma_f32_16x16x32_bf16 v[108:111], v[116:119], a[124:127], v[108:111]
ds_read_b128 v[116:119], v3 offset:29696
v_add_u32 v204, v203, v223
v_add_u32 v222, 3072, v220
s_waitcnt lgkmcnt(4)
v_mfma_f32_16x16x32_bf16 v[96:99], v[120:123], a[128:131], v[96:99]
buffer_load_dwordx4 v1, s[4:7], s78 offen offset:1024 sc1 lds
v_cmp_gt_u32 vcc, 4, v217
s_nop 1
v_cndmask_b32 v222, v221, v222, vcc
v_mfma_f32_16x16x32_bf16 v[96:99], v[124:127], a[132:135], v[96:99]
buffer_load_dwordx4 v1, s[4:7], s78 offen offset:2048 sc1 lds
v_add_u32 v222, v226, v222
v_cmp_gt_u32 s[76:77], 4, v217
v_cmp_eq_u32 vcc, 5, v217
s_nop 0
s_or_b64 vcc, vcc, s[76:77]
v_cndmask_b32 v205, v227, v222, vcc
v_cndmask_b32 v223, v224, v225, vcc
v_mfma_f32_16x16x32_bf16 v[104:107], v[120:123], a[136:139], v[104:107]
ds_read_b128 v[120:123], v3 offset:30720
v_add_u32 v206, v205, v223
v_mfma_f32_16x16x32_bf16 v[104:107], v[124:127], a[140:143], v[104:107]
ds_read_b128 v[124:127], v3 offset:31744
s_waitcnt lgkmcnt(4)
v_mfma_f32_16x16x32_bf16 v[100:103], v[128:131], a[128:131], v[100:103]
s_add_u32 m0, s75, 9472
s_add_u32 s78, s78, 4096
buffer_load_dwordx4 v1, s[4:7], s78 offen sc1 lds
v_add_u32 v207, v206, v223
v_mfma_f32_16x16x32_bf16 v[100:103], v[132:135], a[132:135], v[100:103]
v_add_u32 v208, v207, v223
v_add_u32 v209, v208, v223
v_mfma_f32_16x16x32_bf16 v[108:111], v[128:131], a[136:139], v[108:111]
v_add_u32 v210, v209, v223
v_add_u32 v211, v210, v223
v_mfma_f32_16x16x32_bf16 v[108:111], v[132:135], a[140:143], v[108:111]
v_add_u32 v212, v211, v223
v_add_u32 v213, v212, v223
s_waitcnt lgkmcnt(2)
v_mfma_f32_16x16x32_bf16 v[96:99], v[112:115], a[144:147], v[96:99]
v_accvgpr_write_b32 a2, s80
v_accvgpr_write_b32 a3, 0
v_mfma_f32_16x16x32_bf16 v[96:99], v[116:119], a[148:151], v[96:99]
v_accvgpr_write_b32 a6, s81
v_accvgpr_write_b32 a7, 0
v_mfma_f32_16x16x32_bf16 v[104:107], v[112:115], a[152:155], v[104:107]
v_accvgpr_write_b32 a10, s82
v_accvgpr_write_b32 a11, 0
v_mfma_f32_16x16x32_bf16 v[104:107], v[116:119], a[156:159], v[104:107]
v_accvgpr_write_b32 a14, s83
v_accvgpr_write_b32 a15, 0
s_waitcnt lgkmcnt(0)
v_mfma_f32_16x16x32_bf16 v[100:103], v[120:123], a[144:147], v[100:103]
v_accvgpr_write_b32 a18, s84
v_accvgpr_write_b32 a19, 0
v_mfma_f32_16x16x32_bf16 v[100:103], v[124:127], a[148:151], v[100:103]
v_accvgpr_write_b32 a22, s85
v_accvgpr_write_b32 a23, 0
v_mfma_f32_16x16x32_bf16 v[108:111], v[120:123], a[152:155], v[108:111]
s_waitcnt vmcnt(8)
buffer_atomic_add v9, v8, s[4:7], s91 offen offset:4 sc1
v_accvgpr_write_b32 a26, s86
v_accvgpr_write_b32 a27, 0
v_mfma_f32_16x16x32_bf16 v[108:111], v[124:127], a[156:159], v[108:111]
v_accvgpr_write_b32 a30, s87
v_accvgpr_write_b32 a31, 0
v_mfma_f32_16x16x16_bf16 v[96:99], v[148:149], v[40:41], v[96:99]
v_accvgpr_write_b32 a34, s88
v_accvgpr_write_b32 a35, 0
v_mfma_f32_16x16x16_bf16 v[104:107], v[148:149], v[42:43], v[104:107]
v_mov_b32 v183, 0
v_mov_b32 v187, 0
v_mfma_f32_16x16x16_bf16 v[100:103], v[150:151], v[40:41], v[100:103]
v_mov_b32 v164, -1
v_mov_b32 v165, -1
v_mfma_f32_16x16x16_bf16 v[108:111], v[150:151], v[42:43], v[108:111]
v_mov_b32 v166, -1
v_mov_b32 v167, -1
buffer_load_dwordx2 v[242:243], v241, s[4:7], 0 offen sc1
v_pk_mul_f32 v[96:97], v[96:97], v[214:215] op_sel:[0,0] op_sel_hi:[1,0]
v_pk_mul_f32 v[98:99], v[98:99], v[214:215] op_sel:[0,0] op_sel_hi:[1,0]
v_pk_mul_f32 v[100:101], v[100:101], v[214:215] op_sel:[0,0] op_sel_hi:[1,0]
v_pk_mul_f32 v[102:103], v[102:103], v[214:215] op_sel:[0,0] op_sel_hi:[1,0]
v_cvt_pk_bf16_f32 v56, v96, v97
v_cvt_pk_bf16_f32 v57, v98, v99
v_cvt_pk_bf16_f32 v58, v100, v101
v_cvt_pk_bf16_f32 v59, v102, v103
ds_write_b128 v238, v[56:59] offset:0
v_pk_mul_f32 v[104:105], v[104:105], v[214:215] op_sel:[0,1] op_sel_hi:[1,1]
v_pk_mul_f32 v[106:107], v[106:107], v[214:215] op_sel:[0,1] op_sel_hi:[1,1]
v_pk_mul_f32 v[108:109], v[108:109], v[214:215] op_sel:[0,1] op_sel_hi:[1,1]
v_pk_mul_f32 v[110:111], v[110:111], v[214:215] op_sel:[0,1] op_sel_hi:[1,1]
v_cvt_pk_bf16_f32 v60, v104, v105
v_cvt_pk_bf16_f32 v61, v106, v107
v_cvt_pk_bf16_f32 v62, v108, v109
v_cvt_pk_bf16_f32 v63, v110, v111
ds_write_b128 v238, v[60:63] offset:256
ds_read_b64 v[180:181], v239 offset:2048
ds_read_b128 v[176:179], v239 offset:1024
s_mov_b32 vcc_lo, -1
s_mov_b32 vcc_hi, 0
s_waitcnt lgkmcnt(1)
v_cndmask_b32 v184, v180, v183, vcc
v_cndmask_b32 v180, 0, v180, vcc
v_cndmask_b32 v185, v181, v183, vcc
v_cndmask_b32 v181, 0, v181, vcc
v_dot2_f32_bf16 v216, v172, v64, 0
s_waitcnt lgkmcnt(0)
v_dot2_f32_bf16 v217, v176, v68, 0
v_dot2_f32_bf16 v216, v173, v65, v216
v_dot2_f32_bf16 v217, v177, v69, v217
v_dot2_f32_bf16 v216, v174, v66, v216
v_dot2_f32_bf16 v217, v178, v70, v217
v_dot2_f32_bf16 v216, v175, v67, v216
v_dot2_f32_bf16 v217, v179, v71, v217
v_dot2_f32_bf16 v216, v180, v72, v216
v_dot2_f32_bf16 v217, v184, v72, v217
v_dot2_f32_bf16 v216, v181, v73, v216
v_dot2_f32_bf16 v217, v185, v73, v217
s_mov_b32 s74, 0xfe967699
s_nop 0
v_cvt_pk_bf16_f32 v182, s74, -v216
v_cvt_pk_bf16_f32 v186, s74, -v217
s_waitcnt vmcnt(2)
s_barrier
ds_read_b128 a[36:39], v47 offset:36736
ds_read_b64 a[28:29], v47 offset:40960
ds_read_b128 a[40:43], v47 offset:31488
ds_read_b64 a[24:25], v47 offset:35712
ds_read_b128 a[44:47], v47 offset:26240
ds_read_b64 a[20:21], v47 offset:30464
s_waitcnt lgkmcnt(5)
v_mfma_f32_32x32x16_bf16 v[48:63], a[36:39], v[172:175], 0
s_waitcnt lgkmcnt(4)
v_mfma_f32_32x32x16_bf16 v[48:63], a[28:31], v[180:183], v[48:63]
s_waitcnt lgkmcnt(3)
v_mfma_f32_32x32x16_bf16 v[64:79], a[40:43], v[172:175], 0
ds_read_b128 a[36:39], v47 offset:20992
ds_read_b64 a[16:17], v47 offset:25216
ds_read_b64_tr_b16 a[48:49], v203 offset:0
s_nop 6
v_exp_f32 v48, v48
v_exp_f32 v49, v49
v_exp_f32 v50, v50
v_exp_f32 v51, v51
v_cvt_pk_bf16_f32 v96, v48, v49
v_exp_f32 v52, v52
v_exp_f32 v53, v53
v_cvt_pk_bf16_f32 v97, v50, v51
v_exp_f32 v54, v54
v_exp_f32 v55, v55
v_cvt_pk_bf16_f32 v98, v52, v53
v_exp_f32 v56, v56
s_waitcnt lgkmcnt(5)
v_mfma_f32_32x32x16_bf16 v[64:79], a[24:27], v[180:183], v[64:79]
ds_read_b64_tr_b16 a[50:51], v203 offset:128
ds_read_b64_tr_b16 a[52:53], v203 offset:256
ds_read_b64_tr_b16 a[54:55], v203 offset:384
s_and_b32 s74, s17, 3
s_lshl_b32 s75, s74, 10
s_add_u32 s75, s75, s28
s_add_u32 s75, s75, 67764224
s_add_u32 s76, s75, 4096
buffer_store_dwordx4 v[164:167], v1, s[4:7], s76 offen sc1
v_exp_f32 v57, v57
v_cvt_pk_bf16_f32 v99, v54, v55
v_exp_f32 v58, v58
v_exp_f32 v59, v59
v_cvt_pk_bf16_f32 v100, v56, v57
v_exp_f32 v60, v60
v_exp_f32 v61, v61
v_cvt_pk_bf16_f32 v101, v58, v59
v_exp_f32 v62, v62
v_exp_f32 v63, v63
v_cvt_pk_bf16_f32 v102, v60, v61
v_cvt_pk_bf16_f32 v103, v62, v63
s_waitcnt vmcnt(1)
v_cmp_ne_u64 vcc, v[242:243], v[248:249]
s_nop 0
s_cbranch_vccnz VS20
VB21:
s_waitcnt lgkmcnt(7)
v_mfma_f32_32x32x16_bf16 v[48:63], a[44:47], v[172:175], 0
ds_read_b128 a[40:43], v47 offset:15744
ds_read_b64 a[12:13], v47 offset:19968
s_add_u32 s31, s23, 0
buffer_load_dwordx4 a[160:163], v1, s[4:7], s31 offen offset:0 sc1
v_exp_f32 v64, v64
v_exp_f32 v65, v65
v_exp_f32 v66, v66
v_exp_f32 v67, v67
v_cvt_pk_bf16_f32 v104, v64, v65
v_exp_f32 v68, v68
s_waitcnt lgkmcnt(8)
v_mfma_f32_32x32x16_bf16 v[48:63], a[20:23], v[180:183], v[48:63]
ds_read_b64_tr_b16 a[56:57], v202 offset:0
ds_read_b64_tr_b16 a[58:59], v202 offset:128
buffer_load_dwordx4 a[164:167], v1, s[4:7], s31 offen offset:1024 sc1
s_lshl_b32 s74, s17, 9
s_add_u32 s74, s74, s26
s_add_u32 s74, s74, 67829760
buffer_store_dwordx2 v[164:165], v16, s[4:7], s74 offen sc1
v_exp_f32 v69, v69
v_cvt_pk_bf16_f32 v105, v66, v67
v_exp_f32 v70, v70
v_exp_f32 v71, v71
v_cvt_pk_bf16_f32 v106, v68, v69
v_exp_f32 v72, v72
s_waitcnt lgkmcnt(4)
v_mfma_f32_32x32x16_bf16 v[120:135], a[48:51], v[96:99], 0
ds_read_b64_tr_b16 a[60:61], v202 offset:256
s_load_dword s15, s[4:5], s92 offset:4 glc
v_exp_f32 v73, v73
v_cvt_pk_bf16_f32 v107, v70, v71
v_exp_f32 v74, v74
v_exp_f32 v75, v75
v_cvt_pk_bf16_f32 v108, v72, v73
v_exp_f32 v76, v76
v_mfma_f32_32x32x16_bf16 v[120:135], a[52:55], v[100:103], v[120:135]
ds_read_b64_tr_b16 a[62:63], v202 offset:384
buffer_load_dwordx4 a[168:171], v1, s[4:7], s31 offen offset:2048 sc1
v_exp_f32 v77, v77
v_cvt_pk_bf16_f32 v109, v74, v75
v_exp_f32 v78, v78
v_exp_f32 v79, v79
v_cvt_pk_bf16_f32 v110, v76, v77
v_cvt_pk_bf16_f32 v111, v78, v79
v_mfma_f32_32x32x16_bf16 v[64:79], a[36:39], v[172:175], 0
ds_read_b128 a[44:47], v47 offset:10496
ds_read_b64 a[8:9], v47 offset:14720
v_exp_f32 v48, v48
v_exp_f32 v49, v49
v_exp_f32 v50, v50
v_exp_f32 v51, v51
v_cvt_pk_bf16_f32 v96, v48, v49
v_exp_f32 v52, v52
v_mfma_f32_32x32x16_bf16 v[64:79], a[16:19], v[180:183], v[64:79]
ds_read_b64_tr_b16 a[64:65], v201 offset:0
ds_read_b64_tr_b16 a[66:67], v201 offset:128
PG_s4:
s_cbranch_execz PG_b1
buffer_load_dwordx4 a[172:175], v1, s[4:7], s31 offen offset:3072 sc1
v_exp_f32 v53, v53
v_cvt_pk_bf16_f32 v97, v50, v51
v_exp_f32 v54, v54
v_exp_f32 v55, v55
v_cvt_pk_bf16_f32 v98, v52, v53
v_exp_f32 v56, v56
s_waitcnt lgkmcnt(4)
v_mfma_f32_32x32x16_bf16 v[120:135], a[56:59], v[104:107], v[120:135]
ds_read_b64_tr_b16 a[68:69], v201 offset:256
v_exp_f32 v57, v57
v_cvt_pk_bf16_f32 v99, v54, v55
v_exp_f32 v58, v58
v_exp_f32 v59, v59
v_cvt_pk_bf16_f32 v100, v56, v57
v_exp_f32 v60, v60
v_mfma_f32_32x32x16_bf16 v[120:135], a[60:63], v[108:111], v[120:135]
ds_read_b64_tr_b16 a[70:71], v201 offset:384
v_exp_f32 v61, v61
v_cvt_pk_bf16_f32 v101, v58, v59
v_exp_f32 v62, v62
v_exp_f32 v63, v63
v_cvt_pk_bf16_f32 v102, v60, v61
v_cvt_pk_bf16_f32 v103, v62, v63
v_mfma_f32_32x32x16_bf16 v[48:63], a[40:43], v[172:175], 0
ds_read_b128 a[36:39], v47 offset:5248
ds_read_b64 a[4:5], v47 offset:9472
v_exp_f32 v64, v64
v_exp_f32 v65, v65
v_exp_f32 v66, v66
v_exp_f32 v67, v67
v_cvt_pk_bf16_f32 v104, v64, v65
v_exp_f32 v68, v68
v_mfma_f32_32x32x16_bf16 v[48:63], a[12:15], v[180:183], v[48:63]
ds_read_b64_tr_b16 a[48:49], v200 offset:0
ds_read_b64_tr_b16 a[50:51], v200 offset:128
v_exp_f32 v69, v69
v_cvt_pk_bf16_f32 v105, v66, v67
v_exp_f32 v70, v70
v_exp_f32 v71, v71
v_cvt_pk_bf16_f32 v106, v68, v69
v_exp_f32 v72, v72
s_waitcnt lgkmcnt(4)
s_waitcnt lgkmcnt(0)
s_cmp_ge_u32 s15, s3
s_cbranch_scc0 SP22
BK23:
v_mfma_f32_32x32x16_bf16 v[120:135], a[64:67], v[96:99], v[120:135]
ds_read_b64_tr_b16 a[52:53], v200 offset:256
s_mul_i32 s77, s18, 10496
s_add_u32 m0, s77, 0
s_add_u32 s78, s89, 0
buffer_load_dwordx4 v1, s[4:7], s78 offen offset:3072 sc1 lds
v_exp_f32 v73, v73
v_cvt_pk_bf16_f32 v107, v70, v71
v_exp_f32 v74, v74
v_exp_f32 v75, v75
v_cvt_pk_bf16_f32 v108, v72, v73
v_exp_f32 v76, v76
v_mfma_f32_32x32x16_bf16 v[120:135], a[68:71], v[100:103], v[120:135]
ds_read_b64_tr_b16 a[54:55], v200 offset:384
s_mul_i32 s77, s18, 10496
s_add_u32 m0, s77, 5248
s_add_u32 s78, s89, s90
buffer_load_dwordx4 v1, s[4:7], s78 offen offset:3072 sc1 lds
v_exp_f32 v77, v77
v_cvt_pk_bf16_f32 v109, v74, v75
v_exp_f32 v78, v78
v_exp_f32 v79, v79
v_cvt_pk_bf16_f32 v110, v76, v77
v_cvt_pk_bf16_f32 v111, v78, v79
v_mfma_f32_32x32x16_bf16 v[64:79], a[44:47], v[172:175], 0
ds_read_b128 a[40:43], v47 offset:41984
ds_read_b64 a[32:33], v47 offset:46208
s_add_u32 s31, s23, 4096
buffer_load_dwordx4 a[176:179], v1, s[4:7], s31 offen offset:0 sc1
v_exp_f32 v48, v48
v_exp_f32 v49, v49
v_exp_f32 v50, v50
v_exp_f32 v51, v51
v_cvt_pk_bf16_f32 v96, v48, v49
v_exp_f32 v52, v52
v_mfma_f32_32x32x16_bf16 v[64:79], a[8:11], v[180:183], v[64:79]
ds_read_b64_tr_b16 a[56:57], v199 offset:0
ds_read_b64_tr_b16 a[58:59], v199 offset:128
buffer_load_dwordx4 a[180:183], v1, s[4:7], s31 offen offset:1024 sc1
v_exp_f32 v53, v53
v_cvt_pk_bf16_f32 v97, v50, v51
v_exp_f32 v54, v54
v_exp_f32 v55, v55
v_cvt_pk_bf16_f32 v98, v52, v53
v_exp_f32 v56, v56
s_waitcnt lgkmcnt(4)
v_mfma_f32_32x32x16_bf16 v[120:135], a[48:51], v[104:107], v[120:135]
ds_read_b64_tr_b16 a[60:61], v199 offset:256
buffer_load_dwordx4 a[184:187], v1, s[4:7], s31 offen offset:2048 sc1
v_exp_f32 v57, v57
v_cvt_pk_bf16_f32 v99, v54, v55
v_exp_f32 v58, v58
v_exp_f32 v59, v59
v_cvt_pk_bf16_f32 v100, v56, v57
v_exp_f32 v60, v60
v_mfma_f32_32x32x16_bf16 v[120:135], a[52:55], v[108:111], v[120:135]
ds_read_b64_tr_b16 a[62:63], v199 offset:384
buffer_load_dwordx4 a[188:191], v1, s[4:7], s31 offen offset:3072 sc1
v_exp_f32 v61, v61
v_cvt_pk_bf16_f32 v101, v58, v59
v_exp_f32 v62, v62
v_exp_f32 v63, v63
v_cvt_pk_bf16_f32 v102, v60, v61
v_cvt_pk_bf16_f32 v103, v62, v63
v_mfma_f32_32x32x16_bf16 v[48:63], a[36:39], v[172:175], 0
ds_read_b128 a[44:47], v47 offset:0
ds_read_b64 a[0:1], v47 offset:4224
s_add_u32 s31, s23, 8192
buffer_load_dwordx4 a[192:195], v1, s[4:7], s31 offen offset:0 sc1
v_exp_f32 v64, v64
v_exp_f32 v65, v65
v_exp_f32 v66, v66
v_exp_f32 v67, v67
v_cvt_pk_bf16_f32 v104, v64, v65
v_exp_f32 v68, v68
v_mfma_f32_32x32x16_bf16 v[48:63], a[4:7], v[180:183], v[48:63]
ds_read_b64_tr_b16 a[64:65], v198 offset:0
ds_read_b64_tr_b16 a[66:67], v198 offset:128
buffer_load_dwordx4 a[196:199], v1, s[4:7], s31 offen offset:1024 sc1
v_exp_f32 v69, v69
v_cvt_pk_bf16_f32 v105, v66, v67
v_exp_f32 v70, v70
v_exp_f32 v71, v71
v_cvt_pk_bf16_f32 v106, v68, v69
v_exp_f32 v72, v72
s_waitcnt lgkmcnt(4)
v_mfma_f32_32x32x16_bf16 v[120:135], a[56:59], v[96:99], v[120:135]
ds_read_b64_tr_b16 a[68:69], v198 offset:256
v_exp_f32 v73, v73
v_cvt_pk_bf16_f32 v107, v70, v71
v_exp_f32 v74, v74
v_exp_f32 v75, v75
v_cvt_pk_bf16_f32 v108, v72, v73
v_exp_f32 v76, v76
v_mfma_f32_32x32x16_bf16 v[120:135], a[60:63], v[100:103], v[120:135]
ds_read_b64_tr_b16 a[70:71], v198 offset:384
buffer_load_dwordx4 a[200:203], v1, s[4:7], s31 offen offset:2048 sc1
v_exp_f32 v77, v77
v_cvt_pk_bf16_f32 v109, v74, v75
v_exp_f32 v78, v78
v_exp_f32 v79, v79
v_cvt_pk_bf16_f32 v110, v76, v77
v_cvt_pk_bf16_f32 v111, v78, v79
v_mfma_f32_32x32x16_bf16 v[80:95], a[40:43], v[172:175], 0
ds_read_b128 a[36:39], v47 offset:37760
buffer_load_dwordx4 a[204:207], v1, s[4:7], s31 offen offset:3072 sc1
v_exp_f32 v48, v48
v_exp_f32 v49, v49
v_exp_f32 v50, v50
v_exp_f32 v51, v51
v_mfma_f32_32x32x16_bf16 v[80:95], a[32:35], v[180:183], v[80:95]
ds_read_b64_tr_b16 a[48:49], v197 offset:0
s_add_u32 s31, s23, 12288
buffer_load_dwordx4 a[208:211], v1, s[4:7], s31 offen offset:0 sc1
v_cvt_pk_bf16_f32 v96, v48, v49
v_exp_f32 v52, v52
v_exp_f32 v53, v53
v_cvt_pk_bf16_f32 v97, v50, v51
s_waitcnt lgkmcnt(6)
v_mfma_f32_32x32x16_bf16 v[64:79], a[44:47], v[172:175], 0
ds_read_b64_tr_b16 a[50:51], v197 offset:128
buffer_load_dwordx4 a[212:215], v1, s[4:7], s31 offen offset:1024 sc1
v_exp_f32 v54, v54
v_exp_f32 v55, v55
v_cvt_pk_bf16_f32 v98, v52, v53
v_exp_f32 v56, v56
v_mfma_f32_32x32x16_bf16 v[64:79], a[0:3], v[180:183], v[64:79]
ds_read_b64_tr_b16 a[52:53], v197 offset:256
buffer_load_dwordx4 a[216:219], v1, s[4:7], s31 offen offset:2048 sc1
v_exp_f32 v57, v57
v_cvt_pk_bf16_f32 v99, v54, v55
v_exp_f32 v58, v58
v_exp_f32 v59, v59
s_waitcnt lgkmcnt(4)
v_mfma_f32_32x32x16_bf16 v[120:135], a[64:67], v[104:107], v[120:135]
ds_read_b64_tr_b16 a[54:55], v197 offset:384
buffer_load_dwordx4 a[220:223], v1, s[4:7], s31 offen offset:3072 sc1
v_cvt_pk_bf16_f32 v100, v56, v57
v_exp_f32 v60, v60
v_exp_f32 v61, v61
v_cvt_pk_bf16_f32 v101, v58, v59
v_mfma_f32_32x32x16_bf16 v[120:135], a[68:71], v[108:111], v[120:135]
v_exp_f32 v62, v62
v_exp_f32 v63, v63
v_cvt_pk_bf16_f32 v102, v60, v61
v_cvt_pk_bf16_f32 v103, v62, v63
s_waitcnt lgkmcnt(2)
v_mfma_f32_32x32x16_bf16 v[120:135], a[48:51], v[96:99], v[120:135]
ds_read_b128 a[40:43], v47 offset:32512
ds_read_b128 a[44:47], v47 offset:27264
ds_read_b64_tr_b16 a[56:57], v204 offset:0
s_add_u32 s31, s23, 16384
buffer_load_dwordx4 a[224:227], v1, s[4:7], s31 offen offset:0 sc1
v_cndmask_b32 v80, v64, v80, s[32:33]
v_cndmask_b32 v81, v65, v81, s[34:35]
v_cndmask_b32 v82, v66, v82, s[36:37]
v_cndmask_b32 v83, v67, v83, s[38:39]
v_cndmask_b32 v84, v68, v84, s[40:41]
v_cndmask_b32 v85, v69, v85, s[42:43]
v_cndmask_b32 v86, v70, v86, s[44:45]
v_cndmask_b32 v87, v71, v87, s[46:47]
v_cndmask_b32 v88, v72, v88, s[48:49]
v_cndmask_b32 v89, v73, v89, s[50:51]
v_cndmask_b32 v90, v74, v90, s[52:53]
v_cndmask_b32 v91, v75, v91, s[54:55]
v_cndmask_b32 v92, v76, v92, s[56:57]
v_cndmask_b32 v93, v77, v93, s[58:59]
s_waitcnt lgkmcnt(3)
v_mfma_f32_32x32x16_bf16 v[120:135], a[52:55], v[100:103], v[120:135]
ds_read_b64_tr_b16 a[58:59], v204 offset:128
ds_read_b64_tr_b16 a[60:61], v204 offset:256
ds_read_b64_tr_b16 a[62:63], v204 offset:384
buffer_load_dwordx4 a[228:231], v1, s[4:7], s31 offen offset:1024 sc1
v_cndmask_b32 v94, v78, v94, s[60:61]
v_cndmask_b32 v95, v79, v95, s[62:63]
v_exp_f32 v80, v80
v_exp_f32 v81, v81
v_exp_f32 v82, v82
v_exp_f32 v83, v83
v_cvt_pk_bf16_f32 v104, v80, v81
v_exp_f32 v84, v84
v_exp_f32 v85, v85
v_cvt_pk_bf16_f32 v105, v82, v83
v_exp_f32 v86, v86
v_exp_f32 v87, v87
v_cvt_pk_bf16_f32 v106, v84, v85
v_exp_f32 v88, v88
v_mfma_f32_32x32x16_bf16 v[48:63], a[36:39], v[176:179], 0
ds_read_b64_tr_b16 a[64:65], v196 offset:0
ds_read_b64_tr_b16 a[66:67], v196 offset:128
buffer_load_dwordx4 a[232:235], v1, s[4:7], s31 offen offset:2048 sc1
v_exp_f32 v89, v89
v_cvt_pk_bf16_f32 v107, v86, v87
v_exp_f32 v90, v90
v_exp_f32 v91, v91
v_cvt_pk_bf16_f32 v108, v88, v89
v_exp_f32 v92, v92
v_exp_f32 v93, v93
v_cvt_pk_bf16_f32 v109, v90, v91
v_exp_f32 v94, v94
v_exp_f32 v95, v95
v_cvt_pk_bf16_f32 v110, v92, v93
v_cvt_pk_bf16_f32 v111, v94, v95
v_bfi_b32 v112, v188, 0, v104
v_bfi_b32 v113, v189, 0, v105
v_mfma_f32_32x32x16_bf16 v[48:63], a[28:31], v[184:187], v[48:63]
ds_read_b64_tr_b16 a[68:69], v196 offset:256
ds_read_b64_tr_b16 a[70:71], v196 offset:384
buffer_load_dwordx4 a[236:239], v1, s[4:7], s31 offen offset:3072 sc1
v_bfi_b32 v114, v190, 0, v106
v_bfi_b32 v115, v191, 0, v107
v_bfi_b32 v116, v192, 0, v108
v_bfi_b32 v117, v193, 0, v109
v_bfi_b32 v118, v194, 0, v110
v_bfi_b32 v119, v195, 0, v111
v_and_b32 v104, v188, v104
v_and_b32 v105, v189, v105
v_and_b32 v106, v190, v106
v_and_b32 v107, v191, v107
v_and_b32 v108, v192, v108
v_and_b32 v109, v193, v109
v_and_b32 v110, v194, v110
v_and_b32 v111, v195, v111
s_waitcnt vmcnt(16)
s_barrier
s_waitcnt lgkmcnt(9)
v_mfma_f32_32x32x16_bf16 v[64:79], a[40:43], v[176:179], 0
ds_read_b128 a[36:39], v47 offset:22016
s_add_u32 s31, s23, 20480
buffer_load_dwordx4 a[240:243], v1, s[4:7], s31 offen offset:0 sc1
buffer_atomic_add v9, v8, s[4:7], s27 offen offset:16 sc1
v_exp_f32 v48, v48
v_exp_f32 v49, v49
v_exp_f32 v50, v50
v_exp_f32 v51, v51
v_mfma_f32_32x32x16_bf16 v[64:79], a[24:27], v[184:187], v[64:79]
ds_read_b64_tr_b16 a[48:49], v212 offset:0
buffer_load_dwordx4 a[244:247], v1, s[4:7], s31 offen offset:1024 sc1
v_cvt_pk_bf16_f32 v96, v48, v49
v_exp_f32 v52, v52
v_exp_f32 v53, v53
v_cvt_pk_bf16_f32 v97, v50, v51
s_waitcnt lgkmcnt(6)
v_mfma_f32_32x32x16_bf16 v[120:135], a[56:59], v[104:107], v[120:135]
ds_read_b64_tr_b16 a[50:51], v212 offset:128
v_exp_f32 v54, v54
v_exp_f32 v55, v55
v_cvt_pk_bf16_f32 v98, v52, v53
v_exp_f32 v56, v56
v_mfma_f32_32x32x16_bf16 v[120:135], a[60:63], v[108:111], v[120:135]
ds_read_b64_tr_b16 a[52:53], v212 offset:256
buffer_load_dwordx4 a[248:251], v1, s[4:7], s31 offen offset:2048 sc1
v_exp_f32 v57, v57
v_cvt_pk_bf16_f32 v99, v54, v55
v_exp_f32 v58, v58
v_exp_f32 v59, v59
s_waitcnt lgkmcnt(4)
v_mfma_f32_32x32x16_bf16 v[120:135], a[64:67], v[112:115], v[120:135]
ds_read_b64_tr_b16 a[54:55], v212 offset:384
buffer_load_dwordx4 a[252:255], v1, s[4:7], s31 offen offset:3072 sc1
v_cvt_pk_bf16_f32 v100, v56, v57
v_exp_f32 v60, v60
v_exp_f32 v61, v61
v_cvt_pk_bf16_f32 v101, v58, v59
v_mfma_f32_32x32x16_bf16 v[120:135], a[68:71], v[116:119], v[120:135]
s_add_u32 s31, s23, 24576
buffer_load_dwordx4 v[244:247], v1, s[4:7], s31 offen offset:0 sc1
v_exp_f32 v62, v62
v_exp_f32 v63, v63
v_cvt_pk_bf16_f32 v102, v60, v61
v_cvt_pk_bf16_f32 v103, v62, v63
v_mfma_f32_32x32x16_bf16 v[48:63], a[44:47], v[176:179], 0
ds_read_b128 a[40:43], v47 offset:16768
ds_read_b64_tr_b16 a[56:57], v211 offset:0
s_add_u32 m0, s25, 65536
s_add_u32 s30, s22, 0
buffer_load_dwordx4 v1, s[4:7], s30 offen sc1 lds
v_subrev_u32 v168, 0x1f800000, v132
v_cmp_le_u32 vcc, 0x40000000, v168
s_nop 0
s_cbranch_vccnz FO24
FR25:
v_rcp_f32 v168, v132
s_nop 0
v_mul_f32 v120, v168, v120
v_mul_f32 v121, v168, v121
v_mul_f32 v122, v168, v122
v_mul_f32 v123, v168, v123
v_mul_f32 v124, v168, v124
v_mul_f32 v125, v168, v125
v_mul_f32 v126, v168, v126
v_mul_f32 v127, v168, v127
v_mul_f32 v128, v168, v128
v_mul_f32 v129, v168, v129
v_mfma_f32_32x32x16_bf16 v[48:63], a[20:23], v[184:187], v[48:63]
ds_read_b64_tr_b16 a[58:59], v211 offset:128
buffer_load_dwordx4 v1, s[4:7], s30 offen offset:1024 sc1 lds
v_mul_f32 v130, v168, v130
v_mul_f32 v131, v168, v131
v_cvt_pk_bf16_f32 v152, v120, v121
v_cvt_pk_bf16_f32 v153, v122, v123
v_cvt_pk_bf16_f32 v154, v124, v125
v_cvt_pk_bf16_f32 v155, v126, v127
v_cvt_pk_bf16_f32 v156, v128, v129
v_cvt_pk_bf16_f32 v157, v130, v131
buffer_store_dwordx4 v[152:155], v1, s[4:7], s75 offen sc1
v_exp_f32 v64, v64
v_exp_f32 v65, v65
s_waitcnt lgkmcnt(3)
v_mfma_f32_32x32x16_bf16 v[136:151], a[48:51], v[96:99], 0
ds_read_b64_tr_b16 a[60:61], v211 offset:256
buffer_load_dwordx4 v1, s[4:7], s30 offen offset:2048 sc1 lds
v_exp_f32 v66, v66
v_exp_f32 v67, v67
v_cvt_pk_bf16_f32 v104, v64, v65
v_exp_f32 v68, v68
v_exp_f32 v69, v69
v_cvt_pk_bf16_f32 v105, v66, v67
v_exp_f32 v70, v70
v_exp_f32 v71, v71
v_cvt_pk_bf16_f32 v106, v68, v69
v_exp_f32 v72, v72
v_exp_f32 v73, v73
v_mfma_f32_32x32x16_bf16 v[136:151], a[52:55], v[100:103], v[136:151]
ds_read_b64_tr_b16 a[62:63], v211 offset:384
v_cvt_pk_bf16_f32 v107, v70, v71
v_exp_f32 v74, v74
v_exp_f32 v75, v75
v_cvt_pk_bf16_f32 v108, v72, v73
v_exp_f32 v76, v76
v_exp_f32 v77, v77
v_cvt_pk_bf16_f32 v109, v74, v75
v_exp_f32 v78, v78
v_exp_f32 v79, v79
v_cvt_pk_bf16_f32 v110, v76, v77
v_cvt_pk_bf16_f32 v111, v78, v79
v_mfma_f32_32x32x16_bf16 v[64:79], a[36:39], v[176:179], 0
ds_read_b128 a[44:47], v47 offset:11520
ds_read_b64_tr_b16 a[64:65], v210 offset:0
buffer_load_dwordx4 v1, s[4:7], s30 offen offset:3072 sc1 lds
v_exp_f32 v48, v48
v_exp_f32 v49, v49
v_exp_f32 v50, v50
v_exp_f32 v51, v51
v_cvt_pk_bf16_f32 v96, v48, v49
v_exp_f32 v52, v52
v_mfma_f32_32x32x16_bf16 v[64:79], a[16:19], v[184:187], v[64:79]
ds_read_b64_tr_b16 a[66:67], v210 offset:128
s_add_u32 m0, s25, 81920
s_add_u32 s30, s22, 16384
buffer_load_dwordx4 v1, s[4:7], s30 offen sc1 lds
v_exp_f32 v53, v53
v_cvt_pk_bf16_f32 v97, v50, v51
v_exp_f32 v54, v54
v_exp_f32 v55, v55
v_cvt_pk_bf16_f32 v98, v52, v53
v_exp_f32 v56, v56
s_waitcnt lgkmcnt(3)
v_mfma_f32_32x32x16_bf16 v[136:151], a[56:59], v[104:107], v[136:151]
ds_read_b64_tr_b16 a[68:69], v210 offset:256
buffer_load_dwordx4 v1, s[4:7], s30 offen offset:1024 sc1 lds
v_exp_f32 v57, v57
v_cvt_pk_bf16_f32 v99, v54, v55
v_exp_f32 v58, v58
v_exp_f32 v59, v59
v_cvt_pk_bf16_f32 v100, v56, v57
v_exp_f32 v60, v60
v_mfma_f32_32x32x16_bf16 v[136:151], a[60:63], v[108:111], v[136:151]
ds_read_b64_tr_b16 a[70:71], v210 offset:384
buffer_load_dwordx4 v1, s[4:7], s30 offen offset:2048 sc1 lds
s_lshl_b32 s78, s18, 14
s_add_u32 s78, s78, 67764224
s_add_u32 s12, s78, s66
s_add_u32 s13, s78, s67
s_add_u32 s14, s78, s68
s_add_u32 s77, s78, s69
v_exp_f32 v61, v61
v_cvt_pk_bf16_f32 v101, v58, v59
v_exp_f32 v62, v62
v_exp_f32 v63, v63
v_cvt_pk_bf16_f32 v102, v60, v61
v_cvt_pk_bf16_f32 v103, v62, v63
v_mfma_f32_32x32x16_bf16 v[48:63], a[40:43], v[176:179], 0
ds_read_b128 a[36:39], v47 offset:6272
ds_read_b64_tr_b16 a[48:49], v209 offset:0
buffer_load_dwordx4 v1, s[4:7], s30 offen offset:3072 sc1 lds
v_exp_f32 v64, v64
v_exp_f32 v65, v65
v_exp_f32 v66, v66
v_exp_f32 v67, v67
v_cvt_pk_bf16_f32 v104, v64, v65
v_exp_f32 v68, v68
v_mfma_f32_32x32x16_bf16 v[48:63], a[12:15], v[184:187], v[48:63]
ds_read_b64_tr_b16 a[50:51], v209 offset:128
s_add_u32 m0, s25, 98304
s_add_u32 s30, s22, 32768
buffer_load_dwordx4 v1, s[4:7], s30 offen sc1 lds
v_exp_f32 v69, v69
v_cvt_pk_bf16_f32 v105, v66, v67
v_exp_f32 v70, v70
v_exp_f32 v71, v71
v_cvt_pk_bf16_f32 v106, v68, v69
v_exp_f32 v72, v72
s_waitcnt lgkmcnt(3)
v_mfma_f32_32x32x16_bf16 v[136:151], a[64:67], v[96:99], v[136:151]
ds_read_b64_tr_b16 a[52:53], v209 offset:256
v_exp_f32 v73, v73
v_cvt_pk_bf16_f32 v107, v70, v71
v_exp_f32 v74, v74
v_exp_f32 v75, v75
v_cvt_pk_bf16_f32 v108, v72, v73
v_exp_f32 v76, v76
v_mfma_f32_32x32x16_bf16 v[136:151], a[68:71], v[100:103], v[136:151]
ds_read_b64_tr_b16 a[54:55], v209 offset:384
buffer_load_dwordx4 v1, s[4:7], s30 offen offset:1024 sc1 lds
v_exp_f32 v77, v77
v_cvt_pk_bf16_f32 v109, v74, v75
v_exp_f32 v78, v78
v_exp_f32 v79, v79
v_cvt_pk_bf16_f32 v110, v76, v77
v_cvt_pk_bf16_f32 v111, v78, v79
v_mfma_f32_32x32x16_bf16 v[64:79], a[44:47], v[176:179], 0
ds_read_b128 a[40:43], v47 offset:43008
ds_read_b64_tr_b16 a[56:57], v208 offset:0
buffer_load_dwordx4 v1, s[4:7], s30 offen offset:2048 sc1 lds
v_exp_f32 v48, v48
v_exp_f32 v49, v49
v_exp_f32 v50, v50
v_exp_f32 v51, v51
v_cvt_pk_bf16_f32 v96, v48, v49
v_exp_f32 v52, v52
v_mfma_f32_32x32x16_bf16 v[64:79], a[8:11], v[184:187], v[64:79]
ds_read_b64_tr_b16 a[58:59], v208 offset:128
buffer_load_dwordx4 v1, s[4:7], s30 offen offset:3072 sc1 lds
v_exp_f32 v53, v53
v_cvt_pk_bf16_f32 v97, v50, v51
v_exp_f32 v54, v54
v_exp_f32 v55, v55
v_cvt_pk_bf16_f32 v98, v52, v53
v_exp_f32 v56, v56
s_waitcnt lgkmcnt(3)
v_mfma_f32_32x32x16_bf16 v[136:151], a[48:51], v[104:107], v[136:151]
ds_read_b64_tr_b16 a[60:61], v208 offset:256
s_add_u32 m0, s25, 114688
s_add_u32 s30, s22, 49152
buffer_load_dwordx4 v1, s[4:7], s30 offen sc1 lds
v_exp_f32 v57, v57
v_cvt_pk_bf16_f32 v99, v54, v55
v_exp_f32 v58, v58
v_exp_f32 v59, v59
v_cvt_pk_bf16_f32 v100, v56, v57
v_exp_f32 v60, v60
v_mfma_f32_32x32x16_bf16 v[136:151], a[52:55], v[108:111], v[136:151]
ds_read_b64_tr_b16 a[62:63], v208 offset:384
buffer_load_dwordx4 v1, s[4:7], s30 offen offset:1024 sc1 lds
v_exp_f32 v61, v61
v_cvt_pk_bf16_f32 v101, v58, v59
v_exp_f32 v62, v62
v_exp_f32 v63, v63
v_cvt_pk_bf16_f32 v102, v60, v61
v_cvt_pk_bf16_f32 v103, v62, v63
v_mfma_f32_32x32x16_bf16 v[48:63], a[36:39], v[176:179], 0
ds_read_b128 a[44:47], v47 offset:1024
ds_read_b64_tr_b16 a[64:65], v207 offset:0
buffer_load_dwordx4 v1, s[4:7], s30 offen offset:2048 sc1 lds
s_waitcnt vmcnt(13)
buffer_atomic_add v9, v8, s[4:7], s98 offen offset:0 sc1
v_exp_f32 v64, v64
v_exp_f32 v65, v65
v_exp_f32 v66, v66
v_exp_f32 v67, v67
v_cvt_pk_bf16_f32 v104, v64, v65
v_exp_f32 v68, v68
v_mfma_f32_32x32x16_bf16 v[48:63], a[4:7], v[184:187], v[48:63]
ds_read_b64_tr_b16 a[66:67], v207 offset:128
v_exp_f32 v69, v69
v_cvt_pk_bf16_f32 v105, v66, v67
v_exp_f32 v70, v70
v_exp_f32 v71, v71
v_cvt_pk_bf16_f32 v106, v68, v69
v_exp_f32 v72, v72
s_waitcnt lgkmcnt(3)
v_mfma_f32_32x32x16_bf16 v[136:151], a[56:59], v[96:99], v[136:151]
ds_read_b64_tr_b16 a[68:69], v207 offset:256
buffer_load_dwordx4 v1, s[4:7], s30 offen offset:3072 sc1 lds
v_exp_f32 v73, v73
v_cvt_pk_bf16_f32 v107, v70, v71
v_exp_f32 v74, v74
v_exp_f32 v75, v75
v_cvt_pk_bf16_f32 v108, v72, v73
v_exp_f32 v76, v76
v_mfma_f32_32x32x16_bf16 v[136:151], a[60:63], v[100:103], v[136:151]
ds_read_b64_tr_b16 a[70:71], v207 offset:384
s_add_u32 m0, s25, 131072
s_add_u32 s30, s22, 65536
buffer_load_dwordx4 v1, s[4:7], s30 offen sc1 lds
v_exp_f32 v77, v77
v_cvt_pk_bf16_f32 v109, v74, v75
v_exp_f32 v78, v78
v_exp_f32 v79, v79
v_cvt_pk_bf16_f32 v110, v76, v77
v_cvt_pk_bf16_f32 v111, v78, v79
v_mfma_f32_32x32x16_bf16 v[80:95], a[40:43], v[176:179], 0
ds_read_b64_tr_b16 a[48:49], v206 offset:0
buffer_load_dwordx4 v1, s[4:7], s30 offen offset:1024 sc1 lds
v_exp_f32 v48, v48
v_exp_f32 v49, v49
v_exp_f32 v50, v50
v_exp_f32 v51, v51
v_mfma_f32_32x32x16_bf16 v[80:95], a[32:35], v[184:187], v[80:95]
ds_read_b64_tr_b16 a[50:51], v206 offset:128
buffer_load_dwordx4 v1, s[4:7], s30 offen offset:2048 sc1 lds
v_cvt_pk_bf16_f32 v96, v48, v49
v_exp_f32 v52, v52
v_exp_f32 v53, v53
v_cvt_pk_bf16_f32 v97, v50, v51
s_waitcnt lgkmcnt(6)
v_mfma_f32_32x32x16_bf16 v[64:79], a[44:47], v[176:179], 0
ds_read_b64_tr_b16 a[52:53], v206 offset:256
buffer_load_dwordx4 v1, s[4:7], s30 offen offset:3072 sc1 lds
v_exp_f32 v54, v54
v_exp_f32 v55, v55
v_cvt_pk_bf16_f32 v98, v52, v53
v_exp_f32 v56, v56
v_mfma_f32_32x32x16_bf16 v[64:79], a[0:3], v[184:187], v[64:79]
ds_read_b64_tr_b16 a[54:55], v206 offset:384
s_add_u32 m0, s25, 147456
s_add_u32 s30, s22, 81920
buffer_load_dwordx4 v1, s[4:7], s30 offen sc1 lds
v_exp_f32 v57, v57
v_cvt_pk_bf16_f32 v99, v54, v55
v_exp_f32 v58, v58
v_exp_f32 v59, v59
s_waitcnt lgkmcnt(4)
v_mfma_f32_32x32x16_bf16 v[136:151], a[64:67], v[104:107], v[136:151]
v_cvt_pk_bf16_f32 v100, v56, v57
v_exp_f32 v60, v60
v_exp_f32 v61, v61
v_cvt_pk_bf16_f32 v101, v58, v59
v_mfma_f32_32x32x16_bf16 v[136:151], a[68:71], v[108:111], v[136:151]
buffer_load_dwordx4 v1, s[4:7], s30 offen offset:1024 sc1 lds
v_exp_f32 v62, v62
v_exp_f32 v63, v63
v_cvt_pk_bf16_f32 v102, v60, v61
v_cvt_pk_bf16_f32 v103, v62, v63
s_waitcnt lgkmcnt(2)
v_mfma_f32_32x32x16_bf16 v[136:151], a[48:51], v[96:99], v[136:151]
ds_read_b64_tr_b16 a[56:57], v213 offset:0
ds_read_b64_tr_b16 a[58:59], v213 offset:128
ds_read_b64_tr_b16 a[60:61], v213 offset:256
ds_read_b64_tr_b16 a[62:63], v213 offset:384
buffer_load_dwordx4 v1, s[4:7], s30 offen offset:2048 sc1 lds
v_cndmask_b32 v80, v64, v80, s[32:33]
v_cndmask_b32 v81, v65, v81, s[34:35]
v_cndmask_b32 v82, v66, v82, s[36:37]
v_cndmask_b32 v83, v67, v83, s[38:39]
v_cndmask_b32 v84, v68, v84, s[40:41]
v_cndmask_b32 v85, v69, v85, s[42:43]
v_cndmask_b32 v86, v70, v86, s[44:45]
v_cndmask_b32 v87, v71, v87, s[46:47]
v_cndmask_b32 v88, v72, v88, s[48:49]
v_cndmask_b32 v89, v73, v89, s[50:51]
v_cndmask_b32 v90, v74, v90, s[52:53]
v_cndmask_b32 v91, v75, v91, s[54:55]
v_cndmask_b32 v92, v76, v92, s[56:57]
v_cndmask_b32 v93, v77, v93, s[58:59]
v_cndmask_b32 v94, v78, v94, s[60:61]
v_cndmask_b32 v95, v79, v95, s[62:63]
v_exp_f32 v80, v80
v_exp_f32 v81, v81
v_exp_f32 v82, v82
v_exp_f32 v83, v83
v_cvt_pk_bf16_f32 v104, v80, v81
v_exp_f32 v84, v84
v_exp_f32 v85, v85
v_cvt_pk_bf16_f32 v105, v82, v83
v_exp_f32 v86, v86
v_exp_f32 v87, v87
v_cvt_pk_bf16_f32 v106, v84, v85
v_exp_f32 v88, v88
s_waitcnt lgkmcnt(4)
v_mfma_f32_32x32x16_bf16 v[136:151], a[52:55], v[100:103], v[136:151]
ds_read_b64_tr_b16 a[64:65], v205 offset:0
ds_read_b64_tr_b16 a[66:67], v205 offset:128
ds_read_b64_tr_b16 a[68:69], v205 offset:256
ds_read_b64_tr_b16 a[70:71], v205 offset:384
buffer_load_dwordx4 v1, s[4:7], s30 offen offset:3072 sc1 lds
v_exp_f32 v89, v89
v_cvt_pk_bf16_f32 v107, v86, v87
v_exp_f32 v90, v90
v_exp_f32 v91, v91
v_cvt_pk_bf16_f32 v108, v88, v89
v_exp_f32 v92, v92
v_exp_f32 v93, v93
v_cvt_pk_bf16_f32 v109, v90, v91
v_exp_f32 v94, v94
v_exp_f32 v95, v95
v_cvt_pk_bf16_f32 v110, v92, v93
v_cvt_pk_bf16_f32 v111, v94, v95
v_bfi_b32 v112, v188, 0, v104
v_bfi_b32 v113, v189, 0, v105
v_bfi_b32 v114, v190, 0, v106
v_bfi_b32 v115, v191, 0, v107
v_bfi_b32 v116, v192, 0, v108
v_bfi_b32 v117, v193, 0, v109
v_bfi_b32 v118, v194, 0, v110
PG_s5:
s_cbranch_execz PG_b0
v_bfi_b32 v119, v195, 0, v111
v_and_b32 v104, v188, v104
v_and_b32 v105, v189, v105
v_and_b32 v106, v190, v106
v_and_b32 v107, v191, v107
v_and_b32 v108, v192, v108
v_and_b32 v109, v193, v109
v_and_b32 v110, v194, v110
v_and_b32 v111, v195, v111
s_waitcnt lgkmcnt(6)
v_mfma_f32_32x32x16_bf16 v[136:151], a[56:59], v[104:107], v[136:151]
s_add_u32 s31, s24, 0
buffer_load_dwordx4 v[216:219], v1, s[4:7], s31 offen offset:0 sc1
s_waitcnt lgkmcnt(4)
v_mfma_f32_32x32x16_bf16 v[136:151], a[60:63], v[108:111], v[136:151]
buffer_load_dwordx4 v[220:223], v1, s[4:7], s31 offen offset:1024 sc1
s_waitcnt lgkmcnt(0)
v_mfma_f32_32x32x16_bf16 v[136:151], a[64:67], v[112:115], v[136:151]
v_mfma_f32_32x32x16_bf16 v[136:151], a[68:71], v[116:119], v[136:151]
s_load_dword s15, s[4:5], s99 offset:0 glc
s_nop 10
v_subrev_u32 v168, 0x1f800000, v148
v_cmp_le_u32 vcc, 0x40000000, v168
s_nop 0
s_cbranch_vccnz FO26
FR27:
v_rcp_f32 v168, v148
s_nop 0
v_pk_mul_f32 v[136:137], v[136:137], v[168:169] op_sel_hi:[1,0]
v_pk_mul_f32 v[138:139], v[138:139], v[168:169] op_sel_hi:[1,0]
v_pk_mul_f32 v[140:141], v[140:141], v[168:169] op_sel_hi:[1,0]
v_pk_mul_f32 v[142:143], v[142:143], v[168:169] op_sel_hi:[1,0]
v_pk_mul_f32 v[144:145], v[144:145], v[168:169] op_sel_hi:[1,0]
v_pk_mul_f32 v[146:147], v[146:147], v[168:169] op_sel_hi:[1,0]
v_cvt_pk_bf16_f32 v160, v136, v137
v_cvt_pk_bf16_f32 v161, v138, v139
v_cvt_pk_bf16_f32 v162, v140, v141
v_cvt_pk_bf16_f32 v163, v142, v143
v_cvt_pk_bf16_f32 v164, v144, v145
v_cvt_pk_bf16_f32 v165, v146, v147
s_mov_b32 vcc_lo, -1
s_mov_b32 vcc_hi, 0
v_cndmask_b32 v156, v164, v156, vcc
v_cndmask_b32 v157, v165, v157, vcc
buffer_store_dwordx4 v[160:163], v1, s[4:7], s76 offen sc1
buffer_store_dwordx2 v[156:157], v16, s[4:7], s74 offen sc1
s_waitcnt lgkmcnt(0)
s_cmp_ge_u32 s15, 8
s_cbranch_scc0 SP28
BK29:
buffer_load_dwordx4 a[72:75], v4, s[4:7], s12 offen offset:0 sc1
buffer_load_dwordx4 a[88:91], v4, s[4:7], s12 offen offset:2048 sc1
buffer_load_dwordx4 a[76:79], v4, s[4:7], s13 offen offset:0 sc1
buffer_load_dwordx4 a[92:95], v4, s[4:7], s13 offen offset:2048 sc1
buffer_load_dwordx4 a[80:83], v4, s[4:7], s14 offen offset:0 sc1
buffer_load_dwordx4 a[96:99], v4, s[4:7], s14 offen offset:2048 sc1
buffer_load_dwordx4 a[84:87], v4, s[4:7], s77 offen offset:0 sc1
buffer_load_dwordx4 a[100:103], v4, s[4:7], s77 offen offset:2048 sc1
s_mul_i32 s78, s18, 14336
s_sub_u32 s78, 61440, s78
v_add_u32 v172, s78, v4
s_add_u32 s12, s12, 4096
s_add_u32 s13, s13, 4096
s_add_u32 s14, s14, 4096
s_add_u32 s77, s77, 4096
s_barrier
s_mov_b64 exec, 0
s_cmp_eq_u32 s18, 0
s_cbranch_scc1 PG_s6
s_cmp_eq_u32 s18, 1
s_cbranch_scc1 PG_s7
s_cmp_eq_u32 s18, 2
s_cbranch_scc1 PG_s8
s_cmp_eq_u32 s18, 3
s_cbranch_scc1 PG_s9
PG_b2:
s_mov_b64 exec, -1
s_waitcnt vmcnt(8)
s_waitcnt vmcnt(7)
v_mfma_f32_16x16x32_bf16 v[48:51], a[160:163], a[72:75], 0
buffer_load_dwordx4 v[108:111], v4, s[4:7], s12 offen offset:0 sc1
s_waitcnt vmcnt(7)
v_mfma_f32_16x16x32_bf16 v[48:51], a[180:183], a[88:91], v[48:51]
v_mfma_f32_16x16x32_bf16 v[52:55], a[164:167], a[72:75], 0
v_mfma_f32_16x16x32_bf16 v[52:55], a[184:187], a[88:91], v[52:55]
buffer_load_dwordx4 v[112:115], v4, s[4:7], s12 offen offset:2048 sc1
v_mfma_f32_16x16x32_bf16 v[56:59], a[168:171], a[72:75], 0
v_mfma_f32_16x16x32_bf16 v[56:59], a[188:191], a[88:91], v[56:59]
v_mfma_f32_16x16x32_bf16 v[60:63], a[172:175], a[72:75], 0
buffer_load_dwordx4 v[116:119], v172, s[4:7], s12 offen offset:0 sc1
v_mfma_f32_16x16x32_bf16 v[60:63], a[192:195], a[88:91], v[60:63]
v_mfma_f32_16x16x32_bf16 v[64:67], a[176:179], a[72:75], 0
v_mfma_f32_16x16x32_bf16 v[64:67], a[196:199], a[88:91], v[64:67]
buffer_load_dwordx4 v[120:123], v4, s[4:7], s13 offen offset:0 sc1
s_waitcnt vmcnt(9)
v_mfma_f32_16x16x32_bf16 v[68:71], a[160:163], a[76:79], 0
s_waitcnt vmcnt(8)
v_mfma_f32_16x16x32_bf16 v[68:71], a[180:183], a[92:95], v[68:71]
v_mfma_f32_16x16x32_bf16 v[72:75], a[164:167], a[76:79], 0
buffer_load_dwordx4 v[124:127], v4, s[4:7], s13 offen offset:2048 sc1
v_mfma_f32_16x16x32_bf16 v[72:75], a[184:187], a[92:95], v[72:75]
v_mfma_f32_16x16x32_bf16 v[76:79], a[168:171], a[76:79], 0
v_mfma_f32_16x16x32_bf16 v[76:79], a[188:191], a[92:95], v[76:79]
buffer_load_dwordx4 v[128:131], v172, s[4:7], s13 offen offset:0 sc1
v_mfma_f32_16x16x32_bf16 v[80:83], a[172:175], a[76:79], 0
v_mfma_f32_16x16x32_bf16 v[80:83], a[192:195], a[92:95], v[80:83]
v_mfma_f32_16x16x32_bf16 v[84:87], a[176:179], a[76:79], 0
buffer_load_dwordx4 v[132:135], v4, s[4:7], s14 offen offset:0 sc1
v_mfma_f32_16x16x32_bf16 v[84:87], a[196:199], a[92:95], v[84:87]
s_waitcnt vmcnt(10)
v_mfma_f32_16x16x32_bf16 v[88:91], a[160:163], a[80:83], 0
s_waitcnt vmcnt(9)
v_mfma_f32_16x16x32_bf16 v[88:91], a[180:183], a[96:99], v[88:91]
buffer_load_dwordx4 v[136:139], v4, s[4:7], s14 offen offset:2048 sc1
v_mfma_f32_16x16x32_bf16 v[92:95], a[164:167], a[80:83], 0
v_mfma_f32_16x16x32_bf16 v[92:95], a[184:187], a[96:99], v[92:95]
v_mfma_f32_16x16x32_bf16 v[96:99], a[168:171], a[80:83], 0
buffer_load_dwordx4 v[140:143], v172, s[4:7], s14 offen offset:0 sc1
v_mfma_f32_16x16x32_bf16 v[96:99], a[188:191], a[96:99], v[96:99]
v_mfma_f32_16x16x32_bf16 v[100:103], a[172:175], a[80:83], 0
v_mfma_f32_16x16x32_bf16 v[100:103], a[192:195], a[96:99], v[100:103]
buffer_load_dwordx4 v[176:179], v4, s[4:7], s77 offen offset:0 sc1
v_mfma_f32_16x16x32_bf16 v[104:107], a[176:179], a[80:83], 0
v_mfma_f32_16x16x32_bf16 v[104:107], a[196:199], a[96:99], v[104:107]
s_waitcnt vmcnt(11)
v_mfma_f32_16x16x32_bf16 v[20:23], a[160:163], a[84:87], v[20:23]
buffer_load_dwordx4 v[180:183], v4, s[4:7], s77 offen offset:2048 sc1
s_waitcnt vmcnt(11)
v_mfma_f32_16x16x32_bf16 v[20:23], a[180:183], a[100:103], v[20:23]
v_mfma_f32_16x16x32_bf16 v[24:27], a[164:167], a[84:87], v[24:27]
v_mfma_f32_16x16x32_bf16 v[24:27], a[184:187], a[100:103], v[24:27]
buffer_load_dwordx4 v[184:187], v172, s[4:7], s77 offen offset:0 sc1
v_mfma_f32_16x16x32_bf16 v[28:31], a[168:171], a[84:87], v[28:31]
v_mfma_f32_16x16x32_bf16 v[28:31], a[188:191], a[100:103], v[28:31]
s_waitcnt vmcnt(11)
v_max3_u32 v168, v108, v109, v110
s_waitcnt vmcnt(10)
v_max3_u32 v168, v111, v112, v168
v_mfma_f32_16x16x32_bf16 v[32:35], a[172:175], a[84:87], v[32:35]
v_max3_u32 v168, v113, v114, v168
s_waitcnt vmcnt(9)
v_max3_u32 v168, v115, v116, v168
v_mfma_f32_16x16x32_bf16 v[32:35], a[192:195], a[100:103], v[32:35]
v_max3_u32 v168, v117, v118, v168
v_max_u32 v168, v119, v168
v_mfma_f32_16x16x32_bf16 v[36:39], a[176:179], a[84:87], v[36:39]
v_cmp_eq_u32 vcc, -1, v168
v_mfma_f32_16x16x32_bf16 v[36:39], a[196:199], a[100:103], v[36:39]
s_cbranch_vccnz RT30
RB31:
v_add_u32 v164, 0, v10
v_add_u32 v165, 0, v11
v_add_u32 v166, 0, v12
v_add_u32 v19, 0, v13
v_mfma_f32_16x16x32_bf16 v[48:51], a[200:203], v[108:111], v[48:51]
s_add_u32 s74, s69, 67108864
v_mfma_f32_16x16x32_bf16 v[48:51], a[220:223], v[112:115], v[48:51]
s_lshl_b32 s76, s17, 2
s_add_u32 s76, s76, s18
v_mfma_f32_16x16x32_bf16 v[48:51], a[240:243], v[116:119], v[48:51]
s_lshl_b32 s76, s76, 7
s_and_b32 s2, s99, 0xffffe000
v_mfma_f32_16x16x32_bf16 v[52:55], a[204:207], v[108:111], v[52:55]
s_add_u32 s76, s76, s2
s_add_u32 s76, s76, 4294918144
v_mfma_f32_16x16x32_bf16 v[52:55], a[224:227], v[112:115], v[52:55]
v_mfma_f32_16x16x32_bf16 v[52:55], a[244:247], v[116:119], v[52:55]
v_mfma_f32_16x16x32_bf16 v[56:59], a[208:211], v[108:111], v[56:59]
v_mfma_f32_16x16x32_bf16 v[56:59], a[228:231], v[112:115], v[56:59]
ds_write_b128 v164, v[48:51] offset:0
v_mfma_f32_16x16x32_bf16 v[56:59], a[248:251], v[116:119], v[56:59]
s_waitcnt vmcnt(8)
v_max3_u32 v168, v120, v121, v122
s_waitcnt vmcnt(7)
v_max3_u32 v168, v123, v124, v168
v_mfma_f32_16x16x32_bf16 v[60:63], a[212:215], v[108:111], v[60:63]
v_max3_u32 v168, v125, v126, v168
s_waitcnt vmcnt(6)
v_max3_u32 v168, v127, v128, v168
v_mfma_f32_16x16x32_bf16 v[60:63], a[232:235], v[112:115], v[60:63]
ds_write_b128 v164, v[52:55] offset:1024
v_mfma_f32_16x16x32_bf16 v[60:63], a[252:255], v[116:119], v[60:63]
v_max3_u32 v168, v129, v130, v168
v_max_u32 v168, v131, v168
v_mfma_f32_16x16x32_bf16 v[64:67], a[216:219], v[108:111], v[64:67]
v_cmp_eq_u32 vcc, -1, v168
v_mfma_f32_16x16x32_bf16 v[64:67], a[236:239], v[112:115], v[64:67]
ds_write_b128 v164, v[56:59] offset:2048
v_mfma_f32_16x16x32_bf16 v[64:67], v[244:247], v[116:119], v[64:67]
s_cbranch_vccnz RT32
RB33:
v_mfma_f32_16x16x32_bf16 v[68:71], a[200:203], v[120:123], v[68:71]
buffer_load_dwordx4 v[224:227], v1, s[4:7], s31 offen offset:2048 sc1
v_mfma_f32_16x16x32_bf16 v[68:71], a[220:223], v[124:127], v[68:71]
ds_write_b128 v164, v[60:63] offset:3072
v_mfma_f32_16x16x32_bf16 v[68:71], a[240:243], v[128:131], v[68:71]
v_mfma_f32_16x16x32_bf16 v[72:75], a[204:207], v[120:123], v[72:75]
v_mfma_f32_16x16x32_bf16 v[72:75], a[224:227], v[124:127], v[72:75]
ds_write_b128 v164, v[64:67] offset:4096
v_mfma_f32_16x16x32_bf16 v[72:75], a[244:247], v[128:131], v[72:75]
buffer_load_dwordx4 v[228:231], v1, s[4:7], s31 offen offset:3072 sc1
v_mfma_f32_16x16x32_bf16 v[76:79], a[208:211], v[120:123], v[76:79]
v_mfma_f32_16x16x32_bf16 v[76:79], a[228:231], v[124:127], v[76:79]
s_nop 0
ds_write_b128 v165, v[68:71] offset:0
v_mfma_f32_16x16x32_bf16 v[76:79], a[248:251], v[128:131], v[76:79]
s_waitcnt vmcnt(7)
v_max3_u32 v168, v132, v133, v134
s_waitcnt vmcnt(6)
v_max3_u32 v168, v135, v136, v168
v_mfma_f32_16x16x32_bf16 v[80:83], a[212:215], v[120:123], v[80:83]
v_max3_u32 v168, v137, v138, v168
s_waitcnt vmcnt(5)
v_max3_u32 v168, v139, v140, v168
v_mfma_f32_16x16x32_bf16 v[80:83], a[232:235], v[124:127], v[80:83]
ds_write_b128 v165, v[72:75] offset:1024
v_mfma_f32_16x16x32_bf16 v[80:83], a[252:255], v[128:131], v[80:83]
v_max3_u32 v168, v141, v142, v168
v_max_u32 v168, v143, v168
v_mfma_f32_16x16x32_bf16 v[84:87], a[216:219], v[120:123], v[84:87]
v_cmp_eq_u32 vcc, -1, v168
v_mfma_f32_16x16x32_bf16 v[84:87], a[236:239], v[124:127], v[84:87]
ds_write_b128 v165, v[76:79] offset:2048
v_mfma_f32_16x16x32_bf16 v[84:87], v[244:247], v[128:131], v[84:87]
s_cbranch_vccnz RT34
RB35:
v_mfma_f32_16x16x32_bf16 v[88:91], a[200:203], v[132:135], v[88:91]
s_add_u32 s31, s24, 4096
buffer_load_dwordx4 v[232:235], v1, s[4:7], s31 offen offset:0 sc1
v_mfma_f32_16x16x32_bf16 v[88:91], a[220:223], v[136:139], v[88:91]
ds_write_b128 v165, v[80:83] offset:3072
v_mfma_f32_16x16x32_bf16 v[88:91], a[240:243], v[140:143], v[88:91]
v_mfma_f32_16x16x32_bf16 v[92:95], a[204:207], v[132:135], v[92:95]
v_mfma_f32_16x16x32_bf16 v[92:95], a[224:227], v[136:139], v[92:95]
ds_write_b128 v165, v[84:87] offset:4096
v_mfma_f32_16x16x32_bf16 v[92:95], a[244:247], v[140:143], v[92:95]
buffer_load_dwordx4 v[236:239], v1, s[4:7], s31 offen offset:1024 sc1
v_mfma_f32_16x16x32_bf16 v[96:99], a[208:211], v[132:135], v[96:99]
v_mfma_f32_16x16x32_bf16 v[96:99], a[228:231], v[136:139], v[96:99]
s_nop 0
ds_write_b128 v166, v[88:91] offset:0
v_mfma_f32_16x16x32_bf16 v[96:99], a[248:251], v[140:143], v[96:99]
s_waitcnt vmcnt(6)
v_max3_u32 v168, v176, v177, v178
s_waitcnt vmcnt(5)
v_max3_u32 v168, v179, v180, v168
v_mfma_f32_16x16x32_bf16 v[100:103], a[212:215], v[132:135], v[100:103]
v_max3_u32 v168, v181, v182, v168
s_waitcnt vmcnt(4)
v_max3_u32 v168, v183, v184, v168
v_mfma_f32_16x16x32_bf16 v[100:103], a[232:235], v[136:139], v[100:103]
ds_write_b128 v166, v[92:95] offset:1024
v_mfma_f32_16x16x32_bf16 v[100:103], a[252:255], v[140:143], v[100:103]
v_max3_u32 v168, v185, v186, v168
v_max_u32 v168, v187, v168
v_mfma_f32_16x16x32_bf16 v[104:107], a[216:219], v[132:135], v[104:107]
v_cmp_eq_u32 vcc, -1, v168
v_mfma_f32_16x16x32_bf16 v[104:107], a[236:239], v[136:139], v[104:107]
ds_write_b128 v166, v[96:99] offset:2048
v_mfma_f32_16x16x32_bf16 v[104:107], v[244:247], v[140:143], v[104:107]
s_cbranch_vccnz RT36
RB37:
v_mfma_f32_16x16x32_bf16 v[20:23], a[200:203], v[176:179], v[20:23]
buffer_load_dwordx4 v[240:243], v1, s[4:7], s31 offen offset:2048 sc1
v_mfma_f32_16x16x32_bf16 v[20:23], a[220:223], v[180:183], v[20:23]
ds_write_b128 v166, v[100:103] offset:3072
v_mfma_f32_16x16x32_bf16 v[20:23], a[240:243], v[184:187], v[20:23]
v_mfma_f32_16x16x32_bf16 v[24:27], a[204:207], v[176:179], v[24:27]
v_mfma_f32_16x16x32_bf16 v[24:27], a[224:227], v[180:183], v[24:27]
ds_write_b128 v166, v[104:107] offset:4096
v_mfma_f32_16x16x32_bf16 v[24:27], a[244:247], v[184:187], v[24:27]
buffer_load_dwordx4 v[188:191], v1, s[4:7], s31 offen offset:3072 sc1
v_mfma_f32_16x16x32_bf16 v[28:31], a[208:211], v[176:179], v[28:31]
s_waitcnt lgkmcnt(0)
s_barrier
v_mfma_f32_16x16x32_bf16 v[28:31], a[228:231], v[180:183], v[28:31]
ds_read_b128 v[108:111], v19 offset:0
ds_read_b128 v[128:131], v19 offset:5120
v_mfma_f32_16x16x32_bf16 v[28:31], a[248:251], v[184:187], v[28:31]
ds_read_b128 v[148:151], v19 offset:10240
ds_read_b128 v[112:115], v19 offset:1024
v_mfma_f32_16x16x32_bf16 v[32:35], a[212:215], v[176:179], v[32:35]
ds_read_b128 v[132:135], v19 offset:6144
ds_read_b128 v[152:155], v19 offset:11264
v_mfma_f32_16x16x32_bf16 v[32:35], a[232:235], v[180:183], v[32:35]
ds_read_b128 v[116:119], v19 offset:2048
ds_read_b128 v[136:139], v19 offset:7168
v_mfma_f32_16x16x32_bf16 v[32:35], a[252:255], v[184:187], v[32:35]
ds_read_b128 v[156:159], v19 offset:12288
ds_read_b128 v[120:123], v19 offset:3072
v_mfma_f32_16x16x32_bf16 v[36:39], a[216:219], v[176:179], v[36:39]
ds_read_b128 v[140:143], v19 offset:8192
ds_read_b128 v[160:163], v19 offset:13312
v_mfma_f32_16x16x32_bf16 v[36:39], a[236:239], v[180:183], v[36:39]
ds_read_b128 v[124:127], v19 offset:4096
ds_read_b128 v[144:147], v19 offset:9216
v_mfma_f32_16x16x32_bf16 v[36:39], v[244:247], v[184:187], v[36:39]
ds_read_b128 v[164:167], v19 offset:14336
s_waitcnt lgkmcnt(13)
v_pk_add_f32 v[108:109], v[108:109], v[128:129]
v_pk_add_f32 v[110:111], v[110:111], v[130:131]
s_waitcnt lgkmcnt(10)
v_pk_add_f32 v[112:113], v[112:113], v[132:133]
v_pk_add_f32 v[114:115], v[114:115], v[134:135]
v_pk_add_f32 v[20:21], v[20:21], v[148:149]
v_pk_add_f32 v[22:23], v[22:23], v[150:151]
s_waitcnt lgkmcnt(9)
v_pk_add_f32 v[24:25], v[24:25], v[152:153]
v_pk_add_f32 v[26:27], v[26:27], v[154:155]
v_pk_add_f32 v[20:21], v[20:21], v[108:109]
v_pk_add_f32 v[22:23], v[22:23], v[110:111]
v_pk_add_f32 v[24:25], v[24:25], v[112:113]
v_pk_add_f32 v[26:27], v[26:27], v[114:115]
v_cvt_pk_bf16_f32 v48, v20, v21
v_cvt_pk_bf16_f32 v49, v22, v23
v_cvt_pk_bf16_f32 v50, v24, v25
v_cvt_pk_bf16_f32 v51, v26, v27
s_waitcnt lgkmcnt(7)
v_pk_add_f32 v[116:117], v[116:117], v[136:137]
v_pk_add_f32 v[118:119], v[118:119], v[138:139]
s_waitcnt lgkmcnt(4)
v_pk_add_f32 v[120:121], v[120:121], v[140:141]
v_pk_add_f32 v[122:123], v[122:123], v[142:143]
v_pk_add_f32 v[28:29], v[28:29], v[156:157]
v_pk_add_f32 v[30:31], v[30:31], v[158:159]
s_waitcnt lgkmcnt(3)
v_pk_add_f32 v[32:33], v[32:33], v[160:161]
v_pk_add_f32 v[34:35], v[34:35], v[162:163]
v_pk_add_f32 v[28:29], v[28:29], v[116:117]
v_pk_add_f32 v[30:31], v[30:31], v[118:119]
v_pk_add_f32 v[32:33], v[32:33], v[120:121]
v_pk_add_f32 v[34:35], v[34:35], v[122:123]
v_cvt_pk_bf16_f32 v52, v28, v29
v_cvt_pk_bf16_f32 v53, v30, v31
v_cvt_pk_bf16_f32 v54, v32, v33
v_cvt_pk_bf16_f32 v55, v34, v35
s_waitcnt lgkmcnt(1)
v_pk_add_f32 v[124:125], v[124:125], v[144:145]
v_pk_add_f32 v[126:127], v[126:127], v[146:147]
s_waitcnt lgkmcnt(0)
v_pk_add_f32 v[36:37], v[36:37], v[164:165]
v_pk_add_f32 v[38:39], v[38:39], v[166:167]
v_pk_add_f32 v[36:37], v[36:37], v[124:125]
v_pk_add_f32 v[38:39], v[38:39], v[126:127]
v_cvt_pk_bf16_f32 v56, v36, v37
v_cvt_pk_bf16_f32 v57, v38, v39
buffer_store_dwordx4 v[48:51], v14, s[4:7], s74 offen sc1
buffer_store_dwordx4 v[52:55], v14, s[4:7], s74 offen offset:512 sc1
buffer_store_dwordx2 v[56:57], v15, s[4:7], s74 offen sc1
v_pk_add_f32 v[108:109], v[20:21], v[22:23]
v_pk_mul_f32 v[110:111], v[20:21], v[20:21]
v_pk_fma_f32 v[110:111], v[22:23], v[22:23], v[110:111]
v_pk_add_f32 v[108:109], v[108:109], v[24:25]
v_pk_fma_f32 v[110:111], v[24:25], v[24:25], v[110:111]
v_pk_add_f32 v[108:109], v[108:109], v[26:27]
v_pk_fma_f32 v[110:111], v[26:27], v[26:27], v[110:111]
v_pk_add_f32 v[108:109], v[108:109], v[28:29]
v_pk_fma_f32 v[110:111], v[28:29], v[28:29], v[110:111]
v_pk_add_f32 v[108:109], v[108:109], v[30:31]
v_pk_fma_f32 v[110:111], v[30:31], v[30:31], v[110:111]
v_pk_add_f32 v[108:109], v[108:109], v[32:33]
v_pk_fma_f32 v[110:111], v[32:33], v[32:33], v[110:111]
v_pk_add_f32 v[108:109], v[108:109], v[34:35]
v_pk_fma_f32 v[110:111], v[34:35], v[34:35], v[110:111]
v_pk_add_f32 v[108:109], v[108:109], v[36:37]
v_pk_fma_f32 v[110:111], v[36:37], v[36:37], v[110:111]
v_pk_add_f32 v[108:109], v[108:109], v[38:39]
v_pk_fma_f32 v[110:111], v[38:39], v[38:39], v[110:111]
v_add_f32 v108, v108, v109
v_add_f32 v109, v110, v111
v_mov_b32 v110, v108
v_mov_b32 v111, v109
s_nop 0
v_permlane32_swap_b32 v110, v108
v_permlane32_swap_b32 v111, v109
v_add_f32 v108, v108, v110
v_add_f32 v109, v109, v111
v_mov_b32 v110, v108
v_mov_b32 v111, v109
s_nop 0
v_permlane16_swap_b32 v110, v108
v_permlane16_swap_b32 v111, v109
v_add_f32 v108, v108, v110
v_add_f32 v109, v109, v111
buffer_store_dwordx2 v[108:109], v17, s[4:7], s76 offen sc1
s_barrier
s_add_u32 s31, s24, 8192
buffer_load_dwordx4 v[192:195], v1, s[4:7], s31 offen offset:0 sc1
s_add_u32 m0, s25, 0
s_add_u32 s30, s22, 98304
buffer_load_dwordx4 v1, s[4:7], s30 offen sc1 lds
buffer_load_dwordx4 v1, s[4:7], s30 offen offset:1024 sc1 lds
buffer_load_dwordx4 v1, s[4:7], s30 offen offset:2048 sc1 lds
s_waitcnt vmcnt(4)
buffer_atomic_add v9, v255, s[4:7], s100 offen offset:0 sc1
buffer_load_dwordx4 v1, s[4:7], s30 offen offset:3072 sc1 lds
s_add_u32 m0, s25, 16384
s_add_u32 s30, s22, 114688
buffer_load_dwordx4 v1, s[4:7], s30 offen sc1 lds
buffer_load_dwordx4 v1, s[4:7], s30 offen offset:1024 sc1 lds
buffer_load_dwordx4 v1, s[4:7], s30 offen offset:2048 sc1 lds
buffer_load_dwordx4 v1, s[4:7], s30 offen offset:3072 sc1 lds
s_add_u32 m0, s25, 32768
s_add_u32 s30, s22, 131072
buffer_load_dwordx4 v1, s[4:7], s30 offen sc1 lds
buffer_load_dwordx4 v1, s[4:7], s30 offen offset:1024 sc1 lds
buffer_load_dwordx4 v1, s[4:7], s30 offen offset:2048 sc1 lds
buffer_load_dwordx4 v1, s[4:7], s30 offen offset:3072 sc1 lds
s_add_u32 m0, s25, 49152
s_add_u32 s30, s22, 147456
buffer_load_dwordx4 v1, s[4:7], s30 offen sc1 lds
buffer_load_dwordx4 v1, s[4:7], s30 offen offset:1024 sc1 lds
buffer_load_dwordx4 v1, s[4:7], s30 offen offset:2048 sc1 lds
buffer_load_dwordx4 v1, s[4:7], s30 offen offset:3072 sc1 lds
ds_read_b128 v[112:115], v2 offset:0
ds_read_b128 v[116:119], v2 offset:1024
ds_read_b128 v[120:123], v2 offset:2048
ds_read_b128 v[124:127], v2 offset:3072
ds_read_b128 v[128:131], v2 offset:4096
ds_read_b128 v[132:135], v2 offset:5120
s_load_dword s15, s[4:5], s101 offset:0 glc
s_waitcnt lgkmcnt(0)
s_cmp_ge_u32 s15, 16
s_cbranch_scc0 SP38
BK39:
s_add_u32 s78, s26, 67108864
buffer_load_dwordx4 a[0:3], v4, s[4:7], s78 offen offset:0 sc1
buffer_load_dwordx4 a[4:7], v4, s[4:7], s78 offen offset:2048 sc1
buffer_load_dwordx4 a[8:11], v4, s[4:7], s78 offen offset:256 sc1
buffer_load_dwordx4 a[12:15], v4, s[4:7], s78 offen offset:2304 sc1
s_add_u32 s78, s26, 67112960
buffer_load_dwordx4 a[16:19], v4, s[4:7], s78 offen offset:0 sc1
buffer_load_dwordx4 a[20:23], v4, s[4:7], s78 offen offset:2048 sc1
buffer_load_dwordx4 a[24:27], v4, s[4:7], s78 offen offset:256 sc1
buffer_load_dwordx4 a[28:31], v4, s[4:7], s78 offen offset:2304 sc1
s_add_u32 s78, s26, 67125248
buffer_load_dwordx4 a[32:35], v4, s[4:7], s78 offen offset:0 sc1
buffer_load_dwordx4 a[36:39], v4, s[4:7], s78 offen offset:2048 sc1
buffer_load_dwordx4 a[40:43], v4, s[4:7], s78 offen offset:256 sc1
s_waitcnt vmcnt(9)
v_mfma_f32_16x16x32_bf16 v[48:51], v[112:115], a[0:3], 0
buffer_load_dwordx4 a[44:47], v4, s[4:7], s78 offen offset:2304 sc1
v_mfma_f32_16x16x32_bf16 v[48:51], v[116:119], a[4:7], v[48:51]
s_waitcnt vmcnt(8)
v_mfma_f32_16x16x32_bf16 v[56:59], v[112:115], a[8:11], 0
ds_read_b128 v[112:115], v2 offset:6144
v_mfma_f32_16x16x32_bf16 v[56:59], v[116:119], a[12:15], v[56:59]
ds_read_b128 v[116:119], v2 offset:7168
v_mfma_f32_16x16x32_bf16 v[52:55], v[120:123], a[0:3], 0
s_add_u32 s78, s26, 67129344
v_mfma_f32_16x16x32_bf16 v[52:55], v[124:127], a[4:7], v[52:55]
buffer_load_dwordx4 a[48:51], v4, s[4:7], s78 offen offset:0 sc1
v_mfma_f32_16x16x32_bf16 v[60:63], v[120:123], a[8:11], 0
ds_read_b128 v[120:123], v2 offset:8192
v_mfma_f32_16x16x32_bf16 v[60:63], v[124:127], a[12:15], v[60:63]
ds_read_b128 v[124:127], v2 offset:9216
v_mfma_f32_16x16x32_bf16 v[64:67], v[128:131], a[0:3], 0
buffer_load_dwordx4 a[52:55], v4, s[4:7], s78 offen offset:2048 sc1
v_mfma_f32_16x16x32_bf16 v[64:67], v[132:135], a[4:7], v[64:67]
v_lshrrev_b32 v136, 4, v0
v_lshlrev_b32 v136, 11, v136
v_mfma_f32_16x16x32_bf16 v[72:75], v[128:131], a[8:11], 0
ds_read_b128 v[128:131], v2 offset:10240
v_and_b32 v137, 15, v0
v_mfma_f32_16x16x32_bf16 v[72:75], v[132:135], a[12:15], v[72:75]
ds_read_b128 v[132:135], v2 offset:11264
s_waitcnt lgkmcnt(4)
v_mfma_f32_16x16x32_bf16 v[68:71], v[112:115], a[0:3], 0
buffer_load_dwordx4 a[56:59], v4, s[4:7], s78 offen offset:256 sc1
v_mfma_f32_16x16x32_bf16 v[68:71], v[116:119], a[4:7], v[68:71]
v_lshl_add_u32 v136, v137, 3, v136
v_lshl_add_u32 v136, s18, 8, v136
v_mfma_f32_16x16x32_bf16 v[76:79], v[112:115], a[8:11], 0
ds_read_b128 v[112:115], v2 offset:12288
v_mfma_f32_16x16x32_bf16 v[76:79], v[116:119], a[12:15], v[76:79]
ds_read_b128 v[116:119], v2 offset:13312
s_waitcnt vmcnt(9) lgkmcnt(4)
v_mfma_f32_16x16x32_bf16 v[48:51], v[120:123], a[16:19], v[48:51]
buffer_load_dwordx4 a[60:63], v4, s[4:7], s78 offen offset:2304 sc1
v_mfma_f32_16x16x32_bf16 v[48:51], v[124:127], a[20:23], v[48:51]
s_waitcnt vmcnt(8)
v_mfma_f32_16x16x32_bf16 v[56:59], v[120:123], a[24:27], v[56:59]
ds_read_b128 v[120:123], v2 offset:14336
v_mfma_f32_16x16x32_bf16 v[56:59], v[124:127], a[28:31], v[56:59]
ds_read_b128 v[124:127], v2 offset:15360
s_waitcnt lgkmcnt(4)
v_mfma_f32_16x16x32_bf16 v[52:55], v[128:131], a[16:19], v[52:55]
s_add_u32 s78, s26, 67141632
v_mfma_f32_16x16x32_bf16 v[52:55], v[132:135], a[20:23], v[52:55]
buffer_load_dwordx4 a[64:67], v4, s[4:7], s78 offen offset:0 sc1
v_mfma_f32_16x16x32_bf16 v[60:63], v[128:131], a[24:27], v[60:63]
ds_read_b128 v[128:131], v2 offset:16384
v_mfma_f32_16x16x32_bf16 v[60:63], v[132:135], a[28:31], v[60:63]
ds_read_b128 v[132:135], v2 offset:17408
s_waitcnt lgkmcnt(4)
v_mfma_f32_16x16x32_bf16 v[64:67], v[112:115], a[16:19], v[64:67]
buffer_load_dwordx4 a[68:71], v4, s[4:7], s78 offen offset:2048 sc1
v_mfma_f32_16x16x32_bf16 v[64:67], v[116:119], a[20:23], v[64:67]
v_mfma_f32_16x16x32_bf16 v[72:75], v[112:115], a[24:27], v[72:75]
ds_read_b128 v[112:115], v2 offset:18432
v_mfma_f32_16x16x32_bf16 v[72:75], v[116:119], a[28:31], v[72:75]
ds_read_b128 v[116:119], v2 offset:19456
s_waitcnt lgkmcnt(4)
v_mfma_f32_16x16x32_bf16 v[68:71], v[120:123], a[16:19], v[68:71]
buffer_load_dwordx4 a[72:75], v4, s[4:7], s78 offen offset:256 sc1
v_mfma_f32_16x16x32_bf16 v[68:71], v[124:127], a[20:23], v[68:71]
v_mfma_f32_16x16x32_bf16 v[76:79], v[120:123], a[24:27], v[76:79]
ds_read_b128 v[120:123], v2 offset:20480
v_mfma_f32_16x16x32_bf16 v[76:79], v[124:127], a[28:31], v[76:79]
ds_read_b128 v[124:127], v2 offset:21504
s_waitcnt vmcnt(9) lgkmcnt(4)
v_mfma_f32_16x16x32_bf16 v[48:51], v[128:131], a[32:35], v[48:51]
buffer_load_dwordx4 a[76:79], v4, s[4:7], s78 offen offset:2304 sc1
v_mfma_f32_16x16x32_bf16 v[48:51], v[132:135], a[36:39], v[48:51]
s_waitcnt vmcnt(8)
v_mfma_f32_16x16x32_bf16 v[56:59], v[128:131], a[40:43], v[56:59]
ds_read_b128 v[128:131], v2 offset:22528
v_mfma_f32_16x16x32_bf16 v[56:59], v[132:135], a[44:47], v[56:59]
ds_read_b128 v[132:135], v2 offset:23552
s_waitcnt lgkmcnt(4)
v_mfma_f32_16x16x32_bf16 v[52:55], v[112:115], a[32:35], v[52:55]
s_add_u32 s78, s26, 67145728
v_mfma_f32_16x16x32_bf16 v[52:55], v[116:119], a[36:39], v[52:55]
buffer_load_dwordx4 a[80:83], v4, s[4:7], s78 offen offset:0 sc1
v_mfma_f32_16x16x32_bf16 v[60:63], v[112:115], a[40:43], v[60:63]
ds_read_b128 v[112:115], v2 offset:24576
v_mfma_f32_16x16x32_bf16 v[60:63], v[116:119], a[44:47], v[60:63]
ds_read_b128 v[116:119], v2 offset:25600
s_waitcnt lgkmcnt(4)
v_mfma_f32_16x16x32_bf16 v[64:67], v[120:123], a[32:35], v[64:67]
buffer_load_dwordx4 a[84:87], v4, s[4:7], s78 offen offset:2048 sc1
v_mfma_f32_16x16x32_bf16 v[64:67], v[124:127], a[36:39], v[64:67]
buffer_load_dwordx4 a[88:91], v4, s[4:7], s78 offen offset:256 sc1
v_mfma_f32_16x16x32_bf16 v[72:75], v[120:123], a[40:43], v[72:75]
ds_read_b128 v[120:123], v2 offset:26624
v_mfma_f32_16x16x32_bf16 v[72:75], v[124:127], a[44:47], v[72:75]
ds_read_b128 v[124:127], v2 offset:27648
s_waitcnt lgkmcnt(4)
v_mfma_f32_16x16x32_bf16 v[68:71], v[128:131], a[32:35], v[68:71]
buffer_load_dwordx4 a[92:95], v4, s[4:7], s78 offen offset:2304 sc1
v_mfma_f32_16x16x32_bf16 v[68:71], v[132:135], a[36:39], v[68:71]
v_mfma_f32_16x16x32_bf16 v[76:79], v[128:131], a[40:43], v[76:79]
ds_read_b128 v[128:131], v2 offset:28672
v_mfma_f32_16x16x32_bf16 v[76:79], v[132:135], a[44:47], v[76:79]
ds_read_b128 v[132:135], v2 offset:29696
s_waitcnt vmcnt(10) lgkmcnt(4)
v_mfma_f32_16x16x32_bf16 v[48:51], v[112:115], a[48:51], v[48:51]
s_add_u32 s78, s26, 67158016
v_mfma_f32_16x16x32_bf16 v[48:51], v[116:119], a[52:55], v[48:51]
buffer_load_dwordx4 a[96:99], v4, s[4:7], s78 offen offset:0 sc1
s_waitcnt vmcnt(9)
v_mfma_f32_16x16x32_bf16 v[56:59], v[112:115], a[56:59], v[56:59]
ds_read_b128 v[112:115], v2 offset:30720
v_mfma_f32_16x16x32_bf16 v[56:59], v[116:119], a[60:63], v[56:59]
ds_read_b128 v[116:119], v2 offset:31744
s_waitcnt lgkmcnt(4)
v_mfma_f32_16x16x32_bf16 v[52:55], v[120:123], a[48:51], v[52:55]
buffer_load_dwordx4 a[100:103], v4, s[4:7], s78 offen offset:2048 sc1
v_mfma_f32_16x16x32_bf16 v[52:55], v[124:127], a[52:55], v[52:55]
v_mfma_f32_16x16x32_bf16 v[60:63], v[120:123], a[56:59], v[60:63]
ds_read_b128 v[120:123], v2 offset:32768
v_mfma_f32_16x16x32_bf16 v[60:63], v[124:127], a[60:63], v[60:63]
ds_read_b128 v[124:127], v2 offset:33792
s_waitcnt lgkmcnt(4)
v_mfma_f32_16x16x32_bf16 v[64:67], v[128:131], a[48:51], v[64:67]
s_and_b32 s76, s99, 0xffffe000
s_add_u32 s76, s76, 4294918144
v_mfma_f32_16x16x32_bf16 v[64:67], v[132:135], a[52:55], v[64:67]
buffer_load_dwordx2 v[144:145], v136, s[4:7], s76 offen offset:0 sc1
v_mfma_f32_16x16x32_bf16 v[72:75], v[128:131], a[56:59], v[72:75]
ds_read_b128 v[128:131], v2 offset:34816
v_mfma_f32_16x16x32_bf16 v[72:75], v[132:135], a[60:63], v[72:75]
ds_read_b128 v[132:135], v2 offset:35840
s_waitcnt lgkmcnt(4)
v_mfma_f32_16x16x32_bf16 v[68:71], v[112:115], a[48:51], v[68:71]
buffer_load_dwordx4 a[200:203], v4, s[4:7], s78 offen offset:256 sc1
v_mfma_f32_16x16x32_bf16 v[68:71], v[116:119], a[52:55], v[68:71]
buffer_load_dwordx2 v[146:147], v136, s[4:7], s76 offen offset:1024 sc1
v_mfma_f32_16x16x32_bf16 v[76:79], v[112:115], a[56:59], v[76:79]
ds_read_b128 v[112:115], v2 offset:36864
v_mfma_f32_16x16x32_bf16 v[76:79], v[116:119], a[60:63], v[76:79]
ds_read_b128 v[116:119], v2 offset:37888
PG_s6:
s_cbranch_execz PG_b2
s_waitcnt vmcnt(11) lgkmcnt(4)
v_mfma_f32_16x16x32_bf16 v[48:51], v[120:123], a[64:67], v[48:51]
buffer_load_dwordx4 a[204:207], v4, s[4:7], s78 offen offset:2304 sc1
v_mfma_f32_16x16x32_bf16 v[48:51], v[124:127], a[68:71], v[48:51]
buffer_load_dwordx2 v[148:149], v136, s[4:7], s76 offen offset:128 sc1
s_waitcnt vmcnt(11)
v_mfma_f32_16x16x32_bf16 v[56:59], v[120:123], a[72:75], v[56:59]
ds_read_b128 v[120:123], v2 offset:38912
v_mfma_f32_16x16x32_bf16 v[56:59], v[124:127], a[76:79], v[56:59]
ds_read_b128 v[124:127], v2 offset:39936
s_waitcnt lgkmcnt(4)
v_mfma_f32_16x16x32_bf16 v[52:55], v[128:131], a[64:67], v[52:55]
s_add_u32 s78, s26, 67162112
v_mfma_f32_16x16x32_bf16 v[52:55], v[132:135], a[68:71], v[52:55]
buffer_load_dwordx4 a[208:211], v4, s[4:7], s78 offen offset:0 sc1
v_mfma_f32_16x16x32_bf16 v[60:63], v[128:131], a[72:75], v[60:63]
ds_read_b128 v[128:131], v2 offset:40960
v_mfma_f32_16x16x32_bf16 v[60:63], v[132:135], a[76:79], v[60:63]
ds_read_b128 v[132:135], v2 offset:41984
s_waitcnt lgkmcnt(4)
v_mfma_f32_16x16x32_bf16 v[64:67], v[112:115], a[64:67], v[64:67]
buffer_load_dwordx2 v[150:151], v136, s[4:7], s76 offen offset:1152 sc1
v_mfma_f32_16x16x32_bf16 v[64:67], v[116:119], a[68:71], v[64:67]
buffer_load_dwordx4 a[212:215], v4, s[4:7], s78 offen offset:2048 sc1
v_mfma_f32_16x16x32_bf16 v[72:75], v[112:115], a[72:75], v[72:75]
ds_read_b128 v[112:115], v2 offset:43008
v_mfma_f32_16x16x32_bf16 v[72:75], v[116:119], a[76:79], v[72:75]
ds_read_b128 v[116:119], v2 offset:44032
s_waitcnt lgkmcnt(4)
v_mfma_f32_16x16x32_bf16 v[68:71], v[120:123], a[64:67], v[68:71]
buffer_load_dwordx4 a[216:219], v4, s[4:7], s78 offen offset:256 sc1
v_mfma_f32_16x16x32_bf16 v[68:71], v[124:127], a[68:71], v[68:71]
buffer_load_dwordx4 a[220:223], v4, s[4:7], s78 offen offset:2304 sc1
v_mfma_f32_16x16x32_bf16 v[76:79], v[120:123], a[72:75], v[76:79]
ds_read_b128 v[120:123], v2 offset:45056
v_mfma_f32_16x16x32_bf16 v[76:79], v[124:127], a[76:79], v[76:79]
ds_read_b128 v[124:127], v2 offset:46080
s_waitcnt vmcnt(14) lgkmcnt(4)
v_mfma_f32_16x16x32_bf16 v[48:51], v[128:131], a[80:83], v[48:51]
s_add_u32 s78, s26, 67174400
v_mfma_f32_16x16x32_bf16 v[48:51], v[132:135], a[84:87], v[48:51]
buffer_load_dwordx4 a[224:227], v4, s[4:7], s78 offen offset:0 sc1
s_waitcnt vmcnt(13)
v_mfma_f32_16x16x32_bf16 v[56:59], v[128:131], a[88:91], v[56:59]
ds_read_b128 v[128:131], v2 offset:47104
v_mfma_f32_16x16x32_bf16 v[56:59], v[132:135], a[92:95], v[56:59]
ds_read_b128 v[132:135], v2 offset:48128
s_waitcnt lgkmcnt(4)
v_mfma_f32_16x16x32_bf16 v[52:55], v[112:115], a[80:83], v[52:55]
buffer_load_dwordx4 a[228:231], v4, s[4:7], s78 offen offset:2048 sc1
v_mfma_f32_16x16x32_bf16 v[52:55], v[116:119], a[84:87], v[52:55]
v_mfma_f32_16x16x32_bf16 v[60:63], v[112:115], a[88:91], v[60:63]
ds_read_b128 v[112:115], v2 offset:49152
v_mfma_f32_16x16x32_bf16 v[60:63], v[116:119], a[92:95], v[60:63]
ds_read_b128 v[116:119], v2 offset:50176
s_waitcnt lgkmcnt(4)
v_mfma_f32_16x16x32_bf16 v[64:67], v[120:123], a[80:83], v[64:67]
buffer_load_dwordx4 a[232:235], v4, s[4:7], s78 offen offset:256 sc1
v_mfma_f32_16x16x32_bf16 v[64:67], v[124:127], a[84:87], v[64:67]
v_mfma_f32_16x16x32_bf16 v[72:75], v[120:123], a[88:91], v[72:75]
ds_read_b128 v[120:123], v2 offset:51200
v_mfma_f32_16x16x32_bf16 v[72:75], v[124:127], a[92:95], v[72:75]
ds_read_b128 v[124:127], v2 offset:52224
s_waitcnt lgkmcnt(4)
v_mfma_f32_16x16x32_bf16 v[68:71], v[128:131], a[80:83], v[68:71]
buffer_load_dwordx4 a[236:239], v4, s[4:7], s78 offen offset:2304 sc1
v_mfma_f32_16x16x32_bf16 v[68:71], v[132:135], a[84:87], v[68:71]
v_mfma_f32_16x16x32_bf16 v[76:79], v[128:131], a[88:91], v[76:79]
ds_read_b128 v[128:131], v2 offset:53248
v_mfma_f32_16x16x32_bf16 v[76:79], v[132:135], a[92:95], v[76:79]
ds_read_b128 v[132:135], v2 offset:54272
s_waitcnt vmcnt(14) lgkmcnt(4)
v_mfma_f32_16x16x32_bf16 v[48:51], v[112:115], a[96:99], v[48:51]
s_add_u32 s78, s26, 67178496
v_mfma_f32_16x16x32_bf16 v[48:51], v[116:119], a[100:103], v[48:51]
buffer_load_dwordx4 a[240:243], v4, s[4:7], s78 offen offset:0 sc1
s_waitcnt vmcnt(11)
v_mfma_f32_16x16x32_bf16 v[56:59], v[112:115], a[200:203], v[56:59]
ds_read_b128 v[112:115], v2 offset:55296
v_mfma_f32_16x16x32_bf16 v[56:59], v[116:119], a[204:207], v[56:59]
ds_read_b128 v[116:119], v2 offset:56320
s_waitcnt lgkmcnt(4)
v_mfma_f32_16x16x32_bf16 v[52:55], v[120:123], a[96:99], v[52:55]
s_mul_i32 s77, s17, 6144
s_add_u32 s77, s77, 262144
v_mfma_f32_16x16x32_bf16 v[52:55], v[124:127], a[100:103], v[52:55]
buffer_load_dwordx4 v[152:155], v1, s[4:7], s77 offen offset:0 sc1
v_mfma_f32_16x16x32_bf16 v[60:63], v[120:123], a[200:203], v[60:63]
ds_read_b128 v[120:123], v2 offset:57344
buffer_load_dwordx4 a[244:247], v4, s[4:7], s78 offen offset:2048 sc1
v_mfma_f32_16x16x32_bf16 v[60:63], v[124:127], a[204:207], v[60:63]
ds_read_b128 v[124:127], v2 offset:58368
s_waitcnt lgkmcnt(4)
v_mfma_f32_16x16x32_bf16 v[64:67], v[128:131], a[96:99], v[64:67]
buffer_load_dwordx4 v[156:159], v1, s[4:7], s77 offen offset:1024 sc1
v_mfma_f32_16x16x32_bf16 v[64:67], v[132:135], a[100:103], v[64:67]
buffer_load_dwordx4 a[248:251], v4, s[4:7], s78 offen offset:256 sc1
v_mfma_f32_16x16x32_bf16 v[72:75], v[128:131], a[200:203], v[72:75]
ds_read_b128 v[128:131], v2 offset:59392
v_mfma_f32_16x16x32_bf16 v[72:75], v[132:135], a[204:207], v[72:75]
ds_read_b128 v[132:135], v2 offset:60416
s_waitcnt lgkmcnt(4)
v_mfma_f32_16x16x32_bf16 v[68:71], v[112:115], a[96:99], v[68:71]
s_sub_u32 s12, 15, s16
s_min_u32 s12, s12, 2
v_mfma_f32_16x16x32_bf16 v[68:71], v[116:119], a[100:103], v[68:71]
s_load_dword s15, s[4:5], s91 offset:16 glc
v_add_f32 v144, v144, v146
v_mfma_f32_16x16x32_bf16 v[76:79], v[112:115], a[200:203], v[76:79]
ds_read_b128 v[112:115], v2 offset:61440
v_add_f32 v145, v145, v147
v_mfma_f32_16x16x32_bf16 v[76:79], v[116:119], a[204:207], v[76:79]
ds_read_b128 v[116:119], v2 offset:62464
s_waitcnt vmcnt(11) lgkmcnt(4)
v_mfma_f32_16x16x32_bf16 v[48:51], v[120:123], a[208:211], v[48:51]
buffer_load_dwordx4 a[252:255], v4, s[4:7], s78 offen offset:2304 sc1
v_mfma_f32_16x16x32_bf16 v[48:51], v[124:127], a[212:215], v[48:51]
v_add_f32 v148, v148, v150
v_add_f32 v149, v149, v151
s_waitcnt vmcnt(10)
v_mfma_f32_16x16x32_bf16 v[56:59], v[120:123], a[216:219], v[56:59]
ds_read_b128 v[120:123], v2 offset:63488
v_mov_b32 v146, v144
v_mfma_f32_16x16x32_bf16 v[56:59], v[124:127], a[220:223], v[56:59]
ds_read_b128 v[124:127], v2 offset:64512
s_waitcnt lgkmcnt(4)
v_mfma_f32_16x16x32_bf16 v[52:55], v[128:131], a[208:211], v[52:55]
v_mov_b32 v147, v145
v_mov_b32 v150, v148
v_mfma_f32_16x16x32_bf16 v[52:55], v[132:135], a[212:215], v[52:55]
v_mov_b32 v151, v149
v_permlane32_swap_b32 v146, v144
v_mfma_f32_16x16x32_bf16 v[60:63], v[128:131], a[216:219], v[60:63]
ds_read_b128 v[128:131], v3 offset:0
v_permlane32_swap_b32 v147, v145
v_mfma_f32_16x16x32_bf16 v[60:63], v[132:135], a[220:223], v[60:63]
ds_read_b128 v[132:135], v3 offset:1024
s_waitcnt lgkmcnt(4)
v_mfma_f32_16x16x32_bf16 v[64:67], v[112:115], a[208:211], v[64:67]
v_permlane32_swap_b32 v150, v148
v_permlane32_swap_b32 v151, v149
v_mfma_f32_16x16x32_bf16 v[64:67], v[116:119], a[212:215], v[64:67]
v_add_f32 v144, v144, v146
v_add_f32 v145, v145, v147
v_mfma_f32_16x16x32_bf16 v[72:75], v[112:115], a[216:219], v[72:75]
ds_read_b128 v[112:115], v3 offset:2048
v_add_f32 v148, v148, v150
v_mfma_f32_16x16x32_bf16 v[72:75], v[116:119], a[220:223], v[72:75]
ds_read_b128 v[116:119], v3 offset:3072
s_waitcnt lgkmcnt(4)
v_mfma_f32_16x16x32_bf16 v[68:71], v[120:123], a[208:211], v[68:71]
buffer_load_dwordx4 v[196:199], v1, s[4:7], s31 offen offset:1024 sc1
v_mfma_f32_16x16x32_bf16 v[68:71], v[124:127], a[212:215], v[68:71]
buffer_load_dwordx4 v[200:203], v1, s[4:7], s31 offen offset:2048 sc1
v_mfma_f32_16x16x32_bf16 v[76:79], v[120:123], a[216:219], v[76:79]
ds_read_b128 v[120:123], v3 offset:4096
v_add_f32 v149, v149, v151
v_mfma_f32_16x16x32_bf16 v[76:79], v[124:127], a[220:223], v[76:79]
ds_read_b128 v[124:127], v3 offset:5120
s_waitcnt vmcnt(10) lgkmcnt(4)
v_mfma_f32_16x16x32_bf16 v[48:51], v[128:131], a[224:227], v[48:51]
buffer_load_dwordx4 v[204:207], v1, s[4:7], s31 offen offset:3072 sc1
v_mfma_f32_16x16x32_bf16 v[48:51], v[132:135], a[228:231], v[48:51]
v_mov_b32 v146, v144
v_mov_b32 v147, v145
s_waitcnt vmcnt(9)
v_mfma_f32_16x16x32_bf16 v[56:59], v[128:131], a[232:235], v[56:59]
ds_read_b128 v[128:131], v3 offset:6144
v_mov_b32 v150, v148
v_mfma_f32_16x16x32_bf16 v[56:59], v[132:135], a[236:239], v[56:59]
ds_read_b128 v[132:135], v3 offset:7168
s_waitcnt lgkmcnt(4)
v_mfma_f32_16x16x32_bf16 v[52:55], v[112:115], a[224:227], v[52:55]
s_add_u32 s31, s24, 12288
buffer_load_dwordx4 v[208:211], v1, s[4:7], s31 offen offset:0 sc1
v_mfma_f32_16x16x32_bf16 v[52:55], v[116:119], a[228:231], v[52:55]
buffer_load_dwordx4 v[212:215], v1, s[4:7], s31 offen offset:1024 sc1
v_mfma_f32_16x16x32_bf16 v[60:63], v[112:115], a[232:235], v[60:63]
ds_read_b128 v[112:115], v3 offset:8192
v_mov_b32 v151, v149
v_mfma_f32_16x16x32_bf16 v[60:63], v[116:119], a[236:239], v[60:63]
ds_read_b128 v[116:119], v3 offset:9216
s_waitcnt lgkmcnt(4)
v_mfma_f32_16x16x32_bf16 v[64:67], v[120:123], a[224:227], v[64:67]
buffer_load_dwordx4 a[104:107], v1, s[4:7], s31 offen offset:2048 sc1
v_mfma_f32_16x16x32_bf16 v[64:67], v[124:127], a[228:231], v[64:67]
v_permlane16_swap_b32 v146, v144
v_permlane16_swap_b32 v147, v145
v_mfma_f32_16x16x32_bf16 v[72:75], v[120:123], a[232:235], v[72:75]
ds_read_b128 v[120:123], v3 offset:10240
v_permlane16_swap_b32 v150, v148
v_mfma_f32_16x16x32_bf16 v[72:75], v[124:127], a[236:239], v[72:75]
ds_read_b128 v[124:127], v3 offset:11264
s_waitcnt lgkmcnt(4)
v_mfma_f32_16x16x32_bf16 v[68:71], v[128:131], a[224:227], v[68:71]
buffer_load_dwordx4 a[108:111], v1, s[4:7], s31 offen offset:3072 sc1
v_mfma_f32_16x16x32_bf16 v[68:71], v[132:135], a[228:231], v[68:71]
v_permlane16_swap_b32 v151, v149
v_add_f32 v144, v144, v146
v_mfma_f32_16x16x32_bf16 v[76:79], v[128:131], a[232:235], v[76:79]
ds_read_b128 v[128:131], v3 offset:12288
v_add_f32 v145, v145, v147
v_mfma_f32_16x16x32_bf16 v[76:79], v[132:135], a[236:239], v[76:79]
ds_read_b128 v[132:135], v3 offset:13312
s_waitcnt vmcnt(10) lgkmcnt(4)
v_mfma_f32_16x16x32_bf16 v[48:51], v[112:115], a[240:243], v[48:51]
s_add_u32 s31, s24, 16384
buffer_load_dwordx4 a[112:115], v1, s[4:7], s31 offen offset:0 sc1
v_mfma_f32_16x16x32_bf16 v[48:51], v[116:119], a[244:247], v[48:51]
buffer_load_dwordx4 a[116:119], v1, s[4:7], s31 offen offset:1024 sc1
s_waitcnt vmcnt(9)
v_mfma_f32_16x16x32_bf16 v[56:59], v[112:115], a[248:251], v[56:59]
ds_read_b128 v[112:115], v3 offset:14336
v_add_f32 v148, v148, v150
v_mfma_f32_16x16x32_bf16 v[56:59], v[116:119], a[252:255], v[56:59]
ds_read_b128 v[116:119], v3 offset:15360
s_waitcnt lgkmcnt(4)
v_mfma_f32_16x16x32_bf16 v[52:55], v[120:123], a[240:243], v[52:55]
buffer_load_dwordx4 a[120:123], v1, s[4:7], s31 offen offset:2048 sc1
v_mfma_f32_16x16x32_bf16 v[52:55], v[124:127], a[244:247], v[52:55]
v_add_f32 v149, v149, v151
v_mul_f32 v144, 0xbacccccd, v144
v_mfma_f32_16x16x32_bf16 v[60:63], v[120:123], a[248:251], v[60:63]
ds_read_b128 v[120:123], v3 offset:16384
v_cvt_pk_bf16_f32 v40, v144, v144
v_mfma_f32_16x16x32_bf16 v[60:63], v[124:127], a[252:255], v[60:63]
ds_read_b128 v[124:127], v3 offset:17408
s_waitcnt lgkmcnt(0)
s_cmp_ge_u32 s15, s12
s_cbranch_scc0 SP40
BK41:
v_mfma_f32_16x16x32_bf16 v[64:67], v[128:131], a[240:243], v[64:67]
buffer_load_dwordx4 a[124:127], v1, s[4:7], s31 offen offset:3072 sc1
v_mfma_f32_16x16x32_bf16 v[64:67], v[132:135], a[244:247], v[64:67]
s_add_u32 s31, s24, 20480
buffer_load_dwordx4 a[128:131], v1, s[4:7], s31 offen offset:0 sc1
v_mfma_f32_16x16x32_bf16 v[72:75], v[128:131], a[248:251], v[72:75]
ds_read_b128 v[128:131], v3 offset:18432
v_cvt_pk_bf16_f32 v41, v144, v144
v_mfma_f32_16x16x32_bf16 v[72:75], v[132:135], a[252:255], v[72:75]
ds_read_b128 v[132:135], v3 offset:19456
v_mul_f32 v148, 0xbacccccd, v148
v_mfma_f32_16x16x32_bf16 v[68:71], v[112:115], a[240:243], v[68:71]
buffer_load_dwordx4 a[132:135], v1, s[4:7], s31 offen offset:1024 sc1
v_cvt_pk_bf16_f32 v42, v148, v148
v_cvt_pk_bf16_f32 v43, v148, v148
v_mfma_f32_16x16x32_bf16 v[68:71], v[116:119], a[244:247], v[68:71]
v_mul_f32 v145, 0x3acccccd, v145
v_fma_f32 v145, -v144, v144, v145
v_mfma_f32_16x16x32_bf16 v[76:79], v[112:115], a[248:251], v[76:79]
ds_read_b128 v[112:115], v3 offset:20480
v_max_f32 v145, 0, v145
v_add_f32 v46, 0x3727c5ac, v145
v_mfma_f32_16x16x32_bf16 v[76:79], v[116:119], a[252:255], v[76:79]
ds_read_b128 v[116:119], v3 offset:21504
v_rsq_f32 v146, v46
v_mfma_f32_16x16x16_bf16 v[48:51], v[152:153], v[40:41], v[48:51]
buffer_load_dwordx4 a[136:139], v1, s[4:7], s31 offen offset:2048 sc1
v_rcp_f32 v147, v46
v_mfma_f32_16x16x16_bf16 v[56:59], v[152:153], v[42:43], v[56:59]
v_mul_f32 v44, 0xc0135761, v146
v_mul_f32 v45, 0x3d372713, v44
v_mfma_f32_16x16x16_bf16 v[52:55], v[154:155], v[40:41], v[52:55]
buffer_load_dwordx4 a[140:143], v1, s[4:7], s31 offen offset:3072 sc1
v_mul_f32 v45, v147, v45
v_mul_f32 v149, 0x3acccccd, v149
v_mfma_f32_16x16x16_bf16 v[60:63], v[154:155], v[42:43], v[60:63]
v_fma_f32 v149, -v148, v148, v149
v_max_f32 v149, 0, v149
v_mfma_f32_16x16x16_bf16 v[64:67], v[156:157], v[40:41], v[64:67]
s_add_u32 s31, s24, 24576
buffer_load_dwordx4 a[144:147], v1, s[4:7], s31 offen offset:0 sc1
v_add_f32 v254, 0x3727c5ac, v149
v_rsq_f32 v150, v254
v_mfma_f32_16x16x16_bf16 v[72:75], v[156:157], v[42:43], v[72:75]
v_rcp_f32 v151, v254
v_mfma_f32_16x16x16_bf16 v[68:71], v[158:159], v[40:41], v[68:71]
v_mul_f32 v248, 0xc0135761, v150
v_mul_f32 v249, 0x3d372713, v248
v_mfma_f32_16x16x16_bf16 v[76:79], v[158:159], v[42:43], v[76:79]
v_mul_f32 v249, v151, v249
v_mfma_f32_16x16x32_bf16 v[80:83], v[120:123], a[0:3], 0
v_mfma_f32_16x16x32_bf16 v[80:83], v[124:127], a[4:7], v[80:83]
v_mfma_f32_16x16x32_bf16 v[88:91], v[120:123], a[8:11], 0
ds_read_b128 v[120:123], v3 offset:22528
v_mfma_f32_16x16x32_bf16 v[88:91], v[124:127], a[12:15], v[88:91]
ds_read_b128 v[124:127], v3 offset:23552
s_barrier
s_waitcnt lgkmcnt(4)
v_mfma_f32_16x16x32_bf16 v[84:87], v[128:131], a[0:3], 0
s_add_u32 m0, s25, 65536
s_add_u32 s30, s22, 163840
v_mfma_f32_16x16x32_bf16 v[84:87], v[132:135], a[4:7], v[84:87]
buffer_load_dwordx4 v1, s[4:7], s30 offen sc1 lds
v_mfma_f32_16x16x32_bf16 v[92:95], v[128:131], a[8:11], 0
ds_read_b128 v[128:131], v3 offset:24576
v_mul_f32 v144, v48, v48
v_mfma_f32_16x16x32_bf16 v[92:95], v[132:135], a[12:15], v[92:95]
ds_read_b128 v[132:135], v3 offset:25600
s_waitcnt lgkmcnt(4)
v_mfma_f32_16x16x32_bf16 v[96:99], v[112:115], a[0:3], 0
s_add_u32 s74, s17, 0
s_and_b32 s74, s74, 3
s_lshl_b32 s74, s74, 11
v_mfma_f32_16x16x32_bf16 v[96:99], v[116:119], a[4:7], v[96:99]
s_and_b32 s75, s29, 0xffffe000
s_add_u32 s74, s74, s75
v_mfma_f32_16x16x32_bf16 v[104:107], v[112:115], a[8:11], 0
ds_read_b128 v[112:115], v3 offset:26624
v_mul_f32 v145, v49, v49
v_mfma_f32_16x16x32_bf16 v[104:107], v[116:119], a[12:15], v[104:107]
ds_read_b128 v[116:119], v3 offset:27648
s_waitcnt lgkmcnt(4)
v_mfma_f32_16x16x32_bf16 v[100:103], v[120:123], a[0:3], 0
buffer_load_dwordx4 v1, s[4:7], s30 offen offset:1024 sc1 lds
v_mfma_f32_16x16x32_bf16 v[100:103], v[124:127], a[4:7], v[100:103]
v_mul_f32 v146, v50, v50
v_mul_f32 v147, v51, v51
v_mfma_f32_16x16x32_bf16 v[108:111], v[120:123], a[8:11], 0
ds_read_b128 v[120:123], v3 offset:28672
v_fma_f32 v144, v144, v45, v44
v_mfma_f32_16x16x32_bf16 v[108:111], v[124:127], a[12:15], v[108:111]
ds_read_b128 v[124:127], v3 offset:29696
s_waitcnt lgkmcnt(4)
v_mfma_f32_16x16x32_bf16 v[80:83], v[128:131], a[16:19], v[80:83]
buffer_load_dwordx4 v1, s[4:7], s30 offen offset:2048 sc1 lds
v_mfma_f32_16x16x32_bf16 v[80:83], v[132:135], a[20:23], v[80:83]
v_fma_f32 v145, v145, v45, v44
v_fma_f32 v146, v146, v45, v44
v_mfma_f32_16x16x32_bf16 v[88:91], v[128:131], a[24:27], v[88:91]
ds_read_b128 v[128:131], v3 offset:30720
v_fma_f32 v147, v147, v45, v44
v_mfma_f32_16x16x32_bf16 v[88:91], v[132:135], a[28:31], v[88:91]
ds_read_b128 v[132:135], v3 offset:31744
s_barrier
s_waitcnt lgkmcnt(4)
v_mfma_f32_16x16x32_bf16 v[84:87], v[112:115], a[16:19], v[84:87]
buffer_load_dwordx4 v1, s[4:7], s30 offen offset:3072 sc1 lds
v_mfma_f32_16x16x32_bf16 v[84:87], v[116:119], a[20:23], v[84:87]
v_mul_f32 v144, v144, v48
v_mul_f32 v145, v145, v49
v_mfma_f32_16x16x32_bf16 v[92:95], v[112:115], a[24:27], v[92:95]
ds_read_b128 v[112:115], v1 offset:0
v_mul_f32 v146, v146, v50
v_mfma_f32_16x16x32_bf16 v[92:95], v[116:119], a[28:31], v[92:95]
ds_read_b128 v[116:119], v1 offset:1024
s_waitcnt lgkmcnt(4)
v_mfma_f32_16x16x32_bf16 v[96:99], v[120:123], a[16:19], v[96:99]
s_add_u32 m0, s25, 81920
s_add_u32 s30, s22, 180224
v_mfma_f32_16x16x32_bf16 v[96:99], v[124:127], a[20:23], v[96:99]
buffer_load_dwordx4 v1, s[4:7], s30 offen sc1 lds
v_mfma_f32_16x16x32_bf16 v[104:107], v[120:123], a[24:27], v[104:107]
ds_read_b128 v[120:123], v1 offset:2048
v_mul_f32 v147, v147, v51
v_mfma_f32_16x16x32_bf16 v[104:107], v[124:127], a[28:31], v[104:107]
ds_read_b128 v[124:127], v1 offset:3072
s_waitcnt lgkmcnt(4)
v_mfma_f32_16x16x32_bf16 v[100:103], v[128:131], a[16:19], v[100:103]
buffer_load_dwordx4 v1, s[4:7], s30 offen offset:1024 sc1 lds
v_mfma_f32_16x16x32_bf16 v[100:103], v[132:135], a[20:23], v[100:103]
v_exp_f32 v144, v144
v_mfma_f32_16x16x32_bf16 v[108:111], v[128:131], a[24:27], v[108:111]
ds_read_b128 v[128:131], v1 offset:4096
v_mfma_f32_16x16x32_bf16 v[108:111], v[132:135], a[28:31], v[108:111]
ds_read_b128 v[132:135], v1 offset:5120
s_waitcnt lgkmcnt(4)
v_mfma_f32_16x16x32_bf16 v[80:83], v[112:115], a[32:35], v[80:83]
v_exp_f32 v145, v145
v_mfma_f32_16x16x32_bf16 v[80:83], v[116:119], a[36:39], v[80:83]
v_exp_f32 v146, v146
v_mfma_f32_16x16x32_bf16 v[88:91], v[112:115], a[40:43], v[88:91]
ds_read_b128 v[112:115], v1 offset:6144
v_mfma_f32_16x16x32_bf16 v[88:91], v[116:119], a[44:47], v[88:91]
ds_read_b128 v[116:119], v1 offset:7168
s_waitcnt lgkmcnt(4)
v_mfma_f32_16x16x32_bf16 v[84:87], v[120:123], a[32:35], v[84:87]
buffer_load_dwordx4 v1, s[4:7], s30 offen offset:2048 sc1 lds
v_mfma_f32_16x16x32_bf16 v[84:87], v[124:127], a[36:39], v[84:87]
v_exp_f32 v147, v147
v_mfma_f32_16x16x32_bf16 v[92:95], v[120:123], a[40:43], v[92:95]
ds_read_b128 v[120:123], v1 offset:8192
v_mul_f32 v48, v48, v64
v_mfma_f32_16x16x32_bf16 v[92:95], v[124:127], a[44:47], v[92:95]
ds_read_b128 v[124:127], v1 offset:9216
s_waitcnt lgkmcnt(4)
v_mfma_f32_16x16x32_bf16 v[96:99], v[128:131], a[32:35], v[96:99]
buffer_load_dwordx4 v1, s[4:7], s30 offen offset:3072 sc1 lds
v_mfma_f32_16x16x32_bf16 v[96:99], v[132:135], a[36:39], v[96:99]
v_mul_f32 v49, v49, v65
v_mul_f32 v50, v50, v66
v_mfma_f32_16x16x32_bf16 v[104:107], v[128:131], a[40:43], v[104:107]
ds_read_b128 v[128:131], v1 offset:10240
v_mul_f32 v51, v51, v67
v_mfma_f32_16x16x32_bf16 v[104:107], v[132:135], a[44:47], v[104:107]
ds_read_b128 v[132:135], v1 offset:11264
s_waitcnt lgkmcnt(4)
v_mfma_f32_16x16x32_bf16 v[100:103], v[112:115], a[32:35], v[100:103]
s_add_u32 m0, s25, 98304
s_add_u32 s30, s22, 196608
v_mfma_f32_16x16x32_bf16 v[100:103], v[116:119], a[36:39], v[100:103]
buffer_load_dwordx4 v1, s[4:7], s30 offen sc1 lds
v_mfma_f32_16x16x32_bf16 v[108:111], v[112:115], a[40:43], v[108:111]
ds_read_b128 v[112:115], v1 offset:12288
v_fma_f32 v144, v144, v46, v46
v_mfma_f32_16x16x32_bf16 v[108:111], v[116:119], a[44:47], v[108:111]
ds_read_b128 v[116:119], v1 offset:13312
s_waitcnt lgkmcnt(4)
v_mfma_f32_16x16x32_bf16 v[80:83], v[120:123], a[48:51], v[80:83]
buffer_load_dwordx4 v1, s[4:7], s30 offen offset:1024 sc1 lds
v_mfma_f32_16x16x32_bf16 v[80:83], v[124:127], a[52:55], v[80:83]
v_fma_f32 v145, v145, v46, v46
v_fma_f32 v146, v146, v46, v46
v_mfma_f32_16x16x32_bf16 v[88:91], v[120:123], a[56:59], v[88:91]
ds_read_b128 v[120:123], v1 offset:14336
v_fma_f32 v147, v147, v46, v46
v_mfma_f32_16x16x32_bf16 v[88:91], v[124:127], a[60:63], v[88:91]
ds_read_b128 v[124:127], v1 offset:15360
s_waitcnt lgkmcnt(4)
v_mfma_f32_16x16x32_bf16 v[84:87], v[128:131], a[48:51], v[84:87]
v_rcp_f32 v144, v144
v_mfma_f32_16x16x32_bf16 v[84:87], v[132:135], a[52:55], v[84:87]
v_rcp_f32 v145, v145
v_mfma_f32_16x16x32_bf16 v[92:95], v[128:131], a[56:59], v[92:95]
ds_read_b128 v[128:131], v1 offset:16384
v_mfma_f32_16x16x32_bf16 v[92:95], v[132:135], a[60:63], v[92:95]
ds_read_b128 v[132:135], v1 offset:17408
s_waitcnt lgkmcnt(4)
v_mfma_f32_16x16x32_bf16 v[96:99], v[112:115], a[48:51], v[96:99]
buffer_load_dwordx4 v1, s[4:7], s30 offen offset:2048 sc1 lds
v_mfma_f32_16x16x32_bf16 v[96:99], v[116:119], a[52:55], v[96:99]
v_rcp_f32 v146, v146
v_mfma_f32_16x16x32_bf16 v[104:107], v[112:115], a[56:59], v[104:107]
ds_read_b128 v[112:115], v1 offset:18432
v_mfma_f32_16x16x32_bf16 v[104:107], v[116:119], a[60:63], v[104:107]
ds_read_b128 v[116:119], v1 offset:19456
s_waitcnt lgkmcnt(4)
v_mfma_f32_16x16x32_bf16 v[100:103], v[120:123], a[48:51], v[100:103]
buffer_load_dwordx4 v1, s[4:7], s30 offen offset:3072 sc1 lds
v_mfma_f32_16x16x32_bf16 v[100:103], v[124:127], a[52:55], v[100:103]
v_rcp_f32 v147, v147
v_mfma_f32_16x16x32_bf16 v[108:111], v[120:123], a[56:59], v[108:111]
ds_read_b128 v[120:123], v1 offset:20480
v_mul_f32 v48, v48, v144
v_mfma_f32_16x16x32_bf16 v[108:111], v[124:127], a[60:63], v[108:111]
ds_read_b128 v[124:127], v1 offset:21504
s_waitcnt lgkmcnt(4)
v_mfma_f32_16x16x32_bf16 v[80:83], v[128:131], a[64:67], v[80:83]
s_add_u32 m0, s25, 114688
s_add_u32 s30, s22, 212992
v_mfma_f32_16x16x32_bf16 v[80:83], v[132:135], a[68:71], v[80:83]
buffer_load_dwordx4 v1, s[4:7], s30 offen sc1 lds
v_mfma_f32_16x16x32_bf16 v[88:91], v[128:131], a[72:75], v[88:91]
ds_read_b128 v[128:131], v1 offset:22528
v_mul_f32 v49, v49, v145
v_mfma_f32_16x16x32_bf16 v[88:91], v[132:135], a[76:79], v[88:91]
ds_read_b128 v[132:135], v1 offset:23552
s_waitcnt lgkmcnt(4)
v_mfma_f32_16x16x32_bf16 v[84:87], v[112:115], a[64:67], v[84:87]
buffer_load_dwordx4 v1, s[4:7], s30 offen offset:1024 sc1 lds
v_mfma_f32_16x16x32_bf16 v[84:87], v[116:119], a[68:71], v[84:87]
v_mul_f32 v50, v50, v146
v_mul_f32 v51, v51, v147
v_mfma_f32_16x16x32_bf16 v[92:95], v[112:115], a[72:75], v[92:95]
ds_read_b128 v[112:115], v1 offset:24576
v_cvt_pk_bf16_f32 v136, v48, v49
v_mfma_f32_16x16x32_bf16 v[92:95], v[116:119], a[76:79], v[92:95]
ds_read_b128 v[116:119], v1 offset:25600
s_waitcnt lgkmcnt(4)
v_mfma_f32_16x16x32_bf16 v[96:99], v[120:123], a[64:67], v[96:99]
v_cvt_pk_bf16_f32 v137, v50, v51
v_mul_f32 v144, v52, v52
v_mfma_f32_16x16x32_bf16 v[96:99], v[124:127], a[68:71], v[96:99]
v_mul_f32 v145, v53, v53
v_mul_f32 v146, v54, v54
v_mfma_f32_16x16x32_bf16 v[104:107], v[120:123], a[72:75], v[104:107]
ds_read_b128 v[120:123], v1 offset:26624
v_mul_f32 v147, v55, v55
v_mfma_f32_16x16x32_bf16 v[104:107], v[124:127], a[76:79], v[104:107]
ds_read_b128 v[124:127], v1 offset:27648
s_waitcnt lgkmcnt(4)
v_mfma_f32_16x16x32_bf16 v[100:103], v[128:131], a[64:67], v[100:103]
buffer_load_dwordx4 v1, s[4:7], s30 offen offset:2048 sc1 lds
v_mfma_f32_16x16x32_bf16 v[100:103], v[132:135], a[68:71], v[100:103]
v_fma_f32 v144, v144, v45, v44
v_fma_f32 v145, v145, v45, v44
v_mfma_f32_16x16x32_bf16 v[108:111], v[128:131], a[72:75], v[108:111]
ds_read_b128 v[128:131], v1 offset:28672
v_fma_f32 v146, v146, v45, v44
v_mfma_f32_16x16x32_bf16 v[108:111], v[132:135], a[76:79], v[108:111]
ds_read_b128 v[132:135], v1 offset:29696
s_waitcnt lgkmcnt(4)
v_mfma_f32_16x16x32_bf16 v[80:83], v[112:115], a[80:83], v[80:83]
buffer_load_dwordx4 v1, s[4:7], s30 offen offset:3072 sc1 lds
v_mfma_f32_16x16x32_bf16 v[80:83], v[116:119], a[84:87], v[80:83]
v_fma_f32 v147, v147, v45, v44
v_mul_f32 v144, v144, v52
v_mfma_f32_16x16x32_bf16 v[88:91], v[112:115], a[88:91], v[88:91]
ds_read_b128 v[112:115], v1 offset:30720
v_mul_f32 v145, v145, v53
v_mfma_f32_16x16x32_bf16 v[88:91], v[116:119], a[92:95], v[88:91]
ds_read_b128 v[116:119], v1 offset:31744
s_waitcnt lgkmcnt(4)
v_mfma_f32_16x16x32_bf16 v[84:87], v[120:123], a[80:83], v[84:87]
s_add_u32 m0, s25, 131072
s_add_u32 s30, s22, 229376
v_mfma_f32_16x16x32_bf16 v[84:87], v[124:127], a[84:87], v[84:87]
buffer_load_dwordx4 v1, s[4:7], s30 offen sc1 lds
v_mfma_f32_16x16x32_bf16 v[92:95], v[120:123], a[88:91], v[92:95]
ds_read_b128 v[120:123], v1 offset:32768
v_mul_f32 v146, v146, v54
v_mul_f32 v147, v147, v55
v_mfma_f32_16x16x32_bf16 v[92:95], v[124:127], a[92:95], v[92:95]
ds_read_b128 v[124:127], v1 offset:33792
v_exp_f32 v144, v144
s_waitcnt lgkmcnt(4)
v_mfma_f32_16x16x32_bf16 v[96:99], v[128:131], a[80:83], v[96:99]
buffer_load_dwordx4 v1, s[4:7], s30 offen offset:1024 sc1 lds
v_exp_f32 v145, v145
v_mfma_f32_16x16x32_bf16 v[96:99], v[132:135], a[84:87], v[96:99]
v_exp_f32 v146, v146
v_mfma_f32_16x16x32_bf16 v[104:107], v[128:131], a[88:91], v[104:107]
ds_read_b128 v[128:131], v1 offset:34816
v_exp_f32 v147, v147
v_mfma_f32_16x16x32_bf16 v[104:107], v[132:135], a[92:95], v[104:107]
ds_read_b128 v[132:135], v1 offset:35840
v_mul_f32 v52, v52, v68
v_mul_f32 v53, v53, v69
s_waitcnt lgkmcnt(4)
v_mfma_f32_16x16x32_bf16 v[100:103], v[112:115], a[80:83], v[100:103]
v_mul_f32 v54, v54, v70
v_mul_f32 v55, v55, v71
v_mfma_f32_16x16x32_bf16 v[100:103], v[116:119], a[84:87], v[100:103]
v_fma_f32 v144, v144, v46, v46
v_fma_f32 v145, v145, v46, v46
v_mfma_f32_16x16x32_bf16 v[108:111], v[112:115], a[88:91], v[108:111]
ds_read_b128 v[112:115], v1 offset:36864
v_fma_f32 v146, v146, v46, v46
v_fma_f32 v147, v147, v46, v46
v_mfma_f32_16x16x32_bf16 v[108:111], v[116:119], a[92:95], v[108:111]
ds_read_b128 v[116:119], v1 offset:37888
v_rcp_f32 v144, v144
s_waitcnt lgkmcnt(4)
v_mfma_f32_16x16x32_bf16 v[80:83], v[120:123], a[96:99], v[80:83]
buffer_load_dwordx4 v1, s[4:7], s30 offen offset:2048 sc1 lds
v_rcp_f32 v145, v145
v_mfma_f32_16x16x32_bf16 v[80:83], v[124:127], a[100:103], v[80:83]
v_rcp_f32 v146, v146
v_mfma_f32_16x16x32_bf16 v[88:91], v[120:123], a[200:203], v[88:91]
ds_read_b128 v[120:123], v1 offset:38912
v_rcp_f32 v147, v147
v_mfma_f32_16x16x32_bf16 v[88:91], v[124:127], a[204:207], v[88:91]
ds_read_b128 v[124:127], v1 offset:39936
v_mul_f32 v52, v52, v144
v_mul_f32 v53, v53, v145
s_waitcnt lgkmcnt(4)
v_mfma_f32_16x16x32_bf16 v[84:87], v[128:131], a[96:99], v[84:87]
buffer_load_dwordx4 v1, s[4:7], s30 offen offset:3072 sc1 lds
v_mul_f32 v54, v54, v146
v_mul_f32 v55, v55, v147
v_mfma_f32_16x16x32_bf16 v[84:87], v[132:135], a[100:103], v[84:87]
v_cvt_pk_bf16_f32 v138, v52, v53
v_cvt_pk_bf16_f32 v139, v54, v55
v_mfma_f32_16x16x32_bf16 v[92:95], v[128:131], a[200:203], v[92:95]
ds_read_b128 v[128:131], v1 offset:40960
v_mul_f32 v144, v56, v56
v_mul_f32 v145, v57, v57
v_mfma_f32_16x16x32_bf16 v[92:95], v[132:135], a[204:207], v[92:95]
ds_read_b128 v[132:135], v1 offset:41984
v_mul_f32 v146, v58, v58
v_mul_f32 v147, v59, v59
s_waitcnt lgkmcnt(4)
v_mfma_f32_16x16x32_bf16 v[96:99], v[112:115], a[96:99], v[96:99]
buffer_store_dwordx4 v[136:139], v4, s[4:7], s74 offen sc1
v_fma_f32 v144, v144, v249, v248
v_fma_f32 v145, v145, v249, v248
v_mfma_f32_16x16x32_bf16 v[96:99], v[116:119], a[100:103], v[96:99]
v_fma_f32 v146, v146, v249, v248
v_fma_f32 v147, v147, v249, v248
v_mfma_f32_16x16x32_bf16 v[104:107], v[112:115], a[200:203], v[104:107]
ds_read_b128 v[112:115], v1 offset:43008
v_mul_f32 v144, v144, v56
v_mul_f32 v145, v145, v57
v_mfma_f32_16x16x32_bf16 v[104:107], v[116:119], a[204:207], v[104:107]
ds_read_b128 v[116:119], v1 offset:44032
v_mul_f32 v146, v146, v58
v_mul_f32 v147, v147, v59
s_waitcnt lgkmcnt(4)
v_mfma_f32_16x16x32_bf16 v[100:103], v[120:123], a[96:99], v[100:103]
buffer_load_dwordx4 v[160:163], v1, s[4:7], s77 offen offset:2048 sc1
v_exp_f32 v144, v144
v_mfma_f32_16x16x32_bf16 v[100:103], v[124:127], a[100:103], v[100:103]
PG_s7:
s_cbranch_execz PG_b2
buffer_load_dwordx4 v[164:167], v1, s[4:7], s77 offen offset:3072 sc1
v_exp_f32 v145, v145
v_mfma_f32_16x16x32_bf16 v[108:111], v[120:123], a[200:203], v[108:111]
ds_read_b128 v[120:123], v1 offset:45056
v_exp_f32 v146, v146
v_mfma_f32_16x16x32_bf16 v[108:111], v[124:127], a[204:207], v[108:111]
ds_read_b128 v[124:127], v1 offset:46080
v_exp_f32 v147, v147
s_waitcnt lgkmcnt(4)
v_mfma_f32_16x16x32_bf16 v[80:83], v[128:131], a[208:211], v[80:83]
s_add_u32 s77, s77, 4096
v_mul_f32 v56, v56, v72
v_mul_f32 v57, v57, v73
v_mfma_f32_16x16x32_bf16 v[80:83], v[132:135], a[212:215], v[80:83]
buffer_load_dwordx4 v[168:171], v1, s[4:7], s77 offen offset:0 sc1
v_mul_f32 v58, v58, v74
v_mul_f32 v59, v59, v75
v_mfma_f32_16x16x32_bf16 v[88:91], v[128:131], a[216:219], v[88:91]
ds_read_b128 v[128:131], v1 offset:47104
v_fma_f32 v144, v144, v254, v254
v_fma_f32 v145, v145, v254, v254
v_mfma_f32_16x16x32_bf16 v[88:91], v[132:135], a[220:223], v[88:91]
ds_read_b128 v[132:135], v1 offset:48128
v_fma_f32 v146, v146, v254, v254
v_fma_f32 v147, v147, v254, v254
s_waitcnt lgkmcnt(4)
v_mfma_f32_16x16x32_bf16 v[84:87], v[112:115], a[208:211], v[84:87]
buffer_load_dwordx4 v[172:175], v1, s[4:7], s77 offen offset:1024 sc1
v_rcp_f32 v144, v144
v_mfma_f32_16x16x32_bf16 v[84:87], v[116:119], a[212:215], v[84:87]
v_rcp_f32 v145, v145
v_mfma_f32_16x16x32_bf16 v[92:95], v[112:115], a[216:219], v[92:95]
ds_read_b128 v[112:115], v1 offset:49152
v_rcp_f32 v146, v146
v_mfma_f32_16x16x32_bf16 v[92:95], v[116:119], a[220:223], v[92:95]
ds_read_b128 v[116:119], v1 offset:50176
v_rcp_f32 v147, v147
s_waitcnt lgkmcnt(4)
v_mfma_f32_16x16x32_bf16 v[96:99], v[120:123], a[208:211], v[96:99]
buffer_load_dwordx4 a[148:151], v1, s[4:7], s31 offen offset:1024 sc1
v_mul_f32 v56, v56, v144
v_mul_f32 v57, v57, v145
v_mfma_f32_16x16x32_bf16 v[96:99], v[124:127], a[212:215], v[96:99]
v_mul_f32 v58, v58, v146
v_mul_f32 v59, v59, v147
v_mfma_f32_16x16x32_bf16 v[104:107], v[120:123], a[216:219], v[104:107]
ds_read_b128 v[120:123], v1 offset:51200
v_cvt_pk_bf16_f32 v140, v56, v57
v_cvt_pk_bf16_f32 v141, v58, v59
v_mfma_f32_16x16x32_bf16 v[104:107], v[124:127], a[220:223], v[104:107]
ds_read_b128 v[124:127], v1 offset:52224
v_mul_f32 v144, v60, v60
v_mul_f32 v145, v61, v61
s_waitcnt lgkmcnt(4)
v_mfma_f32_16x16x32_bf16 v[100:103], v[128:131], a[208:211], v[100:103]
buffer_load_dwordx4 a[152:155], v1, s[4:7], s31 offen offset:2048 sc1
v_mul_f32 v146, v62, v62
v_mul_f32 v147, v63, v63
v_mfma_f32_16x16x32_bf16 v[100:103], v[132:135], a[212:215], v[100:103]
v_fma_f32 v144, v144, v249, v248
v_fma_f32 v145, v145, v249, v248
v_mfma_f32_16x16x32_bf16 v[108:111], v[128:131], a[216:219], v[108:111]
ds_read_b128 v[128:131], v1 offset:53248
v_fma_f32 v146, v146, v249, v248
v_fma_f32 v147, v147, v249, v248
v_mfma_f32_16x16x32_bf16 v[108:111], v[132:135], a[220:223], v[108:111]
ds_read_b128 v[132:135], v1 offset:54272
v_mul_f32 v144, v144, v60
v_mul_f32 v145, v145, v61
s_waitcnt lgkmcnt(4)
v_mfma_f32_16x16x32_bf16 v[80:83], v[112:115], a[224:227], v[80:83]
buffer_load_dwordx4 a[156:159], v1, s[4:7], s31 offen offset:3072 sc1
v_mul_f32 v146, v146, v62
v_mul_f32 v147, v147, v63
v_mfma_f32_16x16x32_bf16 v[80:83], v[116:119], a[228:231], v[80:83]
v_exp_f32 v144, v144
v_mfma_f32_16x16x32_bf16 v[88:91], v[112:115], a[232:235], v[88:91]
ds_read_b128 v[112:115], v1 offset:55296
v_exp_f32 v145, v145
v_mfma_f32_16x16x32_bf16 v[88:91], v[116:119], a[236:239], v[88:91]
ds_read_b128 v[116:119], v1 offset:56320
v_exp_f32 v146, v146
s_waitcnt lgkmcnt(4)
v_mfma_f32_16x16x32_bf16 v[84:87], v[120:123], a[224:227], v[84:87]
s_add_u32 s31, s24, 28672
buffer_load_dwordx4 v[176:179], v1, s[4:7], s31 offen offset:0 sc1
v_exp_f32 v147, v147
v_mfma_f32_16x16x32_bf16 v[84:87], v[124:127], a[228:231], v[84:87]
v_mul_f32 v60, v60, v76
v_mul_f32 v61, v61, v77
v_mfma_f32_16x16x32_bf16 v[92:95], v[120:123], a[232:235], v[92:95]
ds_read_b128 v[120:123], v1 offset:57344
v_mul_f32 v62, v62, v78
v_mul_f32 v63, v63, v79
v_mfma_f32_16x16x32_bf16 v[92:95], v[124:127], a[236:239], v[92:95]
ds_read_b128 v[124:127], v1 offset:58368
v_fma_f32 v144, v144, v254, v254
v_fma_f32 v145, v145, v254, v254
s_waitcnt lgkmcnt(4)
v_mfma_f32_16x16x32_bf16 v[96:99], v[128:131], a[224:227], v[96:99]
buffer_load_dwordx4 v[180:183], v1, s[4:7], s31 offen offset:1024 sc1
v_fma_f32 v146, v146, v254, v254
v_fma_f32 v147, v147, v254, v254
v_mfma_f32_16x16x32_bf16 v[96:99], v[132:135], a[228:231], v[96:99]
v_rcp_f32 v144, v144
v_mfma_f32_16x16x32_bf16 v[104:107], v[128:131], a[232:235], v[104:107]
ds_read_b128 v[128:131], v1 offset:59392
v_rcp_f32 v145, v145
v_mfma_f32_16x16x32_bf16 v[104:107], v[132:135], a[236:239], v[104:107]
ds_read_b128 v[132:135], v1 offset:60416
v_rcp_f32 v146, v146
s_waitcnt lgkmcnt(4)
v_mfma_f32_16x16x32_bf16 v[100:103], v[112:115], a[224:227], v[100:103]
buffer_load_dwordx4 v[184:187], v1, s[4:7], s31 offen offset:2048 sc1
v_rcp_f32 v147, v147
v_mfma_f32_16x16x32_bf16 v[100:103], v[116:119], a[228:231], v[100:103]
v_mul_f32 v60, v60, v144
v_mul_f32 v61, v61, v145
v_mfma_f32_16x16x32_bf16 v[108:111], v[112:115], a[232:235], v[108:111]
ds_read_b128 v[112:115], v1 offset:61440
v_mul_f32 v62, v62, v146
v_mul_f32 v63, v63, v147
v_mfma_f32_16x16x32_bf16 v[108:111], v[116:119], a[236:239], v[108:111]
ds_read_b128 v[116:119], v1 offset:62464
v_cvt_pk_bf16_f32 v142, v60, v61
v_cvt_pk_bf16_f32 v143, v62, v63
s_waitcnt lgkmcnt(4)
v_mfma_f32_16x16x32_bf16 v[80:83], v[120:123], a[240:243], v[80:83]
buffer_load_dwordx4 a[160:163], v1, s[4:7], s31 offen offset:3072 sc1
v_mfma_f32_16x16x32_bf16 v[80:83], v[124:127], a[244:247], v[80:83]
buffer_store_dwordx4 v[140:143], v4, s[4:7], s74 offen offset:256 sc1
v_mfma_f32_16x16x32_bf16 v[88:91], v[120:123], a[248:251], v[88:91]
ds_read_b128 v[120:123], v1 offset:63488
v_mfma_f32_16x16x32_bf16 v[88:91], v[124:127], a[252:255], v[88:91]
ds_read_b128 v[124:127], v1 offset:64512
s_waitcnt vmcnt(13)
s_barrier
s_waitcnt lgkmcnt(4)
v_mfma_f32_16x16x32_bf16 v[84:87], v[128:131], a[240:243], v[84:87]
s_add_u32 s31, s24, 32768
buffer_load_dwordx4 a[164:167], v1, s[4:7], s31 offen offset:0 sc1
v_mfma_f32_16x16x32_bf16 v[84:87], v[132:135], a[244:247], v[84:87]
v_mfma_f32_16x16x32_bf16 v[92:95], v[128:131], a[248:251], v[92:95]
ds_read_b128 v[128:131], v2 offset:0
v_mfma_f32_16x16x32_bf16 v[92:95], v[132:135], a[252:255], v[92:95]
ds_read_b128 v[132:135], v2 offset:1024
s_waitcnt lgkmcnt(4)
v_mfma_f32_16x16x32_bf16 v[96:99], v[112:115], a[240:243], v[96:99]
buffer_load_dwordx4 a[168:171], v1, s[4:7], s31 offen offset:1024 sc1
v_mfma_f32_16x16x32_bf16 v[96:99], v[116:119], a[244:247], v[96:99]
v_mfma_f32_16x16x32_bf16 v[104:107], v[112:115], a[248:251], v[104:107]
ds_read_b128 v[112:115], v2 offset:2048
v_mfma_f32_16x16x32_bf16 v[104:107], v[116:119], a[252:255], v[104:107]
ds_read_b128 v[116:119], v2 offset:3072
s_waitcnt lgkmcnt(4)
v_mfma_f32_16x16x32_bf16 v[100:103], v[120:123], a[240:243], v[100:103]
buffer_load_dwordx4 a[172:175], v1, s[4:7], s31 offen offset:2048 sc1
v_mfma_f32_16x16x32_bf16 v[100:103], v[124:127], a[244:247], v[100:103]
v_mfma_f32_16x16x32_bf16 v[108:111], v[120:123], a[248:251], v[108:111]
ds_read_b128 v[120:123], v2 offset:4096
v_mfma_f32_16x16x32_bf16 v[108:111], v[124:127], a[252:255], v[108:111]
ds_read_b128 v[124:127], v2 offset:5120
s_waitcnt vmcnt(14)
v_mfma_f32_16x16x16_bf16 v[80:83], v[160:161], v[40:41], v[80:83]
buffer_load_dwordx4 a[176:179], v1, s[4:7], s31 offen offset:3072 sc1
v_mfma_f32_16x16x16_bf16 v[88:91], v[160:161], v[42:43], v[88:91]
v_mfma_f32_16x16x16_bf16 v[84:87], v[162:163], v[40:41], v[84:87]
v_mfma_f32_16x16x16_bf16 v[92:95], v[162:163], v[42:43], v[92:95]
s_waitcnt vmcnt(14)
v_mfma_f32_16x16x16_bf16 v[96:99], v[164:165], v[40:41], v[96:99]
v_mfma_f32_16x16x16_bf16 v[104:107], v[164:165], v[42:43], v[104:107]
v_mfma_f32_16x16x16_bf16 v[100:103], v[166:167], v[40:41], v[100:103]
v_mfma_f32_16x16x16_bf16 v[108:111], v[166:167], v[42:43], v[108:111]
s_waitcnt lgkmcnt(4)
v_mfma_f32_16x16x32_bf16 v[48:51], v[128:131], a[0:3], 0
v_mfma_f32_16x16x32_bf16 v[48:51], v[132:135], a[4:7], v[48:51]
v_mfma_f32_16x16x32_bf16 v[56:59], v[128:131], a[8:11], 0
ds_read_b128 v[128:131], v2 offset:6144
v_mfma_f32_16x16x32_bf16 v[56:59], v[132:135], a[12:15], v[56:59]
ds_read_b128 v[132:135], v2 offset:7168
s_waitcnt lgkmcnt(4)
v_mfma_f32_16x16x32_bf16 v[52:55], v[112:115], a[0:3], 0
v_mul_f32 v144, v80, v80
v_mul_f32 v145, v81, v81
v_mfma_f32_16x16x32_bf16 v[52:55], v[116:119], a[4:7], v[52:55]
s_add_u32 s74, s17, 1
s_and_b32 s74, s74, 3
s_lshl_b32 s74, s74, 11
v_mfma_f32_16x16x32_bf16 v[60:63], v[112:115], a[8:11], 0
ds_read_b128 v[112:115], v2 offset:8192
v_mul_f32 v146, v82, v82
v_mfma_f32_16x16x32_bf16 v[60:63], v[116:119], a[12:15], v[60:63]
ds_read_b128 v[116:119], v2 offset:9216
s_waitcnt lgkmcnt(4)
v_mfma_f32_16x16x32_bf16 v[64:67], v[120:123], a[0:3], 0
s_and_b32 s75, s29, 0xffffe000
s_add_u32 s74, s74, s75
v_mfma_f32_16x16x32_bf16 v[64:67], v[124:127], a[4:7], v[64:67]
s_add_u32 s31, s24, 36864
buffer_load_dwordx4 a[180:183], v1, s[4:7], s31 offen offset:0 sc1
v_mfma_f32_16x16x32_bf16 v[72:75], v[120:123], a[8:11], 0
ds_read_b128 v[120:123], v2 offset:10240
v_mul_f32 v147, v83, v83
v_mfma_f32_16x16x32_bf16 v[72:75], v[124:127], a[12:15], v[72:75]
ds_read_b128 v[124:127], v2 offset:11264
s_waitcnt lgkmcnt(4)
v_mfma_f32_16x16x32_bf16 v[68:71], v[128:131], a[0:3], 0
buffer_load_dwordx4 a[184:187], v1, s[4:7], s31 offen offset:1024 sc1
v_mfma_f32_16x16x32_bf16 v[68:71], v[132:135], a[4:7], v[68:71]
v_fma_f32 v144, v144, v45, v44
v_fma_f32 v145, v145, v45, v44
v_mfma_f32_16x16x32_bf16 v[76:79], v[128:131], a[8:11], 0
ds_read_b128 v[128:131], v2 offset:12288
v_fma_f32 v146, v146, v45, v44
v_mfma_f32_16x16x32_bf16 v[76:79], v[132:135], a[12:15], v[76:79]
ds_read_b128 v[132:135], v2 offset:13312
s_waitcnt lgkmcnt(4)
v_mfma_f32_16x16x32_bf16 v[48:51], v[112:115], a[16:19], v[48:51]
buffer_load_dwordx4 a[188:191], v1, s[4:7], s31 offen offset:2048 sc1
v_mfma_f32_16x16x32_bf16 v[48:51], v[116:119], a[20:23], v[48:51]
v_fma_f32 v147, v147, v45, v44
v_mul_f32 v144, v144, v80
v_mfma_f32_16x16x32_bf16 v[56:59], v[112:115], a[24:27], v[56:59]
ds_read_b128 v[112:115], v2 offset:14336
v_mul_f32 v145, v145, v81
v_mfma_f32_16x16x32_bf16 v[56:59], v[116:119], a[28:31], v[56:59]
ds_read_b128 v[116:119], v2 offset:15360
s_waitcnt lgkmcnt(4)
v_mfma_f32_16x16x32_bf16 v[52:55], v[120:123], a[16:19], v[52:55]
buffer_load_dwordx4 a[192:195], v1, s[4:7], s31 offen offset:3072 sc1
v_mfma_f32_16x16x32_bf16 v[52:55], v[124:127], a[20:23], v[52:55]
s_waitcnt vmcnt(8)
buffer_atomic_add v9, v8, s[4:7], s98 offen offset:2048 sc1
v_mfma_f32_16x16x32_bf16 v[60:63], v[120:123], a[24:27], v[60:63]
ds_read_b128 v[120:123], v2 offset:16384
v_mul_f32 v146, v146, v82
v_mfma_f32_16x16x32_bf16 v[60:63], v[124:127], a[28:31], v[60:63]
ds_read_b128 v[124:127], v2 offset:17408
s_waitcnt lgkmcnt(4)
v_mfma_f32_16x16x32_bf16 v[64:67], v[128:131], a[16:19], v[64:67]
s_add_u32 s31, s24, 40960
buffer_load_dwordx4 a[196:199], v1, s[4:7], s31 offen offset:0 sc1
v_mfma_f32_16x16x32_bf16 v[64:67], v[132:135], a[20:23], v[64:67]
v_mul_f32 v147, v147, v83
v_mfma_f32_16x16x32_bf16 v[72:75], v[128:131], a[24:27], v[72:75]
ds_read_b128 v[128:131], v2 offset:18432
v_mfma_f32_16x16x32_bf16 v[72:75], v[132:135], a[28:31], v[72:75]
ds_read_b128 v[132:135], v2 offset:19456
s_waitcnt lgkmcnt(4)
v_mfma_f32_16x16x32_bf16 v[68:71], v[112:115], a[16:19], v[68:71]
buffer_load_dwordx4 v[244:247], v1, s[4:7], s31 offen offset:1024 sc1
v_mfma_f32_16x16x32_bf16 v[68:71], v[116:119], a[20:23], v[68:71]
v_exp_f32 v144, v144
v_mfma_f32_16x16x32_bf16 v[76:79], v[112:115], a[24:27], v[76:79]
ds_read_b128 v[112:115], v2 offset:20480
v_mfma_f32_16x16x32_bf16 v[76:79], v[116:119], a[28:31], v[76:79]
ds_read_b128 v[116:119], v2 offset:21504
s_waitcnt lgkmcnt(4)
v_mfma_f32_16x16x32_bf16 v[48:51], v[120:123], a[32:35], v[48:51]
buffer_load_dwordx4 a[0:3], v1, s[4:7], s31 offen offset:2048 sc1
v_mfma_f32_16x16x32_bf16 v[48:51], v[124:127], a[36:39], v[48:51]
v_exp_f32 v145, v145
v_mfma_f32_16x16x32_bf16 v[56:59], v[120:123], a[40:43], v[56:59]
ds_read_b128 v[120:123], v2 offset:22528
v_mfma_f32_16x16x32_bf16 v[56:59], v[124:127], a[44:47], v[56:59]
ds_read_b128 v[124:127], v2 offset:23552
s_waitcnt lgkmcnt(4)
v_mfma_f32_16x16x32_bf16 v[52:55], v[128:131], a[32:35], v[52:55]
buffer_load_dwordx4 a[4:7], v1, s[4:7], s31 offen offset:3072 sc1
v_mfma_f32_16x16x32_bf16 v[52:55], v[132:135], a[36:39], v[52:55]
v_exp_f32 v146, v146
v_mfma_f32_16x16x32_bf16 v[60:63], v[128:131], a[40:43], v[60:63]
ds_read_b128 v[128:131], v2 offset:24576
v_mfma_f32_16x16x32_bf16 v[60:63], v[132:135], a[44:47], v[60:63]
ds_read_b128 v[132:135], v2 offset:25600
s_waitcnt lgkmcnt(4)
v_mfma_f32_16x16x32_bf16 v[64:67], v[112:115], a[32:35], v[64:67]
s_add_u32 s31, s24, 45056
buffer_load_dwordx4 a[8:11], v1, s[4:7], s31 offen offset:0 sc1
v_mfma_f32_16x16x32_bf16 v[64:67], v[116:119], a[36:39], v[64:67]
v_exp_f32 v147, v147
v_mfma_f32_16x16x32_bf16 v[72:75], v[112:115], a[40:43], v[72:75]
ds_read_b128 v[112:115], v2 offset:26624
v_mul_f32 v80, v80, v96
v_mfma_f32_16x16x32_bf16 v[72:75], v[116:119], a[44:47], v[72:75]
ds_read_b128 v[116:119], v2 offset:27648
s_waitcnt lgkmcnt(4)
v_mfma_f32_16x16x32_bf16 v[68:71], v[120:123], a[32:35], v[68:71]
buffer_load_dwordx4 a[12:15], v1, s[4:7], s31 offen offset:1024 sc1
v_mfma_f32_16x16x32_bf16 v[68:71], v[124:127], a[36:39], v[68:71]
v_mul_f32 v81, v81, v97
v_mul_f32 v82, v82, v98
v_mfma_f32_16x16x32_bf16 v[76:79], v[120:123], a[40:43], v[76:79]
ds_read_b128 v[120:123], v2 offset:28672
v_mul_f32 v83, v83, v99
v_mfma_f32_16x16x32_bf16 v[76:79], v[124:127], a[44:47], v[76:79]
ds_read_b128 v[124:127], v2 offset:29696
s_waitcnt lgkmcnt(4)
v_mfma_f32_16x16x32_bf16 v[48:51], v[128:131], a[48:51], v[48:51]
buffer_load_dwordx4 a[16:19], v1, s[4:7], s31 offen offset:2048 sc1
v_fma_f32 v144, v144, v46, v46
v_fma_f32 v145, v145, v46, v46
v_mfma_f32_16x16x32_bf16 v[48:51], v[132:135], a[52:55], v[48:51]
v_fma_f32 v146, v146, v46, v46
v_fma_f32 v147, v147, v46, v46
v_mfma_f32_16x16x32_bf16 v[56:59], v[128:131], a[56:59], v[56:59]
ds_read_b128 v[128:131], v2 offset:30720
v_rcp_f32 v144, v144
v_mfma_f32_16x16x32_bf16 v[56:59], v[132:135], a[60:63], v[56:59]
ds_read_b128 v[132:135], v2 offset:31744
v_rcp_f32 v145, v145
s_waitcnt lgkmcnt(4)
v_mfma_f32_16x16x32_bf16 v[52:55], v[112:115], a[48:51], v[52:55]
buffer_load_dwordx4 a[20:23], v1, s[4:7], s31 offen offset:3072 sc1
v_rcp_f32 v146, v146
v_mfma_f32_16x16x32_bf16 v[52:55], v[116:119], a[52:55], v[52:55]
v_rcp_f32 v147, v147
v_mfma_f32_16x16x32_bf16 v[60:63], v[112:115], a[56:59], v[60:63]
ds_read_b128 v[112:115], v2 offset:32768
v_mul_f32 v80, v80, v144
v_mul_f32 v81, v81, v145
v_mfma_f32_16x16x32_bf16 v[60:63], v[116:119], a[60:63], v[60:63]
ds_read_b128 v[116:119], v2 offset:33792
v_mul_f32 v82, v82, v146
v_mul_f32 v83, v83, v147
s_waitcnt lgkmcnt(4)
v_mfma_f32_16x16x32_bf16 v[64:67], v[120:123], a[48:51], v[64:67]
s_add_u32 s31, s24, 49152
buffer_load_dwordx4 a[24:27], v1, s[4:7], s31 offen offset:0 sc1
v_cvt_pk_bf16_f32 v136, v80, v81
v_cvt_pk_bf16_f32 v137, v82, v83
v_mfma_f32_16x16x32_bf16 v[64:67], v[124:127], a[52:55], v[64:67]
s_load_dword s15, s[4:5], s99 offset:2048 glc
v_mul_f32 v144, v84, v84
v_mul_f32 v145, v85, v85
v_mfma_f32_16x16x32_bf16 v[72:75], v[120:123], a[56:59], v[72:75]
ds_read_b128 v[120:123], v2 offset:34816
v_mul_f32 v146, v86, v86
v_mul_f32 v147, v87, v87
v_mfma_f32_16x16x32_bf16 v[72:75], v[124:127], a[60:63], v[72:75]
ds_read_b128 v[124:127], v2 offset:35840
v_fma_f32 v144, v144, v45, v44
v_fma_f32 v145, v145, v45, v44
s_waitcnt lgkmcnt(4)
v_mfma_f32_16x16x32_bf16 v[68:71], v[128:131], a[48:51], v[68:71]
buffer_load_dwordx4 a[28:31], v1, s[4:7], s31 offen offset:1024 sc1
v_fma_f32 v146, v146, v45, v44
v_fma_f32 v147, v147, v45, v44
v_mfma_f32_16x16x32_bf16 v[68:71], v[132:135], a[52:55], v[68:71]
v_mul_f32 v144, v144, v84
v_mul_f32 v145, v145, v85
v_mfma_f32_16x16x32_bf16 v[76:79], v[128:131], a[56:59], v[76:79]
ds_read_b128 v[128:131], v2 offset:36864
v_mul_f32 v146, v146, v86
v_mul_f32 v147, v147, v87
v_mfma_f32_16x16x32_bf16 v[76:79], v[132:135], a[60:63], v[76:79]
ds_read_b128 v[132:135], v2 offset:37888
v_exp_f32 v144, v144
s_waitcnt lgkmcnt(4)
v_mfma_f32_16x16x32_bf16 v[48:51], v[112:115], a[64:67], v[48:51]
buffer_load_dwordx4 a[32:35], v1, s[4:7], s31 offen offset:2048 sc1
v_exp_f32 v145, v145
v_mfma_f32_16x16x32_bf16 v[48:51], v[116:119], a[68:71], v[48:51]
v_exp_f32 v146, v146
v_mfma_f32_16x16x32_bf16 v[56:59], v[112:115], a[72:75], v[56:59]
ds_read_b128 v[112:115], v2 offset:38912
v_exp_f32 v147, v147
v_mfma_f32_16x16x32_bf16 v[56:59], v[116:119], a[76:79], v[56:59]
ds_read_b128 v[116:119], v2 offset:39936
v_mul_f32 v84, v84, v100
v_mul_f32 v85, v85, v101
s_waitcnt lgkmcnt(4)
v_mfma_f32_16x16x32_bf16 v[52:55], v[120:123], a[64:67], v[52:55]
buffer_load_dwordx4 a[36:39], v1, s[4:7], s31 offen offset:3072 sc1
v_mul_f32 v86, v86, v102
v_mul_f32 v87, v87, v103
v_mfma_f32_16x16x32_bf16 v[52:55], v[124:127], a[68:71], v[52:55]
v_fma_f32 v144, v144, v46, v46
v_fma_f32 v145, v145, v46, v46
v_mfma_f32_16x16x32_bf16 v[60:63], v[120:123], a[72:75], v[60:63]
ds_read_b128 v[120:123], v2 offset:40960
v_fma_f32 v146, v146, v46, v46
v_fma_f32 v147, v147, v46, v46
v_mfma_f32_16x16x32_bf16 v[60:63], v[124:127], a[76:79], v[60:63]
ds_read_b128 v[124:127], v2 offset:41984
v_rcp_f32 v144, v144
s_waitcnt lgkmcnt(4)
v_mfma_f32_16x16x32_bf16 v[64:67], v[128:131], a[64:67], v[64:67]
s_add_u32 s31, s24, 53248
buffer_load_dwordx4 a[40:43], v1, s[4:7], s31 offen offset:0 sc1
v_rcp_f32 v145, v145
v_mfma_f32_16x16x32_bf16 v[64:67], v[132:135], a[68:71], v[64:67]
v_rcp_f32 v146, v146
v_mfma_f32_16x16x32_bf16 v[72:75], v[128:131], a[72:75], v[72:75]
ds_read_b128 v[128:131], v2 offset:43008
v_rcp_f32 v147, v147
v_mfma_f32_16x16x32_bf16 v[72:75], v[132:135], a[76:79], v[72:75]
ds_read_b128 v[132:135], v2 offset:44032
v_mul_f32 v84, v84, v144
v_mul_f32 v85, v85, v145
s_waitcnt lgkmcnt(4)
v_mfma_f32_16x16x32_bf16 v[68:71], v[112:115], a[64:67], v[68:71]
buffer_load_dwordx4 a[44:47], v1, s[4:7], s31 offen offset:1024 sc1
v_mul_f32 v86, v86, v146
v_mul_f32 v87, v87, v147
v_mfma_f32_16x16x32_bf16 v[68:71], v[116:119], a[68:71], v[68:71]
v_cvt_pk_bf16_f32 v138, v84, v85
v_cvt_pk_bf16_f32 v139, v86, v87
v_mfma_f32_16x16x32_bf16 v[76:79], v[112:115], a[72:75], v[76:79]
ds_read_b128 v[112:115], v2 offset:45056
v_mul_f32 v144, v88, v88
v_mul_f32 v145, v89, v89
v_mfma_f32_16x16x32_bf16 v[76:79], v[116:119], a[76:79], v[76:79]
ds_read_b128 v[116:119], v2 offset:46080
v_mul_f32 v146, v90, v90
v_mul_f32 v147, v91, v91
s_waitcnt lgkmcnt(4)
v_mfma_f32_16x16x32_bf16 v[48:51], v[120:123], a[80:83], v[48:51]
buffer_store_dwordx4 v[136:139], v4, s[4:7], s74 offen sc1
v_fma_f32 v144, v144, v249, v248
v_fma_f32 v145, v145, v249, v248
v_mfma_f32_16x16x32_bf16 v[48:51], v[124:127], a[84:87], v[48:51]
buffer_load_dwordx4 a[48:51], v1, s[4:7], s31 offen offset:2048 sc1
v_fma_f32 v146, v146, v249, v248
v_fma_f32 v147, v147, v249, v248
v_mfma_f32_16x16x32_bf16 v[56:59], v[120:123], a[88:91], v[56:59]
ds_read_b128 v[120:123], v2 offset:47104
v_mul_f32 v144, v144, v88
v_mul_f32 v145, v145, v89
v_mfma_f32_16x16x32_bf16 v[56:59], v[124:127], a[92:95], v[56:59]
ds_read_b128 v[124:127], v2 offset:48128
v_mul_f32 v146, v146, v90
v_mul_f32 v147, v147, v91
s_waitcnt lgkmcnt(4)
v_mfma_f32_16x16x32_bf16 v[52:55], v[128:131], a[80:83], v[52:55]
buffer_load_dwordx4 a[52:55], v1, s[4:7], s31 offen offset:3072 sc1
v_exp_f32 v144, v144
v_mfma_f32_16x16x32_bf16 v[52:55], v[132:135], a[84:87], v[52:55]
v_exp_f32 v145, v145
v_mfma_f32_16x16x32_bf16 v[60:63], v[128:131], a[88:91], v[60:63]
ds_read_b128 v[128:131], v2 offset:49152
v_exp_f32 v146, v146
v_mfma_f32_16x16x32_bf16 v[60:63], v[132:135], a[92:95], v[60:63]
ds_read_b128 v[132:135], v2 offset:50176
v_exp_f32 v147, v147
s_waitcnt lgkmcnt(4)
v_mfma_f32_16x16x32_bf16 v[64:67], v[112:115], a[80:83], v[64:67]
v_mul_f32 v88, v88, v104
v_mul_f32 v89, v89, v105
v_mfma_f32_16x16x32_bf16 v[64:67], v[116:119], a[84:87], v[64:67]
v_mul_f32 v90, v90, v106
v_mul_f32 v91, v91, v107
v_mfma_f32_16x16x32_bf16 v[72:75], v[112:115], a[88:91], v[72:75]
ds_read_b128 v[112:115], v2 offset:51200
v_fma_f32 v144, v144, v254, v254
v_fma_f32 v145, v145, v254, v254
v_mfma_f32_16x16x32_bf16 v[72:75], v[116:119], a[92:95], v[72:75]
ds_read_b128 v[116:119], v2 offset:52224
v_fma_f32 v146, v146, v254, v254
v_fma_f32 v147, v147, v254, v254
s_waitcnt lgkmcnt(4)
v_mfma_f32_16x16x32_bf16 v[68:71], v[120:123], a[80:83], v[68:71]
v_rcp_f32 v144, v144
v_mfma_f32_16x16x32_bf16 v[68:71], v[124:127], a[84:87], v[68:71]
v_rcp_f32 v145, v145
v_mfma_f32_16x16x32_bf16 v[76:79], v[120:123], a[88:91], v[76:79]
ds_read_b128 v[120:123], v2 offset:53248
v_rcp_f32 v146, v146
v_mfma_f32_16x16x32_bf16 v[76:79], v[124:127], a[92:95], v[76:79]
ds_read_b128 v[124:127], v2 offset:54272
v_rcp_f32 v147, v147
s_waitcnt lgkmcnt(4)
v_mfma_f32_16x16x32_bf16 v[48:51], v[128:131], a[96:99], v[48:51]
v_mul_f32 v88, v88, v144
v_mul_f32 v89, v89, v145
v_mfma_f32_16x16x32_bf16 v[48:51], v[132:135], a[100:103], v[48:51]
v_mul_f32 v90, v90, v146
v_mul_f32 v91, v91, v147
s_waitcnt lgkmcnt(0)
s_cmp_ge_u32 s15, 8
s_cbranch_scc0 SP42
BK43:
v_mfma_f32_16x16x32_bf16 v[56:59], v[128:131], a[200:203], v[56:59]
ds_read_b128 v[128:131], v2 offset:55296
v_cvt_pk_bf16_f32 v140, v88, v89
v_cvt_pk_bf16_f32 v141, v90, v91
v_mfma_f32_16x16x32_bf16 v[56:59], v[132:135], a[204:207], v[56:59]
ds_read_b128 v[132:135], v2 offset:56320
v_mul_f32 v144, v92, v92
v_mul_f32 v145, v93, v93
v_mfma_f32_16x16x32_bf16 v[52:55], v[112:115], a[96:99], v[52:55]
s_add_u32 s78, s70, 0
v_mul_f32 v146, v94, v94
v_mul_f32 v147, v95, v95
v_mfma_f32_16x16x32_bf16 v[52:55], v[116:119], a[100:103], v[52:55]
buffer_load_dwordx4 a[56:59], v4, s[4:7], s78 offen sc1
v_fma_f32 v144, v144, v249, v248
v_fma_f32 v145, v145, v249, v248
v_mfma_f32_16x16x32_bf16 v[60:63], v[112:115], a[200:203], v[60:63]
ds_read_b128 v[112:115], v2 offset:57344
v_fma_f32 v146, v146, v249, v248
v_fma_f32 v147, v147, v249, v248
v_mfma_f32_16x16x32_bf16 v[60:63], v[116:119], a[204:207], v[60:63]
ds_read_b128 v[116:119], v2 offset:58368
v_mul_f32 v144, v144, v92
v_mul_f32 v145, v145, v93
v_mfma_f32_16x16x32_bf16 v[64:67], v[120:123], a[96:99], v[64:67]
s_add_u32 s78, s70, 18432
v_mul_f32 v146, v146, v94
v_mul_f32 v147, v147, v95
v_mfma_f32_16x16x32_bf16 v[64:67], v[124:127], a[100:103], v[64:67]
buffer_load_dwordx4 a[60:63], v4, s[4:7], s78 offen sc1
v_exp_f32 v144, v144
v_mfma_f32_16x16x32_bf16 v[72:75], v[120:123], a[200:203], v[72:75]
ds_read_b128 v[120:123], v2 offset:59392
v_exp_f32 v145, v145
v_mfma_f32_16x16x32_bf16 v[72:75], v[124:127], a[204:207], v[72:75]
ds_read_b128 v[124:127], v2 offset:60416
v_exp_f32 v146, v146
s_waitcnt lgkmcnt(4)
v_mfma_f32_16x16x32_bf16 v[68:71], v[128:131], a[96:99], v[68:71]
s_add_u32 s78, s71, 0
v_exp_f32 v147, v147
v_mfma_f32_16x16x32_bf16 v[68:71], v[132:135], a[100:103], v[68:71]
buffer_load_dwordx4 a[64:67], v4, s[4:7], s78 offen sc1
v_mul_f32 v92, v92, v108
v_mul_f32 v93, v93, v109
v_mfma_f32_16x16x32_bf16 v[76:79], v[128:131], a[200:203], v[76:79]
ds_read_b128 v[128:131], v2 offset:61440
v_mul_f32 v94, v94, v110
v_mul_f32 v95, v95, v111
v_mfma_f32_16x16x32_bf16 v[76:79], v[132:135], a[204:207], v[76:79]
ds_read_b128 v[132:135], v2 offset:62464
v_fma_f32 v144, v144, v254, v254
v_fma_f32 v145, v145, v254, v254
s_waitcnt lgkmcnt(4)
v_mfma_f32_16x16x32_bf16 v[48:51], v[112:115], a[208:211], v[48:51]
s_add_u32 s78, s71, 18432
v_fma_f32 v146, v146, v254, v254
v_fma_f32 v147, v147, v254, v254
v_mfma_f32_16x16x32_bf16 v[48:51], v[116:119], a[212:215], v[48:51]
buffer_load_dwordx4 a[68:71], v4, s[4:7], s78 offen sc1
v_rcp_f32 v144, v144
v_mfma_f32_16x16x32_bf16 v[56:59], v[112:115], a[216:219], v[56:59]
ds_read_b128 v[112:115], v2 offset:63488
v_rcp_f32 v145, v145
v_mfma_f32_16x16x32_bf16 v[56:59], v[116:119], a[220:223], v[56:59]
ds_read_b128 v[116:119], v2 offset:64512
v_rcp_f32 v146, v146
s_waitcnt lgkmcnt(4)
v_mfma_f32_16x16x32_bf16 v[52:55], v[120:123], a[208:211], v[52:55]
s_add_u32 s78, s72, 0
v_rcp_f32 v147, v147
v_mfma_f32_16x16x32_bf16 v[52:55], v[124:127], a[212:215], v[52:55]
buffer_load_dwordx4 a[72:75], v4, s[4:7], s78 offen sc1
v_mul_f32 v92, v92, v144
v_mul_f32 v93, v93, v145
v_mfma_f32_16x16x32_bf16 v[60:63], v[120:123], a[216:219], v[60:63]
ds_read_b128 v[120:123], v3 offset:0
v_mul_f32 v94, v94, v146
v_mul_f32 v95, v95, v147
v_mfma_f32_16x16x32_bf16 v[60:63], v[124:127], a[220:223], v[60:63]
ds_read_b128 v[124:127], v3 offset:1024
v_cvt_pk_bf16_f32 v142, v92, v93
v_cvt_pk_bf16_f32 v143, v94, v95
s_waitcnt lgkmcnt(4)
v_mfma_f32_16x16x32_bf16 v[64:67], v[128:131], a[208:211], v[64:67]
buffer_store_dwordx4 v[140:143], v4, s[4:7], s74 offen offset:256 sc1
v_mfma_f32_16x16x32_bf16 v[64:67], v[132:135], a[212:215], v[64:67]
v_mfma_f32_16x16x32_bf16 v[72:75], v[128:131], a[216:219], v[72:75]
ds_read_b128 v[128:131], v3 offset:2048
v_mfma_f32_16x16x32_bf16 v[72:75], v[132:135], a[220:223], v[72:75]
ds_read_b128 v[132:135], v3 offset:3072
s_waitcnt lgkmcnt(4)
v_mfma_f32_16x16x32_bf16 v[68:71], v[112:115], a[208:211], v[68:71]
s_add_u32 s78, s72, 18432
v_mfma_f32_16x16x32_bf16 v[68:71], v[116:119], a[212:215], v[68:71]
buffer_load_dwordx4 a[76:79], v4, s[4:7], s78 offen sc1
v_mfma_f32_16x16x32_bf16 v[76:79], v[112:115], a[216:219], v[76:79]
ds_read_b128 v[112:115], v3 offset:4096
v_mfma_f32_16x16x32_bf16 v[76:79], v[116:119], a[220:223], v[76:79]
ds_read_b128 v[116:119], v3 offset:5120
s_waitcnt lgkmcnt(4)
v_mfma_f32_16x16x32_bf16 v[48:51], v[120:123], a[224:227], v[48:51]
s_add_u32 s78, s73, 0
v_mfma_f32_16x16x32_bf16 v[48:51], v[124:127], a[228:231], v[48:51]
buffer_load_dwordx4 a[80:83], v4, s[4:7], s78 offen sc1
v_mfma_f32_16x16x32_bf16 v[56:59], v[120:123], a[232:235], v[56:59]
ds_read_b128 v[120:123], v3 offset:6144
v_mfma_f32_16x16x32_bf16 v[56:59], v[124:127], a[236:239], v[56:59]
ds_read_b128 v[124:127], v3 offset:7168
s_waitcnt lgkmcnt(4)
v_mfma_f32_16x16x32_bf16 v[52:55], v[128:131], a[224:227], v[52:55]
s_add_u32 s78, s73, 18432
v_mfma_f32_16x16x32_bf16 v[52:55], v[132:135], a[228:231], v[52:55]
buffer_load_dwordx4 a[84:87], v4, s[4:7], s78 offen sc1
v_mfma_f32_16x16x32_bf16 v[60:63], v[128:131], a[232:235], v[60:63]
ds_read_b128 v[128:131], v3 offset:8192
v_mfma_f32_16x16x32_bf16 v[60:63], v[132:135], a[236:239], v[60:63]
ds_read_b128 v[132:135], v3 offset:9216
s_waitcnt lgkmcnt(4)
v_mfma_f32_16x16x32_bf16 v[64:67], v[112:115], a[224:227], v[64:67]
s_add_u32 s78, s70, 36864
v_mfma_f32_16x16x32_bf16 v[64:67], v[116:119], a[228:231], v[64:67]
buffer_load_dwordx4 a[88:91], v4, s[4:7], s78 offen sc1
v_mfma_f32_16x16x32_bf16 v[72:75], v[112:115], a[232:235], v[72:75]
ds_read_b128 v[112:115], v3 offset:10240
v_mfma_f32_16x16x32_bf16 v[72:75], v[116:119], a[236:239], v[72:75]
ds_read_b128 v[116:119], v3 offset:11264
s_waitcnt lgkmcnt(4)
v_mfma_f32_16x16x32_bf16 v[68:71], v[120:123], a[224:227], v[68:71]
PG_s8:
s_cbranch_execz PG_b2
s_add_u32 s78, s70, 55296
v_mfma_f32_16x16x32_bf16 v[68:71], v[124:127], a[228:231], v[68:71]
buffer_load_dwordx4 a[92:95], v4, s[4:7], s78 offen sc1
v_mfma_f32_16x16x32_bf16 v[76:79], v[120:123], a[232:235], v[76:79]
ds_read_b128 v[120:123], v3 offset:12288
v_mfma_f32_16x16x32_bf16 v[76:79], v[124:127], a[236:239], v[76:79]
ds_read_b128 v[124:127], v3 offset:13312
s_waitcnt lgkmcnt(4)
v_mfma_f32_16x16x32_bf16 v[48:51], v[128:131], a[240:243], v[48:51]
s_add_u32 s78, s71, 36864
v_mfma_f32_16x16x32_bf16 v[48:51], v[132:135], a[244:247], v[48:51]
buffer_load_dwordx4 a[96:99], v4, s[4:7], s78 offen sc1
v_mfma_f32_16x16x32_bf16 v[56:59], v[128:131], a[248:251], v[56:59]
ds_read_b128 v[128:131], v3 offset:14336
v_mfma_f32_16x16x32_bf16 v[56:59], v[132:135], a[252:255], v[56:59]
ds_read_b128 v[132:135], v3 offset:15360
s_waitcnt lgkmcnt(4)
v_mfma_f32_16x16x32_bf16 v[52:55], v[112:115], a[240:243], v[52:55]
s_add_u32 s78, s71, 55296
v_mfma_f32_16x16x32_bf16 v[52:55], v[116:119], a[244:247], v[52:55]
buffer_load_dwordx4 a[100:103], v4, s[4:7], s78 offen sc1
v_mfma_f32_16x16x32_bf16 v[60:63], v[112:115], a[248:251], v[60:63]
v_mfma_f32_16x16x32_bf16 v[60:63], v[116:119], a[252:255], v[60:63]
s_waitcnt lgkmcnt(2)
v_mfma_f32_16x16x32_bf16 v[64:67], v[120:123], a[240:243], v[64:67]
s_add_u32 s78, s72, 36864
v_mfma_f32_16x16x32_bf16 v[64:67], v[124:127], a[244:247], v[64:67]
buffer_load_dwordx4 a[200:203], v4, s[4:7], s78 offen sc1
v_mfma_f32_16x16x32_bf16 v[72:75], v[120:123], a[248:251], v[72:75]
s_waitcnt vmcnt(8)
buffer_atomic_add v9, v8, s[4:7], s98 offen offset:3072 sc1
v_mfma_f32_16x16x32_bf16 v[72:75], v[124:127], a[252:255], v[72:75]
s_waitcnt lgkmcnt(0)
v_mfma_f32_16x16x32_bf16 v[68:71], v[128:131], a[240:243], v[68:71]
s_add_u32 s78, s72, 55296
v_mfma_f32_16x16x32_bf16 v[68:71], v[132:135], a[244:247], v[68:71]
buffer_load_dwordx4 a[204:207], v4, s[4:7], s78 offen sc1
v_mfma_f32_16x16x32_bf16 v[76:79], v[128:131], a[248:251], v[76:79]
v_mfma_f32_16x16x32_bf16 v[76:79], v[132:135], a[252:255], v[76:79]
v_mfma_f32_16x16x16_bf16 v[48:51], v[168:169], v[40:41], v[48:51]
s_add_u32 s78, s73, 36864
v_mfma_f32_16x16x16_bf16 v[56:59], v[168:169], v[42:43], v[56:59]
buffer_load_dwordx4 a[208:211], v4, s[4:7], s78 offen sc1
v_mfma_f32_16x16x16_bf16 v[52:55], v[170:171], v[40:41], v[52:55]
v_mfma_f32_16x16x16_bf16 v[60:63], v[170:171], v[42:43], v[60:63]
v_mfma_f32_16x16x16_bf16 v[64:67], v[172:173], v[40:41], v[64:67]
v_mfma_f32_16x16x16_bf16 v[72:75], v[172:173], v[42:43], v[72:75]
v_mfma_f32_16x16x16_bf16 v[68:71], v[174:175], v[40:41], v[68:71]
s_add_u32 s78, s73, 55296
v_mfma_f32_16x16x16_bf16 v[76:79], v[174:175], v[42:43], v[76:79]
buffer_load_dwordx4 a[212:215], v4, s[4:7], s78 offen sc1
s_add_u32 s74, s17, 2
s_and_b32 s74, s74, 3
s_lshl_b32 s74, s74, 11
s_and_b32 s75, s29, 0xffffe000
s_add_u32 s74, s74, s75
v_pk_mul_f32 v[144:145], v[48:49], v[48:49]
v_pk_mul_f32 v[146:147], v[50:51], v[50:51]
v_pk_mul_f32 v[148:149], v[52:53], v[52:53]
v_pk_mul_f32 v[150:151], v[54:55], v[54:55]
v_pk_fma_f32 v[144:145], v[144:145], v[44:45], v[44:45] op_sel:[0,1,0] op_sel_hi:[1,1,0]
v_pk_fma_f32 v[146:147], v[146:147], v[44:45], v[44:45] op_sel:[0,1,0] op_sel_hi:[1,1,0]
v_pk_fma_f32 v[148:149], v[148:149], v[44:45], v[44:45] op_sel:[0,1,0] op_sel_hi:[1,1,0]
s_add_u32 s31, s24, 57344
buffer_load_dwordx4 a[216:219], v1, s[4:7], s31 offen offset:0 sc1
v_pk_fma_f32 v[150:151], v[150:151], v[44:45], v[44:45] op_sel:[0,1,0] op_sel_hi:[1,1,0]
v_pk_mul_f32 v[144:145], v[144:145], v[48:49]
v_pk_mul_f32 v[146:147], v[146:147], v[50:51]
v_pk_mul_f32 v[148:149], v[148:149], v[52:53]
v_pk_mul_f32 v[150:151], v[150:151], v[54:55]
v_exp_f32 v144, v144
v_exp_f32 v145, v145
v_exp_f32 v146, v146
v_exp_f32 v147, v147
v_exp_f32 v148, v148
v_exp_f32 v149, v149
v_exp_f32 v150, v150
buffer_load_dwordx4 a[220:223], v1, s[4:7], s31 offen offset:1024 sc1
v_exp_f32 v151, v151
v_pk_mul_f32 v[48:49], v[48:49], v[64:65]
v_pk_mul_f32 v[50:51], v[50:51], v[66:67]
v_pk_mul_f32 v[52:53], v[52:53], v[68:69]
v_pk_mul_f32 v[54:55], v[54:55], v[70:71]
v_pk_fma_f32 v[144:145], v[144:145], v[46:47], v[46:47] op_sel_hi:[1,0,0]
v_pk_fma_f32 v[146:147], v[146:147], v[46:47], v[46:47] op_sel_hi:[1,0,0]
v_pk_fma_f32 v[148:149], v[148:149], v[46:47], v[46:47] op_sel_hi:[1,0,0]
v_pk_fma_f32 v[150:151], v[150:151], v[46:47], v[46:47] op_sel_hi:[1,0,0]
v_rcp_f32 v144, v144
v_rcp_f32 v145, v145
v_rcp_f32 v146, v146
buffer_load_dwordx4 a[224:227], v1, s[4:7], s31 offen offset:2048 sc1
v_rcp_f32 v147, v147
v_rcp_f32 v148, v148
v_rcp_f32 v149, v149
v_rcp_f32 v150, v150
v_rcp_f32 v151, v151
v_pk_mul_f32 v[48:49], v[48:49], v[144:145]
v_pk_mul_f32 v[50:51], v[50:51], v[146:147]
v_pk_mul_f32 v[52:53], v[52:53], v[148:149]
v_pk_mul_f32 v[54:55], v[54:55], v[150:151]
v_cvt_pk_bf16_f32 v136, v48, v49
v_cvt_pk_bf16_f32 v137, v50, v51
v_cvt_pk_bf16_f32 v138, v52, v53
v_cvt_pk_bf16_f32 v139, v54, v55
buffer_store_dwordx4 v[136:139], v4, s[4:7], s74 offen sc1
v_pk_mul_f32 v[144:145], v[56:57], v[56:57]
v_pk_mul_f32 v[146:147], v[58:59], v[58:59]
v_pk_mul_f32 v[148:149], v[60:61], v[60:61]
v_pk_mul_f32 v[150:151], v[62:63], v[62:63]
v_pk_fma_f32 v[144:145], v[144:145], v[248:249], v[248:249] op_sel:[0,1,0] op_sel_hi:[1,1,0]
v_pk_fma_f32 v[146:147], v[146:147], v[248:249], v[248:249] op_sel:[0,1,0] op_sel_hi:[1,1,0]
v_pk_fma_f32 v[148:149], v[148:149], v[248:249], v[248:249] op_sel:[0,1,0] op_sel_hi:[1,1,0]
v_pk_fma_f32 v[150:151], v[150:151], v[248:249], v[248:249] op_sel:[0,1,0] op_sel_hi:[1,1,0]
v_pk_mul_f32 v[144:145], v[144:145], v[56:57]
v_pk_mul_f32 v[146:147], v[146:147], v[58:59]
v_pk_mul_f32 v[148:149], v[148:149], v[60:61]
v_pk_mul_f32 v[150:151], v[150:151], v[62:63]
v_exp_f32 v144, v144
v_exp_f32 v145, v145
v_exp_f32 v146, v146
v_exp_f32 v147, v147
v_exp_f32 v148, v148
v_exp_f32 v149, v149
v_exp_f32 v150, v150
v_exp_f32 v151, v151
v_pk_mul_f32 v[56:57], v[56:57], v[72:73]
v_pk_mul_f32 v[58:59], v[58:59], v[74:75]
v_pk_mul_f32 v[60:61], v[60:61], v[76:77]
v_pk_mul_f32 v[62:63], v[62:63], v[78:79]
v_pk_fma_f32 v[144:145], v[144:145], v[254:255], v[254:255] op_sel_hi:[1,0,0]
v_pk_fma_f32 v[146:147], v[146:147], v[254:255], v[254:255] op_sel_hi:[1,0,0]
v_pk_fma_f32 v[148:149], v[148:149], v[254:255], v[254:255] op_sel_hi:[1,0,0]
v_pk_fma_f32 v[150:151], v[150:151], v[254:255], v[254:255] op_sel_hi:[1,0,0]
v_rcp_f32 v144, v144
v_rcp_f32 v145, v145
v_rcp_f32 v146, v146
v_rcp_f32 v147, v147
v_rcp_f32 v148, v148
v_rcp_f32 v149, v149
v_rcp_f32 v150, v150
v_rcp_f32 v151, v151
v_pk_mul_f32 v[56:57], v[56:57], v[144:145]
v_pk_mul_f32 v[58:59], v[58:59], v[146:147]
v_pk_mul_f32 v[60:61], v[60:61], v[148:149]
v_pk_mul_f32 v[62:63], v[62:63], v[150:151]
v_cvt_pk_bf16_f32 v140, v56, v57
v_cvt_pk_bf16_f32 v141, v58, v59
v_cvt_pk_bf16_f32 v142, v60, v61
v_cvt_pk_bf16_f32 v143, v62, v63
s_load_dword s15, s[4:5], s99 offset:3072 glc
buffer_store_dwordx4 v[140:143], v4, s[4:7], s74 offen offset:256 sc1
s_barrier
v_mfma_f32_16x16x32_bf16 v[48:51], v[216:219], a[56:59], 0
v_mfma_f32_16x16x32_bf16 v[48:51], v[236:239], a[60:63], v[48:51]
v_mfma_f32_16x16x32_bf16 v[52:55], v[220:223], a[56:59], 0
v_mfma_f32_16x16x32_bf16 v[52:55], v[240:243], a[60:63], v[52:55]
v_mfma_f32_16x16x32_bf16 v[56:59], v[224:227], a[56:59], 0
v_mfma_f32_16x16x32_bf16 v[56:59], v[188:191], a[60:63], v[56:59]
v_mfma_f32_16x16x32_bf16 v[60:63], v[228:231], a[56:59], 0
v_mfma_f32_16x16x32_bf16 v[60:63], v[192:195], a[60:63], v[60:63]
v_mfma_f32_16x16x32_bf16 v[64:67], v[232:235], a[56:59], 0
v_mfma_f32_16x16x32_bf16 v[64:67], v[196:199], a[60:63], v[64:67]
v_mfma_f32_16x16x32_bf16 v[68:71], v[216:219], a[64:67], 0
v_mfma_f32_16x16x32_bf16 v[68:71], v[236:239], a[68:71], v[68:71]
v_mfma_f32_16x16x32_bf16 v[72:75], v[220:223], a[64:67], 0
v_mfma_f32_16x16x32_bf16 v[72:75], v[240:243], a[68:71], v[72:75]
v_mfma_f32_16x16x32_bf16 v[76:79], v[224:227], a[64:67], 0
v_mfma_f32_16x16x32_bf16 v[76:79], v[188:191], a[68:71], v[76:79]
v_mfma_f32_16x16x32_bf16 v[80:83], v[228:231], a[64:67], 0
v_mfma_f32_16x16x32_bf16 v[80:83], v[192:195], a[68:71], v[80:83]
v_mfma_f32_16x16x32_bf16 v[84:87], v[232:235], a[64:67], 0
v_mfma_f32_16x16x32_bf16 v[84:87], v[196:199], a[68:71], v[84:87]
s_waitcnt lgkmcnt(0)
s_cmp_ge_u32 s15, 8
s_cbranch_scc0 SP44
BK45:
v_mfma_f32_16x16x32_bf16 v[88:91], v[216:219], a[72:75], 0
s_add_u32 s78, s70, 2048
s_waitcnt vmcnt(16)
v_mfma_f32_16x16x32_bf16 v[88:91], v[236:239], a[76:79], v[88:91]
buffer_load_dwordx4 a[228:231], v4, s[4:7], s78 offen sc1
v_mfma_f32_16x16x32_bf16 v[92:95], v[220:223], a[72:75], 0
v_mfma_f32_16x16x32_bf16 v[92:95], v[240:243], a[76:79], v[92:95]
s_add_u32 s78, s70, 20480
v_mfma_f32_16x16x32_bf16 v[96:99], v[224:227], a[72:75], 0
v_mfma_f32_16x16x32_bf16 v[96:99], v[188:191], a[76:79], v[96:99]
buffer_load_dwordx4 a[232:235], v4, s[4:7], s78 offen sc1
v_mfma_f32_16x16x32_bf16 v[100:103], v[228:231], a[72:75], 0
v_mfma_f32_16x16x32_bf16 v[100:103], v[192:195], a[76:79], v[100:103]
s_add_u32 s78, s71, 2048
v_mfma_f32_16x16x32_bf16 v[104:107], v[232:235], a[72:75], 0
buffer_load_dwordx4 a[236:239], v4, s[4:7], s78 offen sc1
v_mfma_f32_16x16x32_bf16 v[104:107], v[196:199], a[76:79], v[104:107]
s_waitcnt vmcnt(18)
v_mfma_f32_16x16x32_bf16 v[20:23], v[216:219], a[80:83], v[20:23]
s_waitcnt vmcnt(17)
v_mfma_f32_16x16x32_bf16 v[20:23], v[236:239], a[84:87], v[20:23]
s_add_u32 s78, s71, 20480
v_mfma_f32_16x16x32_bf16 v[24:27], v[220:223], a[80:83], v[24:27]
buffer_load_dwordx4 a[240:243], v4, s[4:7], s78 offen sc1
v_mfma_f32_16x16x32_bf16 v[24:27], v[240:243], a[84:87], v[24:27]
v_mfma_f32_16x16x32_bf16 v[28:31], v[224:227], a[80:83], v[28:31]
v_mfma_f32_16x16x32_bf16 v[28:31], v[188:191], a[84:87], v[28:31]
s_add_u32 s78, s72, 2048
v_mfma_f32_16x16x32_bf16 v[32:35], v[228:231], a[80:83], v[32:35]
buffer_load_dwordx4 a[244:247], v4, s[4:7], s78 offen sc1
v_mfma_f32_16x16x32_bf16 v[32:35], v[192:195], a[84:87], v[32:35]
v_mfma_f32_16x16x32_bf16 v[36:39], v[232:235], a[80:83], v[36:39]
v_mfma_f32_16x16x32_bf16 v[36:39], v[196:199], a[84:87], v[36:39]
s_waitcnt vmcnt(18)
v_mfma_f32_16x16x32_bf16 v[48:51], v[200:203], a[88:91], v[48:51]
s_add_u32 s78, s72, 20480
s_waitcnt vmcnt(17)
v_mfma_f32_16x16x32_bf16 v[48:51], a[108:111], a[92:95], v[48:51]
buffer_load_dwordx4 a[248:251], v4, s[4:7], s78 offen sc1
v_mfma_f32_16x16x32_bf16 v[52:55], v[204:207], a[88:91], v[52:55]
s_waitcnt vmcnt(6)
buffer_atomic_add v9, v8, s[4:7], s98 offen offset:8 sc1
v_mfma_f32_16x16x32_bf16 v[52:55], a[112:115], a[92:95], v[52:55]
s_add_u32 s78, s73, 2048
v_mfma_f32_16x16x32_bf16 v[56:59], v[208:211], a[88:91], v[56:59]
v_mfma_f32_16x16x32_bf16 v[56:59], a[116:119], a[92:95], v[56:59]
buffer_load_dwordx4 a[252:255], v4, s[4:7], s78 offen sc1
v_mfma_f32_16x16x32_bf16 v[60:63], v[212:215], a[88:91], v[60:63]
s_add_u32 s78, s73, 20480
v_mfma_f32_16x16x32_bf16 v[60:63], a[120:123], a[92:95], v[60:63]
buffer_load_dwordx4 v[108:111], v4, s[4:7], s78 offen sc1
v_mfma_f32_16x16x32_bf16 v[64:67], a[104:107], a[88:91], v[64:67]
v_mfma_f32_16x16x32_bf16 v[64:67], a[124:127], a[92:95], v[64:67]
v_mfma_f32_16x16x32_bf16 v[68:71], v[200:203], a[96:99], v[68:71]
s_add_u32 s78, s70, 38912
v_mfma_f32_16x16x32_bf16 v[68:71], a[108:111], a[100:103], v[68:71]
buffer_load_dwordx4 v[112:115], v4, s[4:7], s78 offen sc1
v_mfma_f32_16x16x32_bf16 v[72:75], v[204:207], a[96:99], v[72:75]
v_mfma_f32_16x16x32_bf16 v[72:75], a[112:115], a[100:103], v[72:75]
v_mfma_f32_16x16x32_bf16 v[76:79], v[208:211], a[96:99], v[76:79]
v_mfma_f32_16x16x32_bf16 v[76:79], a[116:119], a[100:103], v[76:79]
s_add_u32 s78, s70, 49152
v_mfma_f32_16x16x32_bf16 v[80:83], v[212:215], a[96:99], v[80:83]
buffer_load_dwordx4 v[116:119], v4, s[4:7], s78 offen sc1
v_mfma_f32_16x16x32_bf16 v[80:83], a[120:123], a[100:103], v[80:83]
v_mfma_f32_16x16x32_bf16 v[84:87], a[104:107], a[96:99], v[84:87]
s_add_u32 s78, s71, 38912
v_mfma_f32_16x16x32_bf16 v[84:87], a[124:127], a[100:103], v[84:87]
v_mfma_f32_16x16x32_bf16 v[88:91], v[200:203], a[200:203], v[88:91]
buffer_load_dwordx4 v[120:123], v4, s[4:7], s78 offen sc1
v_mfma_f32_16x16x32_bf16 v[88:91], a[108:111], a[204:207], v[88:91]
s_add_u32 s78, s71, 49152
v_mfma_f32_16x16x32_bf16 v[92:95], v[204:207], a[200:203], v[92:95]
buffer_load_dwordx4 v[124:127], v4, s[4:7], s78 offen sc1
v_mfma_f32_16x16x32_bf16 v[92:95], a[112:115], a[204:207], v[92:95]
v_mfma_f32_16x16x32_bf16 v[96:99], v[208:211], a[200:203], v[96:99]
v_mfma_f32_16x16x32_bf16 v[96:99], a[116:119], a[204:207], v[96:99]
s_add_u32 s78, s72, 38912
v_mfma_f32_16x16x32_bf16 v[100:103], v[212:215], a[200:203], v[100:103]
buffer_load_dwordx4 v[128:131], v4, s[4:7], s78 offen sc1
v_mfma_f32_16x16x32_bf16 v[100:103], a[120:123], a[204:207], v[100:103]
v_mfma_f32_16x16x32_bf16 v[104:107], a[104:107], a[200:203], v[104:107]
v_mfma_f32_16x16x32_bf16 v[104:107], a[124:127], a[204:207], v[104:107]
v_mfma_f32_16x16x32_bf16 v[20:23], v[200:203], a[208:211], v[20:23]
s_add_u32 s78, s72, 49152
v_mfma_f32_16x16x32_bf16 v[20:23], a[108:111], a[212:215], v[20:23]
buffer_load_dwordx4 v[132:135], v4, s[4:7], s78 offen sc1
v_mfma_f32_16x16x32_bf16 v[24:27], v[204:207], a[208:211], v[24:27]
v_mfma_f32_16x16x32_bf16 v[24:27], a[112:115], a[212:215], v[24:27]
s_add_u32 s78, s73, 38912
v_mfma_f32_16x16x32_bf16 v[28:31], v[208:211], a[208:211], v[28:31]
v_mfma_f32_16x16x32_bf16 v[28:31], a[116:119], a[212:215], v[28:31]
buffer_load_dwordx4 v[144:147], v4, s[4:7], s78 offen sc1
v_mfma_f32_16x16x32_bf16 v[32:35], v[212:215], a[208:211], v[32:35]
v_mfma_f32_16x16x32_bf16 v[32:35], a[120:123], a[212:215], v[32:35]
s_add_u32 s78, s73, 49152
v_mfma_f32_16x16x32_bf16 v[36:39], a[104:107], a[208:211], v[36:39]
buffer_load_dwordx4 v[148:151], v4, s[4:7], s78 offen sc1
v_mfma_f32_16x16x32_bf16 v[36:39], a[124:127], a[212:215], v[36:39]
s_waitcnt vmcnt(16)
v_mfma_f32_16x16x32_bf16 v[48:51], a[128:131], a[228:231], v[48:51]
buffer_load_dwordx4 v[152:155], v1, s[4:7], s31 offen offset:3072 sc1
s_waitcnt vmcnt(16)
v_mfma_f32_16x16x32_bf16 v[48:51], a[148:151], a[232:235], v[48:51]
v_mfma_f32_16x16x32_bf16 v[52:55], a[132:135], a[228:231], v[52:55]
v_mfma_f32_16x16x32_bf16 v[52:55], a[152:155], a[232:235], v[52:55]
v_mfma_f32_16x16x32_bf16 v[56:59], a[136:139], a[228:231], v[56:59]
v_mfma_f32_16x16x32_bf16 v[56:59], a[156:159], a[232:235], v[56:59]
v_mfma_f32_16x16x32_bf16 v[60:63], a[140:143], a[228:231], v[60:63]
v_mfma_f32_16x16x32_bf16 v[60:63], v[176:179], a[232:235], v[60:63]
v_mfma_f32_16x16x32_bf16 v[64:67], a[144:147], a[228:231], v[64:67]
s_load_dword s15, s[4:5], s99 offset:8 glc
v_mfma_f32_16x16x32_bf16 v[64:67], v[180:183], a[232:235], v[64:67]
s_waitcnt vmcnt(15)
v_mfma_f32_16x16x32_bf16 v[68:71], a[128:131], a[236:239], v[68:71]
s_waitcnt vmcnt(14)
v_mfma_f32_16x16x32_bf16 v[68:71], a[148:151], a[240:243], v[68:71]
v_mfma_f32_16x16x32_bf16 v[72:75], a[132:135], a[236:239], v[72:75]
v_mfma_f32_16x16x32_bf16 v[72:75], a[152:155], a[240:243], v[72:75]
v_mfma_f32_16x16x32_bf16 v[76:79], a[136:139], a[236:239], v[76:79]
v_mfma_f32_16x16x32_bf16 v[76:79], a[156:159], a[240:243], v[76:79]
v_mfma_f32_16x16x32_bf16 v[80:83], a[140:143], a[236:239], v[80:83]
s_add_u32 m0, s25, 0
s_add_u32 s30, s21, 0
v_mfma_f32_16x16x32_bf16 v[80:83], v[176:179], a[240:243], v[80:83]
buffer_load_dwordx4 v1, s[4:7], s30 offen sc1 lds
v_mfma_f32_16x16x32_bf16 v[84:87], a[144:147], a[236:239], v[84:87]
v_mfma_f32_16x16x32_bf16 v[84:87], v[180:183], a[240:243], v[84:87]
s_waitcnt vmcnt(14)
v_mfma_f32_16x16x32_bf16 v[88:91], a[128:131], a[244:247], v[88:91]
buffer_load_dwordx4 v1, s[4:7], s30 offen offset:1024 sc1 lds
s_waitcnt vmcnt(14)
v_mfma_f32_16x16x32_bf16 v[88:91], a[148:151], a[248:251], v[88:91]
v_mfma_f32_16x16x32_bf16 v[92:95], a[132:135], a[244:247], v[92:95]
v_mfma_f32_16x16x32_bf16 v[92:95], a[152:155], a[248:251], v[92:95]
v_mfma_f32_16x16x32_bf16 v[96:99], a[136:139], a[244:247], v[96:99]
v_mfma_f32_16x16x32_bf16 v[96:99], a[156:159], a[248:251], v[96:99]
buffer_load_dwordx4 v1, s[4:7], s30 offen offset:2048 sc1 lds
v_mfma_f32_16x16x32_bf16 v[100:103], a[140:143], a[244:247], v[100:103]
v_mfma_f32_16x16x32_bf16 v[100:103], v[176:179], a[248:251], v[100:103]
v_mfma_f32_16x16x32_bf16 v[104:107], a[144:147], a[244:247], v[104:107]
buffer_load_dwordx4 v1, s[4:7], s30 offen offset:3072 sc1 lds
v_mfma_f32_16x16x32_bf16 v[104:107], v[180:183], a[248:251], v[104:107]
s_waitcnt vmcnt(14)
v_mfma_f32_16x16x32_bf16 v[20:23], a[128:131], a[252:255], v[20:23]
s_waitcnt vmcnt(13)
v_mfma_f32_16x16x32_bf16 v[20:23], a[148:151], v[108:111], v[20:23]
v_mfma_f32_16x16x32_bf16 v[24:27], a[132:135], a[252:255], v[24:27]
v_mfma_f32_16x16x32_bf16 v[24:27], a[152:155], v[108:111], v[24:27]
s_waitcnt lgkmcnt(0)
s_cmp_ge_u32 s15, 8
s_cbranch_scc0 SP46
BK47:
v_mfma_f32_16x16x32_bf16 v[28:31], a[136:139], a[252:255], v[28:31]
v_mfma_f32_16x16x32_bf16 v[28:31], a[156:159], v[108:111], v[28:31]
s_add_u32 s78, s70, 4096
v_mfma_f32_16x16x32_bf16 v[32:35], a[140:143], a[252:255], v[32:35]
buffer_load_dwordx4 v[156:159], v4, s[4:7], s78 offen sc1
v_mfma_f32_16x16x32_bf16 v[32:35], v[176:179], v[108:111], v[32:35]
s_add_u32 s78, s70, 22528
v_mfma_f32_16x16x32_bf16 v[36:39], a[144:147], a[252:255], v[36:39]
buffer_load_dwordx4 v[160:163], v4, s[4:7], s78 offen sc1
v_mfma_f32_16x16x32_bf16 v[36:39], v[180:183], v[108:111], v[36:39]
s_waitcnt vmcnt(14)
v_mfma_f32_16x16x32_bf16 v[48:51], v[184:187], v[112:115], v[48:51]
s_add_u32 s78, s70, 32768
s_waitcnt vmcnt(13)
v_mfma_f32_16x16x32_bf16 v[48:51], a[176:179], v[116:119], v[48:51]
buffer_load_dwordx4 v[164:167], v4, s[4:7], s78 offen sc1
v_mfma_f32_16x16x32_bf16 v[52:55], a[160:163], v[112:115], v[52:55]
v_mfma_f32_16x16x32_bf16 v[52:55], a[180:183], v[116:119], v[52:55]
s_add_u32 s78, s70, 51200
v_mfma_f32_16x16x32_bf16 v[56:59], a[164:167], v[112:115], v[56:59]
v_mfma_f32_16x16x32_bf16 v[56:59], a[184:187], v[116:119], v[56:59]
buffer_load_dwordx4 v[168:171], v4, s[4:7], s78 offen sc1
v_mfma_f32_16x16x32_bf16 v[60:63], a[168:171], v[112:115], v[60:63]
v_mfma_f32_16x16x32_bf16 v[60:63], a[188:191], v[116:119], v[60:63]
s_add_u32 s78, s71, 4096
v_mfma_f32_16x16x32_bf16 v[64:67], a[172:175], v[112:115], v[64:67]
buffer_load_dwordx4 v[172:175], v4, s[4:7], s78 offen sc1
v_mfma_f32_16x16x32_bf16 v[64:67], a[192:195], v[116:119], v[64:67]
s_waitcnt vmcnt(15)
v_mfma_f32_16x16x32_bf16 v[68:71], v[184:187], v[120:123], v[68:71]
s_add_u32 s78, s71, 22528
s_waitcnt vmcnt(14)
v_mfma_f32_16x16x32_bf16 v[68:71], a[176:179], v[124:127], v[68:71]
buffer_load_dwordx4 a[56:59], v4, s[4:7], s78 offen sc1
v_mfma_f32_16x16x32_bf16 v[72:75], a[160:163], v[120:123], v[72:75]
v_mfma_f32_16x16x32_bf16 v[72:75], a[180:183], v[124:127], v[72:75]
s_add_u32 s78, s71, 32768
v_mfma_f32_16x16x32_bf16 v[76:79], a[164:167], v[120:123], v[76:79]
v_mfma_f32_16x16x32_bf16 v[76:79], a[184:187], v[124:127], v[76:79]
buffer_load_dwordx4 a[60:63], v4, s[4:7], s78 offen sc1
v_mfma_f32_16x16x32_bf16 v[80:83], a[168:171], v[120:123], v[80:83]
v_mfma_f32_16x16x32_bf16 v[80:83], a[188:191], v[124:127], v[80:83]
s_add_u32 s78, s71, 51200
v_mfma_f32_16x16x32_bf16 v[84:87], a[172:175], v[120:123], v[84:87]
buffer_load_dwordx4 a[64:67], v4, s[4:7], s78 offen sc1
v_mfma_f32_16x16x32_bf16 v[84:87], a[192:195], v[124:127], v[84:87]
s_waitcnt vmcnt(16)
v_mfma_f32_16x16x32_bf16 v[88:91], v[184:187], v[128:131], v[88:91]
s_add_u32 s78, s72, 4096
s_waitcnt vmcnt(15)
v_mfma_f32_16x16x32_bf16 v[88:91], a[176:179], v[132:135], v[88:91]
buffer_load_dwordx4 a[68:71], v4, s[4:7], s78 offen sc1
v_mfma_f32_16x16x32_bf16 v[92:95], a[160:163], v[128:131], v[92:95]
v_mfma_f32_16x16x32_bf16 v[92:95], a[180:183], v[132:135], v[92:95]
s_add_u32 s78, s72, 22528
v_mfma_f32_16x16x32_bf16 v[96:99], a[164:167], v[128:131], v[96:99]
v_mfma_f32_16x16x32_bf16 v[96:99], a[184:187], v[132:135], v[96:99]
buffer_load_dwordx4 a[72:75], v4, s[4:7], s78 offen sc1
v_mfma_f32_16x16x32_bf16 v[100:103], a[168:171], v[128:131], v[100:103]
v_mfma_f32_16x16x32_bf16 v[100:103], a[188:191], v[132:135], v[100:103]
s_add_u32 s78, s72, 32768
v_mfma_f32_16x16x32_bf16 v[104:107], a[172:175], v[128:131], v[104:107]
buffer_load_dwordx4 a[76:79], v4, s[4:7], s78 offen sc1
v_mfma_f32_16x16x32_bf16 v[104:107], a[192:195], v[132:135], v[104:107]
s_waitcnt vmcnt(17)
v_mfma_f32_16x16x32_bf16 v[20:23], v[184:187], v[144:147], v[20:23]
s_add_u32 s78, s72, 51200
s_waitcnt vmcnt(16)
v_mfma_f32_16x16x32_bf16 v[20:23], a[176:179], v[148:151], v[20:23]
buffer_load_dwordx4 a[80:83], v4, s[4:7], s78 offen sc1
v_mfma_f32_16x16x32_bf16 v[24:27], a[160:163], v[144:147], v[24:27]
v_mfma_f32_16x16x32_bf16 v[24:27], a[180:183], v[148:151], v[24:27]
s_add_u32 s78, s73, 4096
v_mfma_f32_16x16x32_bf16 v[28:31], a[164:167], v[144:147], v[28:31]
v_mfma_f32_16x16x32_bf16 v[28:31], a[184:187], v[148:151], v[28:31]
buffer_load_dwordx4 a[84:87], v4, s[4:7], s78 offen sc1
v_mfma_f32_16x16x32_bf16 v[32:35], a[168:171], v[144:147], v[32:35]
s_add_u32 s78, s73, 22528
v_mfma_f32_16x16x32_bf16 v[32:35], a[188:191], v[148:151], v[32:35]
buffer_load_dwordx4 a[88:91], v4, s[4:7], s78 offen sc1
v_mfma_f32_16x16x32_bf16 v[36:39], a[172:175], v[144:147], v[36:39]
v_mfma_f32_16x16x32_bf16 v[36:39], a[192:195], v[148:151], v[36:39]
s_add_u32 s78, s73, 32768
buffer_load_dwordx4 a[92:95], v4, s[4:7], s78 offen sc1
s_add_u32 s78, s73, 51200
buffer_load_dwordx4 a[96:99], v4, s[4:7], s78 offen sc1
v_add_u32 v232, 102400, v10
v_add_u32 v233, 102400, v11
v_add_u32 v234, 102400, v12
v_add_u32 v19, 102400, v13
s_waitcnt vmcnt(15)
v_mfma_f32_16x16x32_bf16 v[48:51], a[196:199], v[156:159], v[48:51]
s_add_u32 s74, s69, 67436544
s_waitcnt vmcnt(14)
v_mfma_f32_16x16x32_bf16 v[48:51], a[12:15], v[160:163], v[48:51]
s_lshl_b32 s76, s17, 2
s_add_u32 s76, s76, s18
s_waitcnt vmcnt(13)
v_mfma_f32_16x16x32_bf16 v[48:51], a[32:35], v[164:167], v[48:51]
s_lshl_b32 s76, s76, 7
s_and_b32 s2, s99, 0xffffe000
s_waitcnt vmcnt(12)
v_mfma_f32_16x16x32_bf16 v[48:51], a[52:55], v[168:171], v[48:51]
s_add_u32 s76, s76, s2
s_add_u32 s76, s76, 4294934528
v_mfma_f32_16x16x32_bf16 v[52:55], v[244:247], v[156:159], v[52:55]
s_add_u32 m0, s25, 16384
s_add_u32 s30, s21, 16384
v_mfma_f32_16x16x32_bf16 v[52:55], a[16:19], v[160:163], v[52:55]
buffer_load_dwordx4 v1, s[4:7], s30 offen sc1 lds
v_mfma_f32_16x16x32_bf16 v[52:55], a[36:39], v[164:167], v[52:55]
v_mfma_f32_16x16x32_bf16 v[52:55], a[216:219], v[168:171], v[52:55]
v_mfma_f32_16x16x32_bf16 v[56:59], a[0:3], v[156:159], v[56:59]
ds_write_b128 v232, v[48:51] offset:0
v_mfma_f32_16x16x32_bf16 v[56:59], a[20:23], v[160:163], v[56:59]
buffer_load_dwordx4 v1, s[4:7], s30 offen offset:1024 sc1 lds
v_mfma_f32_16x16x32_bf16 v[56:59], a[40:43], v[164:167], v[56:59]
v_mfma_f32_16x16x32_bf16 v[56:59], a[220:223], v[168:171], v[56:59]
v_mfma_f32_16x16x32_bf16 v[60:63], a[4:7], v[156:159], v[60:63]
s_nop 0
ds_write_b128 v232, v[52:55] offset:1024
v_mfma_f32_16x16x32_bf16 v[60:63], a[24:27], v[160:163], v[60:63]
buffer_load_dwordx4 v1, s[4:7], s30 offen offset:2048 sc1 lds
v_mfma_f32_16x16x32_bf16 v[60:63], a[44:47], v[164:167], v[60:63]
v_mfma_f32_16x16x32_bf16 v[60:63], a[224:227], v[168:171], v[60:63]
v_mfma_f32_16x16x32_bf16 v[64:67], a[8:11], v[156:159], v[64:67]
ds_write_b128 v232, v[56:59] offset:2048
v_mfma_f32_16x16x32_bf16 v[64:67], a[28:31], v[160:163], v[64:67]
buffer_load_dwordx4 v1, s[4:7], s30 offen offset:3072 sc1 lds
v_mfma_f32_16x16x32_bf16 v[64:67], a[48:51], v[164:167], v[64:67]
v_mfma_f32_16x16x32_bf16 v[64:67], v[152:155], v[168:171], v[64:67]
s_waitcnt vmcnt(15)
v_mfma_f32_16x16x32_bf16 v[68:71], a[196:199], v[172:175], v[68:71]
ds_write_b128 v232, v[60:63] offset:3072
s_waitcnt vmcnt(14)
v_mfma_f32_16x16x32_bf16 v[68:71], a[12:15], a[56:59], v[68:71]
s_add_u32 m0, s25, 32768
s_add_u32 s30, s21, 32768
s_waitcnt vmcnt(13)
v_mfma_f32_16x16x32_bf16 v[68:71], a[32:35], a[60:63], v[68:71]
buffer_load_dwordx4 v1, s[4:7], s30 offen sc1 lds
s_waitcnt vmcnt(13)
v_mfma_f32_16x16x32_bf16 v[68:71], a[52:55], a[64:67], v[68:71]
v_mfma_f32_16x16x32_bf16 v[72:75], v[244:247], v[172:175], v[72:75]
ds_write_b128 v232, v[64:67] offset:4096
v_mfma_f32_16x16x32_bf16 v[72:75], a[16:19], a[56:59], v[72:75]
buffer_load_dwordx4 v1, s[4:7], s30 offen offset:1024 sc1 lds
v_mfma_f32_16x16x32_bf16 v[72:75], a[36:39], a[60:63], v[72:75]
v_mfma_f32_16x16x32_bf16 v[72:75], a[216:219], a[64:67], v[72:75]
v_mfma_f32_16x16x32_bf16 v[76:79], a[0:3], v[172:175], v[76:79]
s_nop 0
ds_write_b128 v233, v[68:71] offset:0
v_mfma_f32_16x16x32_bf16 v[76:79], a[20:23], a[56:59], v[76:79]
buffer_load_dwordx4 v1, s[4:7], s30 offen offset:2048 sc1 lds
v_mfma_f32_16x16x32_bf16 v[76:79], a[40:43], a[60:63], v[76:79]
v_mfma_f32_16x16x32_bf16 v[76:79], a[220:223], a[64:67], v[76:79]
v_mfma_f32_16x16x32_bf16 v[80:83], a[4:7], v[172:175], v[80:83]
ds_write_b128 v233, v[72:75] offset:1024
v_mfma_f32_16x16x32_bf16 v[80:83], a[24:27], a[56:59], v[80:83]
buffer_load_dwordx4 v1, s[4:7], s30 offen offset:3072 sc1 lds
v_mfma_f32_16x16x32_bf16 v[80:83], a[44:47], a[60:63], v[80:83]
v_mfma_f32_16x16x32_bf16 v[80:83], a[224:227], a[64:67], v[80:83]
v_mfma_f32_16x16x32_bf16 v[84:87], a[8:11], v[172:175], v[84:87]
s_nop 0
ds_write_b128 v233, v[76:79] offset:2048
v_mfma_f32_16x16x32_bf16 v[84:87], a[28:31], a[56:59], v[84:87]
s_add_u32 m0, s25, 49152
s_add_u32 s30, s21, 49152
v_mfma_f32_16x16x32_bf16 v[84:87], a[48:51], a[60:63], v[84:87]
buffer_load_dwordx4 v1, s[4:7], s30 offen sc1 lds
v_mfma_f32_16x16x32_bf16 v[84:87], v[152:155], a[64:67], v[84:87]
s_waitcnt vmcnt(16)
v_mfma_f32_16x16x32_bf16 v[88:91], a[196:199], a[68:71], v[88:91]
ds_write_b128 v233, v[80:83] offset:3072
s_waitcnt vmcnt(15)
v_mfma_f32_16x16x32_bf16 v[88:91], a[12:15], a[72:75], v[88:91]
buffer_load_dwordx4 v1, s[4:7], s30 offen offset:1024 sc1 lds
s_waitcnt vmcnt(15)
v_mfma_f32_16x16x32_bf16 v[88:91], a[32:35], a[76:79], v[88:91]
s_waitcnt vmcnt(14)
v_mfma_f32_16x16x32_bf16 v[88:91], a[52:55], a[80:83], v[88:91]
v_mfma_f32_16x16x32_bf16 v[92:95], v[244:247], a[68:71], v[92:95]
ds_write_b128 v233, v[84:87] offset:4096
v_mfma_f32_16x16x32_bf16 v[92:95], a[16:19], a[72:75], v[92:95]
buffer_load_dwordx4 v1, s[4:7], s30 offen offset:2048 sc1 lds
v_mfma_f32_16x16x32_bf16 v[92:95], a[36:39], a[76:79], v[92:95]
v_mfma_f32_16x16x32_bf16 v[92:95], a[216:219], a[80:83], v[92:95]
v_mfma_f32_16x16x32_bf16 v[96:99], a[0:3], a[68:71], v[96:99]
s_nop 0
ds_write_b128 v234, v[88:91] offset:0
v_mfma_f32_16x16x32_bf16 v[96:99], a[20:23], a[72:75], v[96:99]
buffer_load_dwordx4 v1, s[4:7], s30 offen offset:3072 sc1 lds
v_mfma_f32_16x16x32_bf16 v[96:99], a[40:43], a[76:79], v[96:99]
v_mfma_f32_16x16x32_bf16 v[96:99], a[220:223], a[80:83], v[96:99]
v_mfma_f32_16x16x32_bf16 v[100:103], a[4:7], a[68:71], v[100:103]
ds_write_b128 v234, v[92:95] offset:1024
v_mfma_f32_16x16x32_bf16 v[100:103], a[24:27], a[72:75], v[100:103]
v_mfma_f32_16x16x32_bf16 v[100:103], a[44:47], a[76:79], v[100:103]
v_mfma_f32_16x16x32_bf16 v[100:103], a[224:227], a[80:83], v[100:103]
v_mfma_f32_16x16x32_bf16 v[104:107], a[8:11], a[68:71], v[104:107]
s_nop 1
ds_write_b128 v234, v[96:99] offset:2048
v_mfma_f32_16x16x32_bf16 v[104:107], a[28:31], a[72:75], v[104:107]
v_mfma_f32_16x16x32_bf16 v[104:107], a[48:51], a[76:79], v[104:107]
v_mfma_f32_16x16x32_bf16 v[104:107], v[152:155], a[80:83], v[104:107]
s_waitcnt vmcnt(15)
v_mfma_f32_16x16x32_bf16 v[20:23], a[196:199], a[84:87], v[20:23]
ds_write_b128 v234, v[100:103] offset:3072
s_waitcnt vmcnt(14)
v_mfma_f32_16x16x32_bf16 v[20:23], a[12:15], a[88:91], v[20:23]
s_waitcnt vmcnt(13)
v_mfma_f32_16x16x32_bf16 v[20:23], a[32:35], a[92:95], v[20:23]
s_waitcnt vmcnt(12)
v_mfma_f32_16x16x32_bf16 v[20:23], a[52:55], a[96:99], v[20:23]
v_mfma_f32_16x16x32_bf16 v[24:27], v[244:247], a[84:87], v[24:27]
ds_write_b128 v234, v[104:107] offset:4096
v_mfma_f32_16x16x32_bf16 v[24:27], a[16:19], a[88:91], v[24:27]
v_mfma_f32_16x16x32_bf16 v[24:27], a[36:39], a[92:95], v[24:27]
s_waitcnt lgkmcnt(0)
s_barrier
v_mfma_f32_16x16x32_bf16 v[24:27], a[216:219], a[96:99], v[24:27]
ds_read_b128 v[176:179], v19 offset:0
ds_read_b128 v[196:199], v19 offset:5120
v_mfma_f32_16x16x32_bf16 v[28:31], a[0:3], a[84:87], v[28:31]
ds_read_b128 v[216:219], v19 offset:10240
ds_read_b128 v[180:183], v19 offset:1024
v_mfma_f32_16x16x32_bf16 v[28:31], a[20:23], a[88:91], v[28:31]
ds_read_b128 v[200:203], v19 offset:6144
ds_read_b128 v[220:223], v19 offset:11264
v_mfma_f32_16x16x32_bf16 v[28:31], a[40:43], a[92:95], v[28:31]
ds_read_b128 v[184:187], v19 offset:2048
ds_read_b128 v[204:207], v19 offset:7168
v_mfma_f32_16x16x32_bf16 v[28:31], a[220:223], a[96:99], v[28:31]
ds_read_b128 v[224:227], v19 offset:12288
ds_read_b128 v[188:191], v19 offset:3072
PG_s9:
s_cbranch_execz PG_b2
v_mfma_f32_16x16x32_bf16 v[32:35], a[4:7], a[84:87], v[32:35]
ds_read_b128 v[208:211], v19 offset:8192
ds_read_b128 v[228:231], v19 offset:13312
v_mfma_f32_16x16x32_bf16 v[32:35], a[24:27], a[88:91], v[32:35]
ds_read_b128 v[192:195], v19 offset:4096
ds_read_b128 v[212:215], v19 offset:9216
v_mfma_f32_16x16x32_bf16 v[32:35], a[44:47], a[92:95], v[32:35]
ds_read_b128 v[232:235], v19 offset:14336
v_mfma_f32_16x16x32_bf16 v[32:35], a[224:227], a[96:99], v[32:35]
v_mfma_f32_16x16x32_bf16 v[36:39], a[8:11], a[84:87], v[36:39]
v_mfma_f32_16x16x32_bf16 v[36:39], a[28:31], a[88:91], v[36:39]
v_mfma_f32_16x16x32_bf16 v[36:39], a[48:51], a[92:95], v[36:39]
v_mfma_f32_16x16x32_bf16 v[36:39], v[152:155], a[96:99], v[36:39]
s_waitcnt lgkmcnt(13)
v_pk_add_f32 v[176:177], v[176:177], v[196:197]
v_pk_add_f32 v[178:179], v[178:179], v[198:199]
s_waitcnt lgkmcnt(10)
v_pk_add_f32 v[180:181], v[180:181], v[200:201]
v_pk_add_f32 v[182:183], v[182:183], v[202:203]
v_pk_add_f32 v[20:21], v[20:21], v[216:217]
v_pk_add_f32 v[22:23], v[22:23], v[218:219]
s_waitcnt lgkmcnt(9)
v_pk_add_f32 v[24:25], v[24:25], v[220:221]
v_pk_add_f32 v[26:27], v[26:27], v[222:223]
v_pk_add_f32 v[20:21], v[20:21], v[176:177]
v_pk_add_f32 v[22:23], v[22:23], v[178:179]
v_pk_add_f32 v[24:25], v[24:25], v[180:181]
v_pk_add_f32 v[26:27], v[26:27], v[182:183]
v_cvt_pk_bf16_f32 v48, v20, v21
v_cvt_pk_bf16_f32 v49, v22, v23
v_cvt_pk_bf16_f32 v50, v24, v25
v_cvt_pk_bf16_f32 v51, v26, v27
s_waitcnt lgkmcnt(7)
v_pk_add_f32 v[184:185], v[184:185], v[204:205]
v_pk_add_f32 v[186:187], v[186:187], v[206:207]
s_waitcnt lgkmcnt(4)
v_pk_add_f32 v[188:189], v[188:189], v[208:209]
v_pk_add_f32 v[190:191], v[190:191], v[210:211]
v_pk_add_f32 v[28:29], v[28:29], v[224:225]
v_pk_add_f32 v[30:31], v[30:31], v[226:227]
s_waitcnt lgkmcnt(3)
v_pk_add_f32 v[32:33], v[32:33], v[228:229]
v_pk_add_f32 v[34:35], v[34:35], v[230:231]
v_pk_add_f32 v[28:29], v[28:29], v[184:185]
v_pk_add_f32 v[30:31], v[30:31], v[186:187]
v_pk_add_f32 v[32:33], v[32:33], v[188:189]
v_pk_add_f32 v[34:35], v[34:35], v[190:191]
v_cvt_pk_bf16_f32 v52, v28, v29
v_cvt_pk_bf16_f32 v53, v30, v31
v_cvt_pk_bf16_f32 v54, v32, v33
v_cvt_pk_bf16_f32 v55, v34, v35
s_waitcnt lgkmcnt(1)
v_pk_add_f32 v[192:193], v[192:193], v[212:213]
v_pk_add_f32 v[194:195], v[194:195], v[214:215]
s_waitcnt lgkmcnt(0)
v_pk_add_f32 v[36:37], v[36:37], v[232:233]
v_pk_add_f32 v[38:39], v[38:39], v[234:235]
v_pk_add_f32 v[36:37], v[36:37], v[192:193]
v_pk_add_f32 v[38:39], v[38:39], v[194:195]
v_cvt_pk_bf16_f32 v56, v36, v37
v_cvt_pk_bf16_f32 v57, v38, v39
buffer_store_dwordx4 v[48:51], v14, s[4:7], s74 offen sc1
buffer_store_dwordx4 v[52:55], v14, s[4:7], s74 offen offset:512 sc1
buffer_store_dwordx2 v[56:57], v15, s[4:7], s74 offen sc1
v_pk_add_f32 v[176:177], v[20:21], v[22:23]
v_pk_mul_f32 v[178:179], v[20:21], v[20:21]
v_pk_fma_f32 v[178:179], v[22:23], v[22:23], v[178:179]
v_pk_add_f32 v[176:177], v[176:177], v[24:25]
v_pk_fma_f32 v[178:179], v[24:25], v[24:25], v[178:179]
v_pk_add_f32 v[176:177], v[176:177], v[26:27]
v_pk_fma_f32 v[178:179], v[26:27], v[26:27], v[178:179]
v_pk_add_f32 v[176:177], v[176:177], v[28:29]
v_pk_fma_f32 v[178:179], v[28:29], v[28:29], v[178:179]
v_pk_add_f32 v[176:177], v[176:177], v[30:31]
v_pk_fma_f32 v[178:179], v[30:31], v[30:31], v[178:179]
v_pk_add_f32 v[176:177], v[176:177], v[32:33]
v_pk_fma_f32 v[178:179], v[32:33], v[32:33], v[178:179]
v_pk_add_f32 v[176:177], v[176:177], v[34:35]
v_pk_fma_f32 v[178:179], v[34:35], v[34:35], v[178:179]
v_pk_add_f32 v[176:177], v[176:177], v[36:37]
v_pk_fma_f32 v[178:179], v[36:37], v[36:37], v[178:179]
v_pk_add_f32 v[176:177], v[176:177], v[38:39]
v_pk_fma_f32 v[178:179], v[38:39], v[38:39], v[178:179]
v_add_f32 v176, v176, v177
v_add_f32 v177, v178, v179
v_mov_b32 v178, v176
v_mov_b32 v179, v177
s_nop 0
v_permlane32_swap_b32 v178, v176
v_permlane32_swap_b32 v179, v177
v_add_f32 v176, v176, v178
v_add_f32 v177, v177, v179
v_mov_b32 v178, v176
v_mov_b32 v179, v177
s_nop 0
v_permlane16_swap_b32 v178, v176
v_permlane16_swap_b32 v179, v177
v_add_f32 v176, v176, v178
v_add_f32 v177, v177, v179
buffer_store_dwordx2 v[176:177], v17, s[4:7], s76 offen sc1
s_barrier
s_mul_i32 s77, s17, 4096
s_add_u32 s77, s77, 196608
buffer_load_dwordx4 v[136:139], v1, s[4:7], s77 offen offset:0 sc1
buffer_load_dwordx4 v[140:143], v1, s[4:7], s77 offen offset:1024 sc1
buffer_load_dwordx4 v[144:147], v1, s[4:7], s77 offen offset:2048 sc1
buffer_load_dwordx4 v[148:151], v1, s[4:7], s77 offen offset:3072 sc1
s_add_u32 m0, s25, 65536
s_add_u32 s30, s21, 65536
buffer_load_dwordx4 v1, s[4:7], s30 offen sc1 lds
s_waitcnt vmcnt(5)
buffer_atomic_add v9, v255, s[4:7], s100 offen offset:512 sc1
buffer_load_dwordx4 v1, s[4:7], s30 offen offset:1024 sc1 lds
buffer_load_dwordx4 v1, s[4:7], s30 offen offset:2048 sc1 lds
buffer_load_dwordx4 v1, s[4:7], s30 offen offset:3072 sc1 lds
s_add_u32 m0, s25, 81920
s_add_u32 s30, s21, 81920
buffer_load_dwordx4 v1, s[4:7], s30 offen sc1 lds
buffer_load_dwordx4 v1, s[4:7], s30 offen offset:1024 sc1 lds
buffer_load_dwordx4 v1, s[4:7], s30 offen offset:2048 sc1 lds
buffer_load_dwordx4 v1, s[4:7], s30 offen offset:3072 sc1 lds
s_add_u32 m0, s25, 98304
s_add_u32 s30, s21, 98304
buffer_load_dwordx4 v1, s[4:7], s30 offen sc1 lds
buffer_load_dwordx4 v1, s[4:7], s30 offen offset:1024 sc1 lds
buffer_load_dwordx4 v1, s[4:7], s30 offen offset:2048 sc1 lds
buffer_load_dwordx4 v1, s[4:7], s30 offen offset:3072 sc1 lds
s_barrier
ds_read_b128 v[112:115], v1 offset:0
ds_read_b128 v[116:119], v1 offset:1024
ds_read_b128 v[120:123], v1 offset:2048
ds_read_b128 v[124:127], v1 offset:3072
ds_read_b128 v[128:131], v1 offset:4096
ds_read_b128 v[132:135], v1 offset:5120
s_load_dword s15, s[4:5], s101 offset:512 glc
s_mov_b64 exec, 0
s_cmp_eq_u32 s18, 0
s_cbranch_scc1 PG_s10
s_cmp_eq_u32 s18, 1
s_cbranch_scc1 PG_s11
s_cmp_eq_u32 s18, 2
s_cbranch_scc1 PG_s12
s_cmp_eq_u32 s18, 3
s_cbranch_scc1 PG_b3
PG_b3:
s_mov_b64 exec, -1
s_waitcnt lgkmcnt(0)
s_cmp_ge_u32 s15, 16
s_cbranch_scc0 SP48
BK49:
s_add_u32 s78, s26, 67436544
buffer_load_dwordx4 a[0:3], v4, s[4:7], s78 offen offset:0 sc1
buffer_load_dwordx4 a[4:7], v4, s[4:7], s78 offen offset:2048 sc1
buffer_load_dwordx4 a[8:11], v4, s[4:7], s78 offen offset:256 sc1
buffer_load_dwordx4 a[12:15], v4, s[4:7], s78 offen offset:2304 sc1
s_add_u32 s78, s26, 67440640
buffer_load_dwordx4 a[16:19], v4, s[4:7], s78 offen offset:0 sc1
buffer_load_dwordx4 a[20:23], v4, s[4:7], s78 offen offset:2048 sc1
buffer_load_dwordx4 a[24:27], v4, s[4:7], s78 offen offset:256 sc1
buffer_load_dwordx4 a[28:31], v4, s[4:7], s78 offen offset:2304 sc1
s_add_u32 s78, s26, 67452928
buffer_load_dwordx4 a[32:35], v4, s[4:7], s78 offen offset:0 sc1
buffer_load_dwordx4 a[36:39], v4, s[4:7], s78 offen offset:2048 sc1
buffer_load_dwordx4 a[40:43], v4, s[4:7], s78 offen offset:256 sc1
v_mov_b32 v228, 0x3f803f80
v_mov_b32 v229, 0x3f803f80
v_mov_b32 v230, 0x3f803f80
v_mov_b32 v231, 0x3f803f80
v_cndmask_b32 v216, 0, -1, s[32:33]
v_cndmask_b32 v217, 0, -1, s[34:35]
v_and_b32 v216, 0xffff, v216
v_lshl_or_b32 v188, v217, 16, v216
v_cndmask_b32 v216, 0, -1, s[36:37]
v_cndmask_b32 v217, 0, -1, s[38:39]
v_and_b32 v216, 0xffff, v216
v_lshl_or_b32 v189, v217, 16, v216
v_cndmask_b32 v216, 0, -1, s[40:41]
v_cndmask_b32 v217, 0, -1, s[42:43]
v_and_b32 v216, 0xffff, v216
v_lshl_or_b32 v190, v217, 16, v216
v_cndmask_b32 v216, 0, -1, s[44:45]
v_cndmask_b32 v217, 0, -1, s[46:47]
v_and_b32 v216, 0xffff, v216
v_lshl_or_b32 v191, v217, 16, v216
v_cndmask_b32 v216, 0, -1, s[48:49]
v_cndmask_b32 v217, 0, -1, s[50:51]
v_and_b32 v216, 0xffff, v216
v_lshl_or_b32 v192, v217, 16, v216
v_cndmask_b32 v216, 0, -1, s[52:53]
v_cndmask_b32 v217, 0, -1, s[54:55]
v_and_b32 v216, 0xffff, v216
v_lshl_or_b32 v193, v217, 16, v216
v_cndmask_b32 v216, 0, -1, s[56:57]
v_cndmask_b32 v217, 0, -1, s[58:59]
v_and_b32 v216, 0xffff, v216
v_lshl_or_b32 v194, v217, 16, v216
v_cndmask_b32 v216, 0, -1, s[60:61]
v_cndmask_b32 v217, 0, -1, s[62:63]
v_and_b32 v216, 0xffff, v216
v_lshl_or_b32 v195, v217, 16, v216
v_lshrrev_b32 v216, 5, v0
v_bfe_u32 v217, v0, 2, 2
v_lshl_add_u32 v216, v216, 2, v217
v_bfe_u32 v217, v0, 4, 1
v_and_b32 v218, 3, v0
v_lshl_add_u32 v217, v217, 2, v218
v_and_b32 v218, 1, v0
v_lshlrev_b32 v219, 2, v218
v_xor_b32 v219, v219, v216
v_lshlrev_b32 v219, 4, v219
v_lshl_add_u32 v219, v218, 9, v219
v_bfe_u32 v220, v0, 1, 1
v_lshl_add_u32 v220, v220, 3, v219
v_add_u32 v221, 4232, v219
v_mov_b32 v224, 128
v_mov_b32 v225, 5248
v_subrev_u32 v226, v5, v47
s_lshl_b32 s76, s18, 7
s_add_u32 s76, s76, 63104
v_mov_b32 v227, s76
v_add_u32 v222, 2048, v220
v_cmp_gt_u32 vcc, 4, v217
s_nop 1
v_cndmask_b32 v222, v221, v222, vcc
v_add_u32 v222, v226, v222
v_cmp_gt_u32 s[64:65], 4, v217
v_cmp_eq_u32 vcc, 4, v217
s_nop 0
s_or_b64 vcc, vcc, s[64:65]
v_cndmask_b32 v196, v227, v222, vcc
v_cndmask_b32 v223, v224, v225, vcc
v_add_u32 v197, v196, v223
v_add_u32 v198, v197, v223
v_add_u32 v199, v198, v223
v_add_u32 v200, v199, v223
v_add_u32 v201, v200, v223
v_add_u32 v202, v201, v223
v_add_u32 v203, v202, v223
v_add_u32 v204, v203, v223
v_add_u32 v222, 3072, v220
v_cmp_gt_u32 vcc, 4, v217
s_nop 1
v_cndmask_b32 v222, v221, v222, vcc
v_add_u32 v222, v226, v222
v_cmp_gt_u32 s[64:65], 4, v217
v_cmp_eq_u32 vcc, 5, v217
s_nop 0
s_or_b64 vcc, vcc, s[64:65]
v_cndmask_b32 v205, v227, v222, vcc
v_cndmask_b32 v223, v224, v225, vcc
v_add_u32 v206, v205, v223
v_add_u32 v207, v206, v223
v_add_u32 v208, v207, v223
v_add_u32 v209, v208, v223
v_add_u32 v210, v209, v223
v_add_u32 v211, v210, v223
v_add_u32 v212, v211, v223
v_add_u32 v213, v212, v223
s_waitcnt vmcnt(9)
v_mfma_f32_16x16x32_bf16 v[48:51], v[112:115], a[0:3], 0
buffer_load_dwordx4 a[44:47], v4, s[4:7], s78 offen offset:2304 sc1
v_mfma_f32_16x16x32_bf16 v[48:51], v[116:119], a[4:7], v[48:51]
s_waitcnt vmcnt(8)
v_mfma_f32_16x16x32_bf16 v[56:59], v[112:115], a[8:11], 0
ds_read_b128 v[112:115], v1 offset:6144
v_mfma_f32_16x16x32_bf16 v[56:59], v[116:119], a[12:15], v[56:59]
ds_read_b128 v[116:119], v1 offset:7168
v_mfma_f32_16x16x32_bf16 v[52:55], v[120:123], a[0:3], 0
s_add_u32 s78, s26, 67457024
v_mfma_f32_16x16x32_bf16 v[52:55], v[124:127], a[4:7], v[52:55]
buffer_load_dwordx4 a[48:51], v4, s[4:7], s78 offen offset:0 sc1
v_mfma_f32_16x16x32_bf16 v[60:63], v[120:123], a[8:11], 0
ds_read_b128 v[120:123], v1 offset:8192
v_mfma_f32_16x16x32_bf16 v[60:63], v[124:127], a[12:15], v[60:63]
ds_read_b128 v[124:127], v1 offset:9216
v_mfma_f32_16x16x32_bf16 v[64:67], v[128:131], a[0:3], 0
buffer_load_dwordx4 a[52:55], v4, s[4:7], s78 offen offset:2048 sc1
v_mfma_f32_16x16x32_bf16 v[64:67], v[132:135], a[4:7], v[64:67]
v_lshrrev_b32 v160, 4, v0
v_lshlrev_b32 v160, 11, v160
v_mfma_f32_16x16x32_bf16 v[72:75], v[128:131], a[8:11], 0
ds_read_b128 v[128:131], v1 offset:10240
v_and_b32 v161, 15, v0
v_mfma_f32_16x16x32_bf16 v[72:75], v[132:135], a[12:15], v[72:75]
ds_read_b128 v[132:135], v1 offset:11264
s_waitcnt lgkmcnt(4)
v_mfma_f32_16x16x32_bf16 v[68:71], v[112:115], a[0:3], 0
buffer_load_dwordx4 a[56:59], v4, s[4:7], s78 offen offset:256 sc1
v_mfma_f32_16x16x32_bf16 v[68:71], v[116:119], a[4:7], v[68:71]
v_lshl_add_u32 v160, v161, 3, v160
v_lshl_add_u32 v160, s18, 8, v160
v_mfma_f32_16x16x32_bf16 v[76:79], v[112:115], a[8:11], 0
ds_read_b128 v[112:115], v1 offset:12288
v_bfe_u32 v238, v0, 4, 1
v_mfma_f32_16x16x32_bf16 v[76:79], v[116:119], a[12:15], v[76:79]
ds_read_b128 v[116:119], v1 offset:13312
s_waitcnt vmcnt(9) lgkmcnt(4)
v_mfma_f32_16x16x32_bf16 v[48:51], v[120:123], a[16:19], v[48:51]
buffer_load_dwordx4 a[60:63], v4, s[4:7], s78 offen offset:2304 sc1
v_mfma_f32_16x16x32_bf16 v[48:51], v[124:127], a[20:23], v[48:51]
v_and_b32 v234, 15, v0
v_lshlrev_b32 v237, 2, v238
s_waitcnt vmcnt(8)
v_mfma_f32_16x16x32_bf16 v[56:59], v[120:123], a[24:27], v[56:59]
ds_read_b128 v[120:123], v1 offset:14336
v_xor_b32 v234, v234, v237
v_mfma_f32_16x16x32_bf16 v[56:59], v[124:127], a[28:31], v[56:59]
ds_read_b128 v[124:127], v1 offset:15360
s_waitcnt lgkmcnt(4)
v_mfma_f32_16x16x32_bf16 v[52:55], v[128:131], a[16:19], v[52:55]
s_add_u32 s78, s26, 67469312
v_lshlrev_b32 v234, 4, v234
v_mfma_f32_16x16x32_bf16 v[52:55], v[132:135], a[20:23], v[52:55]
buffer_load_dwordx4 a[64:67], v4, s[4:7], s78 offen offset:0 sc1
v_mfma_f32_16x16x32_bf16 v[60:63], v[128:131], a[24:27], v[60:63]
ds_read_b128 v[128:131], v1 offset:16384
v_lshl_add_u32 v234, v238, 9, v234
v_mfma_f32_16x16x32_bf16 v[60:63], v[132:135], a[28:31], v[60:63]
ds_read_b128 v[132:135], v1 offset:17408
s_waitcnt lgkmcnt(4)
v_mfma_f32_16x16x32_bf16 v[64:67], v[112:115], a[16:19], v[64:67]
buffer_load_dwordx4 a[68:71], v4, s[4:7], s78 offen offset:2048 sc1
v_mfma_f32_16x16x32_bf16 v[64:67], v[116:119], a[20:23], v[64:67]
v_lshrrev_b32 v239, 5, v0
v_lshl_add_u32 v232, v239, 10, v234
v_mfma_f32_16x16x32_bf16 v[72:75], v[112:115], a[24:27], v[72:75]
ds_read_b128 v[112:115], v1 offset:18432
v_lshl_add_u32 v233, v239, 11, v234
v_mfma_f32_16x16x32_bf16 v[72:75], v[116:119], a[28:31], v[72:75]
ds_read_b128 v[116:119], v1 offset:19456
s_waitcnt lgkmcnt(4)
v_mfma_f32_16x16x32_bf16 v[68:71], v[120:123], a[16:19], v[68:71]
buffer_load_dwordx4 a[72:75], v4, s[4:7], s78 offen offset:256 sc1
v_mfma_f32_16x16x32_bf16 v[68:71], v[124:127], a[20:23], v[68:71]
v_sub_u32 v237, v47, v5
v_add_u32 v237, 41984, v237
v_mfma_f32_16x16x32_bf16 v[76:79], v[120:123], a[24:27], v[76:79]
ds_read_b128 v[120:123], v1 offset:20480
v_add_u32 v235, v237, v232
v_mfma_f32_16x16x32_bf16 v[76:79], v[124:127], a[28:31], v[76:79]
ds_read_b128 v[124:127], v1 offset:21504
s_waitcnt vmcnt(9) lgkmcnt(4)
v_mfma_f32_16x16x32_bf16 v[48:51], v[128:131], a[32:35], v[48:51]
buffer_load_dwordx4 a[76:79], v4, s[4:7], s78 offen offset:2304 sc1
v_mfma_f32_16x16x32_bf16 v[48:51], v[132:135], a[36:39], v[48:51]
v_add_u32 v236, v237, v233
v_lshl_add_u32 v236, v239, 7, v236
s_waitcnt vmcnt(8)
v_mfma_f32_16x16x32_bf16 v[56:59], v[128:131], a[40:43], v[56:59]
ds_read_b128 v[128:131], v1 offset:22528
v_add_u32 v238, s25, v232
v_mfma_f32_16x16x32_bf16 v[56:59], v[132:135], a[44:47], v[56:59]
ds_read_b128 v[132:135], v1 offset:23552
s_waitcnt lgkmcnt(4)
v_mfma_f32_16x16x32_bf16 v[52:55], v[112:115], a[32:35], v[52:55]
s_add_u32 s78, s26, 67473408
v_add_u32 v238, 66560, v238
v_mfma_f32_16x16x32_bf16 v[52:55], v[116:119], a[36:39], v[52:55]
buffer_load_dwordx4 a[80:83], v4, s[4:7], s78 offen offset:0 sc1
v_mfma_f32_16x16x32_bf16 v[60:63], v[112:115], a[40:43], v[60:63]
ds_read_b128 v[112:115], v1 offset:24576
v_add_u32 v237, 3072, v235
v_mfma_f32_16x16x32_bf16 v[60:63], v[116:119], a[44:47], v[60:63]
ds_read_b128 v[116:119], v1 offset:25600
s_waitcnt lgkmcnt(4)
v_mfma_f32_16x16x32_bf16 v[64:67], v[120:123], a[32:35], v[64:67]
buffer_load_dwordx4 a[84:87], v4, s[4:7], s78 offen offset:2048 sc1
v_mfma_f32_16x16x32_bf16 v[64:67], v[124:127], a[36:39], v[64:67]
buffer_load_dwordx4 a[88:91], v4, s[4:7], s78 offen offset:256 sc1
v_mfma_f32_16x16x32_bf16 v[72:75], v[120:123], a[40:43], v[72:75]
ds_read_b128 v[120:123], v1 offset:26624
v_lshl_add_u32 v234, v239, 28, v234
v_mfma_f32_16x16x32_bf16 v[72:75], v[124:127], a[44:47], v[72:75]
ds_read_b128 v[124:127], v1 offset:27648
s_waitcnt lgkmcnt(4)
v_mfma_f32_16x16x32_bf16 v[68:71], v[128:131], a[32:35], v[68:71]
buffer_load_dwordx4 a[92:95], v4, s[4:7], s78 offen offset:2304 sc1
v_mfma_f32_16x16x32_bf16 v[68:71], v[132:135], a[36:39], v[68:71]
v_subrev_u32 v239, 2048, v238
v_mfma_f32_16x16x32_bf16 v[76:79], v[128:131], a[40:43], v[76:79]
ds_read_b128 v[128:131], v1 offset:28672
v_mfma_f32_16x16x32_bf16 v[76:79], v[132:135], a[44:47], v[76:79]
ds_read_b128 v[132:135], v1 offset:29696
s_waitcnt vmcnt(10) lgkmcnt(4)
v_mfma_f32_16x16x32_bf16 v[48:51], v[112:115], a[48:51], v[48:51]
s_add_u32 s78, s26, 67485696
v_mfma_f32_16x16x32_bf16 v[48:51], v[116:119], a[52:55], v[48:51]
buffer_load_dwordx4 a[96:99], v4, s[4:7], s78 offen offset:0 sc1
s_waitcnt vmcnt(9)
v_mfma_f32_16x16x32_bf16 v[56:59], v[112:115], a[56:59], v[56:59]
ds_read_b128 v[112:115], v1 offset:30720
v_mfma_f32_16x16x32_bf16 v[56:59], v[116:119], a[60:63], v[56:59]
ds_read_b128 v[116:119], v1 offset:31744
s_barrier
s_waitcnt lgkmcnt(4)
v_mfma_f32_16x16x32_bf16 v[52:55], v[120:123], a[48:51], v[52:55]
buffer_load_dwordx4 a[100:103], v4, s[4:7], s78 offen offset:2048 sc1
v_mfma_f32_16x16x32_bf16 v[52:55], v[124:127], a[52:55], v[52:55]
s_mov_b32 vcc_lo, -1
s_mov_b32 vcc_hi, 0
v_cndmask_b32 v237, v239, v237, vcc
v_mfma_f32_16x16x32_bf16 v[60:63], v[120:123], a[56:59], v[60:63]
ds_read_b128 v[120:123], v1 offset:32768
v_add_u32 v239, s25, v5
v_mfma_f32_16x16x32_bf16 v[60:63], v[124:127], a[60:63], v[60:63]
ds_read_b128 v[124:127], v1 offset:33792
s_waitcnt lgkmcnt(4)
v_mfma_f32_16x16x32_bf16 v[64:67], v[128:131], a[48:51], v[64:67]
s_and_b32 s76, s99, 0xffffe000
s_add_u32 s76, s76, 4294934528
v_mfma_f32_16x16x32_bf16 v[64:67], v[132:135], a[52:55], v[64:67]
buffer_load_dwordx2 v[152:153], v160, s[4:7], s76 offen offset:0 sc1
v_mfma_f32_16x16x32_bf16 v[72:75], v[128:131], a[56:59], v[72:75]
ds_read_b128 v[128:131], v1 offset:34816
v_add_u32 v239, 65536, v239
v_mfma_f32_16x16x32_bf16 v[72:75], v[132:135], a[60:63], v[72:75]
ds_read_b128 v[132:135], v1 offset:35840
s_waitcnt lgkmcnt(4)
v_mfma_f32_16x16x32_bf16 v[68:71], v[112:115], a[48:51], v[68:71]
buffer_load_dwordx4 a[104:107], v4, s[4:7], s78 offen offset:256 sc1
v_mfma_f32_16x16x32_bf16 v[68:71], v[116:119], a[52:55], v[68:71]
buffer_load_dwordx2 v[154:155], v160, s[4:7], s76 offen offset:1024 sc1
v_mfma_f32_16x16x32_bf16 v[76:79], v[112:115], a[56:59], v[76:79]
ds_read_b128 v[112:115], v1 offset:36864
v_mfma_f32_16x16x32_bf16 v[76:79], v[116:119], a[60:63], v[76:79]
ds_read_b128 v[116:119], v1 offset:37888
s_waitcnt vmcnt(11) lgkmcnt(4)
v_mfma_f32_16x16x32_bf16 v[48:51], v[120:123], a[64:67], v[48:51]
buffer_load_dwordx4 a[108:111], v4, s[4:7], s78 offen offset:2304 sc1
v_mfma_f32_16x16x32_bf16 v[48:51], v[124:127], a[68:71], v[48:51]
buffer_load_dwordx2 v[156:157], v160, s[4:7], s76 offen offset:128 sc1
s_waitcnt vmcnt(11)
v_mfma_f32_16x16x32_bf16 v[56:59], v[120:123], a[72:75], v[56:59]
ds_read_b128 v[120:123], v1 offset:38912
v_mfma_f32_16x16x32_bf16 v[56:59], v[124:127], a[76:79], v[56:59]
ds_read_b128 v[124:127], v1 offset:39936
s_waitcnt lgkmcnt(4)
v_mfma_f32_16x16x32_bf16 v[52:55], v[128:131], a[64:67], v[52:55]
s_add_u32 s78, s26, 67489792
v_mfma_f32_16x16x32_bf16 v[52:55], v[132:135], a[68:71], v[52:55]
buffer_load_dwordx4 a[112:115], v4, s[4:7], s78 offen offset:0 sc1
v_mfma_f32_16x16x32_bf16 v[60:63], v[128:131], a[72:75], v[60:63]
ds_read_b128 v[128:131], v1 offset:40960
v_mfma_f32_16x16x32_bf16 v[60:63], v[132:135], a[76:79], v[60:63]
ds_read_b128 v[132:135], v1 offset:41984
s_waitcnt lgkmcnt(4)
v_mfma_f32_16x16x32_bf16 v[64:67], v[112:115], a[64:67], v[64:67]
buffer_load_dwordx2 v[158:159], v160, s[4:7], s76 offen offset:1152 sc1
v_mfma_f32_16x16x32_bf16 v[64:67], v[116:119], a[68:71], v[64:67]
buffer_load_dwordx4 a[116:119], v4, s[4:7], s78 offen offset:2048 sc1
v_mfma_f32_16x16x32_bf16 v[72:75], v[112:115], a[72:75], v[72:75]
ds_read_b128 v[112:115], v1 offset:43008
v_mfma_f32_16x16x32_bf16 v[72:75], v[116:119], a[76:79], v[72:75]
ds_read_b128 v[116:119], v1 offset:44032
s_waitcnt lgkmcnt(4)
v_mfma_f32_16x16x32_bf16 v[68:71], v[120:123], a[64:67], v[68:71]
buffer_load_dwordx4 a[120:123], v4, s[4:7], s78 offen offset:256 sc1
v_mfma_f32_16x16x32_bf16 v[68:71], v[124:127], a[68:71], v[68:71]
buffer_load_dwordx4 a[124:127], v4, s[4:7], s78 offen offset:2304 sc1
v_mfma_f32_16x16x32_bf16 v[76:79], v[120:123], a[72:75], v[76:79]
ds_read_b128 v[120:123], v1 offset:45056
v_mfma_f32_16x16x32_bf16 v[76:79], v[124:127], a[76:79], v[76:79]
ds_read_b128 v[124:127], v1 offset:46080
s_waitcnt vmcnt(14) lgkmcnt(4)
v_mfma_f32_16x16x32_bf16 v[48:51], v[128:131], a[80:83], v[48:51]
s_add_u32 s78, s26, 67502080
v_mfma_f32_16x16x32_bf16 v[48:51], v[132:135], a[84:87], v[48:51]
buffer_load_dwordx4 a[128:131], v4, s[4:7], s78 offen offset:0 sc1
s_waitcnt vmcnt(13)
v_mfma_f32_16x16x32_bf16 v[56:59], v[128:131], a[88:91], v[56:59]
ds_read_b128 v[128:131], v1 offset:47104
v_mfma_f32_16x16x32_bf16 v[56:59], v[132:135], a[92:95], v[56:59]
ds_read_b128 v[132:135], v1 offset:48128
s_waitcnt lgkmcnt(4)
v_mfma_f32_16x16x32_bf16 v[52:55], v[112:115], a[80:83], v[52:55]
buffer_load_dwordx4 a[132:135], v4, s[4:7], s78 offen offset:2048 sc1
v_mfma_f32_16x16x32_bf16 v[52:55], v[116:119], a[84:87], v[52:55]
v_mfma_f32_16x16x32_bf16 v[60:63], v[112:115], a[88:91], v[60:63]
ds_read_b128 v[112:115], v1 offset:49152
v_mfma_f32_16x16x32_bf16 v[60:63], v[116:119], a[92:95], v[60:63]
ds_read_b128 v[116:119], v1 offset:50176
s_waitcnt lgkmcnt(4)
v_mfma_f32_16x16x32_bf16 v[64:67], v[120:123], a[80:83], v[64:67]
buffer_load_dwordx4 a[136:139], v4, s[4:7], s78 offen offset:256 sc1
v_mfma_f32_16x16x32_bf16 v[64:67], v[124:127], a[84:87], v[64:67]
v_mfma_f32_16x16x32_bf16 v[72:75], v[120:123], a[88:91], v[72:75]
ds_read_b128 v[120:123], v1 offset:51200
v_mfma_f32_16x16x32_bf16 v[72:75], v[124:127], a[92:95], v[72:75]
ds_read_b128 v[124:127], v1 offset:52224
s_waitcnt lgkmcnt(4)
v_mfma_f32_16x16x32_bf16 v[68:71], v[128:131], a[80:83], v[68:71]
buffer_load_dwordx4 a[140:143], v4, s[4:7], s78 offen offset:2304 sc1
v_mfma_f32_16x16x32_bf16 v[68:71], v[132:135], a[84:87], v[68:71]
v_mfma_f32_16x16x32_bf16 v[76:79], v[128:131], a[88:91], v[76:79]
ds_read_b128 v[128:131], v1 offset:53248
v_mfma_f32_16x16x32_bf16 v[76:79], v[132:135], a[92:95], v[76:79]
ds_read_b128 v[132:135], v1 offset:54272
s_waitcnt vmcnt(14) lgkmcnt(4)
v_mfma_f32_16x16x32_bf16 v[48:51], v[112:115], a[96:99], v[48:51]
s_add_u32 s78, s26, 67506176
v_mfma_f32_16x16x32_bf16 v[48:51], v[116:119], a[100:103], v[48:51]
buffer_load_dwordx4 a[144:147], v4, s[4:7], s78 offen offset:0 sc1
s_waitcnt vmcnt(11)
v_mfma_f32_16x16x32_bf16 v[56:59], v[112:115], a[104:107], v[56:59]
ds_read_b128 v[112:115], v1 offset:55296
v_mfma_f32_16x16x32_bf16 v[56:59], v[116:119], a[108:111], v[56:59]
ds_read_b128 v[116:119], v1 offset:56320
s_waitcnt lgkmcnt(4)
v_mfma_f32_16x16x32_bf16 v[52:55], v[120:123], a[96:99], v[52:55]
buffer_load_dwordx4 a[148:151], v4, s[4:7], s78 offen offset:2048 sc1
v_mfma_f32_16x16x32_bf16 v[52:55], v[124:127], a[100:103], v[52:55]
v_mfma_f32_16x16x32_bf16 v[60:63], v[120:123], a[104:107], v[60:63]
ds_read_b128 v[120:123], v1 offset:57344
v_mfma_f32_16x16x32_bf16 v[60:63], v[124:127], a[108:111], v[60:63]
ds_read_b128 v[124:127], v1 offset:58368
s_waitcnt lgkmcnt(4)
v_mfma_f32_16x16x32_bf16 v[64:67], v[128:131], a[96:99], v[64:67]
buffer_load_dwordx4 a[152:155], v4, s[4:7], s78 offen offset:256 sc1
v_mfma_f32_16x16x32_bf16 v[64:67], v[132:135], a[100:103], v[64:67]
v_mfma_f32_16x16x32_bf16 v[72:75], v[128:131], a[104:107], v[72:75]
ds_read_b128 v[128:131], v1 offset:59392
v_mfma_f32_16x16x32_bf16 v[72:75], v[132:135], a[108:111], v[72:75]
ds_read_b128 v[132:135], v1 offset:60416
s_waitcnt lgkmcnt(4)
v_mfma_f32_16x16x32_bf16 v[68:71], v[112:115], a[96:99], v[68:71]
buffer_load_dwordx4 a[156:159], v4, s[4:7], s78 offen offset:2304 sc1
v_mfma_f32_16x16x32_bf16 v[68:71], v[116:119], a[100:103], v[68:71]
v_add_f32 v152, v152, v154
v_add_f32 v153, v153, v155
v_mfma_f32_16x16x32_bf16 v[76:79], v[112:115], a[104:107], v[76:79]
ds_read_b128 v[112:115], v1 offset:61440
s_waitcnt vmcnt(11)
v_add_f32 v156, v156, v158
v_mfma_f32_16x16x32_bf16 v[76:79], v[116:119], a[108:111], v[76:79]
ds_read_b128 v[116:119], v1 offset:62464
s_waitcnt vmcnt(10) lgkmcnt(4)
v_mfma_f32_16x16x32_bf16 v[48:51], v[120:123], a[112:115], v[48:51]
v_add_f32 v157, v157, v159
v_mov_b32 v154, v152
v_mfma_f32_16x16x32_bf16 v[48:51], v[124:127], a[116:119], v[48:51]
v_mov_b32 v155, v153
v_mov_b32 v158, v156
s_waitcnt vmcnt(8)
v_mfma_f32_16x16x32_bf16 v[56:59], v[120:123], a[120:123], v[56:59]
ds_read_b128 v[120:123], v1 offset:63488
v_mov_b32 v159, v157
v_mfma_f32_16x16x32_bf16 v[56:59], v[124:127], a[124:127], v[56:59]
ds_read_b128 v[124:127], v1 offset:64512
s_waitcnt lgkmcnt(4)
v_mfma_f32_16x16x32_bf16 v[52:55], v[128:131], a[112:115], v[52:55]
s_add_u32 m0, s25, 114688
s_add_u32 s30, s21, 114688
v_mfma_f32_16x16x32_bf16 v[52:55], v[132:135], a[116:119], v[52:55]
buffer_load_dwordx4 v1, s[4:7], s30 offen sc1 lds
v_mfma_f32_16x16x32_bf16 v[60:63], v[128:131], a[120:123], v[60:63]
ds_read_b128 v[128:131], v2 offset:0
v_permlane32_swap_b32 v154, v152
v_mfma_f32_16x16x32_bf16 v[60:63], v[132:135], a[124:127], v[60:63]
ds_read_b128 v[132:135], v2 offset:1024
s_waitcnt lgkmcnt(4)
v_mfma_f32_16x16x32_bf16 v[64:67], v[112:115], a[112:115], v[64:67]
buffer_load_dwordx4 v1, s[4:7], s30 offen offset:1024 sc1 lds
v_mfma_f32_16x16x32_bf16 v[64:67], v[116:119], a[116:119], v[64:67]
v_permlane32_swap_b32 v155, v153
v_permlane32_swap_b32 v158, v156
v_mfma_f32_16x16x32_bf16 v[72:75], v[112:115], a[120:123], v[72:75]
ds_read_b128 v[112:115], v2 offset:2048
v_permlane32_swap_b32 v159, v157
v_mfma_f32_16x16x32_bf16 v[72:75], v[116:119], a[124:127], v[72:75]
ds_read_b128 v[116:119], v2 offset:3072
s_waitcnt lgkmcnt(4)
v_mfma_f32_16x16x32_bf16 v[68:71], v[120:123], a[112:115], v[68:71]
buffer_load_dwordx4 v1, s[4:7], s30 offen offset:2048 sc1 lds
v_mfma_f32_16x16x32_bf16 v[68:71], v[124:127], a[116:119], v[68:71]
v_add_f32 v152, v152, v154
v_add_f32 v153, v153, v155
v_mfma_f32_16x16x32_bf16 v[76:79], v[120:123], a[120:123], v[76:79]
ds_read_b128 v[120:123], v2 offset:4096
v_add_f32 v156, v156, v158
v_mfma_f32_16x16x32_bf16 v[76:79], v[124:127], a[124:127], v[76:79]
ds_read_b128 v[124:127], v2 offset:5120
s_waitcnt vmcnt(9) lgkmcnt(4)
v_mfma_f32_16x16x32_bf16 v[48:51], v[128:131], a[128:131], v[48:51]
buffer_load_dwordx4 v1, s[4:7], s30 offen offset:3072 sc1 lds
v_mfma_f32_16x16x32_bf16 v[48:51], v[132:135], a[132:135], v[48:51]
v_add_f32 v157, v157, v159
v_mov_b32 v154, v152
s_waitcnt vmcnt(8)
v_mfma_f32_16x16x32_bf16 v[56:59], v[128:131], a[136:139], v[56:59]
ds_read_b128 v[128:131], v2 offset:6144
v_mov_b32 v155, v153
v_mfma_f32_16x16x32_bf16 v[56:59], v[132:135], a[140:143], v[56:59]
ds_read_b128 v[132:135], v2 offset:7168
PG_s10:
s_cbranch_execz PG_b3
s_waitcnt lgkmcnt(4)
v_mfma_f32_16x16x32_bf16 v[52:55], v[112:115], a[128:131], v[52:55]
s_add_u32 m0, s25, 131072
s_add_u32 s30, s21, 131072
v_mfma_f32_16x16x32_bf16 v[52:55], v[116:119], a[132:135], v[52:55]
buffer_load_dwordx4 v1, s[4:7], s30 offen sc1 lds
v_mfma_f32_16x16x32_bf16 v[60:63], v[112:115], a[136:139], v[60:63]
ds_read_b128 v[112:115], v2 offset:8192
v_mov_b32 v158, v156
v_mfma_f32_16x16x32_bf16 v[60:63], v[116:119], a[140:143], v[60:63]
ds_read_b128 v[116:119], v2 offset:9216
s_waitcnt lgkmcnt(4)
v_mfma_f32_16x16x32_bf16 v[64:67], v[120:123], a[128:131], v[64:67]
buffer_load_dwordx4 v1, s[4:7], s30 offen offset:1024 sc1 lds
v_mfma_f32_16x16x32_bf16 v[64:67], v[124:127], a[132:135], v[64:67]
v_mov_b32 v159, v157
v_permlane16_swap_b32 v154, v152
v_mfma_f32_16x16x32_bf16 v[72:75], v[120:123], a[136:139], v[72:75]
ds_read_b128 v[120:123], v2 offset:10240
v_permlane16_swap_b32 v155, v153
v_mfma_f32_16x16x32_bf16 v[72:75], v[124:127], a[140:143], v[72:75]
ds_read_b128 v[124:127], v2 offset:11264
s_waitcnt lgkmcnt(4)
v_mfma_f32_16x16x32_bf16 v[68:71], v[128:131], a[128:131], v[68:71]
buffer_load_dwordx4 v1, s[4:7], s30 offen offset:2048 sc1 lds
v_mfma_f32_16x16x32_bf16 v[68:71], v[132:135], a[132:135], v[68:71]
v_permlane16_swap_b32 v158, v156
v_permlane16_swap_b32 v159, v157
v_mfma_f32_16x16x32_bf16 v[76:79], v[128:131], a[136:139], v[76:79]
ds_read_b128 v[128:131], v2 offset:12288
v_add_f32 v152, v152, v154
v_mfma_f32_16x16x32_bf16 v[76:79], v[132:135], a[140:143], v[76:79]
ds_read_b128 v[132:135], v2 offset:13312
s_waitcnt vmcnt(9) lgkmcnt(4)
v_mfma_f32_16x16x32_bf16 v[48:51], v[112:115], a[144:147], v[48:51]
buffer_load_dwordx4 v1, s[4:7], s30 offen offset:3072 sc1 lds
v_mfma_f32_16x16x32_bf16 v[48:51], v[116:119], a[148:151], v[48:51]
v_add_f32 v153, v153, v155
v_add_f32 v156, v156, v158
s_waitcnt vmcnt(8)
v_mfma_f32_16x16x32_bf16 v[56:59], v[112:115], a[152:155], v[56:59]
ds_read_b128 v[112:115], v2 offset:14336
v_add_f32 v157, v157, v159
v_mfma_f32_16x16x32_bf16 v[56:59], v[116:119], a[156:159], v[56:59]
ds_read_b128 v[116:119], v2 offset:15360
s_waitcnt lgkmcnt(4)
v_mfma_f32_16x16x32_bf16 v[52:55], v[120:123], a[144:147], v[52:55]
s_add_u32 m0, s25, 147456
s_add_u32 s30, s21, 147456
v_mfma_f32_16x16x32_bf16 v[52:55], v[124:127], a[148:151], v[52:55]
buffer_load_dwordx4 v1, s[4:7], s30 offen sc1 lds
v_mfma_f32_16x16x32_bf16 v[60:63], v[120:123], a[152:155], v[60:63]
ds_read_b128 v[120:123], v2 offset:16384
v_mul_f32 v152, 0xbacccccd, v152
v_mfma_f32_16x16x32_bf16 v[60:63], v[124:127], a[156:159], v[60:63]
ds_read_b128 v[124:127], v2 offset:17408
s_waitcnt lgkmcnt(4)
v_mfma_f32_16x16x32_bf16 v[64:67], v[128:131], a[144:147], v[64:67]
buffer_load_dwordx4 v1, s[4:7], s30 offen offset:1024 sc1 lds
v_mfma_f32_16x16x32_bf16 v[64:67], v[132:135], a[148:151], v[64:67]
v_cvt_pk_bf16_f32 v40, v152, v152
v_cvt_pk_bf16_f32 v41, v152, v152
v_mfma_f32_16x16x32_bf16 v[72:75], v[128:131], a[152:155], v[72:75]
ds_read_b128 v[128:131], v2 offset:18432
v_mul_f32 v156, 0xbacccccd, v156
v_mfma_f32_16x16x32_bf16 v[72:75], v[132:135], a[156:159], v[72:75]
ds_read_b128 v[132:135], v2 offset:19456
s_waitcnt lgkmcnt(4)
v_mfma_f32_16x16x32_bf16 v[68:71], v[112:115], a[144:147], v[68:71]
buffer_load_dwordx4 v1, s[4:7], s30 offen offset:2048 sc1 lds
v_mfma_f32_16x16x32_bf16 v[68:71], v[116:119], a[148:151], v[68:71]
v_cvt_pk_bf16_f32 v42, v156, v156
v_cvt_pk_bf16_f32 v43, v156, v156
v_mfma_f32_16x16x32_bf16 v[76:79], v[112:115], a[152:155], v[76:79]
ds_read_b128 v[112:115], v2 offset:20480
v_mul_f32 v153, 0x3acccccd, v153
v_mfma_f32_16x16x32_bf16 v[76:79], v[116:119], a[156:159], v[76:79]
ds_read_b128 v[116:119], v2 offset:21504
v_mfma_f32_16x16x16_bf16 v[48:51], v[136:137], v[40:41], v[48:51]
buffer_load_dwordx4 v1, s[4:7], s30 offen offset:3072 sc1 lds
v_mfma_f32_16x16x16_bf16 v[56:59], v[136:137], v[42:43], v[56:59]
v_fma_f32 v153, -v152, v152, v153
v_max_f32 v153, 0, v153
v_mfma_f32_16x16x16_bf16 v[52:55], v[138:139], v[40:41], v[52:55]
v_add_f32 v153, 0x3727c5ac, v153
v_mfma_f32_16x16x16_bf16 v[60:63], v[138:139], v[42:43], v[60:63]
v_mfma_f32_16x16x16_bf16 v[64:67], v[140:141], v[40:41], v[64:67]
v_rsq_f32 v18, v153
v_mfma_f32_16x16x16_bf16 v[72:75], v[140:141], v[42:43], v[72:75]
v_mul_f32 v157, 0x3acccccd, v157
v_fma_f32 v157, -v156, v156, v157
v_mfma_f32_16x16x16_bf16 v[68:71], v[142:143], v[40:41], v[68:71]
v_max_f32 v157, 0, v157
v_add_f32 v157, 0x3727c5ac, v157
v_mfma_f32_16x16x16_bf16 v[76:79], v[142:143], v[42:43], v[76:79]
v_rsq_f32 v44, v157
s_waitcnt lgkmcnt(4)
v_mfma_f32_16x16x32_bf16 v[80:83], v[120:123], a[0:3], 0
v_mfma_f32_16x16x32_bf16 v[80:83], v[124:127], a[4:7], v[80:83]
s_add_u32 s74, s29, 134217728
v_mfma_f32_16x16x32_bf16 v[88:91], v[120:123], a[8:11], 0
ds_read_b128 v[120:123], v2 offset:22528
v_mul_f32 v48, v18, v48
v_mul_f32 v49, v18, v49
v_mfma_f32_16x16x32_bf16 v[88:91], v[124:127], a[12:15], v[88:91]
ds_read_b128 v[124:127], v2 offset:23552
v_mul_f32 v50, v18, v50
s_waitcnt lgkmcnt(4)
v_mfma_f32_16x16x32_bf16 v[84:87], v[128:131], a[0:3], 0
v_mul_f32 v51, v18, v51
v_mul_f32 v52, v18, v52
v_mul_f32 v53, v18, v53
v_mfma_f32_16x16x32_bf16 v[84:87], v[132:135], a[4:7], v[84:87]
v_mul_f32 v54, v18, v54
v_mul_f32 v55, v18, v55
v_cvt_pk_bf16_f32 v152, v48, v49
v_mfma_f32_16x16x32_bf16 v[92:95], v[128:131], a[8:11], 0
ds_read_b128 v[128:131], v2 offset:24576
v_cvt_pk_bf16_f32 v153, v50, v51
v_cvt_pk_bf16_f32 v154, v52, v53
v_mfma_f32_16x16x32_bf16 v[92:95], v[132:135], a[12:15], v[92:95]
ds_read_b128 v[132:135], v2 offset:25600
v_cvt_pk_bf16_f32 v155, v54, v55
s_waitcnt lgkmcnt(4)
v_mfma_f32_16x16x32_bf16 v[80:83], v[112:115], a[16:19], v[80:83]
buffer_store_dwordx4 v[152:155], v232, s[4:7], s74 offen offset:0 sc1
v_mul_f32 v56, v44, v56
v_mfma_f32_16x16x32_bf16 v[80:83], v[116:119], a[20:23], v[80:83]
v_mul_f32 v57, v44, v57
v_mul_f32 v58, v44, v58
v_mul_f32 v59, v44, v59
v_mfma_f32_16x16x32_bf16 v[88:91], v[112:115], a[24:27], v[88:91]
ds_read_b128 v[112:115], v2 offset:26624
v_mul_f32 v60, v44, v60
v_mul_f32 v61, v44, v61
v_mfma_f32_16x16x32_bf16 v[88:91], v[116:119], a[28:31], v[88:91]
ds_read_b128 v[116:119], v2 offset:27648
v_mul_f32 v62, v44, v62
s_waitcnt lgkmcnt(4)
v_mfma_f32_16x16x32_bf16 v[84:87], v[120:123], a[16:19], v[84:87]
v_mul_f32 v63, v44, v63
v_cvt_pk_bf16_f32 v156, v56, v57
v_cvt_pk_bf16_f32 v157, v58, v59
v_mfma_f32_16x16x32_bf16 v[84:87], v[124:127], a[20:23], v[84:87]
v_cvt_pk_bf16_f32 v158, v60, v61
v_cvt_pk_bf16_f32 v159, v62, v63
v_mul_f32 v64, v18, v64
v_mfma_f32_16x16x32_bf16 v[92:95], v[120:123], a[24:27], v[92:95]
ds_read_b128 v[120:123], v2 offset:28672
v_mul_f32 v65, v18, v65
v_mul_f32 v66, v18, v66
v_mfma_f32_16x16x32_bf16 v[92:95], v[124:127], a[28:31], v[92:95]
ds_read_b128 v[124:127], v2 offset:29696
v_mul_f32 v67, v18, v67
s_waitcnt lgkmcnt(4)
v_mfma_f32_16x16x32_bf16 v[80:83], v[128:131], a[32:35], v[80:83]
buffer_store_dwordx4 v[156:159], v232, s[4:7], s74 offen offset:256 sc1
v_mul_f32 v68, v18, v68
v_mfma_f32_16x16x32_bf16 v[80:83], v[132:135], a[36:39], v[80:83]
v_mul_f32 v69, v18, v69
v_mul_f32 v70, v18, v70
v_mul_f32 v71, v18, v71
v_mfma_f32_16x16x32_bf16 v[88:91], v[128:131], a[40:43], v[88:91]
ds_read_b128 v[128:131], v2 offset:30720
v_cvt_pk_bf16_f32 v160, v64, v65
v_cvt_pk_bf16_f32 v161, v66, v67
v_mfma_f32_16x16x32_bf16 v[88:91], v[132:135], a[44:47], v[88:91]
ds_read_b128 v[132:135], v2 offset:31744
v_cvt_pk_bf16_f32 v162, v68, v69
s_waitcnt lgkmcnt(4)
v_mfma_f32_16x16x32_bf16 v[84:87], v[112:115], a[32:35], v[84:87]
v_cvt_pk_bf16_f32 v163, v70, v71
v_mul_f32 v72, v44, v72
v_mul_f32 v73, v44, v73
v_mfma_f32_16x16x32_bf16 v[84:87], v[116:119], a[36:39], v[84:87]
buffer_store_dwordx4 v[160:163], v233, s[4:7], s74 offen offset:2048 sc1
v_mul_f32 v74, v44, v74
v_mfma_f32_16x16x32_bf16 v[92:95], v[112:115], a[40:43], v[92:95]
ds_read_b128 v[112:115], v2 offset:32768
v_mul_f32 v75, v44, v75
v_mul_f32 v76, v44, v76
v_mfma_f32_16x16x32_bf16 v[92:95], v[116:119], a[44:47], v[92:95]
ds_read_b128 v[116:119], v2 offset:33792
v_mul_f32 v77, v44, v77
s_waitcnt lgkmcnt(4)
v_mfma_f32_16x16x32_bf16 v[80:83], v[120:123], a[48:51], v[80:83]
v_mul_f32 v78, v44, v78
v_mul_f32 v79, v44, v79
v_cvt_pk_bf16_f32 v164, v72, v73
v_mfma_f32_16x16x32_bf16 v[80:83], v[124:127], a[52:55], v[80:83]
v_cvt_pk_bf16_f32 v165, v74, v75
v_cvt_pk_bf16_f32 v166, v76, v77
v_cvt_pk_bf16_f32 v167, v78, v79
v_mfma_f32_16x16x32_bf16 v[88:91], v[120:123], a[56:59], v[88:91]
ds_read_b128 v[120:123], v2 offset:34816
v_mul_f32 v214, 0x3ea52b5c, v18
v_mul_f32 v215, 0x3ea52b5c, v44
v_mfma_f32_16x16x32_bf16 v[88:91], v[124:127], a[60:63], v[88:91]
ds_read_b128 v[124:127], v2 offset:35840
s_waitcnt lgkmcnt(4)
v_mfma_f32_16x16x32_bf16 v[84:87], v[128:131], a[48:51], v[84:87]
buffer_store_dwordx4 v[164:167], v233, s[4:7], s74 offen offset:2304 sc1
v_mfma_f32_16x16x32_bf16 v[84:87], v[132:135], a[52:55], v[84:87]
s_mov_b32 vcc_lo, -1
s_mov_b32 vcc_hi, 0
v_cndmask_b32 v45, v214, v18, vcc
v_cndmask_b32 v46, v215, v44, vcc
v_mfma_f32_16x16x32_bf16 v[92:95], v[128:131], a[56:59], v[92:95]
ds_read_b128 v[128:131], v2 offset:36864
v_mfma_f32_16x16x32_bf16 v[92:95], v[132:135], a[60:63], v[92:95]
ds_read_b128 v[132:135], v2 offset:37888
s_waitcnt lgkmcnt(4)
v_mfma_f32_16x16x32_bf16 v[80:83], v[112:115], a[64:67], v[80:83]
v_mfma_f32_16x16x32_bf16 v[80:83], v[116:119], a[68:71], v[80:83]
v_mfma_f32_16x16x32_bf16 v[88:91], v[112:115], a[72:75], v[88:91]
ds_read_b128 v[112:115], v2 offset:38912
v_mfma_f32_16x16x32_bf16 v[88:91], v[116:119], a[76:79], v[88:91]
ds_read_b128 v[116:119], v2 offset:39936
s_waitcnt lgkmcnt(4)
v_mfma_f32_16x16x32_bf16 v[84:87], v[120:123], a[64:67], v[84:87]
v_mfma_f32_16x16x32_bf16 v[84:87], v[124:127], a[68:71], v[84:87]
v_mfma_f32_16x16x32_bf16 v[92:95], v[120:123], a[72:75], v[92:95]
ds_read_b128 v[120:123], v2 offset:40960
v_mfma_f32_16x16x32_bf16 v[92:95], v[124:127], a[76:79], v[92:95]
ds_read_b128 v[124:127], v2 offset:41984
s_waitcnt lgkmcnt(4)
v_mfma_f32_16x16x32_bf16 v[80:83], v[128:131], a[80:83], v[80:83]
v_mfma_f32_16x16x32_bf16 v[80:83], v[132:135], a[84:87], v[80:83]
v_mfma_f32_16x16x32_bf16 v[88:91], v[128:131], a[88:91], v[88:91]
ds_read_b128 v[128:131], v2 offset:43008
v_mfma_f32_16x16x32_bf16 v[88:91], v[132:135], a[92:95], v[88:91]
ds_read_b128 v[132:135], v2 offset:44032
s_waitcnt lgkmcnt(4)
v_mfma_f32_16x16x32_bf16 v[84:87], v[112:115], a[80:83], v[84:87]
v_mfma_f32_16x16x32_bf16 v[84:87], v[116:119], a[84:87], v[84:87]
v_mfma_f32_16x16x32_bf16 v[92:95], v[112:115], a[88:91], v[92:95]
ds_read_b128 v[112:115], v2 offset:45056
v_mfma_f32_16x16x32_bf16 v[92:95], v[116:119], a[92:95], v[92:95]
ds_read_b128 v[116:119], v2 offset:46080
s_waitcnt lgkmcnt(4)
v_mfma_f32_16x16x32_bf16 v[80:83], v[120:123], a[96:99], v[80:83]
v_mfma_f32_16x16x32_bf16 v[80:83], v[124:127], a[100:103], v[80:83]
v_mfma_f32_16x16x32_bf16 v[88:91], v[120:123], a[104:107], v[88:91]
ds_read_b128 v[120:123], v2 offset:47104
v_mfma_f32_16x16x32_bf16 v[88:91], v[124:127], a[108:111], v[88:91]
ds_read_b128 v[124:127], v2 offset:48128
s_waitcnt vmcnt(4)
s_barrier
s_waitcnt lgkmcnt(4)
v_mfma_f32_16x16x32_bf16 v[84:87], v[128:131], a[96:99], v[84:87]
s_add_u32 s31, s23, 0
v_mfma_f32_16x16x32_bf16 v[84:87], v[132:135], a[100:103], v[84:87]
buffer_load_dwordx4 a[160:163], v1, s[4:7], s31 offen offset:0 sc1
v_mfma_f32_16x16x32_bf16 v[92:95], v[128:131], a[104:107], v[92:95]
ds_read_b128 v[128:131], v2 offset:49152
v_mfma_f32_16x16x32_bf16 v[92:95], v[132:135], a[108:111], v[92:95]
ds_read_b128 v[132:135], v2 offset:50176
s_waitcnt lgkmcnt(4)
v_mfma_f32_16x16x32_bf16 v[80:83], v[112:115], a[112:115], v[80:83]
ds_write_b128 v235, v[152:155] offset:0
v_mfma_f32_16x16x32_bf16 v[80:83], v[116:119], a[116:119], v[80:83]
buffer_load_dwordx4 a[164:167], v1, s[4:7], s31 offen offset:1024 sc1
v_mfma_f32_16x16x32_bf16 v[88:91], v[112:115], a[120:123], v[88:91]
ds_read_b128 v[112:115], v2 offset:51200
v_mfma_f32_16x16x32_bf16 v[88:91], v[116:119], a[124:127], v[88:91]
ds_read_b128 v[116:119], v2 offset:52224
s_waitcnt lgkmcnt(5)
v_mfma_f32_16x16x32_bf16 v[84:87], v[120:123], a[112:115], v[84:87]
ds_write_b128 v235, v[156:159] offset:256
v_mfma_f32_16x16x32_bf16 v[84:87], v[124:127], a[116:119], v[84:87]
buffer_load_dwordx4 a[168:171], v1, s[4:7], s31 offen offset:2048 sc1
v_mfma_f32_16x16x32_bf16 v[92:95], v[120:123], a[120:123], v[92:95]
ds_read_b128 v[120:123], v2 offset:53248
v_mfma_f32_16x16x32_bf16 v[92:95], v[124:127], a[124:127], v[92:95]
ds_read_b128 v[124:127], v2 offset:54272
s_waitcnt lgkmcnt(6)
v_mfma_f32_16x16x32_bf16 v[80:83], v[128:131], a[128:131], v[80:83]
s_waitcnt vmcnt(3)
buffer_atomic_add v9, v8, s[4:7], s91 offen offset:8 sc1
v_mfma_f32_16x16x32_bf16 v[80:83], v[132:135], a[132:135], v[80:83]
ds_write_b128 v236, v[160:163] offset:2048
v_mfma_f32_16x16x32_bf16 v[88:91], v[128:131], a[136:139], v[88:91]
ds_read_b128 v[128:131], v2 offset:55296
v_mfma_f32_16x16x32_bf16 v[88:91], v[132:135], a[140:143], v[88:91]
ds_read_b128 v[132:135], v2 offset:56320
s_waitcnt lgkmcnt(6)
v_mfma_f32_16x16x32_bf16 v[84:87], v[112:115], a[128:131], v[84:87]
buffer_load_dwordx4 a[172:175], v1, s[4:7], s31 offen offset:3072 sc1
v_mfma_f32_16x16x32_bf16 v[84:87], v[116:119], a[132:135], v[84:87]
ds_write_b128 v236, v[164:167] offset:2304
v_mfma_f32_16x16x32_bf16 v[92:95], v[112:115], a[136:139], v[92:95]
ds_read_b128 v[112:115], v2 offset:57344
v_mfma_f32_16x16x32_bf16 v[92:95], v[116:119], a[140:143], v[92:95]
ds_read_b128 v[116:119], v2 offset:58368
s_waitcnt lgkmcnt(6)
v_mfma_f32_16x16x32_bf16 v[80:83], v[120:123], a[144:147], v[80:83]
s_add_u32 s31, s23, 4096
v_mfma_f32_16x16x32_bf16 v[80:83], v[124:127], a[148:151], v[80:83]
buffer_load_dwordx4 a[176:179], v1, s[4:7], s31 offen offset:0 sc1
v_mfma_f32_16x16x32_bf16 v[88:91], v[120:123], a[152:155], v[88:91]
ds_read_b128 v[120:123], v2 offset:59392
v_mfma_f32_16x16x32_bf16 v[88:91], v[124:127], a[156:159], v[88:91]
ds_read_b128 v[124:127], v2 offset:60416
s_waitcnt lgkmcnt(5)
v_mfma_f32_16x16x32_bf16 v[84:87], v[128:131], a[144:147], v[84:87]
ds_write_b128 v1, v[228:231] offset:62976
v_mfma_f32_16x16x32_bf16 v[84:87], v[132:135], a[148:151], v[84:87]
buffer_load_dwordx4 a[180:183], v1, s[4:7], s31 offen offset:1024 sc1
v_mfma_f32_16x16x32_bf16 v[92:95], v[128:131], a[152:155], v[92:95]
ds_read_b128 v[128:131], v2 offset:61440
v_mfma_f32_16x16x32_bf16 v[92:95], v[132:135], a[156:159], v[92:95]
ds_read_b128 v[132:135], v2 offset:62464
v_mfma_f32_16x16x16_bf16 v[80:83], v[144:145], v[40:41], v[80:83]
ds_write_b128 v1, v[228:231] offset:64000
v_mfma_f32_16x16x16_bf16 v[88:91], v[144:145], v[42:43], v[88:91]
buffer_load_dwordx4 a[184:187], v1, s[4:7], s31 offen offset:2048 sc1
v_mfma_f32_16x16x16_bf16 v[84:87], v[146:147], v[40:41], v[84:87]
buffer_load_dwordx4 a[188:191], v1, s[4:7], s31 offen offset:3072 sc1
v_mfma_f32_16x16x16_bf16 v[92:95], v[146:147], v[42:43], v[92:95]
s_add_u32 s31, s23, 8192
s_waitcnt lgkmcnt(6)
v_mfma_f32_16x16x32_bf16 v[96:99], v[112:115], a[0:3], 0
buffer_load_dwordx4 a[192:195], v1, s[4:7], s31 offen offset:0 sc1
v_mfma_f32_16x16x32_bf16 v[96:99], v[116:119], a[4:7], v[96:99]
v_mfma_f32_16x16x32_bf16 v[104:107], v[112:115], a[8:11], 0
ds_read_b128 v[112:115], v2 offset:63488
v_mfma_f32_16x16x32_bf16 v[104:107], v[116:119], a[12:15], v[104:107]
ds_read_b128 v[116:119], v2 offset:64512
s_waitcnt lgkmcnt(6)
v_mfma_f32_16x16x32_bf16 v[100:103], v[120:123], a[0:3], 0
buffer_load_dwordx4 a[196:199], v1, s[4:7], s31 offen offset:1024 sc1
v_mfma_f32_16x16x32_bf16 v[100:103], v[124:127], a[4:7], v[100:103]
s_load_dword s15, s[4:5], s92 offset:8 glc
v_mul_f32 v80, v45, v80
v_mfma_f32_16x16x32_bf16 v[108:111], v[120:123], a[8:11], 0
ds_read_b128 v[120:123], v3 offset:0
v_mul_f32 v81, v45, v81
v_mfma_f32_16x16x32_bf16 v[108:111], v[124:127], a[12:15], v[108:111]
ds_read_b128 v[124:127], v3 offset:1024
s_waitcnt lgkmcnt(5)
v_mfma_f32_16x16x32_bf16 v[96:99], v[128:131], a[16:19], v[96:99]
buffer_load_dwordx4 a[200:203], v1, s[4:7], s31 offen offset:2048 sc1
v_mfma_f32_16x16x32_bf16 v[96:99], v[132:135], a[20:23], v[96:99]
v_mul_f32 v82, v45, v82
v_mul_f32 v83, v45, v83
v_mfma_f32_16x16x32_bf16 v[104:107], v[128:131], a[24:27], v[104:107]
ds_read_b128 v[128:131], v3 offset:2048
v_mul_f32 v84, v45, v84
v_mfma_f32_16x16x32_bf16 v[104:107], v[132:135], a[28:31], v[104:107]
ds_read_b128 v[132:135], v3 offset:3072
s_waitcnt lgkmcnt(4)
v_mfma_f32_16x16x32_bf16 v[100:103], v[112:115], a[16:19], v[100:103]
buffer_load_dwordx4 a[204:207], v1, s[4:7], s31 offen offset:3072 sc1
v_mfma_f32_16x16x32_bf16 v[100:103], v[116:119], a[20:23], v[100:103]
v_mul_f32 v85, v45, v85
v_mul_f32 v86, v45, v86
v_mfma_f32_16x16x32_bf16 v[108:111], v[112:115], a[24:27], v[108:111]
ds_read_b128 v[112:115], v3 offset:4096
v_mul_f32 v87, v45, v87
v_mfma_f32_16x16x32_bf16 v[108:111], v[116:119], a[28:31], v[108:111]
ds_read_b128 v[116:119], v3 offset:5120
s_waitcnt lgkmcnt(4)
v_mfma_f32_16x16x32_bf16 v[96:99], v[120:123], a[32:35], v[96:99]
v_cvt_pk_bf16_f32 v48, v80, v81
v_cvt_pk_bf16_f32 v49, v82, v83
v_mfma_f32_16x16x32_bf16 v[96:99], v[124:127], a[36:39], v[96:99]
v_cvt_pk_bf16_f32 v50, v84, v85
v_cvt_pk_bf16_f32 v51, v86, v87
v_mfma_f32_16x16x32_bf16 v[104:107], v[120:123], a[40:43], v[104:107]
ds_read_b128 v[120:123], v3 offset:6144
v_mul_f32 v88, v46, v88
v_mfma_f32_16x16x32_bf16 v[104:107], v[124:127], a[44:47], v[104:107]
ds_read_b128 v[124:127], v3 offset:7168
s_waitcnt lgkmcnt(4)
v_mfma_f32_16x16x32_bf16 v[100:103], v[128:131], a[32:35], v[100:103]
s_add_u32 s74, s29, 134217728
v_mul_f32 v89, v46, v89
v_mfma_f32_16x16x32_bf16 v[100:103], v[132:135], a[36:39], v[100:103]
buffer_store_dwordx4 v[48:51], v234, s[4:7], s74 offen offset:3072 sc1
v_mfma_f32_16x16x32_bf16 v[108:111], v[128:131], a[40:43], v[108:111]
ds_read_b128 v[128:131], v3 offset:8192
v_mul_f32 v90, v46, v90
v_mfma_f32_16x16x32_bf16 v[108:111], v[132:135], a[44:47], v[108:111]
ds_read_b128 v[132:135], v3 offset:9216
s_waitcnt lgkmcnt(4)
v_mfma_f32_16x16x32_bf16 v[96:99], v[112:115], a[48:51], v[96:99]
ds_write_b128 v237, v[48:51]
v_mfma_f32_16x16x32_bf16 v[96:99], v[116:119], a[52:55], v[96:99]
v_mul_f32 v91, v46, v91
v_mul_f32 v92, v46, v92
v_mfma_f32_16x16x32_bf16 v[104:107], v[112:115], a[56:59], v[104:107]
ds_read_b128 v[112:115], v3 offset:10240
v_mul_f32 v93, v46, v93
v_mfma_f32_16x16x32_bf16 v[104:107], v[116:119], a[60:63], v[104:107]
ds_read_b128 v[116:119], v3 offset:11264
s_waitcnt lgkmcnt(0)
s_cmp_ge_u32 s15, s3
s_cbranch_scc0 SP50
BK51:
v_mfma_f32_16x16x32_bf16 v[100:103], v[120:123], a[48:51], v[100:103]
s_mul_i32 s75, s18, 10496
s_add_u32 m0, s75, 0
s_add_u32 s78, s89, 0
v_mfma_f32_16x16x32_bf16 v[100:103], v[124:127], a[52:55], v[100:103]
buffer_load_dwordx4 v1, s[4:7], s78 offen sc1 lds
v_mfma_f32_16x16x32_bf16 v[108:111], v[120:123], a[56:59], v[108:111]
ds_read_b128 v[120:123], v3 offset:12288
v_mul_f32 v94, v46, v94
v_mfma_f32_16x16x32_bf16 v[108:111], v[124:127], a[60:63], v[108:111]
ds_read_b128 v[124:127], v3 offset:13312
v_mfma_f32_16x16x32_bf16 v[96:99], v[128:131], a[64:67], v[96:99]
buffer_load_dwordx4 v1, s[4:7], s78 offen offset:1024 sc1 lds
v_mfma_f32_16x16x32_bf16 v[96:99], v[132:135], a[68:71], v[96:99]
v_mul_f32 v95, v46, v95
v_cvt_pk_bf16_f32 v52, v88, v89
v_mfma_f32_16x16x32_bf16 v[104:107], v[128:131], a[72:75], v[104:107]
ds_read_b128 v[128:131], v3 offset:14336
v_cvt_pk_bf16_f32 v53, v90, v91
v_mfma_f32_16x16x32_bf16 v[104:107], v[132:135], a[76:79], v[104:107]
ds_read_b128 v[132:135], v3 offset:15360
v_mfma_f32_16x16x32_bf16 v[100:103], v[112:115], a[64:67], v[100:103]
buffer_load_dwordx4 v1, s[4:7], s78 offen offset:2048 sc1 lds
v_mfma_f32_16x16x32_bf16 v[100:103], v[116:119], a[68:71], v[100:103]
v_cvt_pk_bf16_f32 v54, v92, v93
v_cvt_pk_bf16_f32 v55, v94, v95
v_mfma_f32_16x16x32_bf16 v[108:111], v[112:115], a[72:75], v[108:111]
ds_read_b128 v[112:115], v3 offset:16384
buffer_store_dwordx4 v[52:55], v234, s[4:7], s74 offen offset:3328 sc1
v_mfma_f32_16x16x32_bf16 v[108:111], v[116:119], a[76:79], v[108:111]
ds_read_b128 v[116:119], v3 offset:17408
ds_write_b128 v237, v[52:55] offset:256
s_waitcnt lgkmcnt(5)
v_mfma_f32_16x16x32_bf16 v[96:99], v[120:123], a[80:83], v[96:99]
ds_read_b128 v[172:175], v239
ds_read_b128 v[64:67], v47 offset:41984
v_mfma_f32_16x16x32_bf16 v[96:99], v[124:127], a[84:87], v[96:99]
ds_read_b128 v[68:71], v47 offset:43008
v_accvgpr_write_b32 a2, s80
v_mfma_f32_16x16x32_bf16 v[104:107], v[120:123], a[88:91], v[104:107]
ds_read_b128 v[120:123], v3 offset:18432
ds_read_b64 v[72:73], v47 offset:46208
v_mfma_f32_16x16x32_bf16 v[104:107], v[124:127], a[92:95], v[104:107]
ds_read_b128 v[124:127], v3 offset:19456
s_waitcnt lgkmcnt(9)
v_mfma_f32_16x16x32_bf16 v[100:103], v[128:131], a[80:83], v[100:103]
s_add_u32 m0, s75, 4224
s_add_u32 s78, s78, 4096
v_mfma_f32_16x16x32_bf16 v[100:103], v[132:135], a[84:87], v[100:103]
buffer_load_dwordx4 v1, s[4:7], s78 offen sc1 lds
v_mfma_f32_16x16x32_bf16 v[108:111], v[128:131], a[88:91], v[108:111]
ds_read_b128 v[128:131], v3 offset:20480
v_accvgpr_write_b32 a3, 0
v_mfma_f32_16x16x32_bf16 v[108:111], v[132:135], a[92:95], v[108:111]
ds_read_b128 v[132:135], v3 offset:21504
s_waitcnt lgkmcnt(9)
v_mfma_f32_16x16x32_bf16 v[96:99], v[112:115], a[96:99], v[96:99]
s_add_u32 m0, s75, 5248
s_add_u32 s78, s89, s90
v_mfma_f32_16x16x32_bf16 v[96:99], v[116:119], a[100:103], v[96:99]
buffer_load_dwordx4 v1, s[4:7], s78 offen sc1 lds
v_mfma_f32_16x16x32_bf16 v[104:107], v[112:115], a[104:107], v[104:107]
ds_read_b128 v[112:115], v3 offset:22528
v_accvgpr_write_b32 a6, s81
v_mfma_f32_16x16x32_bf16 v[104:107], v[116:119], a[108:111], v[104:107]
ds_read_b128 v[116:119], v3 offset:23552
s_waitcnt lgkmcnt(4)
v_mfma_f32_16x16x32_bf16 v[100:103], v[120:123], a[96:99], v[100:103]
buffer_load_dwordx4 v1, s[4:7], s78 offen offset:1024 sc1 lds
v_mfma_f32_16x16x32_bf16 v[100:103], v[124:127], a[100:103], v[100:103]
buffer_load_dwordx4 v1, s[4:7], s78 offen offset:2048 sc1 lds
v_mfma_f32_16x16x32_bf16 v[108:111], v[120:123], a[104:107], v[108:111]
ds_read_b128 v[120:123], v3 offset:24576
v_accvgpr_write_b32 a7, 0
v_mfma_f32_16x16x32_bf16 v[108:111], v[124:127], a[108:111], v[108:111]
ds_read_b128 v[124:127], v3 offset:25600
s_waitcnt lgkmcnt(4)
v_mfma_f32_16x16x32_bf16 v[96:99], v[128:131], a[112:115], v[96:99]
s_add_u32 m0, s75, 9472
s_add_u32 s78, s78, 4096
buffer_load_dwordx4 v1, s[4:7], s78 offen sc1 lds
v_mfma_f32_16x16x32_bf16 v[96:99], v[132:135], a[116:119], v[96:99]
v_accvgpr_write_b32 a10, s82
v_accvgpr_write_b32 a11, 0
v_mfma_f32_16x16x32_bf16 v[104:107], v[128:131], a[120:123], v[104:107]
ds_read_b128 v[128:131], v3 offset:26624
v_accvgpr_write_b32 a14, s83
v_mfma_f32_16x16x32_bf16 v[104:107], v[132:135], a[124:127], v[104:107]
ds_read_b128 v[132:135], v3 offset:27648
s_waitcnt lgkmcnt(4)
v_mfma_f32_16x16x32_bf16 v[100:103], v[112:115], a[112:115], v[100:103]
v_accvgpr_write_b32 a15, 0
v_accvgpr_write_b32 a18, s84
v_mfma_f32_16x16x32_bf16 v[100:103], v[116:119], a[116:119], v[100:103]
v_accvgpr_write_b32 a19, 0
v_accvgpr_write_b32 a22, s85
v_mfma_f32_16x16x32_bf16 v[108:111], v[112:115], a[120:123], v[108:111]
ds_read_b128 v[112:115], v3 offset:28672
v_accvgpr_write_b32 a23, 0
v_mfma_f32_16x16x32_bf16 v[108:111], v[116:119], a[124:127], v[108:111]
ds_read_b128 v[116:119], v3 offset:29696
s_waitcnt lgkmcnt(4)
v_mfma_f32_16x16x32_bf16 v[96:99], v[120:123], a[128:131], v[96:99]
v_accvgpr_write_b32 a26, s86
v_accvgpr_write_b32 a27, 0
v_mfma_f32_16x16x32_bf16 v[96:99], v[124:127], a[132:135], v[96:99]
v_accvgpr_write_b32 a30, s87
v_accvgpr_write_b32 a31, 0
v_mfma_f32_16x16x32_bf16 v[104:107], v[120:123], a[136:139], v[104:107]
ds_read_b128 v[120:123], v3 offset:30720
v_accvgpr_write_b32 a34, s88
v_mfma_f32_16x16x32_bf16 v[104:107], v[124:127], a[140:143], v[104:107]
ds_read_b128 v[124:127], v3 offset:31744
s_waitcnt lgkmcnt(4)
v_mfma_f32_16x16x32_bf16 v[100:103], v[128:131], a[128:131], v[100:103]
v_accvgpr_write_b32 a35, 0
v_mov_b32 v183, 0
v_mfma_f32_16x16x32_bf16 v[100:103], v[132:135], a[132:135], v[100:103]
v_mov_b32 v187, 0
v_mov_b32 v164, -1
v_mfma_f32_16x16x32_bf16 v[108:111], v[128:131], a[136:139], v[108:111]
v_mov_b32 v165, -1
v_mov_b32 v166, -1
v_mfma_f32_16x16x32_bf16 v[108:111], v[132:135], a[140:143], v[108:111]
v_mov_b32 v167, -1
s_waitcnt lgkmcnt(2)
v_mfma_f32_16x16x32_bf16 v[96:99], v[112:115], a[144:147], v[96:99]
v_mfma_f32_16x16x32_bf16 v[96:99], v[116:119], a[148:151], v[96:99]
v_mfma_f32_16x16x32_bf16 v[104:107], v[112:115], a[152:155], v[104:107]
v_mfma_f32_16x16x32_bf16 v[104:107], v[116:119], a[156:159], v[104:107]
s_waitcnt lgkmcnt(0)
v_mfma_f32_16x16x32_bf16 v[100:103], v[120:123], a[144:147], v[100:103]
v_mfma_f32_16x16x32_bf16 v[100:103], v[124:127], a[148:151], v[100:103]
v_mfma_f32_16x16x32_bf16 v[108:111], v[120:123], a[152:155], v[108:111]
s_waitcnt vmcnt(5)
buffer_atomic_add v9, v8, s[4:7], s91 offen offset:12 sc1
v_mfma_f32_16x16x32_bf16 v[108:111], v[124:127], a[156:159], v[108:111]
v_mfma_f32_16x16x16_bf16 v[96:99], v[148:149], v[40:41], v[96:99]
v_mfma_f32_16x16x16_bf16 v[104:107], v[148:149], v[42:43], v[104:107]
v_mfma_f32_16x16x16_bf16 v[100:103], v[150:151], v[40:41], v[100:103]
v_mfma_f32_16x16x16_bf16 v[108:111], v[150:151], v[42:43], v[108:111]
s_nop 4
v_pk_mul_f32 v[96:97], v[96:97], v[214:215] op_sel:[0,0] op_sel_hi:[1,0]
v_pk_mul_f32 v[98:99], v[98:99], v[214:215] op_sel:[0,0] op_sel_hi:[1,0]
v_pk_mul_f32 v[100:101], v[100:101], v[214:215] op_sel:[0,0] op_sel_hi:[1,0]
v_pk_mul_f32 v[102:103], v[102:103], v[214:215] op_sel:[0,0] op_sel_hi:[1,0]
v_cvt_pk_bf16_f32 v56, v96, v97
v_cvt_pk_bf16_f32 v57, v98, v99
v_cvt_pk_bf16_f32 v58, v100, v101
v_cvt_pk_bf16_f32 v59, v102, v103
ds_write_b128 v238, v[56:59] offset:0
v_pk_mul_f32 v[104:105], v[104:105], v[214:215] op_sel:[0,1] op_sel_hi:[1,1]
v_pk_mul_f32 v[106:107], v[106:107], v[214:215] op_sel:[0,1] op_sel_hi:[1,1]
v_pk_mul_f32 v[108:109], v[108:109], v[214:215] op_sel:[0,1] op_sel_hi:[1,1]
v_pk_mul_f32 v[110:111], v[110:111], v[214:215] op_sel:[0,1] op_sel_hi:[1,1]
v_cvt_pk_bf16_f32 v60, v104, v105
v_cvt_pk_bf16_f32 v61, v106, v107
v_cvt_pk_bf16_f32 v62, v108, v109
v_cvt_pk_bf16_f32 v63, v110, v111
ds_write_b128 v238, v[60:63] offset:256
ds_read_b64 v[180:181], v239 offset:2048
ds_read_b128 v[176:179], v239 offset:1024
s_mov_b32 vcc_lo, -1
s_mov_b32 vcc_hi, 0
s_waitcnt lgkmcnt(1)
v_cndmask_b32 v184, v180, v183, vcc
v_cndmask_b32 v180, 0, v180, vcc
v_cndmask_b32 v185, v181, v183, vcc
v_cndmask_b32 v181, 0, v181, vcc
v_dot2_f32_bf16 v216, v172, v64, 0
s_waitcnt lgkmcnt(0)
v_dot2_f32_bf16 v217, v176, v68, 0
v_dot2_f32_bf16 v216, v173, v65, v216
v_dot2_f32_bf16 v217, v177, v69, v217
v_dot2_f32_bf16 v216, v174, v66, v216
v_dot2_f32_bf16 v217, v178, v70, v217
v_dot2_f32_bf16 v216, v175, v67, v216
v_dot2_f32_bf16 v217, v179, v71, v217
v_dot2_f32_bf16 v216, v180, v72, v216
v_dot2_f32_bf16 v217, v184, v72, v217
v_dot2_f32_bf16 v216, v181, v73, v216
v_dot2_f32_bf16 v217, v185, v73, v217
s_mov_b32 s74, 0xfe967699
s_nop 0
v_cvt_pk_bf16_f32 v182, s74, -v216
PG_s11:
s_cbranch_execz PG_b3
v_cvt_pk_bf16_f32 v186, s74, -v217
s_waitcnt vmcnt(1)
s_barrier
ds_read_b128 a[36:39], v47 offset:36736
ds_read_b64 a[28:29], v47 offset:40960
ds_read_b128 a[40:43], v47 offset:31488
ds_read_b64 a[24:25], v47 offset:35712
ds_read_b128 a[44:47], v47 offset:26240
ds_read_b64 a[20:21], v47 offset:30464
s_waitcnt lgkmcnt(5)
v_mfma_f32_32x32x16_bf16 v[48:63], a[36:39], v[172:175], 0
s_waitcnt lgkmcnt(4)
v_mfma_f32_32x32x16_bf16 v[48:63], a[28:31], v[180:183], v[48:63]
s_waitcnt lgkmcnt(3)
v_mfma_f32_32x32x16_bf16 v[64:79], a[40:43], v[172:175], 0
ds_read_b128 a[36:39], v47 offset:20992
ds_read_b64 a[16:17], v47 offset:25216
ds_read_b64_tr_b16 a[48:49], v203 offset:0
s_add_u32 s31, s23, 12288
buffer_load_dwordx4 a[208:211], v1, s[4:7], s31 offen offset:0 sc1
s_nop 4
v_exp_f32 v48, v48
v_exp_f32 v49, v49
v_exp_f32 v50, v50
v_exp_f32 v51, v51
v_cvt_pk_bf16_f32 v96, v48, v49
v_exp_f32 v52, v52
v_exp_f32 v53, v53
v_cvt_pk_bf16_f32 v97, v50, v51
v_exp_f32 v54, v54
v_exp_f32 v55, v55
v_cvt_pk_bf16_f32 v98, v52, v53
v_exp_f32 v56, v56
s_waitcnt lgkmcnt(5)
v_mfma_f32_32x32x16_bf16 v[64:79], a[24:27], v[180:183], v[64:79]
ds_read_b64_tr_b16 a[50:51], v203 offset:128
ds_read_b64_tr_b16 a[52:53], v203 offset:256
ds_read_b64_tr_b16 a[54:55], v203 offset:384
s_and_b32 s74, s17, 3
s_lshl_b32 s75, s74, 10
s_add_u32 s75, s75, s28
s_add_u32 s75, s75, 67764224
s_add_u32 s76, s75, 4096
buffer_store_dwordx4 v[164:167], v1, s[4:7], s76 offen sc1
v_exp_f32 v57, v57
v_cvt_pk_bf16_f32 v99, v54, v55
v_exp_f32 v58, v58
v_exp_f32 v59, v59
v_cvt_pk_bf16_f32 v100, v56, v57
v_exp_f32 v60, v60
v_exp_f32 v61, v61
v_cvt_pk_bf16_f32 v101, v58, v59
v_exp_f32 v62, v62
v_exp_f32 v63, v63
v_cvt_pk_bf16_f32 v102, v60, v61
v_cvt_pk_bf16_f32 v103, v62, v63
s_waitcnt lgkmcnt(7)
v_mfma_f32_32x32x16_bf16 v[48:63], a[44:47], v[172:175], 0
ds_read_b128 a[40:43], v47 offset:15744
ds_read_b64 a[12:13], v47 offset:19968
buffer_load_dwordx4 a[212:215], v1, s[4:7], s31 offen offset:1024 sc1
v_exp_f32 v64, v64
v_exp_f32 v65, v65
v_exp_f32 v66, v66
v_exp_f32 v67, v67
v_cvt_pk_bf16_f32 v104, v64, v65
v_exp_f32 v68, v68
s_waitcnt lgkmcnt(8)
v_mfma_f32_32x32x16_bf16 v[48:63], a[20:23], v[180:183], v[48:63]
ds_read_b64_tr_b16 a[56:57], v202 offset:0
ds_read_b64_tr_b16 a[58:59], v202 offset:128
s_lshl_b32 s74, s17, 9
s_add_u32 s74, s74, s26
s_add_u32 s74, s74, 67829760
buffer_store_dwordx2 v[164:165], v16, s[4:7], s74 offen sc1
v_exp_f32 v69, v69
v_cvt_pk_bf16_f32 v105, v66, v67
v_exp_f32 v70, v70
v_exp_f32 v71, v71
v_cvt_pk_bf16_f32 v106, v68, v69
v_exp_f32 v72, v72
s_waitcnt lgkmcnt(4)
v_mfma_f32_32x32x16_bf16 v[120:135], a[48:51], v[96:99], 0
ds_read_b64_tr_b16 a[60:61], v202 offset:256
buffer_load_dwordx4 a[216:219], v1, s[4:7], s31 offen offset:2048 sc1
s_load_dword s15, s[4:5], s92 offset:12 glc
v_exp_f32 v73, v73
v_cvt_pk_bf16_f32 v107, v70, v71
v_exp_f32 v74, v74
v_exp_f32 v75, v75
v_cvt_pk_bf16_f32 v108, v72, v73
v_exp_f32 v76, v76
v_mfma_f32_32x32x16_bf16 v[120:135], a[52:55], v[100:103], v[120:135]
ds_read_b64_tr_b16 a[62:63], v202 offset:384
v_exp_f32 v77, v77
v_cvt_pk_bf16_f32 v109, v74, v75
v_exp_f32 v78, v78
v_exp_f32 v79, v79
v_cvt_pk_bf16_f32 v110, v76, v77
v_cvt_pk_bf16_f32 v111, v78, v79
v_mfma_f32_32x32x16_bf16 v[64:79], a[36:39], v[172:175], 0
ds_read_b128 a[44:47], v47 offset:10496
ds_read_b64 a[8:9], v47 offset:14720
buffer_load_dwordx4 a[220:223], v1, s[4:7], s31 offen offset:3072 sc1
v_exp_f32 v48, v48
v_exp_f32 v49, v49
v_exp_f32 v50, v50
v_exp_f32 v51, v51
v_cvt_pk_bf16_f32 v96, v48, v49
v_exp_f32 v52, v52
v_mfma_f32_32x32x16_bf16 v[64:79], a[16:19], v[180:183], v[64:79]
ds_read_b64_tr_b16 a[64:65], v201 offset:0
ds_read_b64_tr_b16 a[66:67], v201 offset:128
v_exp_f32 v53, v53
v_cvt_pk_bf16_f32 v97, v50, v51
v_exp_f32 v54, v54
v_exp_f32 v55, v55
v_cvt_pk_bf16_f32 v98, v52, v53
v_exp_f32 v56, v56
s_waitcnt lgkmcnt(4)
v_mfma_f32_32x32x16_bf16 v[120:135], a[56:59], v[104:107], v[120:135]
ds_read_b64_tr_b16 a[68:69], v201 offset:256
s_add_u32 s31, s23, 16384
buffer_load_dwordx4 a[224:227], v1, s[4:7], s31 offen offset:0 sc1
v_exp_f32 v57, v57
v_cvt_pk_bf16_f32 v99, v54, v55
v_exp_f32 v58, v58
v_exp_f32 v59, v59
v_cvt_pk_bf16_f32 v100, v56, v57
v_exp_f32 v60, v60
v_mfma_f32_32x32x16_bf16 v[120:135], a[60:63], v[108:111], v[120:135]
ds_read_b64_tr_b16 a[70:71], v201 offset:384
v_exp_f32 v61, v61
v_cvt_pk_bf16_f32 v101, v58, v59
v_exp_f32 v62, v62
v_exp_f32 v63, v63
v_cvt_pk_bf16_f32 v102, v60, v61
v_cvt_pk_bf16_f32 v103, v62, v63
v_mfma_f32_32x32x16_bf16 v[48:63], a[40:43], v[172:175], 0
ds_read_b128 a[36:39], v47 offset:5248
ds_read_b64 a[4:5], v47 offset:9472
buffer_load_dwordx4 a[228:231], v1, s[4:7], s31 offen offset:1024 sc1
v_exp_f32 v64, v64
v_exp_f32 v65, v65
v_exp_f32 v66, v66
v_exp_f32 v67, v67
v_cvt_pk_bf16_f32 v104, v64, v65
v_exp_f32 v68, v68
v_mfma_f32_32x32x16_bf16 v[48:63], a[12:15], v[180:183], v[48:63]
ds_read_b64_tr_b16 a[48:49], v200 offset:0
ds_read_b64_tr_b16 a[50:51], v200 offset:128
v_exp_f32 v69, v69
v_cvt_pk_bf16_f32 v105, v66, v67
v_exp_f32 v70, v70
v_exp_f32 v71, v71
v_cvt_pk_bf16_f32 v106, v68, v69
v_exp_f32 v72, v72
s_waitcnt lgkmcnt(4)
v_mfma_f32_32x32x16_bf16 v[120:135], a[64:67], v[96:99], v[120:135]
ds_read_b64_tr_b16 a[52:53], v200 offset:256
v_exp_f32 v73, v73
v_cvt_pk_bf16_f32 v107, v70, v71
v_exp_f32 v74, v74
v_exp_f32 v75, v75
v_cvt_pk_bf16_f32 v108, v72, v73
v_exp_f32 v76, v76
v_mfma_f32_32x32x16_bf16 v[120:135], a[68:71], v[100:103], v[120:135]
ds_read_b64_tr_b16 a[54:55], v200 offset:384
v_exp_f32 v77, v77
v_cvt_pk_bf16_f32 v109, v74, v75
v_exp_f32 v78, v78
v_exp_f32 v79, v79
v_cvt_pk_bf16_f32 v110, v76, v77
v_cvt_pk_bf16_f32 v111, v78, v79
s_waitcnt lgkmcnt(0)
s_cmp_ge_u32 s15, s3
s_cbranch_scc0 SP52
BK53:
v_mfma_f32_32x32x16_bf16 v[64:79], a[44:47], v[172:175], 0
ds_read_b128 a[40:43], v47 offset:41984
ds_read_b64 a[32:33], v47 offset:46208
s_mul_i32 s77, s18, 10496
s_add_u32 m0, s77, 0
s_add_u32 s78, s89, 0
buffer_load_dwordx4 v1, s[4:7], s78 offen offset:3072 sc1 lds
v_exp_f32 v48, v48
v_exp_f32 v49, v49
v_exp_f32 v50, v50
v_exp_f32 v51, v51
v_cvt_pk_bf16_f32 v96, v48, v49
v_exp_f32 v52, v52
v_mfma_f32_32x32x16_bf16 v[64:79], a[8:11], v[180:183], v[64:79]
ds_read_b64_tr_b16 a[56:57], v199 offset:0
ds_read_b64_tr_b16 a[58:59], v199 offset:128
s_mul_i32 s77, s18, 10496
s_add_u32 m0, s77, 5248
s_add_u32 s78, s89, s90
buffer_load_dwordx4 v1, s[4:7], s78 offen offset:3072 sc1 lds
v_exp_f32 v53, v53
v_cvt_pk_bf16_f32 v97, v50, v51
v_exp_f32 v54, v54
v_exp_f32 v55, v55
v_cvt_pk_bf16_f32 v98, v52, v53
v_exp_f32 v56, v56
v_mfma_f32_32x32x16_bf16 v[120:135], a[48:51], v[104:107], v[120:135]
ds_read_b64_tr_b16 a[60:61], v199 offset:256
buffer_load_dwordx4 a[232:235], v1, s[4:7], s31 offen offset:2048 sc1
v_exp_f32 v57, v57
v_cvt_pk_bf16_f32 v99, v54, v55
v_exp_f32 v58, v58
v_exp_f32 v59, v59
v_cvt_pk_bf16_f32 v100, v56, v57
v_exp_f32 v60, v60
v_mfma_f32_32x32x16_bf16 v[120:135], a[52:55], v[108:111], v[120:135]
ds_read_b64_tr_b16 a[62:63], v199 offset:384
buffer_load_dwordx4 a[236:239], v1, s[4:7], s31 offen offset:3072 sc1
v_exp_f32 v61, v61
v_cvt_pk_bf16_f32 v101, v58, v59
v_exp_f32 v62, v62
v_exp_f32 v63, v63
v_cvt_pk_bf16_f32 v102, v60, v61
v_cvt_pk_bf16_f32 v103, v62, v63
v_mfma_f32_32x32x16_bf16 v[48:63], a[36:39], v[172:175], 0
ds_read_b128 a[44:47], v47 offset:0
ds_read_b64 a[0:1], v47 offset:4224
s_add_u32 s31, s23, 20480
buffer_load_dwordx4 a[240:243], v1, s[4:7], s31 offen offset:0 sc1
v_exp_f32 v64, v64
v_exp_f32 v65, v65
v_exp_f32 v66, v66
v_exp_f32 v67, v67
v_cvt_pk_bf16_f32 v104, v64, v65
v_exp_f32 v68, v68
v_mfma_f32_32x32x16_bf16 v[48:63], a[4:7], v[180:183], v[48:63]
ds_read_b64_tr_b16 a[64:65], v198 offset:0
ds_read_b64_tr_b16 a[66:67], v198 offset:128
v_exp_f32 v69, v69
v_cvt_pk_bf16_f32 v105, v66, v67
v_exp_f32 v70, v70
v_exp_f32 v71, v71
v_cvt_pk_bf16_f32 v106, v68, v69
v_exp_f32 v72, v72
s_waitcnt lgkmcnt(4)
v_mfma_f32_32x32x16_bf16 v[120:135], a[56:59], v[96:99], v[120:135]
ds_read_b64_tr_b16 a[68:69], v198 offset:256
buffer_load_dwordx4 a[244:247], v1, s[4:7], s31 offen offset:1024 sc1
v_exp_f32 v73, v73
v_cvt_pk_bf16_f32 v107, v70, v71
v_exp_f32 v74, v74
v_exp_f32 v75, v75
v_cvt_pk_bf16_f32 v108, v72, v73
v_exp_f32 v76, v76
v_mfma_f32_32x32x16_bf16 v[120:135], a[60:63], v[100:103], v[120:135]
ds_read_b64_tr_b16 a[70:71], v198 offset:384
buffer_load_dwordx4 a[248:251], v1, s[4:7], s31 offen offset:2048 sc1
v_exp_f32 v77, v77
v_cvt_pk_bf16_f32 v109, v74, v75
v_exp_f32 v78, v78
v_exp_f32 v79, v79
v_cvt_pk_bf16_f32 v110, v76, v77
v_cvt_pk_bf16_f32 v111, v78, v79
v_mfma_f32_32x32x16_bf16 v[80:95], a[40:43], v[172:175], 0
ds_read_b128 a[36:39], v47 offset:37760
v_exp_f32 v48, v48
v_exp_f32 v49, v49
v_exp_f32 v50, v50
v_exp_f32 v51, v51
v_mfma_f32_32x32x16_bf16 v[80:95], a[32:35], v[180:183], v[80:95]
ds_read_b64_tr_b16 a[48:49], v197 offset:0
buffer_load_dwordx4 a[252:255], v1, s[4:7], s31 offen offset:3072 sc1
v_cvt_pk_bf16_f32 v96, v48, v49
v_exp_f32 v52, v52
v_exp_f32 v53, v53
v_cvt_pk_bf16_f32 v97, v50, v51
s_waitcnt lgkmcnt(6)
v_mfma_f32_32x32x16_bf16 v[64:79], a[44:47], v[172:175], 0
ds_read_b64_tr_b16 a[50:51], v197 offset:128
s_add_u32 s31, s23, 24576
buffer_load_dwordx4 v[244:247], v1, s[4:7], s31 offen offset:0 sc1
v_exp_f32 v54, v54
v_exp_f32 v55, v55
v_cvt_pk_bf16_f32 v98, v52, v53
v_exp_f32 v56, v56
v_mfma_f32_32x32x16_bf16 v[64:79], a[0:3], v[180:183], v[64:79]
ds_read_b64_tr_b16 a[52:53], v197 offset:256
v_exp_f32 v57, v57
v_cvt_pk_bf16_f32 v99, v54, v55
v_exp_f32 v58, v58
v_exp_f32 v59, v59
s_waitcnt lgkmcnt(4)
v_mfma_f32_32x32x16_bf16 v[120:135], a[64:67], v[104:107], v[120:135]
ds_read_b64_tr_b16 a[54:55], v197 offset:384
s_add_u32 m0, s25, 65536
s_add_u32 s30, s22, 0
buffer_load_dwordx4 v1, s[4:7], s30 offen sc1 lds
v_cvt_pk_bf16_f32 v100, v56, v57
v_exp_f32 v60, v60
v_exp_f32 v61, v61
v_cvt_pk_bf16_f32 v101, v58, v59
v_mfma_f32_32x32x16_bf16 v[120:135], a[68:71], v[108:111], v[120:135]
buffer_load_dwordx4 v1, s[4:7], s30 offen offset:1024 sc1 lds
v_exp_f32 v62, v62
v_exp_f32 v63, v63
v_cvt_pk_bf16_f32 v102, v60, v61
v_cvt_pk_bf16_f32 v103, v62, v63
s_waitcnt lgkmcnt(2)
v_mfma_f32_32x32x16_bf16 v[120:135], a[48:51], v[96:99], v[120:135]
ds_read_b128 a[40:43], v47 offset:32512
ds_read_b128 a[44:47], v47 offset:27264
ds_read_b64_tr_b16 a[56:57], v204 offset:0
v_cndmask_b32 v80, v64, v80, s[32:33]
v_cndmask_b32 v81, v65, v81, s[34:35]
v_cndmask_b32 v82, v66, v82, s[36:37]
v_cndmask_b32 v83, v67, v83, s[38:39]
v_cndmask_b32 v84, v68, v84, s[40:41]
v_cndmask_b32 v85, v69, v85, s[42:43]
v_cndmask_b32 v86, v70, v86, s[44:45]
v_cndmask_b32 v87, v71, v87, s[46:47]
v_cndmask_b32 v88, v72, v88, s[48:49]
v_cndmask_b32 v89, v73, v89, s[50:51]
v_cndmask_b32 v90, v74, v90, s[52:53]
v_cndmask_b32 v91, v75, v91, s[54:55]
v_cndmask_b32 v92, v76, v92, s[56:57]
v_cndmask_b32 v93, v77, v93, s[58:59]
s_waitcnt lgkmcnt(3)
v_mfma_f32_32x32x16_bf16 v[120:135], a[52:55], v[100:103], v[120:135]
ds_read_b64_tr_b16 a[58:59], v204 offset:128
ds_read_b64_tr_b16 a[60:61], v204 offset:256
ds_read_b64_tr_b16 a[62:63], v204 offset:384
buffer_load_dwordx4 v1, s[4:7], s30 offen offset:2048 sc1 lds
v_cndmask_b32 v94, v78, v94, s[60:61]
v_cndmask_b32 v95, v79, v95, s[62:63]
v_exp_f32 v80, v80
v_exp_f32 v81, v81
v_exp_f32 v82, v82
v_exp_f32 v83, v83
v_cvt_pk_bf16_f32 v104, v80, v81
v_exp_f32 v84, v84
v_exp_f32 v85, v85
v_cvt_pk_bf16_f32 v105, v82, v83
v_exp_f32 v86, v86
v_exp_f32 v87, v87
v_cvt_pk_bf16_f32 v106, v84, v85
v_exp_f32 v88, v88
v_mfma_f32_32x32x16_bf16 v[48:63], a[36:39], v[176:179], 0
ds_read_b64_tr_b16 a[64:65], v196 offset:0
ds_read_b64_tr_b16 a[66:67], v196 offset:128
buffer_load_dwordx4 v1, s[4:7], s30 offen offset:3072 sc1 lds
v_exp_f32 v89, v89
v_cvt_pk_bf16_f32 v107, v86, v87
v_exp_f32 v90, v90
v_exp_f32 v91, v91
v_cvt_pk_bf16_f32 v108, v88, v89
v_exp_f32 v92, v92
v_exp_f32 v93, v93
v_cvt_pk_bf16_f32 v109, v90, v91
v_exp_f32 v94, v94
v_exp_f32 v95, v95
v_cvt_pk_bf16_f32 v110, v92, v93
v_cvt_pk_bf16_f32 v111, v94, v95
v_bfi_b32 v112, v188, 0, v104
v_bfi_b32 v113, v189, 0, v105
v_mfma_f32_32x32x16_bf16 v[48:63], a[28:31], v[184:187], v[48:63]
ds_read_b64_tr_b16 a[68:69], v196 offset:256
ds_read_b64_tr_b16 a[70:71], v196 offset:384
v_bfi_b32 v114, v190, 0, v106
v_bfi_b32 v115, v191, 0, v107
v_bfi_b32 v116, v192, 0, v108
v_bfi_b32 v117, v193, 0, v109
v_bfi_b32 v118, v194, 0, v110
v_bfi_b32 v119, v195, 0, v111
v_and_b32 v104, v188, v104
v_and_b32 v105, v189, v105
v_and_b32 v106, v190, v106
v_and_b32 v107, v191, v107
v_and_b32 v108, v192, v108
v_and_b32 v109, v193, v109
v_and_b32 v110, v194, v110
v_and_b32 v111, v195, v111
s_waitcnt vmcnt(11)
s_barrier
s_waitcnt lgkmcnt(9)
v_mfma_f32_32x32x16_bf16 v[64:79], a[40:43], v[176:179], 0
ds_read_b128 a[36:39], v47 offset:22016
s_add_u32 m0, s25, 81920
s_add_u32 s30, s22, 16384
buffer_load_dwordx4 v1, s[4:7], s30 offen sc1 lds
v_exp_f32 v48, v48
v_exp_f32 v49, v49
v_exp_f32 v50, v50
v_exp_f32 v51, v51
v_mfma_f32_32x32x16_bf16 v[64:79], a[24:27], v[184:187], v[64:79]
ds_read_b64_tr_b16 a[48:49], v212 offset:0
buffer_load_dwordx4 v1, s[4:7], s30 offen offset:1024 sc1 lds
v_cvt_pk_bf16_f32 v96, v48, v49
v_exp_f32 v52, v52
v_exp_f32 v53, v53
v_cvt_pk_bf16_f32 v97, v50, v51
s_waitcnt lgkmcnt(6)
v_mfma_f32_32x32x16_bf16 v[120:135], a[56:59], v[104:107], v[120:135]
ds_read_b64_tr_b16 a[50:51], v212 offset:128
v_exp_f32 v54, v54
v_exp_f32 v55, v55
v_cvt_pk_bf16_f32 v98, v52, v53
v_exp_f32 v56, v56
v_mfma_f32_32x32x16_bf16 v[120:135], a[60:63], v[108:111], v[120:135]
ds_read_b64_tr_b16 a[52:53], v212 offset:256
buffer_load_dwordx4 v1, s[4:7], s30 offen offset:2048 sc1 lds
v_exp_f32 v57, v57
v_cvt_pk_bf16_f32 v99, v54, v55
v_exp_f32 v58, v58
v_exp_f32 v59, v59
s_waitcnt lgkmcnt(4)
v_mfma_f32_32x32x16_bf16 v[120:135], a[64:67], v[112:115], v[120:135]
ds_read_b64_tr_b16 a[54:55], v212 offset:384
buffer_load_dwordx4 v1, s[4:7], s30 offen offset:3072 sc1 lds
v_cvt_pk_bf16_f32 v100, v56, v57
v_exp_f32 v60, v60
v_exp_f32 v61, v61
v_cvt_pk_bf16_f32 v101, v58, v59
v_mfma_f32_32x32x16_bf16 v[120:135], a[68:71], v[116:119], v[120:135]
v_exp_f32 v62, v62
v_exp_f32 v63, v63
v_cvt_pk_bf16_f32 v102, v60, v61
v_cvt_pk_bf16_f32 v103, v62, v63
v_mfma_f32_32x32x16_bf16 v[48:63], a[44:47], v[176:179], 0
ds_read_b128 a[40:43], v47 offset:16768
ds_read_b64_tr_b16 a[56:57], v211 offset:0
s_add_u32 m0, s25, 98304
s_add_u32 s30, s22, 32768
buffer_load_dwordx4 v1, s[4:7], s30 offen sc1 lds
s_nop 1
v_subrev_u32 v168, 0x1f800000, v132
v_cmp_le_u32 vcc, 0x40000000, v168
s_nop 0
s_cbranch_vccnz FO54
FR55:
v_rcp_f32 v168, v132
s_nop 0
v_mul_f32 v120, v168, v120
v_mul_f32 v121, v168, v121
v_mul_f32 v122, v168, v122
v_mul_f32 v123, v168, v123
v_mul_f32 v124, v168, v124
v_mul_f32 v125, v168, v125
v_mul_f32 v126, v168, v126
v_mul_f32 v127, v168, v127
v_mul_f32 v128, v168, v128
v_mul_f32 v129, v168, v129
v_mfma_f32_32x32x16_bf16 v[48:63], a[20:23], v[184:187], v[48:63]
ds_read_b64_tr_b16 a[58:59], v211 offset:128
buffer_load_dwordx4 v1, s[4:7], s30 offen offset:1024 sc1 lds
v_mul_f32 v130, v168, v130
v_mul_f32 v131, v168, v131
v_cvt_pk_bf16_f32 v152, v120, v121
v_cvt_pk_bf16_f32 v153, v122, v123
v_cvt_pk_bf16_f32 v154, v124, v125
v_cvt_pk_bf16_f32 v155, v126, v127
v_cvt_pk_bf16_f32 v156, v128, v129
v_cvt_pk_bf16_f32 v157, v130, v131
buffer_store_dwordx4 v[152:155], v1, s[4:7], s75 offen sc1
v_exp_f32 v64, v64
v_exp_f32 v65, v65
s_waitcnt lgkmcnt(3)
v_mfma_f32_32x32x16_bf16 v[136:151], a[48:51], v[96:99], 0
ds_read_b64_tr_b16 a[60:61], v211 offset:256
v_exp_f32 v66, v66
v_exp_f32 v67, v67
v_cvt_pk_bf16_f32 v104, v64, v65
v_exp_f32 v68, v68
v_exp_f32 v69, v69
v_cvt_pk_bf16_f32 v105, v66, v67
v_exp_f32 v70, v70
v_exp_f32 v71, v71
v_cvt_pk_bf16_f32 v106, v68, v69
v_exp_f32 v72, v72
v_exp_f32 v73, v73
v_mfma_f32_32x32x16_bf16 v[136:151], a[52:55], v[100:103], v[136:151]
ds_read_b64_tr_b16 a[62:63], v211 offset:384
buffer_load_dwordx4 v1, s[4:7], s30 offen offset:2048 sc1 lds
v_cvt_pk_bf16_f32 v107, v70, v71
v_exp_f32 v74, v74
v_exp_f32 v75, v75
v_cvt_pk_bf16_f32 v108, v72, v73
v_exp_f32 v76, v76
v_exp_f32 v77, v77
v_cvt_pk_bf16_f32 v109, v74, v75
v_exp_f32 v78, v78
v_exp_f32 v79, v79
v_cvt_pk_bf16_f32 v110, v76, v77
v_cvt_pk_bf16_f32 v111, v78, v79
v_mfma_f32_32x32x16_bf16 v[64:79], a[36:39], v[176:179], 0
ds_read_b128 a[44:47], v47 offset:11520
ds_read_b64_tr_b16 a[64:65], v210 offset:0
buffer_load_dwordx4 v1, s[4:7], s30 offen offset:3072 sc1 lds
v_exp_f32 v48, v48
v_exp_f32 v49, v49
v_exp_f32 v50, v50
v_exp_f32 v51, v51
v_cvt_pk_bf16_f32 v96, v48, v49
v_exp_f32 v52, v52
v_mfma_f32_32x32x16_bf16 v[64:79], a[16:19], v[184:187], v[64:79]
ds_read_b64_tr_b16 a[66:67], v210 offset:128
s_add_u32 m0, s25, 114688
s_add_u32 s30, s22, 49152
buffer_load_dwordx4 v1, s[4:7], s30 offen sc1 lds
v_exp_f32 v53, v53
v_cvt_pk_bf16_f32 v97, v50, v51
v_exp_f32 v54, v54
v_exp_f32 v55, v55
v_cvt_pk_bf16_f32 v98, v52, v53
v_exp_f32 v56, v56
s_waitcnt lgkmcnt(3)
v_mfma_f32_32x32x16_bf16 v[136:151], a[56:59], v[104:107], v[136:151]
ds_read_b64_tr_b16 a[68:69], v210 offset:256
v_exp_f32 v57, v57
v_cvt_pk_bf16_f32 v99, v54, v55
v_exp_f32 v58, v58
v_exp_f32 v59, v59
v_cvt_pk_bf16_f32 v100, v56, v57
v_exp_f32 v60, v60
v_mfma_f32_32x32x16_bf16 v[136:151], a[60:63], v[108:111], v[136:151]
ds_read_b64_tr_b16 a[70:71], v210 offset:384
buffer_load_dwordx4 v1, s[4:7], s30 offen offset:1024 sc1 lds
s_lshl_b32 s78, s18, 14
s_add_u32 s78, s78, 67764224
s_add_u32 s12, s78, s66
s_add_u32 s13, s78, s67
s_add_u32 s14, s78, s68
s_add_u32 s77, s78, s69
v_exp_f32 v61, v61
v_cvt_pk_bf16_f32 v101, v58, v59
v_exp_f32 v62, v62
v_exp_f32 v63, v63
v_cvt_pk_bf16_f32 v102, v60, v61
v_cvt_pk_bf16_f32 v103, v62, v63
v_mfma_f32_32x32x16_bf16 v[48:63], a[40:43], v[176:179], 0
ds_read_b128 a[36:39], v47 offset:6272
ds_read_b64_tr_b16 a[48:49], v209 offset:0
buffer_load_dwordx4 v1, s[4:7], s30 offen offset:2048 sc1 lds
v_exp_f32 v64, v64
v_exp_f32 v65, v65
v_exp_f32 v66, v66
v_exp_f32 v67, v67
v_cvt_pk_bf16_f32 v104, v64, v65
v_exp_f32 v68, v68
v_mfma_f32_32x32x16_bf16 v[48:63], a[12:15], v[184:187], v[48:63]
ds_read_b64_tr_b16 a[50:51], v209 offset:128
v_exp_f32 v69, v69
v_cvt_pk_bf16_f32 v105, v66, v67
v_exp_f32 v70, v70
v_exp_f32 v71, v71
v_cvt_pk_bf16_f32 v106, v68, v69
v_exp_f32 v72, v72
s_waitcnt lgkmcnt(3)
v_mfma_f32_32x32x16_bf16 v[136:151], a[64:67], v[96:99], v[136:151]
ds_read_b64_tr_b16 a[52:53], v209 offset:256
buffer_load_dwordx4 v1, s[4:7], s30 offen offset:3072 sc1 lds
v_exp_f32 v73, v73
v_cvt_pk_bf16_f32 v107, v70, v71
v_exp_f32 v74, v74
v_exp_f32 v75, v75
v_cvt_pk_bf16_f32 v108, v72, v73
v_exp_f32 v76, v76
v_mfma_f32_32x32x16_bf16 v[136:151], a[68:71], v[100:103], v[136:151]
ds_read_b64_tr_b16 a[54:55], v209 offset:384
s_add_u32 m0, s25, 131072
s_add_u32 s30, s22, 65536
buffer_load_dwordx4 v1, s[4:7], s30 offen sc1 lds
v_exp_f32 v77, v77
v_cvt_pk_bf16_f32 v109, v74, v75
v_exp_f32 v78, v78
v_exp_f32 v79, v79
v_cvt_pk_bf16_f32 v110, v76, v77
v_cvt_pk_bf16_f32 v111, v78, v79
v_mfma_f32_32x32x16_bf16 v[64:79], a[44:47], v[176:179], 0
ds_read_b128 a[40:43], v47 offset:43008
ds_read_b64_tr_b16 a[56:57], v208 offset:0
v_exp_f32 v48, v48
v_exp_f32 v49, v49
v_exp_f32 v50, v50
v_exp_f32 v51, v51
v_cvt_pk_bf16_f32 v96, v48, v49
v_exp_f32 v52, v52
v_mfma_f32_32x32x16_bf16 v[64:79], a[8:11], v[184:187], v[64:79]
ds_read_b64_tr_b16 a[58:59], v208 offset:128
buffer_load_dwordx4 v1, s[4:7], s30 offen offset:1024 sc1 lds
v_exp_f32 v53, v53
v_cvt_pk_bf16_f32 v97, v50, v51
v_exp_f32 v54, v54
v_exp_f32 v55, v55
v_cvt_pk_bf16_f32 v98, v52, v53
v_exp_f32 v56, v56
s_waitcnt lgkmcnt(3)
v_mfma_f32_32x32x16_bf16 v[136:151], a[48:51], v[104:107], v[136:151]
ds_read_b64_tr_b16 a[60:61], v208 offset:256
buffer_load_dwordx4 v1, s[4:7], s30 offen offset:2048 sc1 lds
v_exp_f32 v57, v57
v_cvt_pk_bf16_f32 v99, v54, v55
v_exp_f32 v58, v58
v_exp_f32 v59, v59
v_cvt_pk_bf16_f32 v100, v56, v57
v_exp_f32 v60, v60
v_mfma_f32_32x32x16_bf16 v[136:151], a[52:55], v[108:111], v[136:151]
ds_read_b64_tr_b16 a[62:63], v208 offset:384
v_exp_f32 v61, v61
v_cvt_pk_bf16_f32 v101, v58, v59
v_exp_f32 v62, v62
v_exp_f32 v63, v63
v_cvt_pk_bf16_f32 v102, v60, v61
v_cvt_pk_bf16_f32 v103, v62, v63
v_mfma_f32_32x32x16_bf16 v[48:63], a[36:39], v[176:179], 0
ds_read_b128 a[44:47], v47 offset:1024
ds_read_b64_tr_b16 a[64:65], v207 offset:0
buffer_load_dwordx4 v1, s[4:7], s30 offen offset:3072 sc1 lds
v_exp_f32 v64, v64
v_exp_f32 v65, v65
v_exp_f32 v66, v66
v_exp_f32 v67, v67
v_cvt_pk_bf16_f32 v104, v64, v65
v_exp_f32 v68, v68
v_mfma_f32_32x32x16_bf16 v[48:63], a[4:7], v[184:187], v[48:63]
ds_read_b64_tr_b16 a[66:67], v207 offset:128
s_add_u32 m0, s25, 147456
s_add_u32 s30, s22, 81920
buffer_load_dwordx4 v1, s[4:7], s30 offen sc1 lds
v_exp_f32 v69, v69
v_cvt_pk_bf16_f32 v105, v66, v67
v_exp_f32 v70, v70
v_exp_f32 v71, v71
v_cvt_pk_bf16_f32 v106, v68, v69
v_exp_f32 v72, v72
s_waitcnt lgkmcnt(3)
v_mfma_f32_32x32x16_bf16 v[136:151], a[56:59], v[96:99], v[136:151]
ds_read_b64_tr_b16 a[68:69], v207 offset:256
s_waitcnt vmcnt(11)
buffer_atomic_add v9, v8, s[4:7], s98 offen offset:4 sc1
v_exp_f32 v73, v73
v_cvt_pk_bf16_f32 v107, v70, v71
v_exp_f32 v74, v74
v_exp_f32 v75, v75
v_cvt_pk_bf16_f32 v108, v72, v73
v_exp_f32 v76, v76
v_mfma_f32_32x32x16_bf16 v[136:151], a[60:63], v[100:103], v[136:151]
ds_read_b64_tr_b16 a[70:71], v207 offset:384
buffer_load_dwordx4 v1, s[4:7], s30 offen offset:1024 sc1 lds
v_exp_f32 v77, v77
v_cvt_pk_bf16_f32 v109, v74, v75
v_exp_f32 v78, v78
v_exp_f32 v79, v79
v_cvt_pk_bf16_f32 v110, v76, v77
v_cvt_pk_bf16_f32 v111, v78, v79
v_mfma_f32_32x32x16_bf16 v[80:95], a[40:43], v[176:179], 0
ds_read_b64_tr_b16 a[48:49], v206 offset:0
buffer_load_dwordx4 v1, s[4:7], s30 offen offset:2048 sc1 lds
v_exp_f32 v48, v48
v_exp_f32 v49, v49
v_exp_f32 v50, v50
v_exp_f32 v51, v51
v_mfma_f32_32x32x16_bf16 v[80:95], a[32:35], v[184:187], v[80:95]
ds_read_b64_tr_b16 a[50:51], v206 offset:128
PG_s12:
s_cbranch_execz PG_b3
v_cvt_pk_bf16_f32 v96, v48, v49
v_exp_f32 v52, v52
v_exp_f32 v53, v53
v_cvt_pk_bf16_f32 v97, v50, v51
s_waitcnt lgkmcnt(6)
v_mfma_f32_32x32x16_bf16 v[64:79], a[44:47], v[176:179], 0
ds_read_b64_tr_b16 a[52:53], v206 offset:256
buffer_load_dwordx4 v1, s[4:7], s30 offen offset:3072 sc1 lds
v_exp_f32 v54, v54
v_exp_f32 v55, v55
v_cvt_pk_bf16_f32 v98, v52, v53
v_exp_f32 v56, v56
v_mfma_f32_32x32x16_bf16 v[64:79], a[0:3], v[184:187], v[64:79]
ds_read_b64_tr_b16 a[54:55], v206 offset:384
s_add_u32 s31, s24, 0
buffer_load_dwordx4 v[216:219], v1, s[4:7], s31 offen offset:0 sc1
v_exp_f32 v57, v57
v_cvt_pk_bf16_f32 v99, v54, v55
v_exp_f32 v58, v58
v_exp_f32 v59, v59
s_waitcnt lgkmcnt(4)
v_mfma_f32_32x32x16_bf16 v[136:151], a[64:67], v[104:107], v[136:151]
v_cvt_pk_bf16_f32 v100, v56, v57
v_exp_f32 v60, v60
v_exp_f32 v61, v61
v_cvt_pk_bf16_f32 v101, v58, v59
v_mfma_f32_32x32x16_bf16 v[136:151], a[68:71], v[108:111], v[136:151]
buffer_load_dwordx4 v[220:223], v1, s[4:7], s31 offen offset:1024 sc1
v_exp_f32 v62, v62
v_exp_f32 v63, v63
v_cvt_pk_bf16_f32 v102, v60, v61
v_cvt_pk_bf16_f32 v103, v62, v63
s_waitcnt lgkmcnt(2)
v_mfma_f32_32x32x16_bf16 v[136:151], a[48:51], v[96:99], v[136:151]
ds_read_b64_tr_b16 a[56:57], v213 offset:0
ds_read_b64_tr_b16 a[58:59], v213 offset:128
ds_read_b64_tr_b16 a[60:61], v213 offset:256
ds_read_b64_tr_b16 a[62:63], v213 offset:384
buffer_load_dwordx4 v[224:227], v1, s[4:7], s31 offen offset:2048 sc1
v_cndmask_b32 v80, v64, v80, s[32:33]
v_cndmask_b32 v81, v65, v81, s[34:35]
v_cndmask_b32 v82, v66, v82, s[36:37]
v_cndmask_b32 v83, v67, v83, s[38:39]
v_cndmask_b32 v84, v68, v84, s[40:41]
v_cndmask_b32 v85, v69, v85, s[42:43]
v_cndmask_b32 v86, v70, v86, s[44:45]
v_cndmask_b32 v87, v71, v87, s[46:47]
v_cndmask_b32 v88, v72, v88, s[48:49]
v_cndmask_b32 v89, v73, v89, s[50:51]
v_cndmask_b32 v90, v74, v90, s[52:53]
v_cndmask_b32 v91, v75, v91, s[54:55]
v_cndmask_b32 v92, v76, v92, s[56:57]
v_cndmask_b32 v93, v77, v93, s[58:59]
v_cndmask_b32 v94, v78, v94, s[60:61]
v_cndmask_b32 v95, v79, v95, s[62:63]
v_exp_f32 v80, v80
v_exp_f32 v81, v81
v_exp_f32 v82, v82
v_exp_f32 v83, v83
v_cvt_pk_bf16_f32 v104, v80, v81
v_exp_f32 v84, v84
v_exp_f32 v85, v85
v_cvt_pk_bf16_f32 v105, v82, v83
v_exp_f32 v86, v86
v_exp_f32 v87, v87
v_cvt_pk_bf16_f32 v106, v84, v85
v_exp_f32 v88, v88
s_waitcnt lgkmcnt(4)
v_mfma_f32_32x32x16_bf16 v[136:151], a[52:55], v[100:103], v[136:151]
ds_read_b64_tr_b16 a[64:65], v205 offset:0
ds_read_b64_tr_b16 a[66:67], v205 offset:128
ds_read_b64_tr_b16 a[68:69], v205 offset:256
ds_read_b64_tr_b16 a[70:71], v205 offset:384
v_exp_f32 v89, v89
v_cvt_pk_bf16_f32 v107, v86, v87
v_exp_f32 v90, v90
v_exp_f32 v91, v91
v_cvt_pk_bf16_f32 v108, v88, v89
v_exp_f32 v92, v92
v_exp_f32 v93, v93
v_cvt_pk_bf16_f32 v109, v90, v91
v_exp_f32 v94, v94
v_exp_f32 v95, v95
v_cvt_pk_bf16_f32 v110, v92, v93
v_cvt_pk_bf16_f32 v111, v94, v95
v_bfi_b32 v112, v188, 0, v104
v_bfi_b32 v113, v189, 0, v105
v_bfi_b32 v114, v190, 0, v106
v_bfi_b32 v115, v191, 0, v107
v_bfi_b32 v116, v192, 0, v108
v_bfi_b32 v117, v193, 0, v109
v_bfi_b32 v118, v194, 0, v110
v_bfi_b32 v119, v195, 0, v111
v_and_b32 v104, v188, v104
v_and_b32 v105, v189, v105
v_and_b32 v106, v190, v106
v_and_b32 v107, v191, v107
v_and_b32 v108, v192, v108
v_and_b32 v109, v193, v109
v_and_b32 v110, v194, v110
v_and_b32 v111, v195, v111
s_waitcnt lgkmcnt(6)
v_mfma_f32_32x32x16_bf16 v[136:151], a[56:59], v[104:107], v[136:151]
buffer_load_dwordx4 v[228:231], v1, s[4:7], s31 offen offset:3072 sc1
s_waitcnt lgkmcnt(4)
v_mfma_f32_32x32x16_bf16 v[136:151], a[60:63], v[108:111], v[136:151]
s_add_u32 s31, s24, 4096
buffer_load_dwordx4 v[232:235], v1, s[4:7], s31 offen offset:0 sc1
s_waitcnt lgkmcnt(0)
v_mfma_f32_32x32x16_bf16 v[136:151], a[64:67], v[112:115], v[136:151]
v_mfma_f32_32x32x16_bf16 v[136:151], a[68:71], v[116:119], v[136:151]
s_load_dword s15, s[4:5], s99 offset:4 glc
s_nop 10
v_subrev_u32 v168, 0x1f800000, v148
v_cmp_le_u32 vcc, 0x40000000, v168
s_nop 0
s_cbranch_vccnz FO56
FR57:
v_rcp_f32 v168, v148
s_nop 0
v_pk_mul_f32 v[136:137], v[136:137], v[168:169] op_sel_hi:[1,0]
v_pk_mul_f32 v[138:139], v[138:139], v[168:169] op_sel_hi:[1,0]
v_pk_mul_f32 v[140:141], v[140:141], v[168:169] op_sel_hi:[1,0]
v_pk_mul_f32 v[142:143], v[142:143], v[168:169] op_sel_hi:[1,0]
v_pk_mul_f32 v[144:145], v[144:145], v[168:169] op_sel_hi:[1,0]
v_pk_mul_f32 v[146:147], v[146:147], v[168:169] op_sel_hi:[1,0]
v_cvt_pk_bf16_f32 v160, v136, v137
v_cvt_pk_bf16_f32 v161, v138, v139
v_cvt_pk_bf16_f32 v162, v140, v141
v_cvt_pk_bf16_f32 v163, v142, v143
v_cvt_pk_bf16_f32 v164, v144, v145
v_cvt_pk_bf16_f32 v165, v146, v147
s_mov_b32 vcc_lo, -1
s_mov_b32 vcc_hi, 0
v_cndmask_b32 v156, v164, v156, vcc
v_cndmask_b32 v157, v165, v157, vcc
buffer_store_dwordx4 v[160:163], v1, s[4:7], s76 offen sc1
buffer_store_dwordx2 v[156:157], v16, s[4:7], s74 offen sc1
s_waitcnt lgkmcnt(0)
s_cmp_ge_u32 s15, 8
s_cbranch_scc0 SP58
BK59:
buffer_load_dwordx4 a[72:75], v4, s[4:7], s12 offen offset:0 sc1
buffer_load_dwordx4 a[88:91], v4, s[4:7], s12 offen offset:2048 sc1
buffer_load_dwordx4 a[76:79], v4, s[4:7], s13 offen offset:0 sc1
buffer_load_dwordx4 a[92:95], v4, s[4:7], s13 offen offset:2048 sc1
buffer_load_dwordx4 a[80:83], v4, s[4:7], s14 offen offset:0 sc1
buffer_load_dwordx4 a[96:99], v4, s[4:7], s14 offen offset:2048 sc1
buffer_load_dwordx4 a[84:87], v4, s[4:7], s77 offen offset:0 sc1
buffer_load_dwordx4 a[100:103], v4, s[4:7], s77 offen offset:2048 sc1
s_mul_i32 s78, s18, 14336
s_sub_u32 s78, 61440, s78
v_add_u32 v172, s78, v4
s_add_u32 s12, s12, 4096
s_add_u32 s13, s13, 4096
s_add_u32 s14, s14, 4096
s_add_u32 s77, s77, 4096
s_barrier
s_mov_b64 exec, 0
s_cmp_eq_u32 s18, 0
s_cbranch_scc1 PG_s13
s_cmp_eq_u32 s18, 1
s_cbranch_scc1 PG_s14
s_cmp_eq_u32 s18, 2
s_cbranch_scc1 PG_s15
s_cmp_eq_u32 s18, 3
s_cbranch_scc1 PG_s16
PG_b4:
s_mov_b64 exec, -1
s_waitcnt vmcnt(8)
s_waitcnt vmcnt(7)
v_mfma_f32_16x16x32_bf16 v[48:51], a[160:163], a[72:75], 0
buffer_load_dwordx4 v[108:111], v4, s[4:7], s12 offen offset:0 sc1
s_waitcnt vmcnt(7)
v_mfma_f32_16x16x32_bf16 v[48:51], a[180:183], a[88:91], v[48:51]
v_mfma_f32_16x16x32_bf16 v[52:55], a[164:167], a[72:75], 0
v_mfma_f32_16x16x32_bf16 v[52:55], a[184:187], a[88:91], v[52:55]
buffer_load_dwordx4 v[112:115], v4, s[4:7], s12 offen offset:2048 sc1
v_mfma_f32_16x16x32_bf16 v[56:59], a[168:171], a[72:75], 0
v_mfma_f32_16x16x32_bf16 v[56:59], a[188:191], a[88:91], v[56:59]
v_mfma_f32_16x16x32_bf16 v[60:63], a[172:175], a[72:75], 0
buffer_load_dwordx4 v[116:119], v172, s[4:7], s12 offen offset:0 sc1
v_mfma_f32_16x16x32_bf16 v[60:63], a[192:195], a[88:91], v[60:63]
v_mfma_f32_16x16x32_bf16 v[64:67], a[176:179], a[72:75], 0
v_mfma_f32_16x16x32_bf16 v[64:67], a[196:199], a[88:91], v[64:67]
buffer_load_dwordx4 v[120:123], v4, s[4:7], s13 offen offset:0 sc1
s_waitcnt vmcnt(9)
v_mfma_f32_16x16x32_bf16 v[68:71], a[160:163], a[76:79], 0
s_waitcnt vmcnt(8)
v_mfma_f32_16x16x32_bf16 v[68:71], a[180:183], a[92:95], v[68:71]
v_mfma_f32_16x16x32_bf16 v[72:75], a[164:167], a[76:79], 0
buffer_load_dwordx4 v[124:127], v4, s[4:7], s13 offen offset:2048 sc1
v_mfma_f32_16x16x32_bf16 v[72:75], a[184:187], a[92:95], v[72:75]
v_mfma_f32_16x16x32_bf16 v[76:79], a[168:171], a[76:79], 0
v_mfma_f32_16x16x32_bf16 v[76:79], a[188:191], a[92:95], v[76:79]
buffer_load_dwordx4 v[128:131], v172, s[4:7], s13 offen offset:0 sc1
v_mfma_f32_16x16x32_bf16 v[80:83], a[172:175], a[76:79], 0
v_mfma_f32_16x16x32_bf16 v[80:83], a[192:195], a[92:95], v[80:83]
v_mfma_f32_16x16x32_bf16 v[84:87], a[176:179], a[76:79], 0
buffer_load_dwordx4 v[132:135], v4, s[4:7], s14 offen offset:0 sc1
v_mfma_f32_16x16x32_bf16 v[84:87], a[196:199], a[92:95], v[84:87]
s_waitcnt vmcnt(10)
v_mfma_f32_16x16x32_bf16 v[88:91], a[160:163], a[80:83], 0
s_waitcnt vmcnt(9)
v_mfma_f32_16x16x32_bf16 v[88:91], a[180:183], a[96:99], v[88:91]
buffer_load_dwordx4 v[136:139], v4, s[4:7], s14 offen offset:2048 sc1
v_mfma_f32_16x16x32_bf16 v[92:95], a[164:167], a[80:83], 0
v_mfma_f32_16x16x32_bf16 v[92:95], a[184:187], a[96:99], v[92:95]
v_mfma_f32_16x16x32_bf16 v[96:99], a[168:171], a[80:83], 0
buffer_load_dwordx4 v[140:143], v172, s[4:7], s14 offen offset:0 sc1
v_mfma_f32_16x16x32_bf16 v[96:99], a[188:191], a[96:99], v[96:99]
v_mfma_f32_16x16x32_bf16 v[100:103], a[172:175], a[80:83], 0
v_mfma_f32_16x16x32_bf16 v[100:103], a[192:195], a[96:99], v[100:103]
buffer_load_dwordx4 v[176:179], v4, s[4:7], s77 offen offset:0 sc1
v_mfma_f32_16x16x32_bf16 v[104:107], a[176:179], a[80:83], 0
v_mfma_f32_16x16x32_bf16 v[104:107], a[196:199], a[96:99], v[104:107]
s_waitcnt vmcnt(11)
v_mfma_f32_16x16x32_bf16 v[20:23], a[160:163], a[84:87], v[20:23]
buffer_load_dwordx4 v[180:183], v4, s[4:7], s77 offen offset:2048 sc1
s_waitcnt vmcnt(11)
v_mfma_f32_16x16x32_bf16 v[20:23], a[180:183], a[100:103], v[20:23]
v_mfma_f32_16x16x32_bf16 v[24:27], a[164:167], a[84:87], v[24:27]
v_mfma_f32_16x16x32_bf16 v[24:27], a[184:187], a[100:103], v[24:27]
buffer_load_dwordx4 v[184:187], v172, s[4:7], s77 offen offset:0 sc1
v_mfma_f32_16x16x32_bf16 v[28:31], a[168:171], a[84:87], v[28:31]
v_mfma_f32_16x16x32_bf16 v[28:31], a[188:191], a[100:103], v[28:31]
s_waitcnt vmcnt(11)
v_max3_u32 v168, v108, v109, v110
s_waitcnt vmcnt(10)
v_max3_u32 v168, v111, v112, v168
v_mfma_f32_16x16x32_bf16 v[32:35], a[172:175], a[84:87], v[32:35]
v_max3_u32 v168, v113, v114, v168
s_waitcnt vmcnt(9)
v_max3_u32 v168, v115, v116, v168
v_mfma_f32_16x16x32_bf16 v[32:35], a[192:195], a[100:103], v[32:35]
v_max3_u32 v168, v117, v118, v168
v_max_u32 v168, v119, v168
v_mfma_f32_16x16x32_bf16 v[36:39], a[176:179], a[84:87], v[36:39]
v_cmp_eq_u32 vcc, -1, v168
v_mfma_f32_16x16x32_bf16 v[36:39], a[196:199], a[100:103], v[36:39]
s_cbranch_vccnz RT60
RB61:
v_add_u32 v164, 0, v10
v_add_u32 v165, 0, v11
v_add_u32 v166, 0, v12
v_add_u32 v19, 0, v13
v_mfma_f32_16x16x32_bf16 v[48:51], a[200:203], v[108:111], v[48:51]
s_add_u32 s74, s69, 67108864
v_mfma_f32_16x16x32_bf16 v[48:51], a[220:223], v[112:115], v[48:51]
s_lshl_b32 s76, s17, 2
s_add_u32 s76, s76, s18
v_mfma_f32_16x16x32_bf16 v[48:51], a[240:243], v[116:119], v[48:51]
s_lshl_b32 s76, s76, 7
s_and_b32 s2, s99, 0xffffe000
v_mfma_f32_16x16x32_bf16 v[52:55], a[204:207], v[108:111], v[52:55]
s_add_u32 s76, s76, s2
s_add_u32 s76, s76, 4294950912
v_mfma_f32_16x16x32_bf16 v[52:55], a[224:227], v[112:115], v[52:55]
v_mfma_f32_16x16x32_bf16 v[52:55], a[244:247], v[116:119], v[52:55]
v_mfma_f32_16x16x32_bf16 v[56:59], a[208:211], v[108:111], v[56:59]
v_mfma_f32_16x16x32_bf16 v[56:59], a[228:231], v[112:115], v[56:59]
ds_write_b128 v164, v[48:51] offset:0
v_mfma_f32_16x16x32_bf16 v[56:59], a[248:251], v[116:119], v[56:59]
s_waitcnt vmcnt(8)
v_max3_u32 v168, v120, v121, v122
s_waitcnt vmcnt(7)
v_max3_u32 v168, v123, v124, v168
v_mfma_f32_16x16x32_bf16 v[60:63], a[212:215], v[108:111], v[60:63]
v_max3_u32 v168, v125, v126, v168
s_waitcnt vmcnt(6)
v_max3_u32 v168, v127, v128, v168
v_mfma_f32_16x16x32_bf16 v[60:63], a[232:235], v[112:115], v[60:63]
ds_write_b128 v164, v[52:55] offset:1024
v_mfma_f32_16x16x32_bf16 v[60:63], a[252:255], v[116:119], v[60:63]
v_max3_u32 v168, v129, v130, v168
v_max_u32 v168, v131, v168
v_mfma_f32_16x16x32_bf16 v[64:67], a[216:219], v[108:111], v[64:67]
v_cmp_eq_u32 vcc, -1, v168
v_mfma_f32_16x16x32_bf16 v[64:67], a[236:239], v[112:115], v[64:67]
ds_write_b128 v164, v[56:59] offset:2048
v_mfma_f32_16x16x32_bf16 v[64:67], v[244:247], v[116:119], v[64:67]
s_cbranch_vccnz RT62
RB63:
v_mfma_f32_16x16x32_bf16 v[68:71], a[200:203], v[120:123], v[68:71]
buffer_load_dwordx4 v[236:239], v1, s[4:7], s31 offen offset:1024 sc1
v_mfma_f32_16x16x32_bf16 v[68:71], a[220:223], v[124:127], v[68:71]
ds_write_b128 v164, v[60:63] offset:3072
v_mfma_f32_16x16x32_bf16 v[68:71], a[240:243], v[128:131], v[68:71]
v_mfma_f32_16x16x32_bf16 v[72:75], a[204:207], v[120:123], v[72:75]
v_mfma_f32_16x16x32_bf16 v[72:75], a[224:227], v[124:127], v[72:75]
ds_write_b128 v164, v[64:67] offset:4096
v_mfma_f32_16x16x32_bf16 v[72:75], a[244:247], v[128:131], v[72:75]
buffer_load_dwordx4 v[240:243], v1, s[4:7], s31 offen offset:2048 sc1
v_mfma_f32_16x16x32_bf16 v[76:79], a[208:211], v[120:123], v[76:79]
v_mfma_f32_16x16x32_bf16 v[76:79], a[228:231], v[124:127], v[76:79]
s_nop 0
ds_write_b128 v165, v[68:71] offset:0
v_mfma_f32_16x16x32_bf16 v[76:79], a[248:251], v[128:131], v[76:79]
s_waitcnt vmcnt(7)
v_max3_u32 v168, v132, v133, v134
s_waitcnt vmcnt(6)
v_max3_u32 v168, v135, v136, v168
v_mfma_f32_16x16x32_bf16 v[80:83], a[212:215], v[120:123], v[80:83]
v_max3_u32 v168, v137, v138, v168
s_waitcnt vmcnt(5)
v_max3_u32 v168, v139, v140, v168
v_mfma_f32_16x16x32_bf16 v[80:83], a[232:235], v[124:127], v[80:83]
ds_write_b128 v165, v[72:75] offset:1024
v_mfma_f32_16x16x32_bf16 v[80:83], a[252:255], v[128:131], v[80:83]
v_max3_u32 v168, v141, v142, v168
v_max_u32 v168, v143, v168
v_mfma_f32_16x16x32_bf16 v[84:87], a[216:219], v[120:123], v[84:87]
v_cmp_eq_u32 vcc, -1, v168
v_mfma_f32_16x16x32_bf16 v[84:87], a[236:239], v[124:127], v[84:87]
ds_write_b128 v165, v[76:79] offset:2048
v_mfma_f32_16x16x32_bf16 v[84:87], v[244:247], v[128:131], v[84:87]
s_cbranch_vccnz RT64
RB65:
v_mfma_f32_16x16x32_bf16 v[88:91], a[200:203], v[132:135], v[88:91]
buffer_load_dwordx4 v[188:191], v1, s[4:7], s31 offen offset:3072 sc1
v_mfma_f32_16x16x32_bf16 v[88:91], a[220:223], v[136:139], v[88:91]
ds_write_b128 v165, v[80:83] offset:3072
v_mfma_f32_16x16x32_bf16 v[88:91], a[240:243], v[140:143], v[88:91]
v_mfma_f32_16x16x32_bf16 v[92:95], a[204:207], v[132:135], v[92:95]
v_mfma_f32_16x16x32_bf16 v[92:95], a[224:227], v[136:139], v[92:95]
ds_write_b128 v165, v[84:87] offset:4096
v_mfma_f32_16x16x32_bf16 v[92:95], a[244:247], v[140:143], v[92:95]
s_add_u32 s31, s24, 8192
buffer_load_dwordx4 v[192:195], v1, s[4:7], s31 offen offset:0 sc1
v_mfma_f32_16x16x32_bf16 v[96:99], a[208:211], v[132:135], v[96:99]
v_mfma_f32_16x16x32_bf16 v[96:99], a[228:231], v[136:139], v[96:99]
ds_write_b128 v166, v[88:91] offset:0
v_mfma_f32_16x16x32_bf16 v[96:99], a[248:251], v[140:143], v[96:99]
s_waitcnt vmcnt(6)
v_max3_u32 v168, v176, v177, v178
s_waitcnt vmcnt(5)
v_max3_u32 v168, v179, v180, v168
v_mfma_f32_16x16x32_bf16 v[100:103], a[212:215], v[132:135], v[100:103]
v_max3_u32 v168, v181, v182, v168
s_waitcnt vmcnt(4)
v_max3_u32 v168, v183, v184, v168
v_mfma_f32_16x16x32_bf16 v[100:103], a[232:235], v[136:139], v[100:103]
ds_write_b128 v166, v[92:95] offset:1024
v_mfma_f32_16x16x32_bf16 v[100:103], a[252:255], v[140:143], v[100:103]
v_max3_u32 v168, v185, v186, v168
v_max_u32 v168, v187, v168
v_mfma_f32_16x16x32_bf16 v[104:107], a[216:219], v[132:135], v[104:107]
v_cmp_eq_u32 vcc, -1, v168
v_mfma_f32_16x16x32_bf16 v[104:107], a[236:239], v[136:139], v[104:107]
ds_write_b128 v166, v[96:99] offset:2048
v_mfma_f32_16x16x32_bf16 v[104:107], v[244:247], v[140:143], v[104:107]
s_cbranch_vccnz RT66
RB67:
v_mfma_f32_16x16x32_bf16 v[20:23], a[200:203], v[176:179], v[20:23]
buffer_load_dwordx4 v[196:199], v1, s[4:7], s31 offen offset:1024 sc1
v_mfma_f32_16x16x32_bf16 v[20:23], a[220:223], v[180:183], v[20:23]
ds_write_b128 v166, v[100:103] offset:3072
v_mfma_f32_16x16x32_bf16 v[20:23], a[240:243], v[184:187], v[20:23]
v_mfma_f32_16x16x32_bf16 v[24:27], a[204:207], v[176:179], v[24:27]
v_mfma_f32_16x16x32_bf16 v[24:27], a[224:227], v[180:183], v[24:27]
ds_write_b128 v166, v[104:107] offset:4096
v_mfma_f32_16x16x32_bf16 v[24:27], a[244:247], v[184:187], v[24:27]
buffer_load_dwordx4 v[200:203], v1, s[4:7], s31 offen offset:2048 sc1
v_mfma_f32_16x16x32_bf16 v[28:31], a[208:211], v[176:179], v[28:31]
s_waitcnt lgkmcnt(0)
s_barrier
v_mfma_f32_16x16x32_bf16 v[28:31], a[228:231], v[180:183], v[28:31]
ds_read_b128 v[108:111], v19 offset:0
ds_read_b128 v[128:131], v19 offset:5120
v_mfma_f32_16x16x32_bf16 v[28:31], a[248:251], v[184:187], v[28:31]
ds_read_b128 v[148:151], v19 offset:10240
ds_read_b128 v[112:115], v19 offset:1024
v_mfma_f32_16x16x32_bf16 v[32:35], a[212:215], v[176:179], v[32:35]
ds_read_b128 v[132:135], v19 offset:6144
ds_read_b128 v[152:155], v19 offset:11264
v_mfma_f32_16x16x32_bf16 v[32:35], a[232:235], v[180:183], v[32:35]
ds_read_b128 v[116:119], v19 offset:2048
ds_read_b128 v[136:139], v19 offset:7168
v_mfma_f32_16x16x32_bf16 v[32:35], a[252:255], v[184:187], v[32:35]
ds_read_b128 v[156:159], v19 offset:12288
ds_read_b128 v[120:123], v19 offset:3072
v_mfma_f32_16x16x32_bf16 v[36:39], a[216:219], v[176:179], v[36:39]
ds_read_b128 v[140:143], v19 offset:8192
ds_read_b128 v[160:163], v19 offset:13312
v_mfma_f32_16x16x32_bf16 v[36:39], a[236:239], v[180:183], v[36:39]
ds_read_b128 v[124:127], v19 offset:4096
ds_read_b128 v[144:147], v19 offset:9216
v_mfma_f32_16x16x32_bf16 v[36:39], v[244:247], v[184:187], v[36:39]
ds_read_b128 v[164:167], v19 offset:14336
s_waitcnt lgkmcnt(13)
v_pk_add_f32 v[108:109], v[108:109], v[128:129]
v_pk_add_f32 v[110:111], v[110:111], v[130:131]
s_waitcnt lgkmcnt(10)
v_pk_add_f32 v[112:113], v[112:113], v[132:133]
v_pk_add_f32 v[114:115], v[114:115], v[134:135]
v_pk_add_f32 v[20:21], v[20:21], v[148:149]
v_pk_add_f32 v[22:23], v[22:23], v[150:151]
s_waitcnt lgkmcnt(9)
v_pk_add_f32 v[24:25], v[24:25], v[152:153]
v_pk_add_f32 v[26:27], v[26:27], v[154:155]
v_pk_add_f32 v[20:21], v[20:21], v[108:109]
v_pk_add_f32 v[22:23], v[22:23], v[110:111]
v_pk_add_f32 v[24:25], v[24:25], v[112:113]
v_pk_add_f32 v[26:27], v[26:27], v[114:115]
v_cvt_pk_bf16_f32 v48, v20, v21
v_cvt_pk_bf16_f32 v49, v22, v23
v_cvt_pk_bf16_f32 v50, v24, v25
v_cvt_pk_bf16_f32 v51, v26, v27
s_waitcnt lgkmcnt(7)
v_pk_add_f32 v[116:117], v[116:117], v[136:137]
v_pk_add_f32 v[118:119], v[118:119], v[138:139]
s_waitcnt lgkmcnt(4)
v_pk_add_f32 v[120:121], v[120:121], v[140:141]
v_pk_add_f32 v[122:123], v[122:123], v[142:143]
v_pk_add_f32 v[28:29], v[28:29], v[156:157]
v_pk_add_f32 v[30:31], v[30:31], v[158:159]
s_waitcnt lgkmcnt(3)
v_pk_add_f32 v[32:33], v[32:33], v[160:161]
v_pk_add_f32 v[34:35], v[34:35], v[162:163]
v_pk_add_f32 v[28:29], v[28:29], v[116:117]
v_pk_add_f32 v[30:31], v[30:31], v[118:119]
v_pk_add_f32 v[32:33], v[32:33], v[120:121]
v_pk_add_f32 v[34:35], v[34:35], v[122:123]
v_cvt_pk_bf16_f32 v52, v28, v29
v_cvt_pk_bf16_f32 v53, v30, v31
v_cvt_pk_bf16_f32 v54, v32, v33
v_cvt_pk_bf16_f32 v55, v34, v35
s_waitcnt lgkmcnt(1)
v_pk_add_f32 v[124:125], v[124:125], v[144:145]
v_pk_add_f32 v[126:127], v[126:127], v[146:147]
s_waitcnt lgkmcnt(0)
v_pk_add_f32 v[36:37], v[36:37], v[164:165]
v_pk_add_f32 v[38:39], v[38:39], v[166:167]
v_pk_add_f32 v[36:37], v[36:37], v[124:125]
v_pk_add_f32 v[38:39], v[38:39], v[126:127]
v_cvt_pk_bf16_f32 v56, v36, v37
v_cvt_pk_bf16_f32 v57, v38, v39
buffer_store_dwordx4 v[48:51], v14, s[4:7], s74 offen sc1
buffer_store_dwordx4 v[52:55], v14, s[4:7], s74 offen offset:512 sc1
buffer_store_dwordx2 v[56:57], v15, s[4:7], s74 offen sc1
v_pk_add_f32 v[108:109], v[20:21], v[22:23]
v_pk_mul_f32 v[110:111], v[20:21], v[20:21]
v_pk_fma_f32 v[110:111], v[22:23], v[22:23], v[110:111]
v_pk_add_f32 v[108:109], v[108:109], v[24:25]
v_pk_fma_f32 v[110:111], v[24:25], v[24:25], v[110:111]
v_pk_add_f32 v[108:109], v[108:109], v[26:27]
v_pk_fma_f32 v[110:111], v[26:27], v[26:27], v[110:111]
v_pk_add_f32 v[108:109], v[108:109], v[28:29]
v_pk_fma_f32 v[110:111], v[28:29], v[28:29], v[110:111]
v_pk_add_f32 v[108:109], v[108:109], v[30:31]
v_pk_fma_f32 v[110:111], v[30:31], v[30:31], v[110:111]
v_pk_add_f32 v[108:109], v[108:109], v[32:33]
v_pk_fma_f32 v[110:111], v[32:33], v[32:33], v[110:111]
v_pk_add_f32 v[108:109], v[108:109], v[34:35]
v_pk_fma_f32 v[110:111], v[34:35], v[34:35], v[110:111]
v_pk_add_f32 v[108:109], v[108:109], v[36:37]
v_pk_fma_f32 v[110:111], v[36:37], v[36:37], v[110:111]
v_pk_add_f32 v[108:109], v[108:109], v[38:39]
v_pk_fma_f32 v[110:111], v[38:39], v[38:39], v[110:111]
v_add_f32 v108, v108, v109
v_add_f32 v109, v110, v111
v_mov_b32 v110, v108
v_mov_b32 v111, v109
s_nop 0
v_permlane32_swap_b32 v110, v108
v_permlane32_swap_b32 v111, v109
v_add_f32 v108, v108, v110
v_add_f32 v109, v109, v111
v_mov_b32 v110, v108
v_mov_b32 v111, v109
s_nop 0
v_permlane16_swap_b32 v110, v108
v_permlane16_swap_b32 v111, v109
v_add_f32 v108, v108, v110
v_add_f32 v109, v109, v111
buffer_store_dwordx2 v[108:109], v17, s[4:7], s76 offen sc1
s_barrier
buffer_load_dwordx4 v[204:207], v1, s[4:7], s31 offen offset:3072 sc1
s_add_u32 m0, s25, 0
s_add_u32 s30, s22, 98304
buffer_load_dwordx4 v1, s[4:7], s30 offen sc1 lds
buffer_load_dwordx4 v1, s[4:7], s30 offen offset:1024 sc1 lds
buffer_load_dwordx4 v1, s[4:7], s30 offen offset:2048 sc1 lds
s_waitcnt vmcnt(4)
buffer_atomic_add v9, v255, s[4:7], s100 offen offset:4 sc1
buffer_load_dwordx4 v1, s[4:7], s30 offen offset:3072 sc1 lds
s_add_u32 m0, s25, 16384
s_add_u32 s30, s22, 114688
buffer_load_dwordx4 v1, s[4:7], s30 offen sc1 lds
buffer_load_dwordx4 v1, s[4:7], s30 offen offset:1024 sc1 lds
buffer_load_dwordx4 v1, s[4:7], s30 offen offset:2048 sc1 lds
buffer_load_dwordx4 v1, s[4:7], s30 offen offset:3072 sc1 lds
s_add_u32 m0, s25, 32768
s_add_u32 s30, s22, 131072
buffer_load_dwordx4 v1, s[4:7], s30 offen sc1 lds
buffer_load_dwordx4 v1, s[4:7], s30 offen offset:1024 sc1 lds
buffer_load_dwordx4 v1, s[4:7], s30 offen offset:2048 sc1 lds
buffer_load_dwordx4 v1, s[4:7], s30 offen offset:3072 sc1 lds
s_add_u32 m0, s25, 49152
s_add_u32 s30, s22, 147456
buffer_load_dwordx4 v1, s[4:7], s30 offen sc1 lds
buffer_load_dwordx4 v1, s[4:7], s30 offen offset:1024 sc1 lds
buffer_load_dwordx4 v1, s[4:7], s30 offen offset:2048 sc1 lds
buffer_load_dwordx4 v1, s[4:7], s30 offen offset:3072 sc1 lds
ds_read_b128 v[112:115], v2 offset:0
ds_read_b128 v[116:119], v2 offset:1024
ds_read_b128 v[120:123], v2 offset:2048
ds_read_b128 v[124:127], v2 offset:3072
ds_read_b128 v[128:131], v2 offset:4096
ds_read_b128 v[132:135], v2 offset:5120
s_load_dword s15, s[4:5], s101 offset:4 glc
s_waitcnt lgkmcnt(0)
s_cmp_ge_u32 s15, 16
s_cbranch_scc0 SP68
BK69:
s_add_u32 s78, s26, 67108864
buffer_load_dwordx4 a[0:3], v4, s[4:7], s78 offen offset:0 sc1
buffer_load_dwordx4 a[4:7], v4, s[4:7], s78 offen offset:2048 sc1
buffer_load_dwordx4 a[8:11], v4, s[4:7], s78 offen offset:256 sc1
buffer_load_dwordx4 a[12:15], v4, s[4:7], s78 offen offset:2304 sc1
s_add_u32 s78, s26, 67112960
buffer_load_dwordx4 a[16:19], v4, s[4:7], s78 offen offset:0 sc1
buffer_load_dwordx4 a[20:23], v4, s[4:7], s78 offen offset:2048 sc1
buffer_load_dwordx4 a[24:27], v4, s[4:7], s78 offen offset:256 sc1
buffer_load_dwordx4 a[28:31], v4, s[4:7], s78 offen offset:2304 sc1
s_add_u32 s78, s26, 67125248
buffer_load_dwordx4 a[32:35], v4, s[4:7], s78 offen offset:0 sc1
buffer_load_dwordx4 a[36:39], v4, s[4:7], s78 offen offset:2048 sc1
buffer_load_dwordx4 a[40:43], v4, s[4:7], s78 offen offset:256 sc1
s_waitcnt vmcnt(9)
v_mfma_f32_16x16x32_bf16 v[48:51], v[112:115], a[0:3], 0
buffer_load_dwordx4 a[44:47], v4, s[4:7], s78 offen offset:2304 sc1
v_mfma_f32_16x16x32_bf16 v[48:51], v[116:119], a[4:7], v[48:51]
s_waitcnt vmcnt(8)
v_mfma_f32_16x16x32_bf16 v[56:59], v[112:115], a[8:11], 0
ds_read_b128 v[112:115], v2 offset:6144
v_mfma_f32_16x16x32_bf16 v[56:59], v[116:119], a[12:15], v[56:59]
ds_read_b128 v[116:119], v2 offset:7168
v_mfma_f32_16x16x32_bf16 v[52:55], v[120:123], a[0:3], 0
s_add_u32 s78, s26, 67129344
v_mfma_f32_16x16x32_bf16 v[52:55], v[124:127], a[4:7], v[52:55]
buffer_load_dwordx4 a[48:51], v4, s[4:7], s78 offen offset:0 sc1
v_mfma_f32_16x16x32_bf16 v[60:63], v[120:123], a[8:11], 0
ds_read_b128 v[120:123], v2 offset:8192
v_mfma_f32_16x16x32_bf16 v[60:63], v[124:127], a[12:15], v[60:63]
ds_read_b128 v[124:127], v2 offset:9216
v_mfma_f32_16x16x32_bf16 v[64:67], v[128:131], a[0:3], 0
buffer_load_dwordx4 a[52:55], v4, s[4:7], s78 offen offset:2048 sc1
v_mfma_f32_16x16x32_bf16 v[64:67], v[132:135], a[4:7], v[64:67]
v_lshrrev_b32 v136, 4, v0
v_lshlrev_b32 v136, 11, v136
v_mfma_f32_16x16x32_bf16 v[72:75], v[128:131], a[8:11], 0
ds_read_b128 v[128:131], v2 offset:10240
v_and_b32 v137, 15, v0
v_mfma_f32_16x16x32_bf16 v[72:75], v[132:135], a[12:15], v[72:75]
ds_read_b128 v[132:135], v2 offset:11264
s_waitcnt lgkmcnt(4)
v_mfma_f32_16x16x32_bf16 v[68:71], v[112:115], a[0:3], 0
buffer_load_dwordx4 a[56:59], v4, s[4:7], s78 offen offset:256 sc1
v_mfma_f32_16x16x32_bf16 v[68:71], v[116:119], a[4:7], v[68:71]
v_lshl_add_u32 v136, v137, 3, v136
v_lshl_add_u32 v136, s18, 8, v136
v_mfma_f32_16x16x32_bf16 v[76:79], v[112:115], a[8:11], 0
ds_read_b128 v[112:115], v2 offset:12288
v_mfma_f32_16x16x32_bf16 v[76:79], v[116:119], a[12:15], v[76:79]
ds_read_b128 v[116:119], v2 offset:13312
s_waitcnt vmcnt(9) lgkmcnt(4)
v_mfma_f32_16x16x32_bf16 v[48:51], v[120:123], a[16:19], v[48:51]
buffer_load_dwordx4 a[60:63], v4, s[4:7], s78 offen offset:2304 sc1
v_mfma_f32_16x16x32_bf16 v[48:51], v[124:127], a[20:23], v[48:51]
s_waitcnt vmcnt(8)
v_mfma_f32_16x16x32_bf16 v[56:59], v[120:123], a[24:27], v[56:59]
ds_read_b128 v[120:123], v2 offset:14336
v_mfma_f32_16x16x32_bf16 v[56:59], v[124:127], a[28:31], v[56:59]
ds_read_b128 v[124:127], v2 offset:15360
s_waitcnt lgkmcnt(4)
v_mfma_f32_16x16x32_bf16 v[52:55], v[128:131], a[16:19], v[52:55]
s_add_u32 s78, s26, 67141632
v_mfma_f32_16x16x32_bf16 v[52:55], v[132:135], a[20:23], v[52:55]
buffer_load_dwordx4 a[64:67], v4, s[4:7], s78 offen offset:0 sc1
v_mfma_f32_16x16x32_bf16 v[60:63], v[128:131], a[24:27], v[60:63]
ds_read_b128 v[128:131], v2 offset:16384
v_mfma_f32_16x16x32_bf16 v[60:63], v[132:135], a[28:31], v[60:63]
ds_read_b128 v[132:135], v2 offset:17408
s_waitcnt lgkmcnt(4)
v_mfma_f32_16x16x32_bf16 v[64:67], v[112:115], a[16:19], v[64:67]
buffer_load_dwordx4 a[68:71], v4, s[4:7], s78 offen offset:2048 sc1
v_mfma_f32_16x16x32_bf16 v[64:67], v[116:119], a[20:23], v[64:67]
v_mfma_f32_16x16x32_bf16 v[72:75], v[112:115], a[24:27], v[72:75]
ds_read_b128 v[112:115], v2 offset:18432
v_mfma_f32_16x16x32_bf16 v[72:75], v[116:119], a[28:31], v[72:75]
ds_read_b128 v[116:119], v2 offset:19456
s_waitcnt lgkmcnt(4)
v_mfma_f32_16x16x32_bf16 v[68:71], v[120:123], a[16:19], v[68:71]
PG_s13:
s_cbranch_execz PG_b4
buffer_load_dwordx4 a[72:75], v4, s[4:7], s78 offen offset:256 sc1
v_mfma_f32_16x16x32_bf16 v[68:71], v[124:127], a[20:23], v[68:71]
v_mfma_f32_16x16x32_bf16 v[76:79], v[120:123], a[24:27], v[76:79]
ds_read_b128 v[120:123], v2 offset:20480
v_mfma_f32_16x16x32_bf16 v[76:79], v[124:127], a[28:31], v[76:79]
ds_read_b128 v[124:127], v2 offset:21504
s_waitcnt vmcnt(9) lgkmcnt(4)
v_mfma_f32_16x16x32_bf16 v[48:51], v[128:131], a[32:35], v[48:51]
buffer_load_dwordx4 a[76:79], v4, s[4:7], s78 offen offset:2304 sc1
v_mfma_f32_16x16x32_bf16 v[48:51], v[132:135], a[36:39], v[48:51]
s_waitcnt vmcnt(8)
v_mfma_f32_16x16x32_bf16 v[56:59], v[128:131], a[40:43], v[56:59]
ds_read_b128 v[128:131], v2 offset:22528
v_mfma_f32_16x16x32_bf16 v[56:59], v[132:135], a[44:47], v[56:59]
ds_read_b128 v[132:135], v2 offset:23552
s_waitcnt lgkmcnt(4)
v_mfma_f32_16x16x32_bf16 v[52:55], v[112:115], a[32:35], v[52:55]
s_add_u32 s78, s26, 67145728
v_mfma_f32_16x16x32_bf16 v[52:55], v[116:119], a[36:39], v[52:55]
buffer_load_dwordx4 a[80:83], v4, s[4:7], s78 offen offset:0 sc1
v_mfma_f32_16x16x32_bf16 v[60:63], v[112:115], a[40:43], v[60:63]
ds_read_b128 v[112:115], v2 offset:24576
v_mfma_f32_16x16x32_bf16 v[60:63], v[116:119], a[44:47], v[60:63]
ds_read_b128 v[116:119], v2 offset:25600
s_waitcnt lgkmcnt(4)
v_mfma_f32_16x16x32_bf16 v[64:67], v[120:123], a[32:35], v[64:67]
buffer_load_dwordx4 a[84:87], v4, s[4:7], s78 offen offset:2048 sc1
v_mfma_f32_16x16x32_bf16 v[64:67], v[124:127], a[36:39], v[64:67]
buffer_load_dwordx4 a[88:91], v4, s[4:7], s78 offen offset:256 sc1
v_mfma_f32_16x16x32_bf16 v[72:75], v[120:123], a[40:43], v[72:75]
ds_read_b128 v[120:123], v2 offset:26624
v_mfma_f32_16x16x32_bf16 v[72:75], v[124:127], a[44:47], v[72:75]
ds_read_b128 v[124:127], v2 offset:27648
s_waitcnt lgkmcnt(4)
v_mfma_f32_16x16x32_bf16 v[68:71], v[128:131], a[32:35], v[68:71]
buffer_load_dwordx4 a[92:95], v4, s[4:7], s78 offen offset:2304 sc1
v_mfma_f32_16x16x32_bf16 v[68:71], v[132:135], a[36:39], v[68:71]
v_mfma_f32_16x16x32_bf16 v[76:79], v[128:131], a[40:43], v[76:79]
ds_read_b128 v[128:131], v2 offset:28672
v_mfma_f32_16x16x32_bf16 v[76:79], v[132:135], a[44:47], v[76:79]
ds_read_b128 v[132:135], v2 offset:29696
s_waitcnt vmcnt(10) lgkmcnt(4)
v_mfma_f32_16x16x32_bf16 v[48:51], v[112:115], a[48:51], v[48:51]
s_add_u32 s78, s26, 67158016
v_mfma_f32_16x16x32_bf16 v[48:51], v[116:119], a[52:55], v[48:51]
buffer_load_dwordx4 a[96:99], v4, s[4:7], s78 offen offset:0 sc1
s_waitcnt vmcnt(9)
v_mfma_f32_16x16x32_bf16 v[56:59], v[112:115], a[56:59], v[56:59]
ds_read_b128 v[112:115], v2 offset:30720
v_mfma_f32_16x16x32_bf16 v[56:59], v[116:119], a[60:63], v[56:59]
ds_read_b128 v[116:119], v2 offset:31744
s_waitcnt lgkmcnt(4)
v_mfma_f32_16x16x32_bf16 v[52:55], v[120:123], a[48:51], v[52:55]
buffer_load_dwordx4 a[100:103], v4, s[4:7], s78 offen offset:2048 sc1
v_mfma_f32_16x16x32_bf16 v[52:55], v[124:127], a[52:55], v[52:55]
v_mfma_f32_16x16x32_bf16 v[60:63], v[120:123], a[56:59], v[60:63]
ds_read_b128 v[120:123], v2 offset:32768
v_mfma_f32_16x16x32_bf16 v[60:63], v[124:127], a[60:63], v[60:63]
ds_read_b128 v[124:127], v2 offset:33792
s_waitcnt lgkmcnt(4)
v_mfma_f32_16x16x32_bf16 v[64:67], v[128:131], a[48:51], v[64:67]
s_and_b32 s76, s99, 0xffffe000
s_add_u32 s76, s76, 4294950912
v_mfma_f32_16x16x32_bf16 v[64:67], v[132:135], a[52:55], v[64:67]
buffer_load_dwordx2 v[144:145], v136, s[4:7], s76 offen offset:0 sc1
v_mfma_f32_16x16x32_bf16 v[72:75], v[128:131], a[56:59], v[72:75]
ds_read_b128 v[128:131], v2 offset:34816
v_mfma_f32_16x16x32_bf16 v[72:75], v[132:135], a[60:63], v[72:75]
ds_read_b128 v[132:135], v2 offset:35840
s_waitcnt lgkmcnt(4)
v_mfma_f32_16x16x32_bf16 v[68:71], v[112:115], a[48:51], v[68:71]
buffer_load_dwordx4 a[200:203], v4, s[4:7], s78 offen offset:256 sc1
v_mfma_f32_16x16x32_bf16 v[68:71], v[116:119], a[52:55], v[68:71]
buffer_load_dwordx2 v[146:147], v136, s[4:7], s76 offen offset:1024 sc1
v_mfma_f32_16x16x32_bf16 v[76:79], v[112:115], a[56:59], v[76:79]
ds_read_b128 v[112:115], v2 offset:36864
v_mfma_f32_16x16x32_bf16 v[76:79], v[116:119], a[60:63], v[76:79]
ds_read_b128 v[116:119], v2 offset:37888
s_waitcnt vmcnt(11) lgkmcnt(4)
v_mfma_f32_16x16x32_bf16 v[48:51], v[120:123], a[64:67], v[48:51]
buffer_load_dwordx4 a[204:207], v4, s[4:7], s78 offen offset:2304 sc1
v_mfma_f32_16x16x32_bf16 v[48:51], v[124:127], a[68:71], v[48:51]
buffer_load_dwordx2 v[148:149], v136, s[4:7], s76 offen offset:128 sc1
s_waitcnt vmcnt(11)
v_mfma_f32_16x16x32_bf16 v[56:59], v[120:123], a[72:75], v[56:59]
ds_read_b128 v[120:123], v2 offset:38912
v_mfma_f32_16x16x32_bf16 v[56:59], v[124:127], a[76:79], v[56:59]
ds_read_b128 v[124:127], v2 offset:39936
s_waitcnt lgkmcnt(4)
v_mfma_f32_16x16x32_bf16 v[52:55], v[128:131], a[64:67], v[52:55]
s_add_u32 s78, s26, 67162112
v_mfma_f32_16x16x32_bf16 v[52:55], v[132:135], a[68:71], v[52:55]
buffer_load_dwordx4 a[208:211], v4, s[4:7], s78 offen offset:0 sc1
v_mfma_f32_16x16x32_bf16 v[60:63], v[128:131], a[72:75], v[60:63]
ds_read_b128 v[128:131], v2 offset:40960
v_mfma_f32_16x16x32_bf16 v[60:63], v[132:135], a[76:79], v[60:63]
ds_read_b128 v[132:135], v2 offset:41984
s_waitcnt lgkmcnt(4)
v_mfma_f32_16x16x32_bf16 v[64:67], v[112:115], a[64:67], v[64:67]
buffer_load_dwordx2 v[150:151], v136, s[4:7], s76 offen offset:1152 sc1
v_mfma_f32_16x16x32_bf16 v[64:67], v[116:119], a[68:71], v[64:67]
buffer_load_dwordx4 a[212:215], v4, s[4:7], s78 offen offset:2048 sc1
v_mfma_f32_16x16x32_bf16 v[72:75], v[112:115], a[72:75], v[72:75]
ds_read_b128 v[112:115], v2 offset:43008
v_mfma_f32_16x16x32_bf16 v[72:75], v[116:119], a[76:79], v[72:75]
ds_read_b128 v[116:119], v2 offset:44032
s_waitcnt lgkmcnt(4)
v_mfma_f32_16x16x32_bf16 v[68:71], v[120:123], a[64:67], v[68:71]
buffer_load_dwordx4 a[216:219], v4, s[4:7], s78 offen offset:256 sc1
v_mfma_f32_16x16x32_bf16 v[68:71], v[124:127], a[68:71], v[68:71]
buffer_load_dwordx4 a[220:223], v4, s[4:7], s78 offen offset:2304 sc1
v_mfma_f32_16x16x32_bf16 v[76:79], v[120:123], a[72:75], v[76:79]
ds_read_b128 v[120:123], v2 offset:45056
v_mfma_f32_16x16x32_bf16 v[76:79], v[124:127], a[76:79], v[76:79]
ds_read_b128 v[124:127], v2 offset:46080
s_waitcnt vmcnt(14) lgkmcnt(4)
v_mfma_f32_16x16x32_bf16 v[48:51], v[128:131], a[80:83], v[48:51]
s_add_u32 s78, s26, 67174400
v_mfma_f32_16x16x32_bf16 v[48:51], v[132:135], a[84:87], v[48:51]
buffer_load_dwordx4 a[224:227], v4, s[4:7], s78 offen offset:0 sc1
s_waitcnt vmcnt(13)
v_mfma_f32_16x16x32_bf16 v[56:59], v[128:131], a[88:91], v[56:59]
ds_read_b128 v[128:131], v2 offset:47104
v_mfma_f32_16x16x32_bf16 v[56:59], v[132:135], a[92:95], v[56:59]
ds_read_b128 v[132:135], v2 offset:48128
s_waitcnt lgkmcnt(4)
v_mfma_f32_16x16x32_bf16 v[52:55], v[112:115], a[80:83], v[52:55]
buffer_load_dwordx4 a[228:231], v4, s[4:7], s78 offen offset:2048 sc1
v_mfma_f32_16x16x32_bf16 v[52:55], v[116:119], a[84:87], v[52:55]
v_mfma_f32_16x16x32_bf16 v[60:63], v[112:115], a[88:91], v[60:63]
ds_read_b128 v[112:115], v2 offset:49152
v_mfma_f32_16x16x32_bf16 v[60:63], v[116:119], a[92:95], v[60:63]
ds_read_b128 v[116:119], v2 offset:50176
s_waitcnt lgkmcnt(4)
v_mfma_f32_16x16x32_bf16 v[64:67], v[120:123], a[80:83], v[64:67]
buffer_load_dwordx4 a[232:235], v4, s[4:7], s78 offen offset:256 sc1
v_mfma_f32_16x16x32_bf16 v[64:67], v[124:127], a[84:87], v[64:67]
v_mfma_f32_16x16x32_bf16 v[72:75], v[120:123], a[88:91], v[72:75]
ds_read_b128 v[120:123], v2 offset:51200
v_mfma_f32_16x16x32_bf16 v[72:75], v[124:127], a[92:95], v[72:75]
ds_read_b128 v[124:127], v2 offset:52224
s_waitcnt lgkmcnt(4)
v_mfma_f32_16x16x32_bf16 v[68:71], v[128:131], a[80:83], v[68:71]
buffer_load_dwordx4 a[236:239], v4, s[4:7], s78 offen offset:2304 sc1
v_mfma_f32_16x16x32_bf16 v[68:71], v[132:135], a[84:87], v[68:71]
v_mfma_f32_16x16x32_bf16 v[76:79], v[128:131], a[88:91], v[76:79]
ds_read_b128 v[128:131], v2 offset:53248
v_mfma_f32_16x16x32_bf16 v[76:79], v[132:135], a[92:95], v[76:79]
ds_read_b128 v[132:135], v2 offset:54272
s_waitcnt vmcnt(14) lgkmcnt(4)
v_mfma_f32_16x16x32_bf16 v[48:51], v[112:115], a[96:99], v[48:51]
s_add_u32 s78, s26, 67178496
v_mfma_f32_16x16x32_bf16 v[48:51], v[116:119], a[100:103], v[48:51]
buffer_load_dwordx4 a[240:243], v4, s[4:7], s78 offen offset:0 sc1
s_waitcnt vmcnt(11)
v_mfma_f32_16x16x32_bf16 v[56:59], v[112:115], a[200:203], v[56:59]
ds_read_b128 v[112:115], v2 offset:55296
v_mfma_f32_16x16x32_bf16 v[56:59], v[116:119], a[204:207], v[56:59]
ds_read_b128 v[116:119], v2 offset:56320
s_waitcnt lgkmcnt(4)
v_mfma_f32_16x16x32_bf16 v[52:55], v[120:123], a[96:99], v[52:55]
s_mul_i32 s77, s17, 6144
s_add_u32 s77, s77, 262144
v_mfma_f32_16x16x32_bf16 v[52:55], v[124:127], a[100:103], v[52:55]
buffer_load_dwordx4 v[152:155], v1, s[4:7], s77 offen offset:0 sc1
v_mfma_f32_16x16x32_bf16 v[60:63], v[120:123], a[200:203], v[60:63]
ds_read_b128 v[120:123], v2 offset:57344
v_mfma_f32_16x16x32_bf16 v[60:63], v[124:127], a[204:207], v[60:63]
ds_read_b128 v[124:127], v2 offset:58368
s_waitcnt lgkmcnt(4)
v_mfma_f32_16x16x32_bf16 v[64:67], v[128:131], a[96:99], v[64:67]
buffer_load_dwordx4 a[244:247], v4, s[4:7], s78 offen offset:2048 sc1
v_mfma_f32_16x16x32_bf16 v[64:67], v[132:135], a[100:103], v[64:67]
buffer_load_dwordx4 v[156:159], v1, s[4:7], s77 offen offset:1024 sc1
v_mfma_f32_16x16x32_bf16 v[72:75], v[128:131], a[200:203], v[72:75]
ds_read_b128 v[128:131], v2 offset:59392
v_mfma_f32_16x16x32_bf16 v[72:75], v[132:135], a[204:207], v[72:75]
ds_read_b128 v[132:135], v2 offset:60416
s_waitcnt lgkmcnt(4)
v_mfma_f32_16x16x32_bf16 v[68:71], v[112:115], a[96:99], v[68:71]
buffer_load_dwordx4 a[248:251], v4, s[4:7], s78 offen offset:256 sc1
v_mfma_f32_16x16x32_bf16 v[68:71], v[116:119], a[100:103], v[68:71]
buffer_load_dwordx4 a[252:255], v4, s[4:7], s78 offen offset:2304 sc1
v_mfma_f32_16x16x32_bf16 v[76:79], v[112:115], a[200:203], v[76:79]
ds_read_b128 v[112:115], v2 offset:61440
v_add_f32 v144, v144, v146
v_mfma_f32_16x16x32_bf16 v[76:79], v[116:119], a[204:207], v[76:79]
ds_read_b128 v[116:119], v2 offset:62464
s_waitcnt vmcnt(12) lgkmcnt(4)
v_mfma_f32_16x16x32_bf16 v[48:51], v[120:123], a[208:211], v[48:51]
v_add_f32 v145, v145, v147
v_add_f32 v148, v148, v150
v_mfma_f32_16x16x32_bf16 v[48:51], v[124:127], a[212:215], v[48:51]
v_add_f32 v149, v149, v151
v_mov_b32 v146, v144
s_waitcnt vmcnt(10)
v_mfma_f32_16x16x32_bf16 v[56:59], v[120:123], a[216:219], v[56:59]
ds_read_b128 v[120:123], v2 offset:63488
v_mov_b32 v147, v145
v_mfma_f32_16x16x32_bf16 v[56:59], v[124:127], a[220:223], v[56:59]
ds_read_b128 v[124:127], v2 offset:64512
s_waitcnt lgkmcnt(4)
v_mfma_f32_16x16x32_bf16 v[52:55], v[128:131], a[208:211], v[52:55]
v_mov_b32 v150, v148
v_mov_b32 v151, v149
v_mfma_f32_16x16x32_bf16 v[52:55], v[132:135], a[212:215], v[52:55]
v_permlane32_swap_b32 v146, v144
v_permlane32_swap_b32 v147, v145
v_mfma_f32_16x16x32_bf16 v[60:63], v[128:131], a[216:219], v[60:63]
ds_read_b128 v[128:131], v3 offset:0
v_permlane32_swap_b32 v150, v148
v_mfma_f32_16x16x32_bf16 v[60:63], v[132:135], a[220:223], v[60:63]
ds_read_b128 v[132:135], v3 offset:1024
s_waitcnt lgkmcnt(4)
v_mfma_f32_16x16x32_bf16 v[64:67], v[112:115], a[208:211], v[64:67]
v_permlane32_swap_b32 v151, v149
v_add_f32 v144, v144, v146
v_mfma_f32_16x16x32_bf16 v[64:67], v[116:119], a[212:215], v[64:67]
v_add_f32 v145, v145, v147
v_add_f32 v148, v148, v150
v_mfma_f32_16x16x32_bf16 v[72:75], v[112:115], a[216:219], v[72:75]
ds_read_b128 v[112:115], v3 offset:2048
v_add_f32 v149, v149, v151
v_mfma_f32_16x16x32_bf16 v[72:75], v[116:119], a[220:223], v[72:75]
ds_read_b128 v[116:119], v3 offset:3072
s_waitcnt lgkmcnt(4)
v_mfma_f32_16x16x32_bf16 v[68:71], v[120:123], a[208:211], v[68:71]
v_mov_b32 v146, v144
v_mov_b32 v147, v145
v_mfma_f32_16x16x32_bf16 v[68:71], v[124:127], a[212:215], v[68:71]
v_mov_b32 v150, v148
v_mov_b32 v151, v149
v_mfma_f32_16x16x32_bf16 v[76:79], v[120:123], a[216:219], v[76:79]
ds_read_b128 v[120:123], v3 offset:4096
v_permlane16_swap_b32 v146, v144
v_mfma_f32_16x16x32_bf16 v[76:79], v[124:127], a[220:223], v[76:79]
ds_read_b128 v[124:127], v3 offset:5120
s_waitcnt vmcnt(8) lgkmcnt(4)
v_mfma_f32_16x16x32_bf16 v[48:51], v[128:131], a[224:227], v[48:51]
s_add_u32 s31, s24, 12288
buffer_load_dwordx4 v[208:211], v1, s[4:7], s31 offen offset:0 sc1
v_mfma_f32_16x16x32_bf16 v[48:51], v[132:135], a[228:231], v[48:51]
v_permlane16_swap_b32 v147, v145
v_permlane16_swap_b32 v150, v148
s_waitcnt vmcnt(7)
v_mfma_f32_16x16x32_bf16 v[56:59], v[128:131], a[232:235], v[56:59]
ds_read_b128 v[128:131], v3 offset:6144
v_permlane16_swap_b32 v151, v149
v_mfma_f32_16x16x32_bf16 v[56:59], v[132:135], a[236:239], v[56:59]
ds_read_b128 v[132:135], v3 offset:7168
s_waitcnt lgkmcnt(4)
v_mfma_f32_16x16x32_bf16 v[52:55], v[112:115], a[224:227], v[52:55]
buffer_load_dwordx4 v[212:215], v1, s[4:7], s31 offen offset:1024 sc1
v_mfma_f32_16x16x32_bf16 v[52:55], v[116:119], a[228:231], v[52:55]
v_add_f32 v144, v144, v146
v_add_f32 v145, v145, v147
v_mfma_f32_16x16x32_bf16 v[60:63], v[112:115], a[232:235], v[60:63]
ds_read_b128 v[112:115], v3 offset:8192
v_add_f32 v148, v148, v150
v_mfma_f32_16x16x32_bf16 v[60:63], v[116:119], a[236:239], v[60:63]
ds_read_b128 v[116:119], v3 offset:9216
s_waitcnt lgkmcnt(4)
v_mfma_f32_16x16x32_bf16 v[64:67], v[120:123], a[224:227], v[64:67]
buffer_load_dwordx4 a[104:107], v1, s[4:7], s31 offen offset:2048 sc1
v_mfma_f32_16x16x32_bf16 v[64:67], v[124:127], a[228:231], v[64:67]
v_add_f32 v149, v149, v151
v_mul_f32 v144, 0xbacccccd, v144
v_mfma_f32_16x16x32_bf16 v[72:75], v[120:123], a[232:235], v[72:75]
ds_read_b128 v[120:123], v3 offset:10240
v_cvt_pk_bf16_f32 v40, v144, v144
v_mfma_f32_16x16x32_bf16 v[72:75], v[124:127], a[236:239], v[72:75]
ds_read_b128 v[124:127], v3 offset:11264
s_waitcnt lgkmcnt(4)
v_mfma_f32_16x16x32_bf16 v[68:71], v[128:131], a[224:227], v[68:71]
buffer_load_dwordx4 a[108:111], v1, s[4:7], s31 offen offset:3072 sc1
v_mfma_f32_16x16x32_bf16 v[68:71], v[132:135], a[228:231], v[68:71]
v_cvt_pk_bf16_f32 v41, v144, v144
v_mul_f32 v148, 0xbacccccd, v148
v_mfma_f32_16x16x32_bf16 v[76:79], v[128:131], a[232:235], v[76:79]
ds_read_b128 v[128:131], v3 offset:12288
v_cvt_pk_bf16_f32 v42, v148, v148
v_mfma_f32_16x16x32_bf16 v[76:79], v[132:135], a[236:239], v[76:79]
ds_read_b128 v[132:135], v3 offset:13312
s_waitcnt vmcnt(7) lgkmcnt(4)
v_mfma_f32_16x16x32_bf16 v[48:51], v[112:115], a[240:243], v[48:51]
s_add_u32 s31, s24, 16384
buffer_load_dwordx4 a[112:115], v1, s[4:7], s31 offen offset:0 sc1
v_mfma_f32_16x16x32_bf16 v[48:51], v[116:119], a[244:247], v[48:51]
v_cvt_pk_bf16_f32 v43, v148, v148
v_mul_f32 v145, 0x3acccccd, v145
s_waitcnt vmcnt(5)
v_mfma_f32_16x16x32_bf16 v[56:59], v[112:115], a[248:251], v[56:59]
ds_read_b128 v[112:115], v3 offset:14336
v_fma_f32 v145, -v144, v144, v145
v_mfma_f32_16x16x32_bf16 v[56:59], v[116:119], a[252:255], v[56:59]
ds_read_b128 v[116:119], v3 offset:15360
s_waitcnt lgkmcnt(4)
v_mfma_f32_16x16x32_bf16 v[52:55], v[120:123], a[240:243], v[52:55]
buffer_load_dwordx4 a[116:119], v1, s[4:7], s31 offen offset:1024 sc1
v_mfma_f32_16x16x32_bf16 v[52:55], v[124:127], a[244:247], v[52:55]
v_max_f32 v145, 0, v145
v_add_f32 v46, 0x3727c5ac, v145
v_mfma_f32_16x16x32_bf16 v[60:63], v[120:123], a[248:251], v[60:63]
ds_read_b128 v[120:123], v3 offset:16384
v_mfma_f32_16x16x32_bf16 v[60:63], v[124:127], a[252:255], v[60:63]
ds_read_b128 v[124:127], v3 offset:17408
s_waitcnt lgkmcnt(4)
v_mfma_f32_16x16x32_bf16 v[64:67], v[128:131], a[240:243], v[64:67]
buffer_load_dwordx4 a[120:123], v1, s[4:7], s31 offen offset:2048 sc1
v_mfma_f32_16x16x32_bf16 v[64:67], v[132:135], a[244:247], v[64:67]
v_rsq_f32 v146, v46
v_mfma_f32_16x16x32_bf16 v[72:75], v[128:131], a[248:251], v[72:75]
ds_read_b128 v[128:131], v3 offset:18432
v_mfma_f32_16x16x32_bf16 v[72:75], v[132:135], a[252:255], v[72:75]
ds_read_b128 v[132:135], v3 offset:19456
s_waitcnt lgkmcnt(4)
v_mfma_f32_16x16x32_bf16 v[68:71], v[112:115], a[240:243], v[68:71]
buffer_load_dwordx4 a[124:127], v1, s[4:7], s31 offen offset:3072 sc1
v_mfma_f32_16x16x32_bf16 v[68:71], v[116:119], a[244:247], v[68:71]
v_rcp_f32 v147, v46
v_mfma_f32_16x16x32_bf16 v[76:79], v[112:115], a[248:251], v[76:79]
ds_read_b128 v[112:115], v3 offset:20480
v_mul_f32 v44, 0xc0135761, v146
v_mfma_f32_16x16x32_bf16 v[76:79], v[116:119], a[252:255], v[76:79]
ds_read_b128 v[116:119], v3 offset:21504
v_mfma_f32_16x16x16_bf16 v[48:51], v[152:153], v[40:41], v[48:51]
s_add_u32 s31, s24, 20480
buffer_load_dwordx4 a[128:131], v1, s[4:7], s31 offen offset:0 sc1
v_mfma_f32_16x16x16_bf16 v[56:59], v[152:153], v[42:43], v[56:59]
v_mul_f32 v45, 0x3d372713, v44
v_mul_f32 v45, v147, v45
v_mfma_f32_16x16x16_bf16 v[52:55], v[154:155], v[40:41], v[52:55]
buffer_load_dwordx4 a[132:135], v1, s[4:7], s31 offen offset:1024 sc1
v_mul_f32 v149, 0x3acccccd, v149
v_mfma_f32_16x16x16_bf16 v[60:63], v[154:155], v[42:43], v[60:63]
v_fma_f32 v149, -v148, v148, v149
v_max_f32 v149, 0, v149
v_mfma_f32_16x16x16_bf16 v[64:67], v[156:157], v[40:41], v[64:67]
v_add_f32 v254, 0x3727c5ac, v149
v_rsq_f32 v150, v254
v_mfma_f32_16x16x16_bf16 v[72:75], v[156:157], v[42:43], v[72:75]
v_rcp_f32 v151, v254
v_mfma_f32_16x16x16_bf16 v[68:71], v[158:159], v[40:41], v[68:71]
v_mul_f32 v248, 0xc0135761, v150
v_mul_f32 v249, 0x3d372713, v248
v_mfma_f32_16x16x16_bf16 v[76:79], v[158:159], v[42:43], v[76:79]
v_mul_f32 v249, v151, v249
s_waitcnt lgkmcnt(4)
v_mfma_f32_16x16x32_bf16 v[80:83], v[120:123], a[0:3], 0
v_mfma_f32_16x16x32_bf16 v[80:83], v[124:127], a[4:7], v[80:83]
v_mfma_f32_16x16x32_bf16 v[88:91], v[120:123], a[8:11], 0
ds_read_b128 v[120:123], v3 offset:22528
v_mfma_f32_16x16x32_bf16 v[88:91], v[124:127], a[12:15], v[88:91]
ds_read_b128 v[124:127], v3 offset:23552
s_barrier
s_waitcnt lgkmcnt(4)
v_mfma_f32_16x16x32_bf16 v[84:87], v[128:131], a[0:3], 0
s_add_u32 m0, s25, 65536
s_add_u32 s30, s22, 163840
v_mfma_f32_16x16x32_bf16 v[84:87], v[132:135], a[4:7], v[84:87]
buffer_load_dwordx4 v1, s[4:7], s30 offen sc1 lds
v_mfma_f32_16x16x32_bf16 v[92:95], v[128:131], a[8:11], 0
ds_read_b128 v[128:131], v3 offset:24576
v_mul_f32 v144, v48, v48
v_mfma_f32_16x16x32_bf16 v[92:95], v[132:135], a[12:15], v[92:95]
ds_read_b128 v[132:135], v3 offset:25600
s_waitcnt lgkmcnt(4)
v_mfma_f32_16x16x32_bf16 v[96:99], v[112:115], a[0:3], 0
s_add_u32 s74, s17, 0
s_and_b32 s74, s74, 3
s_lshl_b32 s74, s74, 11
v_mfma_f32_16x16x32_bf16 v[96:99], v[116:119], a[4:7], v[96:99]
s_and_b32 s75, s29, 0xffffe000
s_add_u32 s74, s74, s75
v_mfma_f32_16x16x32_bf16 v[104:107], v[112:115], a[8:11], 0
ds_read_b128 v[112:115], v3 offset:26624
v_mul_f32 v145, v49, v49
v_mfma_f32_16x16x32_bf16 v[104:107], v[116:119], a[12:15], v[104:107]
ds_read_b128 v[116:119], v3 offset:27648
s_waitcnt lgkmcnt(4)
v_mfma_f32_16x16x32_bf16 v[100:103], v[120:123], a[0:3], 0
buffer_load_dwordx4 v1, s[4:7], s30 offen offset:1024 sc1 lds
v_mfma_f32_16x16x32_bf16 v[100:103], v[124:127], a[4:7], v[100:103]
buffer_load_dwordx4 v1, s[4:7], s30 offen offset:2048 sc1 lds
v_mfma_f32_16x16x32_bf16 v[108:111], v[120:123], a[8:11], 0
ds_read_b128 v[120:123], v3 offset:28672
v_mul_f32 v146, v50, v50
v_mfma_f32_16x16x32_bf16 v[108:111], v[124:127], a[12:15], v[108:111]
ds_read_b128 v[124:127], v3 offset:29696
s_waitcnt lgkmcnt(4)
v_mfma_f32_16x16x32_bf16 v[80:83], v[128:131], a[16:19], v[80:83]
buffer_load_dwordx4 v1, s[4:7], s30 offen offset:3072 sc1 lds
v_mfma_f32_16x16x32_bf16 v[80:83], v[132:135], a[20:23], v[80:83]
v_mul_f32 v147, v51, v51
v_fma_f32 v144, v144, v45, v44
v_mfma_f32_16x16x32_bf16 v[88:91], v[128:131], a[24:27], v[88:91]
ds_read_b128 v[128:131], v3 offset:30720
v_fma_f32 v145, v145, v45, v44
v_mfma_f32_16x16x32_bf16 v[88:91], v[132:135], a[28:31], v[88:91]
ds_read_b128 v[132:135], v3 offset:31744
s_barrier
s_waitcnt lgkmcnt(4)
v_mfma_f32_16x16x32_bf16 v[84:87], v[112:115], a[16:19], v[84:87]
s_add_u32 m0, s25, 81920
s_add_u32 s30, s22, 180224
v_mfma_f32_16x16x32_bf16 v[84:87], v[116:119], a[20:23], v[84:87]
buffer_load_dwordx4 v1, s[4:7], s30 offen sc1 lds
v_mfma_f32_16x16x32_bf16 v[92:95], v[112:115], a[24:27], v[92:95]
ds_read_b128 v[112:115], v1 offset:0
v_fma_f32 v146, v146, v45, v44
v_mfma_f32_16x16x32_bf16 v[92:95], v[116:119], a[28:31], v[92:95]
ds_read_b128 v[116:119], v1 offset:1024
s_waitcnt lgkmcnt(4)
v_mfma_f32_16x16x32_bf16 v[96:99], v[120:123], a[16:19], v[96:99]
buffer_load_dwordx4 v1, s[4:7], s30 offen offset:1024 sc1 lds
v_mfma_f32_16x16x32_bf16 v[96:99], v[124:127], a[20:23], v[96:99]
v_fma_f32 v147, v147, v45, v44
v_mul_f32 v144, v144, v48
v_mfma_f32_16x16x32_bf16 v[104:107], v[120:123], a[24:27], v[104:107]
ds_read_b128 v[120:123], v1 offset:2048
v_mul_f32 v145, v145, v49
v_mfma_f32_16x16x32_bf16 v[104:107], v[124:127], a[28:31], v[104:107]
ds_read_b128 v[124:127], v1 offset:3072
s_waitcnt lgkmcnt(4)
v_mfma_f32_16x16x32_bf16 v[100:103], v[128:131], a[16:19], v[100:103]
buffer_load_dwordx4 v1, s[4:7], s30 offen offset:2048 sc1 lds
v_mfma_f32_16x16x32_bf16 v[100:103], v[132:135], a[20:23], v[100:103]
v_mul_f32 v146, v146, v50
v_mul_f32 v147, v147, v51
v_mfma_f32_16x16x32_bf16 v[108:111], v[128:131], a[24:27], v[108:111]
ds_read_b128 v[128:131], v1 offset:4096
v_mfma_f32_16x16x32_bf16 v[108:111], v[132:135], a[28:31], v[108:111]
ds_read_b128 v[132:135], v1 offset:5120
s_waitcnt lgkmcnt(4)
v_mfma_f32_16x16x32_bf16 v[80:83], v[112:115], a[32:35], v[80:83]
buffer_load_dwordx4 v1, s[4:7], s30 offen offset:3072 sc1 lds
v_mfma_f32_16x16x32_bf16 v[80:83], v[116:119], a[36:39], v[80:83]
v_exp_f32 v144, v144
v_mfma_f32_16x16x32_bf16 v[88:91], v[112:115], a[40:43], v[88:91]
ds_read_b128 v[112:115], v1 offset:6144
v_mfma_f32_16x16x32_bf16 v[88:91], v[116:119], a[44:47], v[88:91]
ds_read_b128 v[116:119], v1 offset:7168
s_waitcnt lgkmcnt(4)
v_mfma_f32_16x16x32_bf16 v[84:87], v[120:123], a[32:35], v[84:87]
s_add_u32 m0, s25, 98304
s_add_u32 s30, s22, 196608
v_mfma_f32_16x16x32_bf16 v[84:87], v[124:127], a[36:39], v[84:87]
buffer_load_dwordx4 v1, s[4:7], s30 offen sc1 lds
v_mfma_f32_16x16x32_bf16 v[92:95], v[120:123], a[40:43], v[92:95]
ds_read_b128 v[120:123], v1 offset:8192
v_mfma_f32_16x16x32_bf16 v[92:95], v[124:127], a[44:47], v[92:95]
ds_read_b128 v[124:127], v1 offset:9216
s_waitcnt lgkmcnt(4)
v_mfma_f32_16x16x32_bf16 v[96:99], v[128:131], a[32:35], v[96:99]
buffer_load_dwordx4 v1, s[4:7], s30 offen offset:1024 sc1 lds
v_mfma_f32_16x16x32_bf16 v[96:99], v[132:135], a[36:39], v[96:99]
v_exp_f32 v145, v145
v_mfma_f32_16x16x32_bf16 v[104:107], v[128:131], a[40:43], v[104:107]
ds_read_b128 v[128:131], v1 offset:10240
v_mfma_f32_16x16x32_bf16 v[104:107], v[132:135], a[44:47], v[104:107]
ds_read_b128 v[132:135], v1 offset:11264
s_waitcnt lgkmcnt(4)
v_mfma_f32_16x16x32_bf16 v[100:103], v[112:115], a[32:35], v[100:103]
v_exp_f32 v146, v146
v_mfma_f32_16x16x32_bf16 v[100:103], v[116:119], a[36:39], v[100:103]
v_exp_f32 v147, v147
v_mfma_f32_16x16x32_bf16 v[108:111], v[112:115], a[40:43], v[108:111]
ds_read_b128 v[112:115], v1 offset:12288
v_mul_f32 v48, v48, v64
v_mfma_f32_16x16x32_bf16 v[108:111], v[116:119], a[44:47], v[108:111]
ds_read_b128 v[116:119], v1 offset:13312
s_waitcnt lgkmcnt(4)
v_mfma_f32_16x16x32_bf16 v[80:83], v[120:123], a[48:51], v[80:83]
buffer_load_dwordx4 v1, s[4:7], s30 offen offset:2048 sc1 lds
v_mfma_f32_16x16x32_bf16 v[80:83], v[124:127], a[52:55], v[80:83]
v_mul_f32 v49, v49, v65
v_mul_f32 v50, v50, v66
v_mfma_f32_16x16x32_bf16 v[88:91], v[120:123], a[56:59], v[88:91]
ds_read_b128 v[120:123], v1 offset:14336
v_mul_f32 v51, v51, v67
v_mfma_f32_16x16x32_bf16 v[88:91], v[124:127], a[60:63], v[88:91]
ds_read_b128 v[124:127], v1 offset:15360
s_waitcnt lgkmcnt(4)
v_mfma_f32_16x16x32_bf16 v[84:87], v[128:131], a[48:51], v[84:87]
buffer_load_dwordx4 v1, s[4:7], s30 offen offset:3072 sc1 lds
v_mfma_f32_16x16x32_bf16 v[84:87], v[132:135], a[52:55], v[84:87]
v_fma_f32 v144, v144, v46, v46
v_fma_f32 v145, v145, v46, v46
v_mfma_f32_16x16x32_bf16 v[92:95], v[128:131], a[56:59], v[92:95]
ds_read_b128 v[128:131], v1 offset:16384
v_fma_f32 v146, v146, v46, v46
v_mfma_f32_16x16x32_bf16 v[92:95], v[132:135], a[60:63], v[92:95]
ds_read_b128 v[132:135], v1 offset:17408
s_waitcnt lgkmcnt(4)
v_mfma_f32_16x16x32_bf16 v[96:99], v[112:115], a[48:51], v[96:99]
s_add_u32 m0, s25, 114688
s_add_u32 s30, s22, 212992
v_mfma_f32_16x16x32_bf16 v[96:99], v[116:119], a[52:55], v[96:99]
buffer_load_dwordx4 v1, s[4:7], s30 offen sc1 lds
v_mfma_f32_16x16x32_bf16 v[104:107], v[112:115], a[56:59], v[104:107]
ds_read_b128 v[112:115], v1 offset:18432
v_fma_f32 v147, v147, v46, v46
v_mfma_f32_16x16x32_bf16 v[104:107], v[116:119], a[60:63], v[104:107]
ds_read_b128 v[116:119], v1 offset:19456
s_waitcnt lgkmcnt(4)
v_mfma_f32_16x16x32_bf16 v[100:103], v[120:123], a[48:51], v[100:103]
buffer_load_dwordx4 v1, s[4:7], s30 offen offset:1024 sc1 lds
v_mfma_f32_16x16x32_bf16 v[100:103], v[124:127], a[52:55], v[100:103]
v_rcp_f32 v144, v144
v_mfma_f32_16x16x32_bf16 v[108:111], v[120:123], a[56:59], v[108:111]
ds_read_b128 v[120:123], v1 offset:20480
v_mfma_f32_16x16x32_bf16 v[108:111], v[124:127], a[60:63], v[108:111]
ds_read_b128 v[124:127], v1 offset:21504
s_waitcnt lgkmcnt(4)
v_mfma_f32_16x16x32_bf16 v[80:83], v[128:131], a[64:67], v[80:83]
buffer_load_dwordx4 v1, s[4:7], s30 offen offset:2048 sc1 lds
v_mfma_f32_16x16x32_bf16 v[80:83], v[132:135], a[68:71], v[80:83]
v_rcp_f32 v145, v145
v_mfma_f32_16x16x32_bf16 v[88:91], v[128:131], a[72:75], v[88:91]
ds_read_b128 v[128:131], v1 offset:22528
v_mfma_f32_16x16x32_bf16 v[88:91], v[132:135], a[76:79], v[88:91]
ds_read_b128 v[132:135], v1 offset:23552
s_waitcnt lgkmcnt(4)
v_mfma_f32_16x16x32_bf16 v[84:87], v[112:115], a[64:67], v[84:87]
buffer_load_dwordx4 v1, s[4:7], s30 offen offset:3072 sc1 lds
v_mfma_f32_16x16x32_bf16 v[84:87], v[116:119], a[68:71], v[84:87]
v_rcp_f32 v146, v146
v_mfma_f32_16x16x32_bf16 v[92:95], v[112:115], a[72:75], v[92:95]
ds_read_b128 v[112:115], v1 offset:24576
v_mfma_f32_16x16x32_bf16 v[92:95], v[116:119], a[76:79], v[92:95]
ds_read_b128 v[116:119], v1 offset:25600
s_waitcnt lgkmcnt(4)
v_mfma_f32_16x16x32_bf16 v[96:99], v[120:123], a[64:67], v[96:99]
s_add_u32 m0, s25, 131072
s_add_u32 s30, s22, 229376
v_mfma_f32_16x16x32_bf16 v[96:99], v[124:127], a[68:71], v[96:99]
buffer_load_dwordx4 v1, s[4:7], s30 offen sc1 lds
v_mfma_f32_16x16x32_bf16 v[104:107], v[120:123], a[72:75], v[104:107]
ds_read_b128 v[120:123], v1 offset:26624
v_mfma_f32_16x16x32_bf16 v[104:107], v[124:127], a[76:79], v[104:107]
ds_read_b128 v[124:127], v1 offset:27648
s_waitcnt lgkmcnt(4)
v_mfma_f32_16x16x32_bf16 v[100:103], v[128:131], a[64:67], v[100:103]
buffer_load_dwordx4 v1, s[4:7], s30 offen offset:1024 sc1 lds
v_mfma_f32_16x16x32_bf16 v[100:103], v[132:135], a[68:71], v[100:103]
v_rcp_f32 v147, v147
v_mfma_f32_16x16x32_bf16 v[108:111], v[128:131], a[72:75], v[108:111]
ds_read_b128 v[128:131], v1 offset:28672
v_mul_f32 v48, v48, v144
v_mul_f32 v49, v49, v145
v_mfma_f32_16x16x32_bf16 v[108:111], v[132:135], a[76:79], v[108:111]
ds_read_b128 v[132:135], v1 offset:29696
v_mul_f32 v50, v50, v146
v_mul_f32 v51, v51, v147
s_waitcnt lgkmcnt(4)
v_mfma_f32_16x16x32_bf16 v[80:83], v[112:115], a[80:83], v[80:83]
buffer_load_dwordx4 v1, s[4:7], s30 offen offset:2048 sc1 lds
v_cvt_pk_bf16_f32 v136, v48, v49
v_cvt_pk_bf16_f32 v137, v50, v51
v_mfma_f32_16x16x32_bf16 v[80:83], v[116:119], a[84:87], v[80:83]
v_mul_f32 v144, v52, v52
v_mul_f32 v145, v53, v53
v_mfma_f32_16x16x32_bf16 v[88:91], v[112:115], a[88:91], v[88:91]
ds_read_b128 v[112:115], v1 offset:30720
v_mul_f32 v146, v54, v54
v_mul_f32 v147, v55, v55
v_mfma_f32_16x16x32_bf16 v[88:91], v[116:119], a[92:95], v[88:91]
ds_read_b128 v[116:119], v1 offset:31744
v_fma_f32 v144, v144, v45, v44
v_fma_f32 v145, v145, v45, v44
s_waitcnt lgkmcnt(4)
v_mfma_f32_16x16x32_bf16 v[84:87], v[120:123], a[80:83], v[84:87]
buffer_load_dwordx4 v1, s[4:7], s30 offen offset:3072 sc1 lds
v_fma_f32 v146, v146, v45, v44
v_fma_f32 v147, v147, v45, v44
v_mfma_f32_16x16x32_bf16 v[84:87], v[124:127], a[84:87], v[84:87]
v_mul_f32 v144, v144, v52
v_mul_f32 v145, v145, v53
v_mfma_f32_16x16x32_bf16 v[92:95], v[120:123], a[88:91], v[92:95]
ds_read_b128 v[120:123], v1 offset:32768
PG_s14:
s_cbranch_execz PG_b4
v_mul_f32 v146, v146, v54
v_mul_f32 v147, v147, v55
v_mfma_f32_16x16x32_bf16 v[92:95], v[124:127], a[92:95], v[92:95]
ds_read_b128 v[124:127], v1 offset:33792
v_exp_f32 v144, v144
s_waitcnt lgkmcnt(4)
v_mfma_f32_16x16x32_bf16 v[96:99], v[128:131], a[80:83], v[96:99]
v_exp_f32 v145, v145
v_mfma_f32_16x16x32_bf16 v[96:99], v[132:135], a[84:87], v[96:99]
v_exp_f32 v146, v146
v_mfma_f32_16x16x32_bf16 v[104:107], v[128:131], a[88:91], v[104:107]
ds_read_b128 v[128:131], v1 offset:34816
v_exp_f32 v147, v147
v_mfma_f32_16x16x32_bf16 v[104:107], v[132:135], a[92:95], v[104:107]
ds_read_b128 v[132:135], v1 offset:35840
v_mul_f32 v52, v52, v68
v_mul_f32 v53, v53, v69
s_waitcnt lgkmcnt(4)
v_mfma_f32_16x16x32_bf16 v[100:103], v[112:115], a[80:83], v[100:103]
buffer_load_dwordx4 v[160:163], v1, s[4:7], s77 offen offset:2048 sc1
v_mul_f32 v54, v54, v70
v_mul_f32 v55, v55, v71
v_mfma_f32_16x16x32_bf16 v[100:103], v[116:119], a[84:87], v[100:103]
v_fma_f32 v144, v144, v46, v46
v_fma_f32 v145, v145, v46, v46
v_mfma_f32_16x16x32_bf16 v[108:111], v[112:115], a[88:91], v[108:111]
ds_read_b128 v[112:115], v1 offset:36864
v_fma_f32 v146, v146, v46, v46
v_fma_f32 v147, v147, v46, v46
v_mfma_f32_16x16x32_bf16 v[108:111], v[116:119], a[92:95], v[108:111]
ds_read_b128 v[116:119], v1 offset:37888
v_rcp_f32 v144, v144
s_waitcnt lgkmcnt(4)
v_mfma_f32_16x16x32_bf16 v[80:83], v[120:123], a[96:99], v[80:83]
buffer_load_dwordx4 v[164:167], v1, s[4:7], s77 offen offset:3072 sc1
v_rcp_f32 v145, v145
v_mfma_f32_16x16x32_bf16 v[80:83], v[124:127], a[100:103], v[80:83]
v_rcp_f32 v146, v146
v_mfma_f32_16x16x32_bf16 v[88:91], v[120:123], a[200:203], v[88:91]
ds_read_b128 v[120:123], v1 offset:38912
v_rcp_f32 v147, v147
v_mfma_f32_16x16x32_bf16 v[88:91], v[124:127], a[204:207], v[88:91]
ds_read_b128 v[124:127], v1 offset:39936
v_mul_f32 v52, v52, v144
v_mul_f32 v53, v53, v145
s_waitcnt lgkmcnt(4)
v_mfma_f32_16x16x32_bf16 v[84:87], v[128:131], a[96:99], v[84:87]
s_add_u32 s77, s77, 4096
v_mul_f32 v54, v54, v146
v_mul_f32 v55, v55, v147
v_mfma_f32_16x16x32_bf16 v[84:87], v[132:135], a[100:103], v[84:87]
buffer_load_dwordx4 v[168:171], v1, s[4:7], s77 offen offset:0 sc1
v_cvt_pk_bf16_f32 v138, v52, v53
v_cvt_pk_bf16_f32 v139, v54, v55
v_mfma_f32_16x16x32_bf16 v[92:95], v[128:131], a[200:203], v[92:95]
ds_read_b128 v[128:131], v1 offset:40960
v_mul_f32 v144, v56, v56
v_mul_f32 v145, v57, v57
v_mfma_f32_16x16x32_bf16 v[92:95], v[132:135], a[204:207], v[92:95]
ds_read_b128 v[132:135], v1 offset:41984
v_mul_f32 v146, v58, v58
v_mul_f32 v147, v59, v59
s_waitcnt lgkmcnt(4)
v_mfma_f32_16x16x32_bf16 v[96:99], v[112:115], a[96:99], v[96:99]
buffer_store_dwordx4 v[136:139], v4, s[4:7], s74 offen sc1
v_fma_f32 v144, v144, v249, v248
v_fma_f32 v145, v145, v249, v248
v_mfma_f32_16x16x32_bf16 v[96:99], v[116:119], a[100:103], v[96:99]
buffer_load_dwordx4 v[172:175], v1, s[4:7], s77 offen offset:1024 sc1
v_fma_f32 v146, v146, v249, v248
v_fma_f32 v147, v147, v249, v248
v_mfma_f32_16x16x32_bf16 v[104:107], v[112:115], a[200:203], v[104:107]
ds_read_b128 v[112:115], v1 offset:43008
v_mul_f32 v144, v144, v56
v_mul_f32 v145, v145, v57
v_mfma_f32_16x16x32_bf16 v[104:107], v[116:119], a[204:207], v[104:107]
ds_read_b128 v[116:119], v1 offset:44032
v_mul_f32 v146, v146, v58
v_mul_f32 v147, v147, v59
s_waitcnt lgkmcnt(4)
v_mfma_f32_16x16x32_bf16 v[100:103], v[120:123], a[96:99], v[100:103]
buffer_load_dwordx4 a[136:139], v1, s[4:7], s31 offen offset:2048 sc1
v_exp_f32 v144, v144
v_mfma_f32_16x16x32_bf16 v[100:103], v[124:127], a[100:103], v[100:103]
v_exp_f32 v145, v145
v_mfma_f32_16x16x32_bf16 v[108:111], v[120:123], a[200:203], v[108:111]
ds_read_b128 v[120:123], v1 offset:45056
v_exp_f32 v146, v146
v_mfma_f32_16x16x32_bf16 v[108:111], v[124:127], a[204:207], v[108:111]
ds_read_b128 v[124:127], v1 offset:46080
v_exp_f32 v147, v147
s_waitcnt lgkmcnt(4)
v_mfma_f32_16x16x32_bf16 v[80:83], v[128:131], a[208:211], v[80:83]
buffer_load_dwordx4 a[140:143], v1, s[4:7], s31 offen offset:3072 sc1
v_mul_f32 v56, v56, v72
v_mul_f32 v57, v57, v73
v_mfma_f32_16x16x32_bf16 v[80:83], v[132:135], a[212:215], v[80:83]
v_mul_f32 v58, v58, v74
v_mul_f32 v59, v59, v75
v_mfma_f32_16x16x32_bf16 v[88:91], v[128:131], a[216:219], v[88:91]
ds_read_b128 v[128:131], v1 offset:47104
v_fma_f32 v144, v144, v254, v254
v_fma_f32 v145, v145, v254, v254
v_mfma_f32_16x16x32_bf16 v[88:91], v[132:135], a[220:223], v[88:91]
ds_read_b128 v[132:135], v1 offset:48128
v_fma_f32 v146, v146, v254, v254
v_fma_f32 v147, v147, v254, v254
s_waitcnt lgkmcnt(4)
v_mfma_f32_16x16x32_bf16 v[84:87], v[112:115], a[208:211], v[84:87]
v_rcp_f32 v144, v144
v_mfma_f32_16x16x32_bf16 v[84:87], v[116:119], a[212:215], v[84:87]
v_rcp_f32 v145, v145
v_mfma_f32_16x16x32_bf16 v[92:95], v[112:115], a[216:219], v[92:95]
ds_read_b128 v[112:115], v1 offset:49152
v_rcp_f32 v146, v146
v_mfma_f32_16x16x32_bf16 v[92:95], v[116:119], a[220:223], v[92:95]
ds_read_b128 v[116:119], v1 offset:50176
v_rcp_f32 v147, v147
s_waitcnt lgkmcnt(4)
v_mfma_f32_16x16x32_bf16 v[96:99], v[120:123], a[208:211], v[96:99]
s_add_u32 s31, s24, 24576
buffer_load_dwordx4 a[144:147], v1, s[4:7], s31 offen offset:0 sc1
v_mul_f32 v56, v56, v144
v_mul_f32 v57, v57, v145
v_mfma_f32_16x16x32_bf16 v[96:99], v[124:127], a[212:215], v[96:99]
v_mul_f32 v58, v58, v146
v_mul_f32 v59, v59, v147
v_mfma_f32_16x16x32_bf16 v[104:107], v[120:123], a[216:219], v[104:107]
ds_read_b128 v[120:123], v1 offset:51200
v_cvt_pk_bf16_f32 v140, v56, v57
v_cvt_pk_bf16_f32 v141, v58, v59
v_mfma_f32_16x16x32_bf16 v[104:107], v[124:127], a[220:223], v[104:107]
ds_read_b128 v[124:127], v1 offset:52224
v_mul_f32 v144, v60, v60
v_mul_f32 v145, v61, v61
s_waitcnt lgkmcnt(4)
v_mfma_f32_16x16x32_bf16 v[100:103], v[128:131], a[208:211], v[100:103]
buffer_load_dwordx4 a[148:151], v1, s[4:7], s31 offen offset:1024 sc1
v_mul_f32 v146, v62, v62
v_mul_f32 v147, v63, v63
v_mfma_f32_16x16x32_bf16 v[100:103], v[132:135], a[212:215], v[100:103]
v_fma_f32 v144, v144, v249, v248
v_fma_f32 v145, v145, v249, v248
v_mfma_f32_16x16x32_bf16 v[108:111], v[128:131], a[216:219], v[108:111]
ds_read_b128 v[128:131], v1 offset:53248
v_fma_f32 v146, v146, v249, v248
v_fma_f32 v147, v147, v249, v248
v_mfma_f32_16x16x32_bf16 v[108:111], v[132:135], a[220:223], v[108:111]
ds_read_b128 v[132:135], v1 offset:54272
v_mul_f32 v144, v144, v60
v_mul_f32 v145, v145, v61
s_waitcnt lgkmcnt(4)
v_mfma_f32_16x16x32_bf16 v[80:83], v[112:115], a[224:227], v[80:83]
buffer_load_dwordx4 a[152:155], v1, s[4:7], s31 offen offset:2048 sc1
v_mul_f32 v146, v146, v62
v_mul_f32 v147, v147, v63
v_mfma_f32_16x16x32_bf16 v[80:83], v[116:119], a[228:231], v[80:83]
v_exp_f32 v144, v144
v_mfma_f32_16x16x32_bf16 v[88:91], v[112:115], a[232:235], v[88:91]
ds_read_b128 v[112:115], v1 offset:55296
v_exp_f32 v145, v145
v_mfma_f32_16x16x32_bf16 v[88:91], v[116:119], a[236:239], v[88:91]
ds_read_b128 v[116:119], v1 offset:56320
v_exp_f32 v146, v146
s_waitcnt lgkmcnt(4)
v_mfma_f32_16x16x32_bf16 v[84:87], v[120:123], a[224:227], v[84:87]
buffer_load_dwordx4 a[156:159], v1, s[4:7], s31 offen offset:3072 sc1
v_exp_f32 v147, v147
v_mfma_f32_16x16x32_bf16 v[84:87], v[124:127], a[228:231], v[84:87]
v_mul_f32 v60, v60, v76
v_mul_f32 v61, v61, v77
v_mfma_f32_16x16x32_bf16 v[92:95], v[120:123], a[232:235], v[92:95]
ds_read_b128 v[120:123], v1 offset:57344
v_mul_f32 v62, v62, v78
v_mul_f32 v63, v63, v79
v_mfma_f32_16x16x32_bf16 v[92:95], v[124:127], a[236:239], v[92:95]
ds_read_b128 v[124:127], v1 offset:58368
v_fma_f32 v144, v144, v254, v254
v_fma_f32 v145, v145, v254, v254
s_waitcnt lgkmcnt(4)
v_mfma_f32_16x16x32_bf16 v[96:99], v[128:131], a[224:227], v[96:99]
s_add_u32 s31, s24, 28672
buffer_load_dwordx4 v[176:179], v1, s[4:7], s31 offen offset:0 sc1
v_fma_f32 v146, v146, v254, v254
v_fma_f32 v147, v147, v254, v254
v_mfma_f32_16x16x32_bf16 v[96:99], v[132:135], a[228:231], v[96:99]
v_rcp_f32 v144, v144
v_mfma_f32_16x16x32_bf16 v[104:107], v[128:131], a[232:235], v[104:107]
ds_read_b128 v[128:131], v1 offset:59392
v_rcp_f32 v145, v145
v_mfma_f32_16x16x32_bf16 v[104:107], v[132:135], a[236:239], v[104:107]
ds_read_b128 v[132:135], v1 offset:60416
v_rcp_f32 v146, v146
s_waitcnt lgkmcnt(4)
v_mfma_f32_16x16x32_bf16 v[100:103], v[112:115], a[224:227], v[100:103]
v_rcp_f32 v147, v147
v_mfma_f32_16x16x32_bf16 v[100:103], v[116:119], a[228:231], v[100:103]
v_mul_f32 v60, v60, v144
v_mul_f32 v61, v61, v145
v_mfma_f32_16x16x32_bf16 v[108:111], v[112:115], a[232:235], v[108:111]
ds_read_b128 v[112:115], v1 offset:61440
v_mul_f32 v62, v62, v146
v_mul_f32 v63, v63, v147
v_mfma_f32_16x16x32_bf16 v[108:111], v[116:119], a[236:239], v[108:111]
ds_read_b128 v[116:119], v1 offset:62464
v_cvt_pk_bf16_f32 v142, v60, v61
v_cvt_pk_bf16_f32 v143, v62, v63
s_waitcnt lgkmcnt(4)
v_mfma_f32_16x16x32_bf16 v[80:83], v[120:123], a[240:243], v[80:83]
buffer_load_dwordx4 v[180:183], v1, s[4:7], s31 offen offset:1024 sc1
v_mfma_f32_16x16x32_bf16 v[80:83], v[124:127], a[244:247], v[80:83]
buffer_store_dwordx4 v[140:143], v4, s[4:7], s74 offen offset:256 sc1
v_mfma_f32_16x16x32_bf16 v[88:91], v[120:123], a[248:251], v[88:91]
ds_read_b128 v[120:123], v1 offset:63488
v_mfma_f32_16x16x32_bf16 v[88:91], v[124:127], a[252:255], v[88:91]
ds_read_b128 v[124:127], v1 offset:64512
s_waitcnt vmcnt(14)
s_barrier
s_waitcnt lgkmcnt(4)
v_mfma_f32_16x16x32_bf16 v[84:87], v[128:131], a[240:243], v[84:87]
buffer_load_dwordx4 v[184:187], v1, s[4:7], s31 offen offset:2048 sc1
v_mfma_f32_16x16x32_bf16 v[84:87], v[132:135], a[244:247], v[84:87]
v_mfma_f32_16x16x32_bf16 v[92:95], v[128:131], a[248:251], v[92:95]
ds_read_b128 v[128:131], v2 offset:0
v_mfma_f32_16x16x32_bf16 v[92:95], v[132:135], a[252:255], v[92:95]
ds_read_b128 v[132:135], v2 offset:1024
s_waitcnt lgkmcnt(4)
v_mfma_f32_16x16x32_bf16 v[96:99], v[112:115], a[240:243], v[96:99]
buffer_load_dwordx4 a[160:163], v1, s[4:7], s31 offen offset:3072 sc1
v_mfma_f32_16x16x32_bf16 v[96:99], v[116:119], a[244:247], v[96:99]
v_mfma_f32_16x16x32_bf16 v[104:107], v[112:115], a[248:251], v[104:107]
ds_read_b128 v[112:115], v2 offset:2048
v_mfma_f32_16x16x32_bf16 v[104:107], v[116:119], a[252:255], v[104:107]
ds_read_b128 v[116:119], v2 offset:3072
s_waitcnt lgkmcnt(4)
v_mfma_f32_16x16x32_bf16 v[100:103], v[120:123], a[240:243], v[100:103]
s_add_u32 s31, s24, 32768
buffer_load_dwordx4 a[164:167], v1, s[4:7], s31 offen offset:0 sc1
v_mfma_f32_16x16x32_bf16 v[100:103], v[124:127], a[244:247], v[100:103]
v_mfma_f32_16x16x32_bf16 v[108:111], v[120:123], a[248:251], v[108:111]
ds_read_b128 v[120:123], v2 offset:4096
v_mfma_f32_16x16x32_bf16 v[108:111], v[124:127], a[252:255], v[108:111]
ds_read_b128 v[124:127], v2 offset:5120
s_waitcnt vmcnt(16)
v_mfma_f32_16x16x16_bf16 v[80:83], v[160:161], v[40:41], v[80:83]
v_mfma_f32_16x16x16_bf16 v[88:91], v[160:161], v[42:43], v[88:91]
v_mfma_f32_16x16x16_bf16 v[84:87], v[162:163], v[40:41], v[84:87]
v_mfma_f32_16x16x16_bf16 v[92:95], v[162:163], v[42:43], v[92:95]
s_waitcnt vmcnt(15)
v_mfma_f32_16x16x16_bf16 v[96:99], v[164:165], v[40:41], v[96:99]
v_mfma_f32_16x16x16_bf16 v[104:107], v[164:165], v[42:43], v[104:107]
v_mfma_f32_16x16x16_bf16 v[100:103], v[166:167], v[40:41], v[100:103]
v_mfma_f32_16x16x16_bf16 v[108:111], v[166:167], v[42:43], v[108:111]
s_waitcnt lgkmcnt(4)
v_mfma_f32_16x16x32_bf16 v[48:51], v[128:131], a[0:3], 0
v_mfma_f32_16x16x32_bf16 v[48:51], v[132:135], a[4:7], v[48:51]
v_mfma_f32_16x16x32_bf16 v[56:59], v[128:131], a[8:11], 0
ds_read_b128 v[128:131], v2 offset:6144
v_mfma_f32_16x16x32_bf16 v[56:59], v[132:135], a[12:15], v[56:59]
ds_read_b128 v[132:135], v2 offset:7168
s_waitcnt lgkmcnt(4)
v_mfma_f32_16x16x32_bf16 v[52:55], v[112:115], a[0:3], 0
v_mul_f32 v144, v80, v80
v_mul_f32 v145, v81, v81
v_mfma_f32_16x16x32_bf16 v[52:55], v[116:119], a[4:7], v[52:55]
s_add_u32 s74, s17, 1
s_and_b32 s74, s74, 3
s_lshl_b32 s74, s74, 11
v_mfma_f32_16x16x32_bf16 v[60:63], v[112:115], a[8:11], 0
ds_read_b128 v[112:115], v2 offset:8192
v_mul_f32 v146, v82, v82
v_mfma_f32_16x16x32_bf16 v[60:63], v[116:119], a[12:15], v[60:63]
ds_read_b128 v[116:119], v2 offset:9216
s_waitcnt lgkmcnt(4)
v_mfma_f32_16x16x32_bf16 v[64:67], v[120:123], a[0:3], 0
s_and_b32 s75, s29, 0xffffe000
s_add_u32 s74, s74, s75
v_mfma_f32_16x16x32_bf16 v[64:67], v[124:127], a[4:7], v[64:67]
buffer_load_dwordx4 a[168:171], v1, s[4:7], s31 offen offset:1024 sc1
v_mfma_f32_16x16x32_bf16 v[72:75], v[120:123], a[8:11], 0
ds_read_b128 v[120:123], v2 offset:10240
v_mul_f32 v147, v83, v83
v_mfma_f32_16x16x32_bf16 v[72:75], v[124:127], a[12:15], v[72:75]
ds_read_b128 v[124:127], v2 offset:11264
s_waitcnt lgkmcnt(4)
v_mfma_f32_16x16x32_bf16 v[68:71], v[128:131], a[0:3], 0
buffer_load_dwordx4 a[172:175], v1, s[4:7], s31 offen offset:2048 sc1
v_mfma_f32_16x16x32_bf16 v[68:71], v[132:135], a[4:7], v[68:71]
v_fma_f32 v144, v144, v45, v44
v_fma_f32 v145, v145, v45, v44
v_mfma_f32_16x16x32_bf16 v[76:79], v[128:131], a[8:11], 0
ds_read_b128 v[128:131], v2 offset:12288
v_fma_f32 v146, v146, v45, v44
v_mfma_f32_16x16x32_bf16 v[76:79], v[132:135], a[12:15], v[76:79]
ds_read_b128 v[132:135], v2 offset:13312
s_waitcnt lgkmcnt(4)
v_mfma_f32_16x16x32_bf16 v[48:51], v[112:115], a[16:19], v[48:51]
buffer_load_dwordx4 a[176:179], v1, s[4:7], s31 offen offset:3072 sc1
v_mfma_f32_16x16x32_bf16 v[48:51], v[116:119], a[20:23], v[48:51]
v_fma_f32 v147, v147, v45, v44
v_mul_f32 v144, v144, v80
v_mfma_f32_16x16x32_bf16 v[56:59], v[112:115], a[24:27], v[56:59]
ds_read_b128 v[112:115], v2 offset:14336
v_mul_f32 v145, v145, v81
v_mfma_f32_16x16x32_bf16 v[56:59], v[116:119], a[28:31], v[56:59]
ds_read_b128 v[116:119], v2 offset:15360
s_waitcnt lgkmcnt(4)
v_mfma_f32_16x16x32_bf16 v[52:55], v[120:123], a[16:19], v[52:55]
s_add_u32 s31, s24, 36864
buffer_load_dwordx4 a[180:183], v1, s[4:7], s31 offen offset:0 sc1
v_mfma_f32_16x16x32_bf16 v[52:55], v[124:127], a[20:23], v[52:55]
s_waitcnt vmcnt(7)
buffer_atomic_add v9, v8, s[4:7], s98 offen offset:2052 sc1
v_mfma_f32_16x16x32_bf16 v[60:63], v[120:123], a[24:27], v[60:63]
ds_read_b128 v[120:123], v2 offset:16384
v_mul_f32 v146, v146, v82
v_mfma_f32_16x16x32_bf16 v[60:63], v[124:127], a[28:31], v[60:63]
ds_read_b128 v[124:127], v2 offset:17408
s_waitcnt lgkmcnt(4)
v_mfma_f32_16x16x32_bf16 v[64:67], v[128:131], a[16:19], v[64:67]
buffer_load_dwordx4 a[184:187], v1, s[4:7], s31 offen offset:1024 sc1
v_mfma_f32_16x16x32_bf16 v[64:67], v[132:135], a[20:23], v[64:67]
v_mul_f32 v147, v147, v83
v_mfma_f32_16x16x32_bf16 v[72:75], v[128:131], a[24:27], v[72:75]
ds_read_b128 v[128:131], v2 offset:18432
v_mfma_f32_16x16x32_bf16 v[72:75], v[132:135], a[28:31], v[72:75]
ds_read_b128 v[132:135], v2 offset:19456
s_waitcnt lgkmcnt(4)
v_mfma_f32_16x16x32_bf16 v[68:71], v[112:115], a[16:19], v[68:71]
buffer_load_dwordx4 a[188:191], v1, s[4:7], s31 offen offset:2048 sc1
v_mfma_f32_16x16x32_bf16 v[68:71], v[116:119], a[20:23], v[68:71]
v_exp_f32 v144, v144
v_mfma_f32_16x16x32_bf16 v[76:79], v[112:115], a[24:27], v[76:79]
ds_read_b128 v[112:115], v2 offset:20480
v_mfma_f32_16x16x32_bf16 v[76:79], v[116:119], a[28:31], v[76:79]
ds_read_b128 v[116:119], v2 offset:21504
s_waitcnt lgkmcnt(4)
v_mfma_f32_16x16x32_bf16 v[48:51], v[120:123], a[32:35], v[48:51]
buffer_load_dwordx4 a[192:195], v1, s[4:7], s31 offen offset:3072 sc1
v_mfma_f32_16x16x32_bf16 v[48:51], v[124:127], a[36:39], v[48:51]
v_exp_f32 v145, v145
v_mfma_f32_16x16x32_bf16 v[56:59], v[120:123], a[40:43], v[56:59]
ds_read_b128 v[120:123], v2 offset:22528
v_mfma_f32_16x16x32_bf16 v[56:59], v[124:127], a[44:47], v[56:59]
ds_read_b128 v[124:127], v2 offset:23552
s_waitcnt lgkmcnt(4)
v_mfma_f32_16x16x32_bf16 v[52:55], v[128:131], a[32:35], v[52:55]
s_add_u32 s31, s24, 40960
buffer_load_dwordx4 a[196:199], v1, s[4:7], s31 offen offset:0 sc1
v_mfma_f32_16x16x32_bf16 v[52:55], v[132:135], a[36:39], v[52:55]
v_exp_f32 v146, v146
v_mfma_f32_16x16x32_bf16 v[60:63], v[128:131], a[40:43], v[60:63]
ds_read_b128 v[128:131], v2 offset:24576
v_mfma_f32_16x16x32_bf16 v[60:63], v[132:135], a[44:47], v[60:63]
ds_read_b128 v[132:135], v2 offset:25600
s_waitcnt lgkmcnt(4)
v_mfma_f32_16x16x32_bf16 v[64:67], v[112:115], a[32:35], v[64:67]
buffer_load_dwordx4 v[244:247], v1, s[4:7], s31 offen offset:1024 sc1
v_mfma_f32_16x16x32_bf16 v[64:67], v[116:119], a[36:39], v[64:67]
v_exp_f32 v147, v147
v_mfma_f32_16x16x32_bf16 v[72:75], v[112:115], a[40:43], v[72:75]
ds_read_b128 v[112:115], v2 offset:26624
v_mul_f32 v80, v80, v96
v_mfma_f32_16x16x32_bf16 v[72:75], v[116:119], a[44:47], v[72:75]
ds_read_b128 v[116:119], v2 offset:27648
s_waitcnt lgkmcnt(4)
v_mfma_f32_16x16x32_bf16 v[68:71], v[120:123], a[32:35], v[68:71]
buffer_load_dwordx4 a[0:3], v1, s[4:7], s31 offen offset:2048 sc1
v_mfma_f32_16x16x32_bf16 v[68:71], v[124:127], a[36:39], v[68:71]
v_mul_f32 v81, v81, v97
v_mul_f32 v82, v82, v98
v_mfma_f32_16x16x32_bf16 v[76:79], v[120:123], a[40:43], v[76:79]
ds_read_b128 v[120:123], v2 offset:28672
v_mul_f32 v83, v83, v99
v_mfma_f32_16x16x32_bf16 v[76:79], v[124:127], a[44:47], v[76:79]
ds_read_b128 v[124:127], v2 offset:29696
s_waitcnt lgkmcnt(4)
v_mfma_f32_16x16x32_bf16 v[48:51], v[128:131], a[48:51], v[48:51]
buffer_load_dwordx4 a[4:7], v1, s[4:7], s31 offen offset:3072 sc1
v_fma_f32 v144, v144, v46, v46
v_fma_f32 v145, v145, v46, v46
v_mfma_f32_16x16x32_bf16 v[48:51], v[132:135], a[52:55], v[48:51]
v_fma_f32 v146, v146, v46, v46
v_fma_f32 v147, v147, v46, v46
v_mfma_f32_16x16x32_bf16 v[56:59], v[128:131], a[56:59], v[56:59]
ds_read_b128 v[128:131], v2 offset:30720
v_rcp_f32 v144, v144
v_mfma_f32_16x16x32_bf16 v[56:59], v[132:135], a[60:63], v[56:59]
ds_read_b128 v[132:135], v2 offset:31744
v_rcp_f32 v145, v145
s_waitcnt lgkmcnt(4)
v_mfma_f32_16x16x32_bf16 v[52:55], v[112:115], a[48:51], v[52:55]
s_add_u32 s31, s24, 45056
buffer_load_dwordx4 a[8:11], v1, s[4:7], s31 offen offset:0 sc1
v_rcp_f32 v146, v146
v_mfma_f32_16x16x32_bf16 v[52:55], v[116:119], a[52:55], v[52:55]
v_rcp_f32 v147, v147
v_mfma_f32_16x16x32_bf16 v[60:63], v[112:115], a[56:59], v[60:63]
ds_read_b128 v[112:115], v2 offset:32768
v_mul_f32 v80, v80, v144
v_mul_f32 v81, v81, v145
v_mfma_f32_16x16x32_bf16 v[60:63], v[116:119], a[60:63], v[60:63]
ds_read_b128 v[116:119], v2 offset:33792
v_mul_f32 v82, v82, v146
v_mul_f32 v83, v83, v147
s_waitcnt lgkmcnt(4)
v_mfma_f32_16x16x32_bf16 v[64:67], v[120:123], a[48:51], v[64:67]
buffer_load_dwordx4 a[12:15], v1, s[4:7], s31 offen offset:1024 sc1
v_cvt_pk_bf16_f32 v136, v80, v81
v_cvt_pk_bf16_f32 v137, v82, v83
v_mfma_f32_16x16x32_bf16 v[64:67], v[124:127], a[52:55], v[64:67]
s_load_dword s15, s[4:5], s99 offset:2052 glc
v_mul_f32 v144, v84, v84
v_mul_f32 v145, v85, v85
v_mfma_f32_16x16x32_bf16 v[72:75], v[120:123], a[56:59], v[72:75]
ds_read_b128 v[120:123], v2 offset:34816
v_mul_f32 v146, v86, v86
v_mul_f32 v147, v87, v87
v_mfma_f32_16x16x32_bf16 v[72:75], v[124:127], a[60:63], v[72:75]
ds_read_b128 v[124:127], v2 offset:35840
v_fma_f32 v144, v144, v45, v44
v_fma_f32 v145, v145, v45, v44
s_waitcnt lgkmcnt(4)
v_mfma_f32_16x16x32_bf16 v[68:71], v[128:131], a[48:51], v[68:71]
buffer_load_dwordx4 a[16:19], v1, s[4:7], s31 offen offset:2048 sc1
v_fma_f32 v146, v146, v45, v44
v_fma_f32 v147, v147, v45, v44
v_mfma_f32_16x16x32_bf16 v[68:71], v[132:135], a[52:55], v[68:71]
v_mul_f32 v144, v144, v84
v_mul_f32 v145, v145, v85
v_mfma_f32_16x16x32_bf16 v[76:79], v[128:131], a[56:59], v[76:79]
ds_read_b128 v[128:131], v2 offset:36864
v_mul_f32 v146, v146, v86
v_mul_f32 v147, v147, v87
v_mfma_f32_16x16x32_bf16 v[76:79], v[132:135], a[60:63], v[76:79]
ds_read_b128 v[132:135], v2 offset:37888
v_exp_f32 v144, v144
s_waitcnt lgkmcnt(4)
v_mfma_f32_16x16x32_bf16 v[48:51], v[112:115], a[64:67], v[48:51]
buffer_load_dwordx4 a[20:23], v1, s[4:7], s31 offen offset:3072 sc1
v_exp_f32 v145, v145
v_mfma_f32_16x16x32_bf16 v[48:51], v[116:119], a[68:71], v[48:51]
v_exp_f32 v146, v146
v_mfma_f32_16x16x32_bf16 v[56:59], v[112:115], a[72:75], v[56:59]
ds_read_b128 v[112:115], v2 offset:38912
v_exp_f32 v147, v147
v_mfma_f32_16x16x32_bf16 v[56:59], v[116:119], a[76:79], v[56:59]
ds_read_b128 v[116:119], v2 offset:39936
v_mul_f32 v84, v84, v100
v_mul_f32 v85, v85, v101
s_waitcnt lgkmcnt(4)
v_mfma_f32_16x16x32_bf16 v[52:55], v[120:123], a[64:67], v[52:55]
s_add_u32 s31, s24, 49152
buffer_load_dwordx4 a[24:27], v1, s[4:7], s31 offen offset:0 sc1
v_mul_f32 v86, v86, v102
v_mul_f32 v87, v87, v103
v_mfma_f32_16x16x32_bf16 v[52:55], v[124:127], a[68:71], v[52:55]
v_fma_f32 v144, v144, v46, v46
v_fma_f32 v145, v145, v46, v46
v_mfma_f32_16x16x32_bf16 v[60:63], v[120:123], a[72:75], v[60:63]
ds_read_b128 v[120:123], v2 offset:40960
v_fma_f32 v146, v146, v46, v46
v_fma_f32 v147, v147, v46, v46
v_mfma_f32_16x16x32_bf16 v[60:63], v[124:127], a[76:79], v[60:63]
ds_read_b128 v[124:127], v2 offset:41984
v_rcp_f32 v144, v144
s_waitcnt lgkmcnt(4)
v_mfma_f32_16x16x32_bf16 v[64:67], v[128:131], a[64:67], v[64:67]
buffer_load_dwordx4 a[28:31], v1, s[4:7], s31 offen offset:1024 sc1
v_rcp_f32 v145, v145
v_mfma_f32_16x16x32_bf16 v[64:67], v[132:135], a[68:71], v[64:67]
v_rcp_f32 v146, v146
v_mfma_f32_16x16x32_bf16 v[72:75], v[128:131], a[72:75], v[72:75]
ds_read_b128 v[128:131], v2 offset:43008
v_rcp_f32 v147, v147
v_mfma_f32_16x16x32_bf16 v[72:75], v[132:135], a[76:79], v[72:75]
ds_read_b128 v[132:135], v2 offset:44032
v_mul_f32 v84, v84, v144
v_mul_f32 v85, v85, v145
s_waitcnt lgkmcnt(4)
v_mfma_f32_16x16x32_bf16 v[68:71], v[112:115], a[64:67], v[68:71]
buffer_load_dwordx4 a[32:35], v1, s[4:7], s31 offen offset:2048 sc1
v_mul_f32 v86, v86, v146
v_mul_f32 v87, v87, v147
v_mfma_f32_16x16x32_bf16 v[68:71], v[116:119], a[68:71], v[68:71]
v_cvt_pk_bf16_f32 v138, v84, v85
v_cvt_pk_bf16_f32 v139, v86, v87
v_mfma_f32_16x16x32_bf16 v[76:79], v[112:115], a[72:75], v[76:79]
ds_read_b128 v[112:115], v2 offset:45056
v_mul_f32 v144, v88, v88
v_mul_f32 v145, v89, v89
v_mfma_f32_16x16x32_bf16 v[76:79], v[116:119], a[76:79], v[76:79]
ds_read_b128 v[116:119], v2 offset:46080
v_mul_f32 v146, v90, v90
v_mul_f32 v147, v91, v91
s_waitcnt lgkmcnt(4)
v_mfma_f32_16x16x32_bf16 v[48:51], v[120:123], a[80:83], v[48:51]
buffer_store_dwordx4 v[136:139], v4, s[4:7], s74 offen sc1
v_fma_f32 v144, v144, v249, v248
v_fma_f32 v145, v145, v249, v248
v_mfma_f32_16x16x32_bf16 v[48:51], v[124:127], a[84:87], v[48:51]
buffer_load_dwordx4 a[36:39], v1, s[4:7], s31 offen offset:3072 sc1
v_fma_f32 v146, v146, v249, v248
v_fma_f32 v147, v147, v249, v248
v_mfma_f32_16x16x32_bf16 v[56:59], v[120:123], a[88:91], v[56:59]
ds_read_b128 v[120:123], v2 offset:47104
v_mul_f32 v144, v144, v88
v_mul_f32 v145, v145, v89
v_mfma_f32_16x16x32_bf16 v[56:59], v[124:127], a[92:95], v[56:59]
ds_read_b128 v[124:127], v2 offset:48128
v_mul_f32 v146, v146, v90
v_mul_f32 v147, v147, v91
s_waitcnt lgkmcnt(4)
v_mfma_f32_16x16x32_bf16 v[52:55], v[128:131], a[80:83], v[52:55]
s_add_u32 s31, s24, 53248
buffer_load_dwordx4 a[40:43], v1, s[4:7], s31 offen offset:0 sc1
v_exp_f32 v144, v144
v_mfma_f32_16x16x32_bf16 v[52:55], v[132:135], a[84:87], v[52:55]
v_exp_f32 v145, v145
v_mfma_f32_16x16x32_bf16 v[60:63], v[128:131], a[88:91], v[60:63]
ds_read_b128 v[128:131], v2 offset:49152
v_exp_f32 v146, v146
v_mfma_f32_16x16x32_bf16 v[60:63], v[132:135], a[92:95], v[60:63]
ds_read_b128 v[132:135], v2 offset:50176
v_exp_f32 v147, v147
s_waitcnt lgkmcnt(4)
v_mfma_f32_16x16x32_bf16 v[64:67], v[112:115], a[80:83], v[64:67]
v_mul_f32 v88, v88, v104
v_mul_f32 v89, v89, v105
v_mfma_f32_16x16x32_bf16 v[64:67], v[116:119], a[84:87], v[64:67]
v_mul_f32 v90, v90, v106
v_mul_f32 v91, v91, v107
v_mfma_f32_16x16x32_bf16 v[72:75], v[112:115], a[88:91], v[72:75]
ds_read_b128 v[112:115], v2 offset:51200
v_fma_f32 v144, v144, v254, v254
v_fma_f32 v145, v145, v254, v254
v_mfma_f32_16x16x32_bf16 v[72:75], v[116:119], a[92:95], v[72:75]
ds_read_b128 v[116:119], v2 offset:52224
v_fma_f32 v146, v146, v254, v254
v_fma_f32 v147, v147, v254, v254
s_waitcnt lgkmcnt(4)
v_mfma_f32_16x16x32_bf16 v[68:71], v[120:123], a[80:83], v[68:71]
v_rcp_f32 v144, v144
v_mfma_f32_16x16x32_bf16 v[68:71], v[124:127], a[84:87], v[68:71]
v_rcp_f32 v145, v145
v_mfma_f32_16x16x32_bf16 v[76:79], v[120:123], a[88:91], v[76:79]
ds_read_b128 v[120:123], v2 offset:53248
v_rcp_f32 v146, v146
v_mfma_f32_16x16x32_bf16 v[76:79], v[124:127], a[92:95], v[76:79]
ds_read_b128 v[124:127], v2 offset:54272
v_rcp_f32 v147, v147
s_waitcnt lgkmcnt(4)
v_mfma_f32_16x16x32_bf16 v[48:51], v[128:131], a[96:99], v[48:51]
v_mul_f32 v88, v88, v144
v_mul_f32 v89, v89, v145
v_mfma_f32_16x16x32_bf16 v[48:51], v[132:135], a[100:103], v[48:51]
v_mul_f32 v90, v90, v146
v_mul_f32 v91, v91, v147
s_waitcnt lgkmcnt(0)
s_cmp_ge_u32 s15, 8
s_cbranch_scc0 SP70
BK71:
v_mfma_f32_16x16x32_bf16 v[56:59], v[128:131], a[200:203], v[56:59]
ds_read_b128 v[128:131], v2 offset:55296
v_cvt_pk_bf16_f32 v140, v88, v89
v_cvt_pk_bf16_f32 v141, v90, v91
v_mfma_f32_16x16x32_bf16 v[56:59], v[132:135], a[204:207], v[56:59]
ds_read_b128 v[132:135], v2 offset:56320
v_mul_f32 v144, v92, v92
v_mul_f32 v145, v93, v93
v_mfma_f32_16x16x32_bf16 v[52:55], v[112:115], a[96:99], v[52:55]
s_add_u32 s78, s70, 0
v_mul_f32 v146, v94, v94
v_mul_f32 v147, v95, v95
v_mfma_f32_16x16x32_bf16 v[52:55], v[116:119], a[100:103], v[52:55]
buffer_load_dwordx4 a[44:47], v4, s[4:7], s78 offen sc1
v_fma_f32 v144, v144, v249, v248
v_fma_f32 v145, v145, v249, v248
v_mfma_f32_16x16x32_bf16 v[60:63], v[112:115], a[200:203], v[60:63]
ds_read_b128 v[112:115], v2 offset:57344
v_fma_f32 v146, v146, v249, v248
v_fma_f32 v147, v147, v249, v248
v_mfma_f32_16x16x32_bf16 v[60:63], v[116:119], a[204:207], v[60:63]
ds_read_b128 v[116:119], v2 offset:58368
v_mul_f32 v144, v144, v92
v_mul_f32 v145, v145, v93
v_mfma_f32_16x16x32_bf16 v[64:67], v[120:123], a[96:99], v[64:67]
s_add_u32 s78, s70, 18432
v_mul_f32 v146, v146, v94
v_mul_f32 v147, v147, v95
v_mfma_f32_16x16x32_bf16 v[64:67], v[124:127], a[100:103], v[64:67]
buffer_load_dwordx4 a[48:51], v4, s[4:7], s78 offen sc1
v_exp_f32 v144, v144
v_mfma_f32_16x16x32_bf16 v[72:75], v[120:123], a[200:203], v[72:75]
ds_read_b128 v[120:123], v2 offset:59392
v_exp_f32 v145, v145
v_mfma_f32_16x16x32_bf16 v[72:75], v[124:127], a[204:207], v[72:75]
ds_read_b128 v[124:127], v2 offset:60416
v_exp_f32 v146, v146
s_waitcnt lgkmcnt(4)
v_mfma_f32_16x16x32_bf16 v[68:71], v[128:131], a[96:99], v[68:71]
s_add_u32 s78, s71, 0
v_exp_f32 v147, v147
v_mfma_f32_16x16x32_bf16 v[68:71], v[132:135], a[100:103], v[68:71]
buffer_load_dwordx4 a[52:55], v4, s[4:7], s78 offen sc1
v_mul_f32 v92, v92, v108
v_mul_f32 v93, v93, v109
v_mfma_f32_16x16x32_bf16 v[76:79], v[128:131], a[200:203], v[76:79]
ds_read_b128 v[128:131], v2 offset:61440
v_mul_f32 v94, v94, v110
v_mul_f32 v95, v95, v111
v_mfma_f32_16x16x32_bf16 v[76:79], v[132:135], a[204:207], v[76:79]
ds_read_b128 v[132:135], v2 offset:62464
v_fma_f32 v144, v144, v254, v254
v_fma_f32 v145, v145, v254, v254
s_waitcnt lgkmcnt(4)
v_mfma_f32_16x16x32_bf16 v[48:51], v[112:115], a[208:211], v[48:51]
s_add_u32 s78, s71, 18432
v_fma_f32 v146, v146, v254, v254
v_fma_f32 v147, v147, v254, v254
v_mfma_f32_16x16x32_bf16 v[48:51], v[116:119], a[212:215], v[48:51]
PG_s15:
s_cbranch_execz PG_b4
buffer_load_dwordx4 a[56:59], v4, s[4:7], s78 offen sc1
v_rcp_f32 v144, v144
v_mfma_f32_16x16x32_bf16 v[56:59], v[112:115], a[216:219], v[56:59]
ds_read_b128 v[112:115], v2 offset:63488
v_rcp_f32 v145, v145
v_mfma_f32_16x16x32_bf16 v[56:59], v[116:119], a[220:223], v[56:59]
ds_read_b128 v[116:119], v2 offset:64512
v_rcp_f32 v146, v146
s_waitcnt lgkmcnt(4)
v_mfma_f32_16x16x32_bf16 v[52:55], v[120:123], a[208:211], v[52:55]
s_add_u32 s78, s72, 0
v_rcp_f32 v147, v147
v_mfma_f32_16x16x32_bf16 v[52:55], v[124:127], a[212:215], v[52:55]
buffer_load_dwordx4 a[60:63], v4, s[4:7], s78 offen sc1
v_mul_f32 v92, v92, v144
v_mul_f32 v93, v93, v145
v_mfma_f32_16x16x32_bf16 v[60:63], v[120:123], a[216:219], v[60:63]
ds_read_b128 v[120:123], v3 offset:0
v_mul_f32 v94, v94, v146
v_mul_f32 v95, v95, v147
v_mfma_f32_16x16x32_bf16 v[60:63], v[124:127], a[220:223], v[60:63]
ds_read_b128 v[124:127], v3 offset:1024
v_cvt_pk_bf16_f32 v142, v92, v93
v_cvt_pk_bf16_f32 v143, v94, v95
s_waitcnt lgkmcnt(4)
v_mfma_f32_16x16x32_bf16 v[64:67], v[128:131], a[208:211], v[64:67]
buffer_store_dwordx4 v[140:143], v4, s[4:7], s74 offen offset:256 sc1
v_mfma_f32_16x16x32_bf16 v[64:67], v[132:135], a[212:215], v[64:67]
v_mfma_f32_16x16x32_bf16 v[72:75], v[128:131], a[216:219], v[72:75]
ds_read_b128 v[128:131], v3 offset:2048
v_mfma_f32_16x16x32_bf16 v[72:75], v[132:135], a[220:223], v[72:75]
ds_read_b128 v[132:135], v3 offset:3072
s_waitcnt lgkmcnt(4)
v_mfma_f32_16x16x32_bf16 v[68:71], v[112:115], a[208:211], v[68:71]
s_add_u32 s78, s72, 18432
v_mfma_f32_16x16x32_bf16 v[68:71], v[116:119], a[212:215], v[68:71]
buffer_load_dwordx4 a[64:67], v4, s[4:7], s78 offen sc1
v_mfma_f32_16x16x32_bf16 v[76:79], v[112:115], a[216:219], v[76:79]
ds_read_b128 v[112:115], v3 offset:4096
v_mfma_f32_16x16x32_bf16 v[76:79], v[116:119], a[220:223], v[76:79]
ds_read_b128 v[116:119], v3 offset:5120
s_waitcnt lgkmcnt(4)
v_mfma_f32_16x16x32_bf16 v[48:51], v[120:123], a[224:227], v[48:51]
s_add_u32 s78, s73, 0
v_mfma_f32_16x16x32_bf16 v[48:51], v[124:127], a[228:231], v[48:51]
buffer_load_dwordx4 a[68:71], v4, s[4:7], s78 offen sc1
v_mfma_f32_16x16x32_bf16 v[56:59], v[120:123], a[232:235], v[56:59]
ds_read_b128 v[120:123], v3 offset:6144
v_mfma_f32_16x16x32_bf16 v[56:59], v[124:127], a[236:239], v[56:59]
ds_read_b128 v[124:127], v3 offset:7168
s_waitcnt lgkmcnt(4)
v_mfma_f32_16x16x32_bf16 v[52:55], v[128:131], a[224:227], v[52:55]
s_add_u32 s78, s73, 18432
v_mfma_f32_16x16x32_bf16 v[52:55], v[132:135], a[228:231], v[52:55]
buffer_load_dwordx4 a[72:75], v4, s[4:7], s78 offen sc1
v_mfma_f32_16x16x32_bf16 v[60:63], v[128:131], a[232:235], v[60:63]
ds_read_b128 v[128:131], v3 offset:8192
v_mfma_f32_16x16x32_bf16 v[60:63], v[132:135], a[236:239], v[60:63]
ds_read_b128 v[132:135], v3 offset:9216
s_waitcnt lgkmcnt(4)
v_mfma_f32_16x16x32_bf16 v[64:67], v[112:115], a[224:227], v[64:67]
s_add_u32 s78, s70, 36864
v_mfma_f32_16x16x32_bf16 v[64:67], v[116:119], a[228:231], v[64:67]
buffer_load_dwordx4 a[76:79], v4, s[4:7], s78 offen sc1
v_mfma_f32_16x16x32_bf16 v[72:75], v[112:115], a[232:235], v[72:75]
ds_read_b128 v[112:115], v3 offset:10240
v_mfma_f32_16x16x32_bf16 v[72:75], v[116:119], a[236:239], v[72:75]
ds_read_b128 v[116:119], v3 offset:11264
s_waitcnt lgkmcnt(4)
v_mfma_f32_16x16x32_bf16 v[68:71], v[120:123], a[224:227], v[68:71]
s_add_u32 s78, s70, 55296
v_mfma_f32_16x16x32_bf16 v[68:71], v[124:127], a[228:231], v[68:71]
buffer_load_dwordx4 a[80:83], v4, s[4:7], s78 offen sc1
v_mfma_f32_16x16x32_bf16 v[76:79], v[120:123], a[232:235], v[76:79]
ds_read_b128 v[120:123], v3 offset:12288
v_mfma_f32_16x16x32_bf16 v[76:79], v[124:127], a[236:239], v[76:79]
ds_read_b128 v[124:127], v3 offset:13312
s_waitcnt lgkmcnt(4)
v_mfma_f32_16x16x32_bf16 v[48:51], v[128:131], a[240:243], v[48:51]
s_add_u32 s78, s71, 36864
v_mfma_f32_16x16x32_bf16 v[48:51], v[132:135], a[244:247], v[48:51]
buffer_load_dwordx4 a[84:87], v4, s[4:7], s78 offen sc1
v_mfma_f32_16x16x32_bf16 v[56:59], v[128:131], a[248:251], v[56:59]
ds_read_b128 v[128:131], v3 offset:14336
v_mfma_f32_16x16x32_bf16 v[56:59], v[132:135], a[252:255], v[56:59]
ds_read_b128 v[132:135], v3 offset:15360
s_waitcnt lgkmcnt(4)
v_mfma_f32_16x16x32_bf16 v[52:55], v[112:115], a[240:243], v[52:55]
s_add_u32 s78, s71, 55296
v_mfma_f32_16x16x32_bf16 v[52:55], v[116:119], a[244:247], v[52:55]
buffer_load_dwordx4 a[88:91], v4, s[4:7], s78 offen sc1
v_mfma_f32_16x16x32_bf16 v[60:63], v[112:115], a[248:251], v[60:63]
v_mfma_f32_16x16x32_bf16 v[60:63], v[116:119], a[252:255], v[60:63]
s_waitcnt lgkmcnt(2)
v_mfma_f32_16x16x32_bf16 v[64:67], v[120:123], a[240:243], v[64:67]
s_add_u32 s78, s72, 36864
v_mfma_f32_16x16x32_bf16 v[64:67], v[124:127], a[244:247], v[64:67]
buffer_load_dwordx4 a[92:95], v4, s[4:7], s78 offen sc1
v_mfma_f32_16x16x32_bf16 v[72:75], v[120:123], a[248:251], v[72:75]
s_waitcnt vmcnt(8)
buffer_atomic_add v9, v8, s[4:7], s98 offen offset:3076 sc1
v_mfma_f32_16x16x32_bf16 v[72:75], v[124:127], a[252:255], v[72:75]
s_waitcnt lgkmcnt(0)
v_mfma_f32_16x16x32_bf16 v[68:71], v[128:131], a[240:243], v[68:71]
s_add_u32 s78, s72, 55296
v_mfma_f32_16x16x32_bf16 v[68:71], v[132:135], a[244:247], v[68:71]
buffer_load_dwordx4 a[96:99], v4, s[4:7], s78 offen sc1
v_mfma_f32_16x16x32_bf16 v[76:79], v[128:131], a[248:251], v[76:79]
v_mfma_f32_16x16x32_bf16 v[76:79], v[132:135], a[252:255], v[76:79]
v_mfma_f32_16x16x16_bf16 v[48:51], v[168:169], v[40:41], v[48:51]
s_add_u32 s78, s73, 36864
v_mfma_f32_16x16x16_bf16 v[56:59], v[168:169], v[42:43], v[56:59]
buffer_load_dwordx4 a[100:103], v4, s[4:7], s78 offen sc1
v_mfma_f32_16x16x16_bf16 v[52:55], v[170:171], v[40:41], v[52:55]
v_mfma_f32_16x16x16_bf16 v[60:63], v[170:171], v[42:43], v[60:63]
v_mfma_f32_16x16x16_bf16 v[64:67], v[172:173], v[40:41], v[64:67]
v_mfma_f32_16x16x16_bf16 v[72:75], v[172:173], v[42:43], v[72:75]
v_mfma_f32_16x16x16_bf16 v[68:71], v[174:175], v[40:41], v[68:71]
s_add_u32 s78, s73, 55296
v_mfma_f32_16x16x16_bf16 v[76:79], v[174:175], v[42:43], v[76:79]
buffer_load_dwordx4 a[200:203], v4, s[4:7], s78 offen sc1
s_add_u32 s74, s17, 2
s_and_b32 s74, s74, 3
s_lshl_b32 s74, s74, 11
s_and_b32 s75, s29, 0xffffe000
s_add_u32 s74, s74, s75
v_pk_mul_f32 v[144:145], v[48:49], v[48:49]
v_pk_mul_f32 v[146:147], v[50:51], v[50:51]
v_pk_mul_f32 v[148:149], v[52:53], v[52:53]
v_pk_mul_f32 v[150:151], v[54:55], v[54:55]
v_pk_fma_f32 v[144:145], v[144:145], v[44:45], v[44:45] op_sel:[0,1,0] op_sel_hi:[1,1,0]
v_pk_fma_f32 v[146:147], v[146:147], v[44:45], v[44:45] op_sel:[0,1,0] op_sel_hi:[1,1,0]
v_pk_fma_f32 v[148:149], v[148:149], v[44:45], v[44:45] op_sel:[0,1,0] op_sel_hi:[1,1,0]
buffer_load_dwordx4 a[204:207], v1, s[4:7], s31 offen offset:1024 sc1
v_pk_fma_f32 v[150:151], v[150:151], v[44:45], v[44:45] op_sel:[0,1,0] op_sel_hi:[1,1,0]
v_pk_mul_f32 v[144:145], v[144:145], v[48:49]
v_pk_mul_f32 v[146:147], v[146:147], v[50:51]
v_pk_mul_f32 v[148:149], v[148:149], v[52:53]
v_pk_mul_f32 v[150:151], v[150:151], v[54:55]
v_exp_f32 v144, v144
v_exp_f32 v145, v145
v_exp_f32 v146, v146
v_exp_f32 v147, v147
v_exp_f32 v148, v148
v_exp_f32 v149, v149
v_exp_f32 v150, v150
buffer_load_dwordx4 a[208:211], v1, s[4:7], s31 offen offset:2048 sc1
v_exp_f32 v151, v151
v_pk_mul_f32 v[48:49], v[48:49], v[64:65]
v_pk_mul_f32 v[50:51], v[50:51], v[66:67]
v_pk_mul_f32 v[52:53], v[52:53], v[68:69]
v_pk_mul_f32 v[54:55], v[54:55], v[70:71]
v_pk_fma_f32 v[144:145], v[144:145], v[46:47], v[46:47] op_sel_hi:[1,0,0]
v_pk_fma_f32 v[146:147], v[146:147], v[46:47], v[46:47] op_sel_hi:[1,0,0]
v_pk_fma_f32 v[148:149], v[148:149], v[46:47], v[46:47] op_sel_hi:[1,0,0]
v_pk_fma_f32 v[150:151], v[150:151], v[46:47], v[46:47] op_sel_hi:[1,0,0]
v_rcp_f32 v144, v144
v_rcp_f32 v145, v145
v_rcp_f32 v146, v146
buffer_load_dwordx4 a[212:215], v1, s[4:7], s31 offen offset:3072 sc1
v_rcp_f32 v147, v147
v_rcp_f32 v148, v148
v_rcp_f32 v149, v149
v_rcp_f32 v150, v150
v_rcp_f32 v151, v151
v_pk_mul_f32 v[48:49], v[48:49], v[144:145]
v_pk_mul_f32 v[50:51], v[50:51], v[146:147]
v_pk_mul_f32 v[52:53], v[52:53], v[148:149]
v_pk_mul_f32 v[54:55], v[54:55], v[150:151]
v_cvt_pk_bf16_f32 v136, v48, v49
v_cvt_pk_bf16_f32 v137, v50, v51
v_cvt_pk_bf16_f32 v138, v52, v53
v_cvt_pk_bf16_f32 v139, v54, v55
buffer_store_dwordx4 v[136:139], v4, s[4:7], s74 offen sc1
v_pk_mul_f32 v[144:145], v[56:57], v[56:57]
v_pk_mul_f32 v[146:147], v[58:59], v[58:59]
v_pk_mul_f32 v[148:149], v[60:61], v[60:61]
v_pk_mul_f32 v[150:151], v[62:63], v[62:63]
v_pk_fma_f32 v[144:145], v[144:145], v[248:249], v[248:249] op_sel:[0,1,0] op_sel_hi:[1,1,0]
v_pk_fma_f32 v[146:147], v[146:147], v[248:249], v[248:249] op_sel:[0,1,0] op_sel_hi:[1,1,0]
v_pk_fma_f32 v[148:149], v[148:149], v[248:249], v[248:249] op_sel:[0,1,0] op_sel_hi:[1,1,0]
v_pk_fma_f32 v[150:151], v[150:151], v[248:249], v[248:249] op_sel:[0,1,0] op_sel_hi:[1,1,0]
v_pk_mul_f32 v[144:145], v[144:145], v[56:57]
v_pk_mul_f32 v[146:147], v[146:147], v[58:59]
v_pk_mul_f32 v[148:149], v[148:149], v[60:61]
v_pk_mul_f32 v[150:151], v[150:151], v[62:63]
v_exp_f32 v144, v144
v_exp_f32 v145, v145
v_exp_f32 v146, v146
v_exp_f32 v147, v147
v_exp_f32 v148, v148
v_exp_f32 v149, v149
v_exp_f32 v150, v150
v_exp_f32 v151, v151
v_pk_mul_f32 v[56:57], v[56:57], v[72:73]
v_pk_mul_f32 v[58:59], v[58:59], v[74:75]
v_pk_mul_f32 v[60:61], v[60:61], v[76:77]
v_pk_mul_f32 v[62:63], v[62:63], v[78:79]
v_pk_fma_f32 v[144:145], v[144:145], v[254:255], v[254:255] op_sel_hi:[1,0,0]
v_pk_fma_f32 v[146:147], v[146:147], v[254:255], v[254:255] op_sel_hi:[1,0,0]
v_pk_fma_f32 v[148:149], v[148:149], v[254:255], v[254:255] op_sel_hi:[1,0,0]
v_pk_fma_f32 v[150:151], v[150:151], v[254:255], v[254:255] op_sel_hi:[1,0,0]
v_rcp_f32 v144, v144
v_rcp_f32 v145, v145
v_rcp_f32 v146, v146
v_rcp_f32 v147, v147
v_rcp_f32 v148, v148
v_rcp_f32 v149, v149
v_rcp_f32 v150, v150
v_rcp_f32 v151, v151
v_pk_mul_f32 v[56:57], v[56:57], v[144:145]
v_pk_mul_f32 v[58:59], v[58:59], v[146:147]
v_pk_mul_f32 v[60:61], v[60:61], v[148:149]
v_pk_mul_f32 v[62:63], v[62:63], v[150:151]
v_cvt_pk_bf16_f32 v140, v56, v57
v_cvt_pk_bf16_f32 v141, v58, v59
v_cvt_pk_bf16_f32 v142, v60, v61
v_cvt_pk_bf16_f32 v143, v62, v63
s_load_dword s15, s[4:5], s99 offset:3076 glc
buffer_store_dwordx4 v[140:143], v4, s[4:7], s74 offen offset:256 sc1
s_barrier
v_mfma_f32_16x16x32_bf16 v[48:51], v[216:219], a[44:47], 0
v_mfma_f32_16x16x32_bf16 v[48:51], v[236:239], a[48:51], v[48:51]
v_mfma_f32_16x16x32_bf16 v[52:55], v[220:223], a[44:47], 0
v_add_u32 v44, 0, v0
v_mul_u32_u24 v45, 6554, v44
v_mfma_f32_16x16x32_bf16 v[52:55], v[240:243], a[48:51], v[52:55]
v_mfma_f32_16x16x32_bf16 v[56:59], v[224:227], a[44:47], 0
v_mfma_f32_16x16x32_bf16 v[56:59], v[188:191], a[48:51], v[56:59]
v_lshrrev_b32 v45, 16, v45
v_mul_u32_u24 v45, 1120, v45
v_mfma_f32_16x16x32_bf16 v[60:63], v[228:231], a[44:47], 0
v_lshl_add_u32 v40, v44, 4, v45
v_add_u32 v44, 64, v0
v_mfma_f32_16x16x32_bf16 v[60:63], v[192:195], a[48:51], v[60:63]
v_mfma_f32_16x16x32_bf16 v[64:67], v[232:235], a[44:47], 0
v_mul_u32_u24 v45, 6554, v44
v_lshrrev_b32 v45, 16, v45
v_mfma_f32_16x16x32_bf16 v[64:67], v[196:199], a[48:51], v[64:67]
v_mfma_f32_16x16x32_bf16 v[68:71], v[216:219], a[52:55], 0
v_mul_u32_u24 v45, 1120, v45
v_lshl_add_u32 v41, v44, 4, v45
v_mfma_f32_16x16x32_bf16 v[68:71], v[236:239], a[56:59], v[68:71]
v_mfma_f32_16x16x32_bf16 v[72:75], v[220:223], a[52:55], 0
v_add_u32 v44, 128, v0
v_mul_u32_u24 v45, 6554, v44
v_mfma_f32_16x16x32_bf16 v[72:75], v[240:243], a[56:59], v[72:75]
v_mfma_f32_16x16x32_bf16 v[76:79], v[224:227], a[52:55], 0
v_mfma_f32_16x16x32_bf16 v[76:79], v[188:191], a[56:59], v[76:79]
v_lshrrev_b32 v45, 16, v45
v_mul_u32_u24 v45, 1120, v45
v_mfma_f32_16x16x32_bf16 v[80:83], v[228:231], a[52:55], 0
v_lshl_add_u32 v42, v44, 4, v45
v_lshrrev_b32 v44, 5, v0
v_mfma_f32_16x16x32_bf16 v[80:83], v[192:195], a[56:59], v[80:83]
v_mfma_f32_16x16x32_bf16 v[84:87], v[232:235], a[52:55], 0
v_lshl_add_u32 v42, v44, 28, v42
v_add_u32 v43, s25, v1
v_mfma_f32_16x16x32_bf16 v[84:87], v[196:199], a[56:59], v[84:87]
v_mfma_f32_16x16x32_bf16 v[88:91], v[216:219], a[60:63], 0
s_waitcnt vmcnt(16)
v_mfma_f32_16x16x32_bf16 v[88:91], v[236:239], a[64:67], v[88:91]
s_or_b32 s74, s16, s17
s_or_b32 s74, s74, s18
v_mfma_f32_16x16x32_bf16 v[92:95], v[220:223], a[60:63], 0
s_cmp_eq_u32 s74, 0
s_cselect_b32 s74, 0, 268435456
v_mfma_f32_16x16x32_bf16 v[92:95], v[240:243], a[64:67], v[92:95]
v_add_u32 v46, s74, v8
v_mov_b32 v18, s0
s_waitcnt lgkmcnt(0)
s_cmp_ge_u32 s15, 8
s_cbranch_scc0 SP72
BK73:
v_mfma_f32_16x16x32_bf16 v[96:99], v[224:227], a[60:63], 0
v_mfma_f32_16x16x32_bf16 v[96:99], v[188:191], a[64:67], v[96:99]
s_add_u32 s78, s70, 2048
v_mfma_f32_16x16x32_bf16 v[100:103], v[228:231], a[60:63], 0
buffer_load_dwordx4 a[216:219], v4, s[4:7], s78 offen sc1
v_mfma_f32_16x16x32_bf16 v[100:103], v[192:195], a[64:67], v[100:103]
s_mov_b32 s74, 983040
v_mfma_f32_16x16x32_bf16 v[104:107], v[232:235], a[60:63], 0
buffer_store_dword v18, v46, s[4:7], s74 offen sc1
v_mfma_f32_16x16x32_bf16 v[104:107], v[196:199], a[64:67], v[104:107]
s_waitcnt vmcnt(17)
v_mfma_f32_16x16x32_bf16 v[20:23], v[216:219], a[68:71], v[20:23]
s_add_u32 s78, s70, 20480
s_waitcnt vmcnt(16)
v_mfma_f32_16x16x32_bf16 v[20:23], v[236:239], a[72:75], v[20:23]
buffer_load_dwordx4 a[220:223], v4, s[4:7], s78 offen sc1
v_mfma_f32_16x16x32_bf16 v[24:27], v[220:223], a[68:71], v[24:27]
s_add_u32 s78, s71, 2048
v_mfma_f32_16x16x32_bf16 v[24:27], v[240:243], a[72:75], v[24:27]
buffer_load_dwordx4 a[224:227], v4, s[4:7], s78 offen sc1
v_mfma_f32_16x16x32_bf16 v[28:31], v[224:227], a[68:71], v[28:31]
v_mfma_f32_16x16x32_bf16 v[28:31], v[188:191], a[72:75], v[28:31]
v_mfma_f32_16x16x32_bf16 v[32:35], v[228:231], a[68:71], v[32:35]
s_add_u32 s78, s71, 20480
v_mfma_f32_16x16x32_bf16 v[32:35], v[192:195], a[72:75], v[32:35]
buffer_load_dwordx4 a[228:231], v4, s[4:7], s78 offen sc1
v_mfma_f32_16x16x32_bf16 v[36:39], v[232:235], a[68:71], v[36:39]
v_mfma_f32_16x16x32_bf16 v[36:39], v[196:199], a[72:75], v[36:39]
s_waitcnt vmcnt(18)
v_mfma_f32_16x16x32_bf16 v[48:51], v[200:203], a[76:79], v[48:51]
s_add_u32 s78, s72, 2048
s_waitcnt vmcnt(17)
v_mfma_f32_16x16x32_bf16 v[48:51], a[108:111], a[80:83], v[48:51]
buffer_load_dwordx4 a[232:235], v4, s[4:7], s78 offen sc1
v_mfma_f32_16x16x32_bf16 v[52:55], v[204:207], a[76:79], v[52:55]
s_waitcnt vmcnt(6)
buffer_atomic_add v9, v8, s[4:7], s98 offen offset:12 sc1
v_mfma_f32_16x16x32_bf16 v[52:55], a[112:115], a[80:83], v[52:55]
v_mfma_f32_16x16x32_bf16 v[56:59], v[208:211], a[76:79], v[56:59]
v_mfma_f32_16x16x32_bf16 v[56:59], a[116:119], a[80:83], v[56:59]
s_add_u32 s78, s72, 20480
v_mfma_f32_16x16x32_bf16 v[60:63], v[212:215], a[76:79], v[60:63]
buffer_load_dwordx4 a[236:239], v4, s[4:7], s78 offen sc1
v_mfma_f32_16x16x32_bf16 v[60:63], a[120:123], a[80:83], v[60:63]
v_mfma_f32_16x16x32_bf16 v[64:67], a[104:107], a[76:79], v[64:67]
s_add_u32 s78, s73, 2048
v_mfma_f32_16x16x32_bf16 v[64:67], a[124:127], a[80:83], v[64:67]
v_mfma_f32_16x16x32_bf16 v[68:71], v[200:203], a[84:87], v[68:71]
buffer_load_dwordx4 a[240:243], v4, s[4:7], s78 offen sc1
v_mfma_f32_16x16x32_bf16 v[68:71], a[108:111], a[88:91], v[68:71]
v_mfma_f32_16x16x32_bf16 v[72:75], v[204:207], a[84:87], v[72:75]
s_add_u32 s78, s73, 20480
v_mfma_f32_16x16x32_bf16 v[72:75], a[112:115], a[88:91], v[72:75]
buffer_load_dwordx4 a[244:247], v4, s[4:7], s78 offen sc1
v_mfma_f32_16x16x32_bf16 v[76:79], v[208:211], a[84:87], v[76:79]
v_mfma_f32_16x16x32_bf16 v[76:79], a[116:119], a[88:91], v[76:79]
v_mfma_f32_16x16x32_bf16 v[80:83], v[212:215], a[84:87], v[80:83]
s_add_u32 s78, s70, 38912
v_mfma_f32_16x16x32_bf16 v[80:83], a[120:123], a[88:91], v[80:83]
buffer_load_dwordx4 a[248:251], v4, s[4:7], s78 offen sc1
v_mfma_f32_16x16x32_bf16 v[84:87], a[104:107], a[84:87], v[84:87]
v_mfma_f32_16x16x32_bf16 v[84:87], a[124:127], a[88:91], v[84:87]
v_mfma_f32_16x16x32_bf16 v[88:91], v[200:203], a[92:95], v[88:91]
s_add_u32 s78, s70, 49152
v_mfma_f32_16x16x32_bf16 v[88:91], a[108:111], a[96:99], v[88:91]
buffer_load_dwordx4 a[252:255], v4, s[4:7], s78 offen sc1
v_mfma_f32_16x16x32_bf16 v[92:95], v[204:207], a[92:95], v[92:95]
v_mfma_f32_16x16x32_bf16 v[92:95], a[112:115], a[96:99], v[92:95]
v_mfma_f32_16x16x32_bf16 v[96:99], v[208:211], a[92:95], v[96:99]
v_mfma_f32_16x16x32_bf16 v[96:99], a[116:119], a[96:99], v[96:99]
s_add_u32 s78, s71, 38912
v_mfma_f32_16x16x32_bf16 v[100:103], v[212:215], a[92:95], v[100:103]
buffer_load_dwordx4 v[108:111], v4, s[4:7], s78 offen sc1
v_mfma_f32_16x16x32_bf16 v[100:103], a[120:123], a[96:99], v[100:103]
v_mfma_f32_16x16x32_bf16 v[104:107], a[104:107], a[92:95], v[104:107]
v_mfma_f32_16x16x32_bf16 v[104:107], a[124:127], a[96:99], v[104:107]
v_mfma_f32_16x16x32_bf16 v[20:23], v[200:203], a[100:103], v[20:23]
s_add_u32 s78, s71, 49152
v_mfma_f32_16x16x32_bf16 v[20:23], a[108:111], a[200:203], v[20:23]
buffer_load_dwordx4 v[112:115], v4, s[4:7], s78 offen sc1
v_mfma_f32_16x16x32_bf16 v[24:27], v[204:207], a[100:103], v[24:27]
v_mfma_f32_16x16x32_bf16 v[24:27], a[112:115], a[200:203], v[24:27]
s_add_u32 s78, s72, 38912
v_mfma_f32_16x16x32_bf16 v[28:31], v[208:211], a[100:103], v[28:31]
v_mfma_f32_16x16x32_bf16 v[28:31], a[116:119], a[200:203], v[28:31]
buffer_load_dwordx4 v[116:119], v4, s[4:7], s78 offen sc1
v_mfma_f32_16x16x32_bf16 v[32:35], v[212:215], a[100:103], v[32:35]
v_mfma_f32_16x16x32_bf16 v[32:35], a[120:123], a[200:203], v[32:35]
s_add_u32 s78, s72, 49152
v_mfma_f32_16x16x32_bf16 v[36:39], a[104:107], a[100:103], v[36:39]
buffer_load_dwordx4 v[120:123], v4, s[4:7], s78 offen sc1
v_mfma_f32_16x16x32_bf16 v[36:39], a[124:127], a[200:203], v[36:39]
s_waitcnt vmcnt(15)
v_mfma_f32_16x16x32_bf16 v[48:51], a[128:131], a[216:219], v[48:51]
s_waitcnt vmcnt(13)
v_mfma_f32_16x16x32_bf16 v[48:51], a[148:151], a[220:223], v[48:51]
s_add_u32 s78, s73, 38912
v_mfma_f32_16x16x32_bf16 v[52:55], a[132:135], a[216:219], v[52:55]
buffer_load_dwordx4 v[124:127], v4, s[4:7], s78 offen sc1
v_mfma_f32_16x16x32_bf16 v[52:55], a[152:155], a[220:223], v[52:55]
v_mfma_f32_16x16x32_bf16 v[56:59], a[136:139], a[216:219], v[56:59]
v_mfma_f32_16x16x32_bf16 v[56:59], a[156:159], a[220:223], v[56:59]
s_add_u32 s78, s73, 49152
v_mfma_f32_16x16x32_bf16 v[60:63], a[140:143], a[216:219], v[60:63]
buffer_load_dwordx4 v[128:131], v4, s[4:7], s78 offen sc1
v_mfma_f32_16x16x32_bf16 v[60:63], v[176:179], a[220:223], v[60:63]
v_mfma_f32_16x16x32_bf16 v[64:67], a[144:147], a[216:219], v[64:67]
s_load_dword s15, s[4:5], s99 offset:12 glc
v_mfma_f32_16x16x32_bf16 v[64:67], v[180:183], a[220:223], v[64:67]
s_waitcnt vmcnt(14)
v_mfma_f32_16x16x32_bf16 v[68:71], a[128:131], a[224:227], v[68:71]
s_add_u32 s31, s24, 57344
buffer_load_dwordx4 v[132:135], v1, s[4:7], s31 offen offset:0 sc1
s_waitcnt vmcnt(14)
v_mfma_f32_16x16x32_bf16 v[68:71], a[148:151], a[228:231], v[68:71]
v_mfma_f32_16x16x32_bf16 v[72:75], a[132:135], a[224:227], v[72:75]
v_mfma_f32_16x16x32_bf16 v[72:75], a[152:155], a[228:231], v[72:75]
buffer_load_dwordx4 v[144:147], v1, s[4:7], s31 offen offset:1024 sc1
v_mfma_f32_16x16x32_bf16 v[76:79], a[136:139], a[224:227], v[76:79]
v_mfma_f32_16x16x32_bf16 v[76:79], a[156:159], a[228:231], v[76:79]
v_mfma_f32_16x16x32_bf16 v[80:83], a[140:143], a[224:227], v[80:83]
v_mfma_f32_16x16x32_bf16 v[80:83], v[176:179], a[228:231], v[80:83]
buffer_load_dwordx4 v[148:151], v1, s[4:7], s31 offen offset:2048 sc1
v_mfma_f32_16x16x32_bf16 v[84:87], a[144:147], a[224:227], v[84:87]
v_mfma_f32_16x16x32_bf16 v[84:87], v[180:183], a[228:231], v[84:87]
s_waitcnt vmcnt(15)
v_mfma_f32_16x16x32_bf16 v[88:91], a[128:131], a[232:235], v[88:91]
s_waitcnt vmcnt(13)
v_mfma_f32_16x16x32_bf16 v[88:91], a[148:151], a[236:239], v[88:91]
buffer_load_dwordx4 v[152:155], v1, s[4:7], s31 offen offset:3072 sc1
v_mfma_f32_16x16x32_bf16 v[92:95], a[132:135], a[232:235], v[92:95]
v_mfma_f32_16x16x32_bf16 v[92:95], a[152:155], a[236:239], v[92:95]
v_mfma_f32_16x16x32_bf16 v[96:99], a[136:139], a[232:235], v[96:99]
v_mfma_f32_16x16x32_bf16 v[96:99], a[156:159], a[236:239], v[96:99]
v_mfma_f32_16x16x32_bf16 v[100:103], a[140:143], a[232:235], v[100:103]
v_mfma_f32_16x16x32_bf16 v[100:103], v[176:179], a[236:239], v[100:103]
v_mfma_f32_16x16x32_bf16 v[104:107], a[144:147], a[232:235], v[104:107]
v_mfma_f32_16x16x32_bf16 v[104:107], v[180:183], a[236:239], v[104:107]
s_waitcnt vmcnt(13)
v_mfma_f32_16x16x32_bf16 v[20:23], a[128:131], a[240:243], v[20:23]
s_waitcnt vmcnt(12)
v_mfma_f32_16x16x32_bf16 v[20:23], a[148:151], a[244:247], v[20:23]
v_mfma_f32_16x16x32_bf16 v[24:27], a[132:135], a[240:243], v[24:27]
v_mfma_f32_16x16x32_bf16 v[24:27], a[152:155], a[244:247], v[24:27]
s_waitcnt lgkmcnt(0)
s_cmp_ge_u32 s15, 8
s_cbranch_scc0 SP74
BK75:
v_mfma_f32_16x16x32_bf16 v[28:31], a[136:139], a[240:243], v[28:31]
v_mfma_f32_16x16x32_bf16 v[28:31], a[156:159], a[244:247], v[28:31]
s_add_u32 s78, s70, 4096
v_mfma_f32_16x16x32_bf16 v[32:35], a[140:143], a[240:243], v[32:35]
buffer_load_dwordx4 v[156:159], v4, s[4:7], s78 offen sc1
v_mfma_f32_16x16x32_bf16 v[32:35], v[176:179], a[244:247], v[32:35]
s_add_u32 s78, s70, 22528
v_mfma_f32_16x16x32_bf16 v[36:39], a[144:147], a[240:243], v[36:39]
buffer_load_dwordx4 v[160:163], v4, s[4:7], s78 offen sc1
v_mfma_f32_16x16x32_bf16 v[36:39], v[180:183], a[244:247], v[36:39]
s_waitcnt vmcnt(13)
v_mfma_f32_16x16x32_bf16 v[48:51], v[184:187], a[248:251], v[48:51]
s_add_u32 s78, s70, 32768
s_waitcnt vmcnt(12)
v_mfma_f32_16x16x32_bf16 v[48:51], a[176:179], a[252:255], v[48:51]
buffer_load_dwordx4 v[164:167], v4, s[4:7], s78 offen sc1
v_mfma_f32_16x16x32_bf16 v[52:55], a[160:163], a[248:251], v[52:55]
v_mfma_f32_16x16x32_bf16 v[52:55], a[180:183], a[252:255], v[52:55]
s_add_u32 s78, s70, 51200
v_mfma_f32_16x16x32_bf16 v[56:59], a[164:167], a[248:251], v[56:59]
v_mfma_f32_16x16x32_bf16 v[56:59], a[184:187], a[252:255], v[56:59]
buffer_load_dwordx4 v[168:171], v4, s[4:7], s78 offen sc1
v_mfma_f32_16x16x32_bf16 v[60:63], a[168:171], a[248:251], v[60:63]
v_mfma_f32_16x16x32_bf16 v[60:63], a[188:191], a[252:255], v[60:63]
s_add_u32 s78, s71, 4096
v_mfma_f32_16x16x32_bf16 v[64:67], a[172:175], a[248:251], v[64:67]
buffer_load_dwordx4 v[172:175], v4, s[4:7], s78 offen sc1
v_mfma_f32_16x16x32_bf16 v[64:67], a[192:195], a[252:255], v[64:67]
s_waitcnt vmcnt(14)
v_mfma_f32_16x16x32_bf16 v[68:71], v[184:187], v[108:111], v[68:71]
s_add_u32 s78, s71, 22528
s_waitcnt vmcnt(13)
v_mfma_f32_16x16x32_bf16 v[68:71], a[176:179], v[112:115], v[68:71]
buffer_load_dwordx4 a[44:47], v4, s[4:7], s78 offen sc1
v_mfma_f32_16x16x32_bf16 v[72:75], a[160:163], v[108:111], v[72:75]
v_mfma_f32_16x16x32_bf16 v[72:75], a[180:183], v[112:115], v[72:75]
s_add_u32 s78, s71, 32768
v_mfma_f32_16x16x32_bf16 v[76:79], a[164:167], v[108:111], v[76:79]
v_mfma_f32_16x16x32_bf16 v[76:79], a[184:187], v[112:115], v[76:79]
buffer_load_dwordx4 a[48:51], v4, s[4:7], s78 offen sc1
v_mfma_f32_16x16x32_bf16 v[80:83], a[168:171], v[108:111], v[80:83]
v_mfma_f32_16x16x32_bf16 v[80:83], a[188:191], v[112:115], v[80:83]
s_add_u32 s78, s71, 51200
v_mfma_f32_16x16x32_bf16 v[84:87], a[172:175], v[108:111], v[84:87]
buffer_load_dwordx4 a[52:55], v4, s[4:7], s78 offen sc1
v_mfma_f32_16x16x32_bf16 v[84:87], a[192:195], v[112:115], v[84:87]
s_waitcnt vmcnt(15)
v_mfma_f32_16x16x32_bf16 v[88:91], v[184:187], v[116:119], v[88:91]
s_add_u32 s78, s72, 4096
s_waitcnt vmcnt(14)
v_mfma_f32_16x16x32_bf16 v[88:91], a[176:179], v[120:123], v[88:91]
buffer_load_dwordx4 a[56:59], v4, s[4:7], s78 offen sc1
v_mfma_f32_16x16x32_bf16 v[92:95], a[160:163], v[116:119], v[92:95]
v_mfma_f32_16x16x32_bf16 v[92:95], a[180:183], v[120:123], v[92:95]
s_add_u32 s78, s72, 22528
v_mfma_f32_16x16x32_bf16 v[96:99], a[164:167], v[116:119], v[96:99]
v_mfma_f32_16x16x32_bf16 v[96:99], a[184:187], v[120:123], v[96:99]
buffer_load_dwordx4 a[60:63], v4, s[4:7], s78 offen sc1
v_mfma_f32_16x16x32_bf16 v[100:103], a[168:171], v[116:119], v[100:103]
v_mfma_f32_16x16x32_bf16 v[100:103], a[188:191], v[120:123], v[100:103]
s_add_u32 s78, s72, 32768
v_mfma_f32_16x16x32_bf16 v[104:107], a[172:175], v[116:119], v[104:107]
buffer_load_dwordx4 a[64:67], v4, s[4:7], s78 offen sc1
v_mfma_f32_16x16x32_bf16 v[104:107], a[192:195], v[120:123], v[104:107]
s_waitcnt vmcnt(16)
v_mfma_f32_16x16x32_bf16 v[20:23], v[184:187], v[124:127], v[20:23]
s_add_u32 s78, s72, 51200
s_waitcnt vmcnt(15)
v_mfma_f32_16x16x32_bf16 v[20:23], a[176:179], v[128:131], v[20:23]
buffer_load_dwordx4 a[68:71], v4, s[4:7], s78 offen sc1
v_mfma_f32_16x16x32_bf16 v[24:27], a[160:163], v[124:127], v[24:27]
v_mfma_f32_16x16x32_bf16 v[24:27], a[180:183], v[128:131], v[24:27]
s_add_u32 s78, s73, 4096
v_mfma_f32_16x16x32_bf16 v[28:31], a[164:167], v[124:127], v[28:31]
v_mfma_f32_16x16x32_bf16 v[28:31], a[184:187], v[128:131], v[28:31]
buffer_load_dwordx4 a[72:75], v4, s[4:7], s78 offen sc1
v_mfma_f32_16x16x32_bf16 v[32:35], a[168:171], v[124:127], v[32:35]
s_add_u32 s78, s73, 22528
v_mfma_f32_16x16x32_bf16 v[32:35], a[188:191], v[128:131], v[32:35]
buffer_load_dwordx4 a[76:79], v4, s[4:7], s78 offen sc1
v_mfma_f32_16x16x32_bf16 v[36:39], a[172:175], v[124:127], v[36:39]
v_mfma_f32_16x16x32_bf16 v[36:39], a[192:195], v[128:131], v[36:39]
s_add_u32 s78, s73, 32768
buffer_load_dwordx4 a[80:83], v4, s[4:7], s78 offen sc1
s_add_u32 s78, s73, 51200
buffer_load_dwordx4 a[84:87], v4, s[4:7], s78 offen sc1
v_add_u32 v232, 102400, v10
v_add_u32 v233, 102400, v11
v_add_u32 v234, 102400, v12
v_add_u32 v19, 102400, v13
s_waitcnt vmcnt(15)
v_mfma_f32_16x16x32_bf16 v[48:51], a[196:199], v[156:159], v[48:51]
s_waitcnt vmcnt(14)
v_mfma_f32_16x16x32_bf16 v[48:51], a[12:15], v[160:163], v[48:51]
s_waitcnt vmcnt(13)
v_mfma_f32_16x16x32_bf16 v[48:51], a[32:35], v[164:167], v[48:51]
s_waitcnt vmcnt(12)
v_mfma_f32_16x16x32_bf16 v[48:51], a[212:215], v[168:171], v[48:51]
v_mfma_f32_16x16x32_bf16 v[52:55], v[244:247], v[156:159], v[52:55]
v_mfma_f32_16x16x32_bf16 v[52:55], a[16:19], v[160:163], v[52:55]
v_mfma_f32_16x16x32_bf16 v[52:55], a[36:39], v[164:167], v[52:55]
v_mfma_f32_16x16x32_bf16 v[52:55], v[132:135], v[168:171], v[52:55]
v_mfma_f32_16x16x32_bf16 v[56:59], a[0:3], v[156:159], v[56:59]
s_nop 2
ds_write_b128 v232, v[48:51] offset:0
v_mfma_f32_16x16x32_bf16 v[56:59], a[20:23], v[160:163], v[56:59]
v_mfma_f32_16x16x32_bf16 v[56:59], a[40:43], v[164:167], v[56:59]
v_mfma_f32_16x16x32_bf16 v[56:59], v[144:147], v[168:171], v[56:59]
v_mfma_f32_16x16x32_bf16 v[60:63], a[4:7], v[156:159], v[60:63]
ds_write_b128 v232, v[52:55] offset:1024
v_mfma_f32_16x16x32_bf16 v[60:63], a[24:27], v[160:163], v[60:63]
v_mfma_f32_16x16x32_bf16 v[60:63], a[204:207], v[164:167], v[60:63]
v_mfma_f32_16x16x32_bf16 v[60:63], v[148:151], v[168:171], v[60:63]
v_mfma_f32_16x16x32_bf16 v[64:67], a[8:11], v[156:159], v[64:67]
s_nop 1
ds_write_b128 v232, v[56:59] offset:2048
v_mfma_f32_16x16x32_bf16 v[64:67], a[28:31], v[160:163], v[64:67]
v_mfma_f32_16x16x32_bf16 v[64:67], a[208:211], v[164:167], v[64:67]
v_mfma_f32_16x16x32_bf16 v[64:67], v[152:155], v[168:171], v[64:67]
s_waitcnt vmcnt(11)
v_mfma_f32_16x16x32_bf16 v[68:71], a[196:199], v[172:175], v[68:71]
ds_write_b128 v232, v[60:63] offset:3072
s_waitcnt vmcnt(10)
v_mfma_f32_16x16x32_bf16 v[68:71], a[12:15], a[44:47], v[68:71]
s_waitcnt vmcnt(9)
v_mfma_f32_16x16x32_bf16 v[68:71], a[32:35], a[48:51], v[68:71]
s_waitcnt vmcnt(8)
v_mfma_f32_16x16x32_bf16 v[68:71], a[212:215], a[52:55], v[68:71]
v_mfma_f32_16x16x32_bf16 v[72:75], v[244:247], v[172:175], v[72:75]
ds_write_b128 v232, v[64:67] offset:4096
v_mfma_f32_16x16x32_bf16 v[72:75], a[16:19], a[44:47], v[72:75]
v_mfma_f32_16x16x32_bf16 v[72:75], a[36:39], a[48:51], v[72:75]
v_mfma_f32_16x16x32_bf16 v[72:75], v[132:135], a[52:55], v[72:75]
v_mfma_f32_16x16x32_bf16 v[76:79], a[0:3], v[172:175], v[76:79]
s_nop 1
ds_write_b128 v233, v[68:71] offset:0
v_mfma_f32_16x16x32_bf16 v[76:79], a[20:23], a[44:47], v[76:79]
v_mfma_f32_16x16x32_bf16 v[76:79], a[40:43], a[48:51], v[76:79]
v_mfma_f32_16x16x32_bf16 v[76:79], v[144:147], a[52:55], v[76:79]
v_mfma_f32_16x16x32_bf16 v[80:83], a[4:7], v[172:175], v[80:83]
ds_write_b128 v233, v[72:75] offset:1024
v_mfma_f32_16x16x32_bf16 v[80:83], a[24:27], a[44:47], v[80:83]
v_mfma_f32_16x16x32_bf16 v[80:83], a[204:207], a[48:51], v[80:83]
PG_s16:
s_cbranch_execz PG_b4
v_mfma_f32_16x16x32_bf16 v[80:83], v[148:151], a[52:55], v[80:83]
v_mfma_f32_16x16x32_bf16 v[84:87], a[8:11], v[172:175], v[84:87]
s_nop 1
ds_write_b128 v233, v[76:79] offset:2048
v_mfma_f32_16x16x32_bf16 v[84:87], a[28:31], a[44:47], v[84:87]
v_mfma_f32_16x16x32_bf16 v[84:87], a[208:211], a[48:51], v[84:87]
v_mfma_f32_16x16x32_bf16 v[84:87], v[152:155], a[52:55], v[84:87]
s_waitcnt vmcnt(7)
v_mfma_f32_16x16x32_bf16 v[88:91], a[196:199], a[56:59], v[88:91]
ds_write_b128 v233, v[80:83] offset:3072
s_waitcnt vmcnt(6)
v_mfma_f32_16x16x32_bf16 v[88:91], a[12:15], a[60:63], v[88:91]
s_waitcnt vmcnt(5)
v_mfma_f32_16x16x32_bf16 v[88:91], a[32:35], a[64:67], v[88:91]
s_waitcnt vmcnt(4)
v_mfma_f32_16x16x32_bf16 v[88:91], a[212:215], a[68:71], v[88:91]
v_mfma_f32_16x16x32_bf16 v[92:95], v[244:247], a[56:59], v[92:95]
ds_write_b128 v233, v[84:87] offset:4096
v_mfma_f32_16x16x32_bf16 v[92:95], a[16:19], a[60:63], v[92:95]
v_mfma_f32_16x16x32_bf16 v[92:95], a[36:39], a[64:67], v[92:95]
v_mfma_f32_16x16x32_bf16 v[92:95], v[132:135], a[68:71], v[92:95]
v_mfma_f32_16x16x32_bf16 v[96:99], a[0:3], a[56:59], v[96:99]
s_nop 1
ds_write_b128 v234, v[88:91] offset:0
v_mfma_f32_16x16x32_bf16 v[96:99], a[20:23], a[60:63], v[96:99]
v_mfma_f32_16x16x32_bf16 v[96:99], a[40:43], a[64:67], v[96:99]
v_mfma_f32_16x16x32_bf16 v[96:99], v[144:147], a[68:71], v[96:99]
v_mfma_f32_16x16x32_bf16 v[100:103], a[4:7], a[56:59], v[100:103]
ds_write_b128 v234, v[92:95] offset:1024
v_mfma_f32_16x16x32_bf16 v[100:103], a[24:27], a[60:63], v[100:103]
v_mfma_f32_16x16x32_bf16 v[100:103], a[204:207], a[64:67], v[100:103]
v_mfma_f32_16x16x32_bf16 v[100:103], v[148:151], a[68:71], v[100:103]
v_mfma_f32_16x16x32_bf16 v[104:107], a[8:11], a[56:59], v[104:107]
s_nop 1
ds_write_b128 v234, v[96:99] offset:2048
v_mfma_f32_16x16x32_bf16 v[104:107], a[28:31], a[60:63], v[104:107]
v_mfma_f32_16x16x32_bf16 v[104:107], a[208:211], a[64:67], v[104:107]
v_mfma_f32_16x16x32_bf16 v[104:107], v[152:155], a[68:71], v[104:107]
s_waitcnt vmcnt(3)
v_mfma_f32_16x16x32_bf16 v[20:23], a[196:199], a[72:75], v[20:23]
ds_write_b128 v234, v[100:103] offset:3072
s_waitcnt vmcnt(2)
v_mfma_f32_16x16x32_bf16 v[20:23], a[12:15], a[76:79], v[20:23]
s_waitcnt vmcnt(1)
v_mfma_f32_16x16x32_bf16 v[20:23], a[32:35], a[80:83], v[20:23]
s_waitcnt vmcnt(0)
v_mfma_f32_16x16x32_bf16 v[20:23], a[212:215], a[84:87], v[20:23]
v_mfma_f32_16x16x32_bf16 v[24:27], v[244:247], a[72:75], v[24:27]
ds_write_b128 v234, v[104:107] offset:4096
v_mfma_f32_16x16x32_bf16 v[24:27], a[16:19], a[76:79], v[24:27]
v_mfma_f32_16x16x32_bf16 v[24:27], a[36:39], a[80:83], v[24:27]
s_waitcnt lgkmcnt(0)
s_barrier
v_mfma_f32_16x16x32_bf16 v[24:27], v[132:135], a[84:87], v[24:27]
ds_read_b128 v[176:179], v19 offset:0
ds_read_b128 v[196:199], v19 offset:5120
v_mfma_f32_16x16x32_bf16 v[28:31], a[0:3], a[72:75], v[28:31]
ds_read_b128 v[216:219], v19 offset:10240
ds_read_b128 v[180:183], v19 offset:1024
v_mfma_f32_16x16x32_bf16 v[28:31], a[20:23], a[76:79], v[28:31]
ds_read_b128 v[200:203], v19 offset:6144
ds_read_b128 v[220:223], v19 offset:11264
v_mfma_f32_16x16x32_bf16 v[28:31], a[40:43], a[80:83], v[28:31]
ds_read_b128 v[184:187], v19 offset:2048
ds_read_b128 v[204:207], v19 offset:7168
v_mfma_f32_16x16x32_bf16 v[28:31], v[144:147], a[84:87], v[28:31]
ds_read_b128 v[224:227], v19 offset:12288
ds_read_b128 v[188:191], v19 offset:3072
v_mfma_f32_16x16x32_bf16 v[32:35], a[4:7], a[72:75], v[32:35]
ds_read_b128 v[208:211], v19 offset:8192
ds_read_b128 v[228:231], v19 offset:13312
v_mfma_f32_16x16x32_bf16 v[32:35], a[24:27], a[76:79], v[32:35]
ds_read_b128 v[192:195], v19 offset:4096
ds_read_b128 v[212:215], v19 offset:9216
v_mfma_f32_16x16x32_bf16 v[32:35], a[204:207], a[80:83], v[32:35]
ds_read_b128 v[232:235], v19 offset:14336
v_mfma_f32_16x16x32_bf16 v[32:35], v[148:151], a[84:87], v[32:35]
v_mfma_f32_16x16x32_bf16 v[36:39], a[8:11], a[72:75], v[36:39]
v_mfma_f32_16x16x32_bf16 v[36:39], a[28:31], a[76:79], v[36:39]
v_mfma_f32_16x16x32_bf16 v[36:39], a[208:211], a[80:83], v[36:39]
v_mfma_f32_16x16x32_bf16 v[36:39], v[152:155], a[84:87], v[36:39]
s_waitcnt lgkmcnt(13)
v_pk_add_f32 v[176:177], v[176:177], v[196:197]
v_pk_add_f32 v[178:179], v[178:179], v[198:199]
s_waitcnt lgkmcnt(10)
v_pk_add_f32 v[180:181], v[180:181], v[200:201]
v_pk_add_f32 v[182:183], v[182:183], v[202:203]
v_pk_add_f32 v[20:21], v[20:21], v[216:217]
v_pk_add_f32 v[22:23], v[22:23], v[218:219]
s_waitcnt lgkmcnt(9)
v_pk_add_f32 v[24:25], v[24:25], v[220:221]
v_pk_add_f32 v[26:27], v[26:27], v[222:223]
v_pk_add_f32 v[20:21], v[20:21], v[176:177]
v_pk_add_f32 v[22:23], v[22:23], v[178:179]
v_pk_add_f32 v[24:25], v[24:25], v[180:181]
v_pk_add_f32 v[26:27], v[26:27], v[182:183]
v_cvt_pk_bf16_f32 v48, v20, v21
v_cvt_pk_bf16_f32 v49, v22, v23
v_cvt_pk_bf16_f32 v50, v24, v25
v_cvt_pk_bf16_f32 v51, v26, v27
ds_write_b128 v250, v[48:51]
s_waitcnt lgkmcnt(8)
v_pk_add_f32 v[184:185], v[184:185], v[204:205]
v_pk_add_f32 v[186:187], v[186:187], v[206:207]
s_waitcnt lgkmcnt(5)
v_pk_add_f32 v[188:189], v[188:189], v[208:209]
v_pk_add_f32 v[190:191], v[190:191], v[210:211]
v_pk_add_f32 v[28:29], v[28:29], v[224:225]
v_pk_add_f32 v[30:31], v[30:31], v[226:227]
s_waitcnt lgkmcnt(4)
v_pk_add_f32 v[32:33], v[32:33], v[228:229]
v_pk_add_f32 v[34:35], v[34:35], v[230:231]
v_pk_add_f32 v[28:29], v[28:29], v[184:185]
v_pk_add_f32 v[30:31], v[30:31], v[186:187]
v_pk_add_f32 v[32:33], v[32:33], v[188:189]
v_pk_add_f32 v[34:35], v[34:35], v[190:191]
v_cvt_pk_bf16_f32 v52, v28, v29
v_cvt_pk_bf16_f32 v53, v30, v31
v_cvt_pk_bf16_f32 v54, v32, v33
v_cvt_pk_bf16_f32 v55, v34, v35
ds_write_b128 v250, v[52:55] offset:16
s_waitcnt lgkmcnt(3)
v_pk_add_f32 v[192:193], v[192:193], v[212:213]
v_pk_add_f32 v[194:195], v[194:195], v[214:215]
s_waitcnt lgkmcnt(2)
v_pk_add_f32 v[36:37], v[36:37], v[232:233]
v_pk_add_f32 v[38:39], v[38:39], v[234:235]
v_pk_add_f32 v[36:37], v[36:37], v[192:193]
v_pk_add_f32 v[38:39], v[38:39], v[194:195]
v_cvt_pk_bf16_f32 v56, v36, v37
v_cvt_pk_bf16_f32 v57, v38, v39
ds_write_b64 v251, v[56:57] offset:128
ds_read_b128 v[60:63], v43 offset:0
ds_read_b128 v[64:67], v43 offset:1024
ds_read_b128 v[68:71], v43 offset:2048
s_waitcnt lgkmcnt(2)
buffer_store_dwordx4 v[60:63], v40, s[8:11], s93 offen nt
s_waitcnt lgkmcnt(1)
buffer_store_dwordx4 v[64:67], v41, s[8:11], s93 offen nt
s_waitcnt lgkmcnt(0)
buffer_store_dwordx4 v[68:71], v42, s[8:11], s93 offen nt
s_endpgm
EXIT:
s_endpgm
VS11:
s_mov_b32 s79, 0x100000
VS11_l:
s_sleep 4
buffer_load_dwordx2 v[242:243], v240, s[4:7], 0 offen sc1
s_waitcnt vmcnt(0)
v_cmp_ne_u64 vcc, v[242:243], v[248:249]
s_nop 1
s_cbranch_vccz VB12
s_sub_u32 s79, s79, 1
s_cmp_lg_u32 s79, 0
s_cbranch_scc1 VS11_l
s_branch VB12
VT15:
s_mov_b32 s79, 0x100000
VT15_l:
s_sleep 4
buffer_load_dword v175, v174, s[4:7], 0 offen sc1
s_waitcnt vmcnt(0)
v_sub_u32 v175, v175, v248
v_cmp_lt_u32 vcc, 7, v175
s_nop 1
s_cbranch_vccz VB16
s_sub_u32 s79, s79, 1
s_cmp_lg_u32 s79, 0
s_cbranch_scc1 VT15_l
s_branch VB16
SP18:
s_mov_b32 s79, 0x200000
SP18_l:
s_sleep 1
s_load_dword s15, s[4:5], s92 offset:0 glc
s_waitcnt lgkmcnt(0)
s_cmp_ge_u32 s15, s3
s_cbranch_scc1 BK19
s_sub_u32 s79, s79, 1
s_cmp_lg_u32 s79, 0
s_cbranch_scc1 SP18_l
s_branch BK19
FB0:
s_waitcnt vmcnt(0) lgkmcnt(0)
s_nop 7
s_nop 7
v_accvgpr_write_b32 a104, v48
v_accvgpr_write_b32 a105, v49
v_accvgpr_write_b32 a106, v50
v_accvgpr_write_b32 a107, v51
v_accvgpr_write_b32 a108, v52
v_accvgpr_write_b32 a109, v53
v_accvgpr_write_b32 a110, v54
v_accvgpr_write_b32 a111, v55
v_accvgpr_write_b32 a112, v56
v_accvgpr_write_b32 a113, v57
v_accvgpr_write_b32 a114, v58
v_accvgpr_write_b32 a115, v59
v_accvgpr_write_b32 a116, v60
v_accvgpr_write_b32 a117, v61
v_accvgpr_write_b32 a118, v62
v_accvgpr_write_b32 a119, v63
v_accvgpr_write_b32 a120, v64
v_accvgpr_write_b32 a121, v65
v_accvgpr_write_b32 a122, v66
v_accvgpr_write_b32 a123, v67
v_accvgpr_write_b32 a124, v68
v_accvgpr_write_b32 a125, v69
v_accvgpr_write_b32 a126, v70
v_accvgpr_write_b32 a127, v71
v_accvgpr_write_b32 a128, v72
v_accvgpr_write_b32 a129, v73
v_accvgpr_write_b32 a130, v74
v_accvgpr_write_b32 a131, v75
v_accvgpr_write_b32 a132, v76
v_accvgpr_write_b32 a133, v77
v_accvgpr_write_b32 a134, v78
v_accvgpr_write_b32 a135, v79
v_mov_b32 v248, 0xff7fffff
ds_read_b128 a[136:139], v47 offset:41984
s_waitcnt lgkmcnt(0)
v_mfma_f32_32x32x16_bf16 v[64:79], a[136:139], v[172:175], 0
v_mfma_f32_32x32x16_bf16 v[64:79], a[32:35], v[180:183], v[64:79]
ds_read_b128 a[136:139], v47 offset:36736
s_waitcnt lgkmcnt(0)
v_mfma_f32_32x32x16_bf16 v[48:63], a[136:139], v[172:175], 0
v_mfma_f32_32x32x16_bf16 v[48:63], a[28:31], v[180:183], v[48:63]
s_nop 11
v_max3_f32 v248, v48, v49, v248
v_max3_f32 v248, v50, v51, v248
v_max3_f32 v248, v52, v53, v248
v_max3_f32 v248, v54, v55, v248
v_max3_f32 v248, v56, v57, v248
v_max3_f32 v248, v58, v59, v248
v_max3_f32 v248, v60, v61, v248
v_max3_f32 v248, v62, v63, v248
ds_read_b128 a[136:139], v47 offset:31488
s_waitcnt lgkmcnt(0)
v_mfma_f32_32x32x16_bf16 v[48:63], a[136:139], v[172:175], 0
v_mfma_f32_32x32x16_bf16 v[48:63], a[24:27], v[180:183], v[48:63]
s_nop 11
v_max3_f32 v248, v48, v49, v248
v_max3_f32 v248, v50, v51, v248
v_max3_f32 v248, v52, v53, v248
v_max3_f32 v248, v54, v55, v248
v_max3_f32 v248, v56, v57, v248
v_max3_f32 v248, v58, v59, v248
v_max3_f32 v248, v60, v61, v248
v_max3_f32 v248, v62, v63, v248
ds_read_b128 a[136:139], v47 offset:26240
s_waitcnt lgkmcnt(0)
v_mfma_f32_32x32x16_bf16 v[48:63], a[136:139], v[172:175], 0
v_mfma_f32_32x32x16_bf16 v[48:63], a[20:23], v[180:183], v[48:63]
s_nop 11
v_max3_f32 v248, v48, v49, v248
v_max3_f32 v248, v50, v51, v248
v_max3_f32 v248, v52, v53, v248
v_max3_f32 v248, v54, v55, v248
v_max3_f32 v248, v56, v57, v248
v_max3_f32 v248, v58, v59, v248
v_max3_f32 v248, v60, v61, v248
v_max3_f32 v248, v62, v63, v248
ds_read_b128 a[136:139], v47 offset:20992
s_waitcnt lgkmcnt(0)
v_mfma_f32_32x32x16_bf16 v[48:63], a[136:139], v[172:175], 0
v_mfma_f32_32x32x16_bf16 v[48:63], a[16:19], v[180:183], v[48:63]
s_nop 11
v_max3_f32 v248, v48, v49, v248
v_max3_f32 v248, v50, v51, v248
v_max3_f32 v248, v52, v53, v248
v_max3_f32 v248, v54, v55, v248
v_max3_f32 v248, v56, v57, v248
v_max3_f32 v248, v58, v59, v248
v_max3_f32 v248, v60, v61, v248
v_max3_f32 v248, v62, v63, v248
ds_read_b128 a[136:139], v47 offset:15744
s_waitcnt lgkmcnt(0)
v_mfma_f32_32x32x16_bf16 v[48:63], a[136:139], v[172:175], 0
v_mfma_f32_32x32x16_bf16 v[48:63], a[12:15], v[180:183], v[48:63]
s_nop 11
v_max3_f32 v248, v48, v49, v248
v_max3_f32 v248, v50, v51, v248
v_max3_f32 v248, v52, v53, v248
v_max3_f32 v248, v54, v55, v248
v_max3_f32 v248, v56, v57, v248
v_max3_f32 v248, v58, v59, v248
v_max3_f32 v248, v60, v61, v248
v_max3_f32 v248, v62, v63, v248
ds_read_b128 a[136:139], v47 offset:10496
s_waitcnt lgkmcnt(0)
v_mfma_f32_32x32x16_bf16 v[48:63], a[136:139], v[172:175], 0
v_mfma_f32_32x32x16_bf16 v[48:63], a[8:11], v[180:183], v[48:63]
s_nop 11
v_max3_f32 v248, v48, v49, v248
v_max3_f32 v248, v50, v51, v248
v_max3_f32 v248, v52, v53, v248
v_max3_f32 v248, v54, v55, v248
v_max3_f32 v248, v56, v57, v248
v_max3_f32 v248, v58, v59, v248
v_max3_f32 v248, v60, v61, v248
v_max3_f32 v248, v62, v63, v248
ds_read_b128 a[136:139], v47 offset:5248
s_waitcnt lgkmcnt(0)
v_mfma_f32_32x32x16_bf16 v[48:63], a[136:139], v[172:175], 0
v_mfma_f32_32x32x16_bf16 v[48:63], a[4:7], v[180:183], v[48:63]
s_nop 11
v_max3_f32 v248, v48, v49, v248
v_max3_f32 v248, v50, v51, v248
v_max3_f32 v248, v52, v53, v248
v_max3_f32 v248, v54, v55, v248
v_max3_f32 v248, v56, v57, v248
v_max3_f32 v248, v58, v59, v248
v_max3_f32 v248, v60, v61, v248
v_max3_f32 v248, v62, v63, v248
ds_read_b128 a[136:139], v47 offset:0
s_waitcnt lgkmcnt(0)
v_mfma_f32_32x32x16_bf16 v[48:63], a[136:139], v[172:175], 0
v_mfma_f32_32x32x16_bf16 v[48:63], a[0:3], v[180:183], v[48:63]
s_nop 11
v_cndmask_b32 v64, v48, v64, s[32:33]
v_cndmask_b32 v65, v49, v65, s[34:35]
v_cndmask_b32 v66, v50, v66, s[36:37]
v_cndmask_b32 v67, v51, v67, s[38:39]
v_cndmask_b32 v68, v52, v68, s[40:41]
v_cndmask_b32 v69, v53, v69, s[42:43]
v_cndmask_b32 v70, v54, v70, s[44:45]
v_cndmask_b32 v71, v55, v71, s[46:47]
v_cndmask_b32 v72, v56, v72, s[48:49]
v_cndmask_b32 v73, v57, v73, s[50:51]
v_cndmask_b32 v74, v58, v74, s[52:53]
v_cndmask_b32 v75, v59, v75, s[54:55]
v_cndmask_b32 v76, v60, v76, s[56:57]
v_cndmask_b32 v77, v61, v77, s[58:59]
v_cndmask_b32 v78, v62, v78, s[60:61]
v_cndmask_b32 v79, v63, v79, s[62:63]
v_max3_f32 v248, v64, v65, v248
v_max3_f32 v248, v66, v67, v248
v_max3_f32 v248, v68, v69, v248
v_max3_f32 v248, v70, v71, v248
v_max3_f32 v248, v72, v73, v248
v_max3_f32 v248, v74, v75, v248
v_max3_f32 v248, v76, v77, v248
v_max3_f32 v248, v78, v79, v248
v_mov_b32 v249, v248
s_nop 1
v_permlane32_swap_b32 v249, v248
v_max_f32 v248, v248, v249
v_sub_f32 v214, 0, v248
v_sub_f32 v215, 0, v248
v_sub_f32 v216, 0, v248
v_sub_f32 v217, 0, v248
v_sub_f32 v218, 0, v248
v_sub_f32 v219, 0, v248
v_sub_f32 v220, 0, v248
v_sub_f32 v221, 0, v248
v_sub_f32 v222, 0, v248
v_sub_f32 v223, 0, v248
v_sub_f32 v224, 0, v248
v_sub_f32 v225, 0, v248
v_sub_f32 v226, 0, v248
v_sub_f32 v227, 0, v248
v_sub_f32 v228, 0, v248
v_sub_f32 v229, 0, v248
v_add_f32 v64, v214, v64
v_add_f32 v65, v214, v65
v_add_f32 v66, v214, v66
v_add_f32 v67, v214, v67
v_add_f32 v68, v214, v68
v_add_f32 v69, v214, v69
v_add_f32 v70, v214, v70
v_add_f32 v71, v214, v71
v_add_f32 v72, v214, v72
v_add_f32 v73, v214, v73
v_add_f32 v74, v214, v74
v_add_f32 v75, v214, v75
v_add_f32 v76, v214, v76
v_add_f32 v77, v214, v77
v_add_f32 v78, v214, v78
v_add_f32 v79, v214, v79
v_exp_f32 v64, v64
v_exp_f32 v65, v65
v_exp_f32 v66, v66
v_exp_f32 v67, v67
v_cvt_pk_bf16_f32 v230, v64, v65
v_exp_f32 v68, v68
v_exp_f32 v69, v69
v_cvt_pk_bf16_f32 v231, v66, v67
v_exp_f32 v70, v70
v_exp_f32 v71, v71
v_cvt_pk_bf16_f32 v232, v68, v69
v_exp_f32 v72, v72
v_exp_f32 v73, v73
v_cvt_pk_bf16_f32 v233, v70, v71
v_exp_f32 v74, v74
v_exp_f32 v75, v75
v_cvt_pk_bf16_f32 v234, v72, v73
v_exp_f32 v76, v76
v_exp_f32 v77, v77
v_cvt_pk_bf16_f32 v235, v74, v75
v_exp_f32 v78, v78
v_exp_f32 v79, v79
v_cvt_pk_bf16_f32 v236, v76, v77
v_cvt_pk_bf16_f32 v237, v78, v79
v_bfi_b32 v160, v188, 0, v230
v_bfi_b32 v161, v189, 0, v231
v_bfi_b32 v162, v190, 0, v232
v_bfi_b32 v163, v191, 0, v233
v_bfi_b32 v164, v192, 0, v234
v_bfi_b32 v165, v193, 0, v235
v_bfi_b32 v166, v194, 0, v236
v_bfi_b32 v167, v195, 0, v237
v_and_b32 v230, v188, v230
v_and_b32 v231, v189, v231
v_and_b32 v232, v190, v232
v_and_b32 v233, v191, v233
v_and_b32 v234, v192, v234
v_and_b32 v235, v193, v235
v_and_b32 v236, v194, v236
v_and_b32 v237, v195, v237
ds_read_b64_tr_b16 a[140:141], v204 offset:0
ds_read_b64_tr_b16 a[142:143], v204 offset:128
ds_read_b64_tr_b16 a[144:145], v204 offset:256
ds_read_b64_tr_b16 a[146:147], v204 offset:384
s_waitcnt lgkmcnt(2)
v_mfma_f32_32x32x16_bf16 v[120:135], a[140:143], v[230:233], 0
s_waitcnt lgkmcnt(0)
v_mfma_f32_32x32x16_bf16 v[120:135], a[144:147], v[234:237], v[120:135]
s_nop 7
s_nop 7
ds_read_b64_tr_b16 a[140:141], v196 offset:0
ds_read_b64_tr_b16 a[142:143], v196 offset:128
ds_read_b64_tr_b16 a[144:145], v196 offset:256
ds_read_b64_tr_b16 a[146:147], v196 offset:384
s_waitcnt lgkmcnt(2)
v_mfma_f32_32x32x16_bf16 v[120:135], a[140:143], v[160:163], v[120:135]
s_waitcnt lgkmcnt(0)
v_mfma_f32_32x32x16_bf16 v[120:135], a[144:147], v[164:167], v[120:135]
s_nop 7
s_nop 7
ds_read_b128 a[136:139], v47 offset:36736
ds_read_b64_tr_b16 a[140:141], v203 offset:0
ds_read_b64_tr_b16 a[142:143], v203 offset:128
ds_read_b64_tr_b16 a[144:145], v203 offset:256
ds_read_b64_tr_b16 a[146:147], v203 offset:384
s_waitcnt lgkmcnt(4)
v_mfma_f32_32x32x16_bf16 v[48:63], a[136:139], v[172:175], v[214:229]
v_mfma_f32_32x32x16_bf16 v[48:63], a[28:31], v[180:183], v[48:63]
s_nop 11
v_exp_f32 v48, v48
v_exp_f32 v49, v49
v_exp_f32 v50, v50
v_exp_f32 v51, v51
v_cvt_pk_bf16_f32 v230, v48, v49
v_exp_f32 v52, v52
v_exp_f32 v53, v53
v_cvt_pk_bf16_f32 v231, v50, v51
v_exp_f32 v54, v54
v_exp_f32 v55, v55
v_cvt_pk_bf16_f32 v232, v52, v53
v_exp_f32 v56, v56
v_exp_f32 v57, v57
v_cvt_pk_bf16_f32 v233, v54, v55
v_exp_f32 v58, v58
v_exp_f32 v59, v59
v_cvt_pk_bf16_f32 v234, v56, v57
v_exp_f32 v60, v60
v_exp_f32 v61, v61
v_cvt_pk_bf16_f32 v235, v58, v59
v_exp_f32 v62, v62
v_exp_f32 v63, v63
v_cvt_pk_bf16_f32 v236, v60, v61
v_cvt_pk_bf16_f32 v237, v62, v63
s_waitcnt lgkmcnt(2)
v_mfma_f32_32x32x16_bf16 v[120:135], a[140:143], v[230:233], v[120:135]
s_waitcnt lgkmcnt(0)
v_mfma_f32_32x32x16_bf16 v[120:135], a[144:147], v[234:237], v[120:135]
s_nop 7
s_nop 7
ds_read_b128 a[136:139], v47 offset:31488
ds_read_b64_tr_b16 a[140:141], v202 offset:0
ds_read_b64_tr_b16 a[142:143], v202 offset:128
ds_read_b64_tr_b16 a[144:145], v202 offset:256
ds_read_b64_tr_b16 a[146:147], v202 offset:384
s_waitcnt lgkmcnt(4)
v_mfma_f32_32x32x16_bf16 v[48:63], a[136:139], v[172:175], v[214:229]
v_mfma_f32_32x32x16_bf16 v[48:63], a[24:27], v[180:183], v[48:63]
s_nop 11
v_exp_f32 v48, v48
v_exp_f32 v49, v49
v_exp_f32 v50, v50
v_exp_f32 v51, v51
v_cvt_pk_bf16_f32 v230, v48, v49
v_exp_f32 v52, v52
v_exp_f32 v53, v53
v_cvt_pk_bf16_f32 v231, v50, v51
v_exp_f32 v54, v54
v_exp_f32 v55, v55
v_cvt_pk_bf16_f32 v232, v52, v53
v_exp_f32 v56, v56
v_exp_f32 v57, v57
v_cvt_pk_bf16_f32 v233, v54, v55
v_exp_f32 v58, v58
v_exp_f32 v59, v59
v_cvt_pk_bf16_f32 v234, v56, v57
v_exp_f32 v60, v60
v_exp_f32 v61, v61
v_cvt_pk_bf16_f32 v235, v58, v59
v_exp_f32 v62, v62
v_exp_f32 v63, v63
v_cvt_pk_bf16_f32 v236, v60, v61
v_cvt_pk_bf16_f32 v237, v62, v63
s_waitcnt lgkmcnt(2)
v_mfma_f32_32x32x16_bf16 v[120:135], a[140:143], v[230:233], v[120:135]
s_waitcnt lgkmcnt(0)
v_mfma_f32_32x32x16_bf16 v[120:135], a[144:147], v[234:237], v[120:135]
s_nop 7
s_nop 7
ds_read_b128 a[136:139], v47 offset:26240
ds_read_b64_tr_b16 a[140:141], v201 offset:0
ds_read_b64_tr_b16 a[142:143], v201 offset:128
ds_read_b64_tr_b16 a[144:145], v201 offset:256
ds_read_b64_tr_b16 a[146:147], v201 offset:384
s_waitcnt lgkmcnt(4)
v_mfma_f32_32x32x16_bf16 v[48:63], a[136:139], v[172:175], v[214:229]
v_mfma_f32_32x32x16_bf16 v[48:63], a[20:23], v[180:183], v[48:63]
s_nop 11
v_exp_f32 v48, v48
v_exp_f32 v49, v49
v_exp_f32 v50, v50
v_exp_f32 v51, v51
v_cvt_pk_bf16_f32 v230, v48, v49
v_exp_f32 v52, v52
v_exp_f32 v53, v53
v_cvt_pk_bf16_f32 v231, v50, v51
v_exp_f32 v54, v54
v_exp_f32 v55, v55
v_cvt_pk_bf16_f32 v232, v52, v53
v_exp_f32 v56, v56
v_exp_f32 v57, v57
v_cvt_pk_bf16_f32 v233, v54, v55
v_exp_f32 v58, v58
v_exp_f32 v59, v59
v_cvt_pk_bf16_f32 v234, v56, v57
v_exp_f32 v60, v60
v_exp_f32 v61, v61
v_cvt_pk_bf16_f32 v235, v58, v59
v_exp_f32 v62, v62
v_exp_f32 v63, v63
v_cvt_pk_bf16_f32 v236, v60, v61
v_cvt_pk_bf16_f32 v237, v62, v63
s_waitcnt lgkmcnt(2)
v_mfma_f32_32x32x16_bf16 v[120:135], a[140:143], v[230:233], v[120:135]
s_waitcnt lgkmcnt(0)
v_mfma_f32_32x32x16_bf16 v[120:135], a[144:147], v[234:237], v[120:135]
s_nop 7
s_nop 7
ds_read_b128 a[136:139], v47 offset:20992
ds_read_b64_tr_b16 a[140:141], v200 offset:0
ds_read_b64_tr_b16 a[142:143], v200 offset:128
ds_read_b64_tr_b16 a[144:145], v200 offset:256
ds_read_b64_tr_b16 a[146:147], v200 offset:384
s_waitcnt lgkmcnt(4)
v_mfma_f32_32x32x16_bf16 v[48:63], a[136:139], v[172:175], v[214:229]
v_mfma_f32_32x32x16_bf16 v[48:63], a[16:19], v[180:183], v[48:63]
s_nop 11
v_exp_f32 v48, v48
v_exp_f32 v49, v49
v_exp_f32 v50, v50
v_exp_f32 v51, v51
v_cvt_pk_bf16_f32 v230, v48, v49
v_exp_f32 v52, v52
v_exp_f32 v53, v53
v_cvt_pk_bf16_f32 v231, v50, v51
v_exp_f32 v54, v54
v_exp_f32 v55, v55
v_cvt_pk_bf16_f32 v232, v52, v53
v_exp_f32 v56, v56
v_exp_f32 v57, v57
v_cvt_pk_bf16_f32 v233, v54, v55
v_exp_f32 v58, v58
v_exp_f32 v59, v59
v_cvt_pk_bf16_f32 v234, v56, v57
v_exp_f32 v60, v60
v_exp_f32 v61, v61
v_cvt_pk_bf16_f32 v235, v58, v59
v_exp_f32 v62, v62
v_exp_f32 v63, v63
v_cvt_pk_bf16_f32 v236, v60, v61
v_cvt_pk_bf16_f32 v237, v62, v63
s_waitcnt lgkmcnt(2)
v_mfma_f32_32x32x16_bf16 v[120:135], a[140:143], v[230:233], v[120:135]
s_waitcnt lgkmcnt(0)
v_mfma_f32_32x32x16_bf16 v[120:135], a[144:147], v[234:237], v[120:135]
s_nop 7
s_nop 7
ds_read_b128 a[136:139], v47 offset:15744
ds_read_b64_tr_b16 a[140:141], v199 offset:0
ds_read_b64_tr_b16 a[142:143], v199 offset:128
ds_read_b64_tr_b16 a[144:145], v199 offset:256
ds_read_b64_tr_b16 a[146:147], v199 offset:384
s_waitcnt lgkmcnt(4)
v_mfma_f32_32x32x16_bf16 v[48:63], a[136:139], v[172:175], v[214:229]
v_mfma_f32_32x32x16_bf16 v[48:63], a[12:15], v[180:183], v[48:63]
s_nop 11
v_exp_f32 v48, v48
v_exp_f32 v49, v49
v_exp_f32 v50, v50
v_exp_f32 v51, v51
v_cvt_pk_bf16_f32 v230, v48, v49
v_exp_f32 v52, v52
v_exp_f32 v53, v53
v_cvt_pk_bf16_f32 v231, v50, v51
v_exp_f32 v54, v54
v_exp_f32 v55, v55
v_cvt_pk_bf16_f32 v232, v52, v53
v_exp_f32 v56, v56
v_exp_f32 v57, v57
v_cvt_pk_bf16_f32 v233, v54, v55
v_exp_f32 v58, v58
v_exp_f32 v59, v59
v_cvt_pk_bf16_f32 v234, v56, v57
v_exp_f32 v60, v60
v_exp_f32 v61, v61
v_cvt_pk_bf16_f32 v235, v58, v59
v_exp_f32 v62, v62
v_exp_f32 v63, v63
v_cvt_pk_bf16_f32 v236, v60, v61
v_cvt_pk_bf16_f32 v237, v62, v63
s_waitcnt lgkmcnt(2)
v_mfma_f32_32x32x16_bf16 v[120:135], a[140:143], v[230:233], v[120:135]
s_waitcnt lgkmcnt(0)
v_mfma_f32_32x32x16_bf16 v[120:135], a[144:147], v[234:237], v[120:135]
s_nop 7
s_nop 7
ds_read_b128 a[136:139], v47 offset:10496
ds_read_b64_tr_b16 a[140:141], v198 offset:0
ds_read_b64_tr_b16 a[142:143], v198 offset:128
ds_read_b64_tr_b16 a[144:145], v198 offset:256
ds_read_b64_tr_b16 a[146:147], v198 offset:384
s_waitcnt lgkmcnt(4)
v_mfma_f32_32x32x16_bf16 v[48:63], a[136:139], v[172:175], v[214:229]
v_mfma_f32_32x32x16_bf16 v[48:63], a[8:11], v[180:183], v[48:63]
s_nop 11
v_exp_f32 v48, v48
v_exp_f32 v49, v49
v_exp_f32 v50, v50
v_exp_f32 v51, v51
v_cvt_pk_bf16_f32 v230, v48, v49
v_exp_f32 v52, v52
v_exp_f32 v53, v53
v_cvt_pk_bf16_f32 v231, v50, v51
v_exp_f32 v54, v54
v_exp_f32 v55, v55
v_cvt_pk_bf16_f32 v232, v52, v53
v_exp_f32 v56, v56
v_exp_f32 v57, v57
v_cvt_pk_bf16_f32 v233, v54, v55
v_exp_f32 v58, v58
v_exp_f32 v59, v59
v_cvt_pk_bf16_f32 v234, v56, v57
v_exp_f32 v60, v60
v_exp_f32 v61, v61
v_cvt_pk_bf16_f32 v235, v58, v59
v_exp_f32 v62, v62
v_exp_f32 v63, v63
v_cvt_pk_bf16_f32 v236, v60, v61
v_cvt_pk_bf16_f32 v237, v62, v63
s_waitcnt lgkmcnt(2)
v_mfma_f32_32x32x16_bf16 v[120:135], a[140:143], v[230:233], v[120:135]
s_waitcnt lgkmcnt(0)
v_mfma_f32_32x32x16_bf16 v[120:135], a[144:147], v[234:237], v[120:135]
s_nop 7
s_nop 7
ds_read_b128 a[136:139], v47 offset:5248
ds_read_b64_tr_b16 a[140:141], v197 offset:0
ds_read_b64_tr_b16 a[142:143], v197 offset:128
ds_read_b64_tr_b16 a[144:145], v197 offset:256
ds_read_b64_tr_b16 a[146:147], v197 offset:384
s_waitcnt lgkmcnt(4)
v_mfma_f32_32x32x16_bf16 v[48:63], a[136:139], v[172:175], v[214:229]
v_mfma_f32_32x32x16_bf16 v[48:63], a[4:7], v[180:183], v[48:63]
s_nop 11
v_exp_f32 v48, v48
v_exp_f32 v49, v49
v_exp_f32 v50, v50
v_exp_f32 v51, v51
v_cvt_pk_bf16_f32 v230, v48, v49
v_exp_f32 v52, v52
v_exp_f32 v53, v53
v_cvt_pk_bf16_f32 v231, v50, v51
v_exp_f32 v54, v54
v_exp_f32 v55, v55
v_cvt_pk_bf16_f32 v232, v52, v53
v_exp_f32 v56, v56
v_exp_f32 v57, v57
v_cvt_pk_bf16_f32 v233, v54, v55
v_exp_f32 v58, v58
v_exp_f32 v59, v59
v_cvt_pk_bf16_f32 v234, v56, v57
v_exp_f32 v60, v60
v_exp_f32 v61, v61
v_cvt_pk_bf16_f32 v235, v58, v59
v_exp_f32 v62, v62
v_exp_f32 v63, v63
v_cvt_pk_bf16_f32 v236, v60, v61
v_cvt_pk_bf16_f32 v237, v62, v63
s_waitcnt lgkmcnt(2)
v_mfma_f32_32x32x16_bf16 v[120:135], a[140:143], v[230:233], v[120:135]
s_waitcnt lgkmcnt(0)
v_mfma_f32_32x32x16_bf16 v[120:135], a[144:147], v[234:237], v[120:135]
s_nop 7
s_nop 7
v_accvgpr_read_b32 v48, a104
v_accvgpr_read_b32 v49, a105
v_accvgpr_read_b32 v50, a106
v_accvgpr_read_b32 v51, a107
v_accvgpr_read_b32 v52, a108
v_accvgpr_read_b32 v53, a109
v_accvgpr_read_b32 v54, a110
v_accvgpr_read_b32 v55, a111
v_accvgpr_read_b32 v56, a112
v_accvgpr_read_b32 v57, a113
v_accvgpr_read_b32 v58, a114
v_accvgpr_read_b32 v59, a115
v_accvgpr_read_b32 v60, a116
v_accvgpr_read_b32 v61, a117
v_accvgpr_read_b32 v62, a118
v_accvgpr_read_b32 v63, a119
v_accvgpr_read_b32 v64, a120
v_accvgpr_read_b32 v65, a121
v_accvgpr_read_b32 v66, a122
v_accvgpr_read_b32 v67, a123
v_accvgpr_read_b32 v68, a124
v_accvgpr_read_b32 v69, a125
v_accvgpr_read_b32 v70, a126
v_accvgpr_read_b32 v71, a127
v_accvgpr_read_b32 v72, a128
v_accvgpr_read_b32 v73, a129
v_accvgpr_read_b32 v74, a130
v_accvgpr_read_b32 v75, a131
v_accvgpr_read_b32 v76, a132
v_accvgpr_read_b32 v77, a133
v_accvgpr_read_b32 v78, a134
v_accvgpr_read_b32 v79, a135
s_nop 7
s_nop 7
s_add_u32 s79, s24, 0
buffer_load_dwordx4 v[216:219], v1, s[4:7], s79 offen sc1
s_add_u32 s79, s24, 1024
buffer_load_dwordx4 v[220:223], v1, s[4:7], s79 offen sc1
s_add_u32 s79, s24, 2048
buffer_load_dwordx4 v[224:227], v1, s[4:7], s79 offen sc1
s_add_u32 s79, s24, 3072
buffer_load_dwordx4 v[228:231], v1, s[4:7], s79 offen sc1
s_add_u32 s79, s24, 4096
buffer_load_dwordx4 v[232:235], v1, s[4:7], s79 offen sc1
s_add_u32 s79, s24, 5120
buffer_load_dwordx4 v[236:239], v1, s[4:7], s79 offen sc1
s_add_u32 s79, s24, 6144
buffer_load_dwordx4 v[240:243], v1, s[4:7], s79 offen sc1
s_waitcnt vmcnt(0)
s_nop 7
s_nop 7
s_setpc_b64 s[64:65]
FB1:
s_waitcnt vmcnt(0) lgkmcnt(0)
s_nop 7
s_nop 7
v_accvgpr_write_b32 a104, v48
v_accvgpr_write_b32 a105, v49
v_accvgpr_write_b32 a106, v50
v_accvgpr_write_b32 a107, v51
v_accvgpr_write_b32 a108, v52
v_accvgpr_write_b32 a109, v53
v_accvgpr_write_b32 a110, v54
v_accvgpr_write_b32 a111, v55
v_accvgpr_write_b32 a112, v56
v_accvgpr_write_b32 a113, v57
v_accvgpr_write_b32 a114, v58
v_accvgpr_write_b32 a115, v59
v_accvgpr_write_b32 a116, v60
v_accvgpr_write_b32 a117, v61
v_accvgpr_write_b32 a118, v62
v_accvgpr_write_b32 a119, v63
v_accvgpr_write_b32 a120, v64
v_accvgpr_write_b32 a121, v65
v_accvgpr_write_b32 a122, v66
v_accvgpr_write_b32 a123, v67
v_accvgpr_write_b32 a124, v68
v_accvgpr_write_b32 a125, v69
v_accvgpr_write_b32 a126, v70
v_accvgpr_write_b32 a127, v71
v_accvgpr_write_b32 a128, v72
v_accvgpr_write_b32 a129, v73
v_accvgpr_write_b32 a130, v74
v_accvgpr_write_b32 a131, v75
v_accvgpr_write_b32 a132, v76
v_accvgpr_write_b32 a133, v77
v_accvgpr_write_b32 a134, v78
v_accvgpr_write_b32 a135, v79
v_mov_b32 v248, 0xff7fffff
ds_read_b128 a[136:139], v47 offset:43008
s_waitcnt lgkmcnt(0)
v_mfma_f32_32x32x16_bf16 v[64:79], a[136:139], v[176:179], 0
v_mfma_f32_32x32x16_bf16 v[64:79], a[32:35], v[184:187], v[64:79]
ds_read_b128 a[136:139], v47 offset:37760
s_waitcnt lgkmcnt(0)
v_mfma_f32_32x32x16_bf16 v[48:63], a[136:139], v[176:179], 0
v_mfma_f32_32x32x16_bf16 v[48:63], a[28:31], v[184:187], v[48:63]
s_nop 11
v_max3_f32 v248, v48, v49, v248
v_max3_f32 v248, v50, v51, v248
v_max3_f32 v248, v52, v53, v248
v_max3_f32 v248, v54, v55, v248
v_max3_f32 v248, v56, v57, v248
v_max3_f32 v248, v58, v59, v248
v_max3_f32 v248, v60, v61, v248
v_max3_f32 v248, v62, v63, v248
ds_read_b128 a[136:139], v47 offset:32512
s_waitcnt lgkmcnt(0)
v_mfma_f32_32x32x16_bf16 v[48:63], a[136:139], v[176:179], 0
v_mfma_f32_32x32x16_bf16 v[48:63], a[24:27], v[184:187], v[48:63]
s_nop 11
v_max3_f32 v248, v48, v49, v248
v_max3_f32 v248, v50, v51, v248
v_max3_f32 v248, v52, v53, v248
v_max3_f32 v248, v54, v55, v248
v_max3_f32 v248, v56, v57, v248
v_max3_f32 v248, v58, v59, v248
v_max3_f32 v248, v60, v61, v248
v_max3_f32 v248, v62, v63, v248
ds_read_b128 a[136:139], v47 offset:27264
s_waitcnt lgkmcnt(0)
v_mfma_f32_32x32x16_bf16 v[48:63], a[136:139], v[176:179], 0
v_mfma_f32_32x32x16_bf16 v[48:63], a[20:23], v[184:187], v[48:63]
s_nop 11
v_max3_f32 v248, v48, v49, v248
v_max3_f32 v248, v50, v51, v248
v_max3_f32 v248, v52, v53, v248
v_max3_f32 v248, v54, v55, v248
v_max3_f32 v248, v56, v57, v248
v_max3_f32 v248, v58, v59, v248
v_max3_f32 v248, v60, v61, v248
v_max3_f32 v248, v62, v63, v248
ds_read_b128 a[136:139], v47 offset:22016
s_waitcnt lgkmcnt(0)
v_mfma_f32_32x32x16_bf16 v[48:63], a[136:139], v[176:179], 0
v_mfma_f32_32x32x16_bf16 v[48:63], a[16:19], v[184:187], v[48:63]
s_nop 11
v_max3_f32 v248, v48, v49, v248
v_max3_f32 v248, v50, v51, v248
v_max3_f32 v248, v52, v53, v248
v_max3_f32 v248, v54, v55, v248
v_max3_f32 v248, v56, v57, v248
v_max3_f32 v248, v58, v59, v248
v_max3_f32 v248, v60, v61, v248
v_max3_f32 v248, v62, v63, v248
ds_read_b128 a[136:139], v47 offset:16768
s_waitcnt lgkmcnt(0)
v_mfma_f32_32x32x16_bf16 v[48:63], a[136:139], v[176:179], 0
v_mfma_f32_32x32x16_bf16 v[48:63], a[12:15], v[184:187], v[48:63]
s_nop 11
v_max3_f32 v248, v48, v49, v248
v_max3_f32 v248, v50, v51, v248
v_max3_f32 v248, v52, v53, v248
v_max3_f32 v248, v54, v55, v248
v_max3_f32 v248, v56, v57, v248
v_max3_f32 v248, v58, v59, v248
v_max3_f32 v248, v60, v61, v248
v_max3_f32 v248, v62, v63, v248
ds_read_b128 a[136:139], v47 offset:11520
s_waitcnt lgkmcnt(0)
v_mfma_f32_32x32x16_bf16 v[48:63], a[136:139], v[176:179], 0
v_mfma_f32_32x32x16_bf16 v[48:63], a[8:11], v[184:187], v[48:63]
s_nop 11
v_max3_f32 v248, v48, v49, v248
v_max3_f32 v248, v50, v51, v248
v_max3_f32 v248, v52, v53, v248
v_max3_f32 v248, v54, v55, v248
v_max3_f32 v248, v56, v57, v248
v_max3_f32 v248, v58, v59, v248
v_max3_f32 v248, v60, v61, v248
v_max3_f32 v248, v62, v63, v248
ds_read_b128 a[136:139], v47 offset:6272
s_waitcnt lgkmcnt(0)
v_mfma_f32_32x32x16_bf16 v[48:63], a[136:139], v[176:179], 0
v_mfma_f32_32x32x16_bf16 v[48:63], a[4:7], v[184:187], v[48:63]
s_nop 11
v_max3_f32 v248, v48, v49, v248
v_max3_f32 v248, v50, v51, v248
v_max3_f32 v248, v52, v53, v248
v_max3_f32 v248, v54, v55, v248
v_max3_f32 v248, v56, v57, v248
v_max3_f32 v248, v58, v59, v248
v_max3_f32 v248, v60, v61, v248
v_max3_f32 v248, v62, v63, v248
ds_read_b128 a[136:139], v47 offset:1024
s_waitcnt lgkmcnt(0)
v_mfma_f32_32x32x16_bf16 v[48:63], a[136:139], v[176:179], 0
v_mfma_f32_32x32x16_bf16 v[48:63], a[0:3], v[184:187], v[48:63]
s_nop 11
v_cndmask_b32 v64, v48, v64, s[32:33]
v_cndmask_b32 v65, v49, v65, s[34:35]
v_cndmask_b32 v66, v50, v66, s[36:37]
v_cndmask_b32 v67, v51, v67, s[38:39]
v_cndmask_b32 v68, v52, v68, s[40:41]
v_cndmask_b32 v69, v53, v69, s[42:43]
v_cndmask_b32 v70, v54, v70, s[44:45]
v_cndmask_b32 v71, v55, v71, s[46:47]
v_cndmask_b32 v72, v56, v72, s[48:49]
v_cndmask_b32 v73, v57, v73, s[50:51]
v_cndmask_b32 v74, v58, v74, s[52:53]
v_cndmask_b32 v75, v59, v75, s[54:55]
v_cndmask_b32 v76, v60, v76, s[56:57]
v_cndmask_b32 v77, v61, v77, s[58:59]
v_cndmask_b32 v78, v62, v78, s[60:61]
v_cndmask_b32 v79, v63, v79, s[62:63]
v_max3_f32 v248, v64, v65, v248
v_max3_f32 v248, v66, v67, v248
v_max3_f32 v248, v68, v69, v248
v_max3_f32 v248, v70, v71, v248
v_max3_f32 v248, v72, v73, v248
v_max3_f32 v248, v74, v75, v248
v_max3_f32 v248, v76, v77, v248
v_max3_f32 v248, v78, v79, v248
v_mov_b32 v249, v248
s_nop 1
v_permlane32_swap_b32 v249, v248
v_max_f32 v248, v248, v249
v_sub_f32 v214, 0, v248
v_sub_f32 v215, 0, v248
v_sub_f32 v216, 0, v248
v_sub_f32 v217, 0, v248
v_sub_f32 v218, 0, v248
v_sub_f32 v219, 0, v248
v_sub_f32 v220, 0, v248
v_sub_f32 v221, 0, v248
v_sub_f32 v222, 0, v248
v_sub_f32 v223, 0, v248
v_sub_f32 v224, 0, v248
v_sub_f32 v225, 0, v248
v_sub_f32 v226, 0, v248
v_sub_f32 v227, 0, v248
v_sub_f32 v228, 0, v248
v_sub_f32 v229, 0, v248
v_add_f32 v64, v214, v64
v_add_f32 v65, v214, v65
v_add_f32 v66, v214, v66
v_add_f32 v67, v214, v67
v_add_f32 v68, v214, v68
v_add_f32 v69, v214, v69
v_add_f32 v70, v214, v70
v_add_f32 v71, v214, v71
v_add_f32 v72, v214, v72
v_add_f32 v73, v214, v73
v_add_f32 v74, v214, v74
v_add_f32 v75, v214, v75
v_add_f32 v76, v214, v76
v_add_f32 v77, v214, v77
v_add_f32 v78, v214, v78
v_add_f32 v79, v214, v79
v_exp_f32 v64, v64
v_exp_f32 v65, v65
v_exp_f32 v66, v66
v_exp_f32 v67, v67
v_cvt_pk_bf16_f32 v230, v64, v65
v_exp_f32 v68, v68
v_exp_f32 v69, v69
v_cvt_pk_bf16_f32 v231, v66, v67
v_exp_f32 v70, v70
v_exp_f32 v71, v71
v_cvt_pk_bf16_f32 v232, v68, v69
v_exp_f32 v72, v72
v_exp_f32 v73, v73
v_cvt_pk_bf16_f32 v233, v70, v71
v_exp_f32 v74, v74
v_exp_f32 v75, v75
v_cvt_pk_bf16_f32 v234, v72, v73
v_exp_f32 v76, v76
v_exp_f32 v77, v77
v_cvt_pk_bf16_f32 v235, v74, v75
v_exp_f32 v78, v78
v_exp_f32 v79, v79
v_cvt_pk_bf16_f32 v236, v76, v77
v_cvt_pk_bf16_f32 v237, v78, v79
v_bfi_b32 v160, v188, 0, v230
v_bfi_b32 v161, v189, 0, v231
v_bfi_b32 v162, v190, 0, v232
v_bfi_b32 v163, v191, 0, v233
v_bfi_b32 v164, v192, 0, v234
v_bfi_b32 v165, v193, 0, v235
v_bfi_b32 v166, v194, 0, v236
v_bfi_b32 v167, v195, 0, v237
v_and_b32 v230, v188, v230
v_and_b32 v231, v189, v231
v_and_b32 v232, v190, v232
v_and_b32 v233, v191, v233
v_and_b32 v234, v192, v234
v_and_b32 v235, v193, v235
v_and_b32 v236, v194, v236
v_and_b32 v237, v195, v237
ds_read_b64_tr_b16 a[140:141], v213 offset:0
ds_read_b64_tr_b16 a[142:143], v213 offset:128
ds_read_b64_tr_b16 a[144:145], v213 offset:256
ds_read_b64_tr_b16 a[146:147], v213 offset:384
s_waitcnt lgkmcnt(2)
v_mfma_f32_32x32x16_bf16 v[136:151], a[140:143], v[230:233], 0
s_waitcnt lgkmcnt(0)
v_mfma_f32_32x32x16_bf16 v[136:151], a[144:147], v[234:237], v[136:151]
s_nop 7
s_nop 7
ds_read_b64_tr_b16 a[140:141], v205 offset:0
ds_read_b64_tr_b16 a[142:143], v205 offset:128
ds_read_b64_tr_b16 a[144:145], v205 offset:256
ds_read_b64_tr_b16 a[146:147], v205 offset:384
s_waitcnt lgkmcnt(2)
v_mfma_f32_32x32x16_bf16 v[136:151], a[140:143], v[160:163], v[136:151]
s_waitcnt lgkmcnt(0)
v_mfma_f32_32x32x16_bf16 v[136:151], a[144:147], v[164:167], v[136:151]
s_nop 7
s_nop 7
ds_read_b128 a[136:139], v47 offset:37760
ds_read_b64_tr_b16 a[140:141], v212 offset:0
ds_read_b64_tr_b16 a[142:143], v212 offset:128
ds_read_b64_tr_b16 a[144:145], v212 offset:256
ds_read_b64_tr_b16 a[146:147], v212 offset:384
s_waitcnt lgkmcnt(4)
v_mfma_f32_32x32x16_bf16 v[48:63], a[136:139], v[176:179], v[214:229]
v_mfma_f32_32x32x16_bf16 v[48:63], a[28:31], v[184:187], v[48:63]
s_nop 11
v_exp_f32 v48, v48
v_exp_f32 v49, v49
v_exp_f32 v50, v50
v_exp_f32 v51, v51
v_cvt_pk_bf16_f32 v230, v48, v49
v_exp_f32 v52, v52
v_exp_f32 v53, v53
v_cvt_pk_bf16_f32 v231, v50, v51
v_exp_f32 v54, v54
v_exp_f32 v55, v55
v_cvt_pk_bf16_f32 v232, v52, v53
v_exp_f32 v56, v56
v_exp_f32 v57, v57
v_cvt_pk_bf16_f32 v233, v54, v55
v_exp_f32 v58, v58
v_exp_f32 v59, v59
v_cvt_pk_bf16_f32 v234, v56, v57
v_exp_f32 v60, v60
v_exp_f32 v61, v61
v_cvt_pk_bf16_f32 v235, v58, v59
v_exp_f32 v62, v62
v_exp_f32 v63, v63
v_cvt_pk_bf16_f32 v236, v60, v61
v_cvt_pk_bf16_f32 v237, v62, v63
s_waitcnt lgkmcnt(2)
v_mfma_f32_32x32x16_bf16 v[136:151], a[140:143], v[230:233], v[136:151]
s_waitcnt lgkmcnt(0)
v_mfma_f32_32x32x16_bf16 v[136:151], a[144:147], v[234:237], v[136:151]
s_nop 7
s_nop 7
ds_read_b128 a[136:139], v47 offset:32512
ds_read_b64_tr_b16 a[140:141], v211 offset:0
ds_read_b64_tr_b16 a[142:143], v211 offset:128
ds_read_b64_tr_b16 a[144:145], v211 offset:256
ds_read_b64_tr_b16 a[146:147], v211 offset:384
s_waitcnt lgkmcnt(4)
v_mfma_f32_32x32x16_bf16 v[48:63], a[136:139], v[176:179], v[214:229]
v_mfma_f32_32x32x16_bf16 v[48:63], a[24:27], v[184:187], v[48:63]
s_nop 11
v_exp_f32 v48, v48
v_exp_f32 v49, v49
v_exp_f32 v50, v50
v_exp_f32 v51, v51
v_cvt_pk_bf16_f32 v230, v48, v49
v_exp_f32 v52, v52
v_exp_f32 v53, v53
v_cvt_pk_bf16_f32 v231, v50, v51
v_exp_f32 v54, v54
v_exp_f32 v55, v55
v_cvt_pk_bf16_f32 v232, v52, v53
v_exp_f32 v56, v56
v_exp_f32 v57, v57
v_cvt_pk_bf16_f32 v233, v54, v55
v_exp_f32 v58, v58
v_exp_f32 v59, v59
v_cvt_pk_bf16_f32 v234, v56, v57
v_exp_f32 v60, v60
v_exp_f32 v61, v61
v_cvt_pk_bf16_f32 v235, v58, v59
v_exp_f32 v62, v62
v_exp_f32 v63, v63
v_cvt_pk_bf16_f32 v236, v60, v61
v_cvt_pk_bf16_f32 v237, v62, v63
s_waitcnt lgkmcnt(2)
v_mfma_f32_32x32x16_bf16 v[136:151], a[140:143], v[230:233], v[136:151]
s_waitcnt lgkmcnt(0)
v_mfma_f32_32x32x16_bf16 v[136:151], a[144:147], v[234:237], v[136:151]
s_nop 7
s_nop 7
ds_read_b128 a[136:139], v47 offset:27264
ds_read_b64_tr_b16 a[140:141], v210 offset:0
ds_read_b64_tr_b16 a[142:143], v210 offset:128
ds_read_b64_tr_b16 a[144:145], v210 offset:256
ds_read_b64_tr_b16 a[146:147], v210 offset:384
s_waitcnt lgkmcnt(4)
v_mfma_f32_32x32x16_bf16 v[48:63], a[136:139], v[176:179], v[214:229]
v_mfma_f32_32x32x16_bf16 v[48:63], a[20:23], v[184:187], v[48:63]
s_nop 11
v_exp_f32 v48, v48
v_exp_f32 v49, v49
v_exp_f32 v50, v50
v_exp_f32 v51, v51
v_cvt_pk_bf16_f32 v230, v48, v49
v_exp_f32 v52, v52
v_exp_f32 v53, v53
v_cvt_pk_bf16_f32 v231, v50, v51
v_exp_f32 v54, v54
v_exp_f32 v55, v55
v_cvt_pk_bf16_f32 v232, v52, v53
v_exp_f32 v56, v56
v_exp_f32 v57, v57
v_cvt_pk_bf16_f32 v233, v54, v55
v_exp_f32 v58, v58
v_exp_f32 v59, v59
v_cvt_pk_bf16_f32 v234, v56, v57
v_exp_f32 v60, v60
v_exp_f32 v61, v61
v_cvt_pk_bf16_f32 v235, v58, v59
v_exp_f32 v62, v62
v_exp_f32 v63, v63
v_cvt_pk_bf16_f32 v236, v60, v61
v_cvt_pk_bf16_f32 v237, v62, v63
s_waitcnt lgkmcnt(2)
v_mfma_f32_32x32x16_bf16 v[136:151], a[140:143], v[230:233], v[136:151]
s_waitcnt lgkmcnt(0)
v_mfma_f32_32x32x16_bf16 v[136:151], a[144:147], v[234:237], v[136:151]
s_nop 7
s_nop 7
ds_read_b128 a[136:139], v47 offset:22016
ds_read_b64_tr_b16 a[140:141], v209 offset:0
ds_read_b64_tr_b16 a[142:143], v209 offset:128
ds_read_b64_tr_b16 a[144:145], v209 offset:256
ds_read_b64_tr_b16 a[146:147], v209 offset:384
s_waitcnt lgkmcnt(4)
v_mfma_f32_32x32x16_bf16 v[48:63], a[136:139], v[176:179], v[214:229]
v_mfma_f32_32x32x16_bf16 v[48:63], a[16:19], v[184:187], v[48:63]
s_nop 11
v_exp_f32 v48, v48
v_exp_f32 v49, v49
v_exp_f32 v50, v50
v_exp_f32 v51, v51
v_cvt_pk_bf16_f32 v230, v48, v49
v_exp_f32 v52, v52
v_exp_f32 v53, v53
v_cvt_pk_bf16_f32 v231, v50, v51
v_exp_f32 v54, v54
v_exp_f32 v55, v55
v_cvt_pk_bf16_f32 v232, v52, v53
v_exp_f32 v56, v56
v_exp_f32 v57, v57
v_cvt_pk_bf16_f32 v233, v54, v55
v_exp_f32 v58, v58
v_exp_f32 v59, v59
v_cvt_pk_bf16_f32 v234, v56, v57
v_exp_f32 v60, v60
v_exp_f32 v61, v61
v_cvt_pk_bf16_f32 v235, v58, v59
v_exp_f32 v62, v62
v_exp_f32 v63, v63
v_cvt_pk_bf16_f32 v236, v60, v61
v_cvt_pk_bf16_f32 v237, v62, v63
s_waitcnt lgkmcnt(2)
v_mfma_f32_32x32x16_bf16 v[136:151], a[140:143], v[230:233], v[136:151]
s_waitcnt lgkmcnt(0)
v_mfma_f32_32x32x16_bf16 v[136:151], a[144:147], v[234:237], v[136:151]
s_nop 7
s_nop 7
ds_read_b128 a[136:139], v47 offset:16768
ds_read_b64_tr_b16 a[140:141], v208 offset:0
ds_read_b64_tr_b16 a[142:143], v208 offset:128
ds_read_b64_tr_b16 a[144:145], v208 offset:256
ds_read_b64_tr_b16 a[146:147], v208 offset:384
s_waitcnt lgkmcnt(4)
v_mfma_f32_32x32x16_bf16 v[48:63], a[136:139], v[176:179], v[214:229]
v_mfma_f32_32x32x16_bf16 v[48:63], a[12:15], v[184:187], v[48:63]
s_nop 11
v_exp_f32 v48, v48
v_exp_f32 v49, v49
v_exp_f32 v50, v50
v_exp_f32 v51, v51
v_cvt_pk_bf16_f32 v230, v48, v49
v_exp_f32 v52, v52
v_exp_f32 v53, v53
v_cvt_pk_bf16_f32 v231, v50, v51
v_exp_f32 v54, v54
v_exp_f32 v55, v55
v_cvt_pk_bf16_f32 v232, v52, v53
v_exp_f32 v56, v56
v_exp_f32 v57, v57
v_cvt_pk_bf16_f32 v233, v54, v55
v_exp_f32 v58, v58
v_exp_f32 v59, v59
v_cvt_pk_bf16_f32 v234, v56, v57
v_exp_f32 v60, v60
v_exp_f32 v61, v61
v_cvt_pk_bf16_f32 v235, v58, v59
v_exp_f32 v62, v62
v_exp_f32 v63, v63
v_cvt_pk_bf16_f32 v236, v60, v61
v_cvt_pk_bf16_f32 v237, v62, v63
s_waitcnt lgkmcnt(2)
v_mfma_f32_32x32x16_bf16 v[136:151], a[140:143], v[230:233], v[136:151]
s_waitcnt lgkmcnt(0)
v_mfma_f32_32x32x16_bf16 v[136:151], a[144:147], v[234:237], v[136:151]
s_nop 7
s_nop 7
ds_read_b128 a[136:139], v47 offset:11520
ds_read_b64_tr_b16 a[140:141], v207 offset:0
ds_read_b64_tr_b16 a[142:143], v207 offset:128
ds_read_b64_tr_b16 a[144:145], v207 offset:256
ds_read_b64_tr_b16 a[146:147], v207 offset:384
s_waitcnt lgkmcnt(4)
v_mfma_f32_32x32x16_bf16 v[48:63], a[136:139], v[176:179], v[214:229]
v_mfma_f32_32x32x16_bf16 v[48:63], a[8:11], v[184:187], v[48:63]
s_nop 11
v_exp_f32 v48, v48
v_exp_f32 v49, v49
v_exp_f32 v50, v50
v_exp_f32 v51, v51
v_cvt_pk_bf16_f32 v230, v48, v49
v_exp_f32 v52, v52
v_exp_f32 v53, v53
v_cvt_pk_bf16_f32 v231, v50, v51
v_exp_f32 v54, v54
v_exp_f32 v55, v55
v_cvt_pk_bf16_f32 v232, v52, v53
v_exp_f32 v56, v56
v_exp_f32 v57, v57
v_cvt_pk_bf16_f32 v233, v54, v55
v_exp_f32 v58, v58
v_exp_f32 v59, v59
v_cvt_pk_bf16_f32 v234, v56, v57
v_exp_f32 v60, v60
v_exp_f32 v61, v61
v_cvt_pk_bf16_f32 v235, v58, v59
v_exp_f32 v62, v62
v_exp_f32 v63, v63
v_cvt_pk_bf16_f32 v236, v60, v61
v_cvt_pk_bf16_f32 v237, v62, v63
s_waitcnt lgkmcnt(2)
v_mfma_f32_32x32x16_bf16 v[136:151], a[140:143], v[230:233], v[136:151]
s_waitcnt lgkmcnt(0)
v_mfma_f32_32x32x16_bf16 v[136:151], a[144:147], v[234:237], v[136:151]
s_nop 7
s_nop 7
ds_read_b128 a[136:139], v47 offset:6272
ds_read_b64_tr_b16 a[140:141], v206 offset:0
ds_read_b64_tr_b16 a[142:143], v206 offset:128
ds_read_b64_tr_b16 a[144:145], v206 offset:256
ds_read_b64_tr_b16 a[146:147], v206 offset:384
s_waitcnt lgkmcnt(4)
v_mfma_f32_32x32x16_bf16 v[48:63], a[136:139], v[176:179], v[214:229]
v_mfma_f32_32x32x16_bf16 v[48:63], a[4:7], v[184:187], v[48:63]
s_nop 11
v_exp_f32 v48, v48
v_exp_f32 v49, v49
v_exp_f32 v50, v50
v_exp_f32 v51, v51
v_cvt_pk_bf16_f32 v230, v48, v49
v_exp_f32 v52, v52
v_exp_f32 v53, v53
v_cvt_pk_bf16_f32 v231, v50, v51
v_exp_f32 v54, v54
v_exp_f32 v55, v55
v_cvt_pk_bf16_f32 v232, v52, v53
v_exp_f32 v56, v56
v_exp_f32 v57, v57
v_cvt_pk_bf16_f32 v233, v54, v55
v_exp_f32 v58, v58
v_exp_f32 v59, v59
v_cvt_pk_bf16_f32 v234, v56, v57
v_exp_f32 v60, v60
v_exp_f32 v61, v61
v_cvt_pk_bf16_f32 v235, v58, v59
v_exp_f32 v62, v62
v_exp_f32 v63, v63
v_cvt_pk_bf16_f32 v236, v60, v61
v_cvt_pk_bf16_f32 v237, v62, v63
s_waitcnt lgkmcnt(2)
v_mfma_f32_32x32x16_bf16 v[136:151], a[140:143], v[230:233], v[136:151]
s_waitcnt lgkmcnt(0)
v_mfma_f32_32x32x16_bf16 v[136:151], a[144:147], v[234:237], v[136:151]
s_nop 7
s_nop 7
v_accvgpr_read_b32 v48, a104
v_accvgpr_read_b32 v49, a105
v_accvgpr_read_b32 v50, a106
v_accvgpr_read_b32 v51, a107
v_accvgpr_read_b32 v52, a108
v_accvgpr_read_b32 v53, a109
v_accvgpr_read_b32 v54, a110
v_accvgpr_read_b32 v55, a111
v_accvgpr_read_b32 v56, a112
v_accvgpr_read_b32 v57, a113
v_accvgpr_read_b32 v58, a114
v_accvgpr_read_b32 v59, a115
v_accvgpr_read_b32 v60, a116
v_accvgpr_read_b32 v61, a117
v_accvgpr_read_b32 v62, a118
v_accvgpr_read_b32 v63, a119
v_accvgpr_read_b32 v64, a120
v_accvgpr_read_b32 v65, a121
v_accvgpr_read_b32 v66, a122
v_accvgpr_read_b32 v67, a123
v_accvgpr_read_b32 v68, a124
v_accvgpr_read_b32 v69, a125
v_accvgpr_read_b32 v70, a126
v_accvgpr_read_b32 v71, a127
v_accvgpr_read_b32 v72, a128
v_accvgpr_read_b32 v73, a129
v_accvgpr_read_b32 v74, a130
v_accvgpr_read_b32 v75, a131
v_accvgpr_read_b32 v76, a132
v_accvgpr_read_b32 v77, a133
v_accvgpr_read_b32 v78, a134
v_accvgpr_read_b32 v79, a135
s_nop 7
s_nop 7
s_add_u32 s79, s24, 0
buffer_load_dwordx4 v[216:219], v1, s[4:7], s79 offen sc1
s_add_u32 s79, s24, 1024
buffer_load_dwordx4 v[220:223], v1, s[4:7], s79 offen sc1
s_add_u32 s79, s24, 2048
buffer_load_dwordx4 v[224:227], v1, s[4:7], s79 offen sc1
s_add_u32 s79, s24, 3072
buffer_load_dwordx4 v[228:231], v1, s[4:7], s79 offen sc1
s_add_u32 s79, s24, 4096
buffer_load_dwordx4 v[232:235], v1, s[4:7], s79 offen sc1
s_add_u32 s79, s24, 5120
buffer_load_dwordx4 v[236:239], v1, s[4:7], s79 offen sc1
s_add_u32 s79, s24, 6144
buffer_load_dwordx4 v[240:243], v1, s[4:7], s79 offen sc1
s_waitcnt vmcnt(0)
s_nop 7
s_nop 7
s_setpc_b64 s[64:65]
VS20:
s_mov_b32 s79, 0x100000
VS20_l:
s_sleep 4
buffer_load_dwordx2 v[242:243], v241, s[4:7], 0 offen sc1
s_waitcnt vmcnt(0)
v_cmp_ne_u64 vcc, v[242:243], v[248:249]
s_nop 1
s_cbranch_vccz VB21
s_sub_u32 s79, s79, 1
s_cmp_lg_u32 s79, 0
s_cbranch_scc1 VS20_l
s_branch VB21
SP22:
s_mov_b32 s79, 0x200000
SP22_l:
s_sleep 1
s_load_dword s15, s[4:5], s92 offset:4 glc
s_waitcnt lgkmcnt(0)
s_cmp_ge_u32 s15, s3
s_cbranch_scc1 BK23
s_sub_u32 s79, s79, 1
s_cmp_lg_u32 s79, 0
s_cbranch_scc1 SP22_l
s_branch BK23
FO24:
s_call_b64 s[64:65], FB0
s_branch FR25
FO26:
s_call_b64 s[64:65], FB1
s_branch FR27
SP28:
s_mov_b32 s79, 0x200000
SP28_l:
s_sleep 1
s_load_dword s15, s[4:5], s99 offset:0 glc
s_waitcnt lgkmcnt(0)
s_cmp_ge_u32 s15, 8
s_cbranch_scc1 BK29
s_sub_u32 s79, s79, 1
s_cmp_lg_u32 s79, 0
s_cbranch_scc1 SP28_l
s_branch BK29
RT30:
s_mov_b32 s79, 0x200000
RT30_l:
buffer_load_dwordx4 v[108:111], v4, s[4:7], s12 offen offset:0 sc1
buffer_load_dwordx4 v[112:115], v4, s[4:7], s12 offen offset:2048 sc1
buffer_load_dwordx4 v[116:119], v172, s[4:7], s12 offen offset:0 sc1
s_waitcnt vmcnt(0)
v_max3_u32 v168, v108, v109, v110
v_max3_u32 v168, v111, v112, v168
v_max3_u32 v168, v113, v114, v168
v_max3_u32 v168, v115, v116, v168
v_max3_u32 v168, v117, v118, v168
v_max_u32 v168, v119, v168
v_cmp_eq_u32 vcc, -1, v168
s_sub_u32 s79, s79, 1
s_nop 0
s_cbranch_vccz RB31
s_cmp_lg_u32 s79, 0
s_cbranch_scc1 RT30_l
s_branch RB31
RT32:
s_mov_b32 s79, 0x200000
RT32_l:
buffer_load_dwordx4 v[120:123], v4, s[4:7], s13 offen offset:0 sc1
buffer_load_dwordx4 v[124:127], v4, s[4:7], s13 offen offset:2048 sc1
buffer_load_dwordx4 v[128:131], v172, s[4:7], s13 offen offset:0 sc1
s_waitcnt vmcnt(0)
v_max3_u32 v168, v120, v121, v122
v_max3_u32 v168, v123, v124, v168
v_max3_u32 v168, v125, v126, v168
v_max3_u32 v168, v127, v128, v168
v_max3_u32 v168, v129, v130, v168
v_max_u32 v168, v131, v168
v_cmp_eq_u32 vcc, -1, v168
s_sub_u32 s79, s79, 1
s_nop 0
s_cbranch_vccz RB33
s_cmp_lg_u32 s79, 0
s_cbranch_scc1 RT32_l
s_branch RB33
RT34:
s_mov_b32 s79, 0x200000
RT34_l:
buffer_load_dwordx4 v[132:135], v4, s[4:7], s14 offen offset:0 sc1
buffer_load_dwordx4 v[136:139], v4, s[4:7], s14 offen offset:2048 sc1
buffer_load_dwordx4 v[140:143], v172, s[4:7], s14 offen offset:0 sc1
s_waitcnt vmcnt(0)
v_max3_u32 v168, v132, v133, v134
v_max3_u32 v168, v135, v136, v168
v_max3_u32 v168, v137, v138, v168
v_max3_u32 v168, v139, v140, v168
v_max3_u32 v168, v141, v142, v168
v_max_u32 v168, v143, v168
v_cmp_eq_u32 vcc, -1, v168
s_sub_u32 s79, s79, 1
s_nop 0
s_cbranch_vccz RB35
s_cmp_lg_u32 s79, 0
s_cbranch_scc1 RT34_l
s_branch RB35
RT36:
s_mov_b32 s79, 0x200000
RT36_l:
buffer_load_dwordx4 v[176:179], v4, s[4:7], s77 offen offset:0 sc1
buffer_load_dwordx4 v[180:183], v4, s[4:7], s77 offen offset:2048 sc1
buffer_load_dwordx4 v[184:187], v172, s[4:7], s77 offen offset:0 sc1
s_waitcnt vmcnt(0)
v_max3_u32 v168, v176, v177, v178
v_max3_u32 v168, v179, v180, v168
v_max3_u32 v168, v181, v182, v168
v_max3_u32 v168, v183, v184, v168
v_max3_u32 v168, v185, v186, v168
v_max_u32 v168, v187, v168
v_cmp_eq_u32 vcc, -1, v168
s_sub_u32 s79, s79, 1
s_nop 0
s_cbranch_vccz RB37
s_cmp_lg_u32 s79, 0
s_cbranch_scc1 RT36_l
s_branch RB37
SP38:
s_mov_b32 s79, 0x200000
SP38_l:
s_sleep 1
s_load_dword s15, s[4:5], s101 offset:0 glc
s_waitcnt lgkmcnt(0)
s_cmp_ge_u32 s15, 16
s_cbranch_scc1 BK39
s_sub_u32 s79, s79, 1
s_cmp_lg_u32 s79, 0
s_cbranch_scc1 SP38_l
s_branch BK39
SP40:
s_mov_b32 s79, 0x200000
SP40_l:
s_sleep 1
s_load_dword s15, s[4:5], s91 offset:16 glc
s_waitcnt lgkmcnt(0)
s_cmp_ge_u32 s15, s12
s_cbranch_scc1 BK41
s_sub_u32 s79, s79, 1
s_cmp_lg_u32 s79, 0
s_cbranch_scc1 SP40_l
s_branch BK41
SP42:
s_mov_b32 s79, 0x200000
SP42_l:
s_sleep 1
s_load_dword s15, s[4:5], s99 offset:2048 glc
s_waitcnt lgkmcnt(0)
s_cmp_ge_u32 s15, 8
s_cbranch_scc1 BK43
s_sub_u32 s79, s79, 1
s_cmp_lg_u32 s79, 0
s_cbranch_scc1 SP42_l
s_branch BK43
SP44:
s_mov_b32 s79, 0x200000
SP44_l:
s_sleep 1
s_load_dword s15, s[4:5], s99 offset:3072 glc
s_waitcnt lgkmcnt(0)
s_cmp_ge_u32 s15, 8
s_cbranch_scc1 BK45
s_sub_u32 s79, s79, 1
s_cmp_lg_u32 s79, 0
s_cbranch_scc1 SP44_l
s_branch BK45
SP46:
s_mov_b32 s79, 0x200000
SP46_l:
s_sleep 1
s_load_dword s15, s[4:5], s99 offset:8 glc
s_waitcnt lgkmcnt(0)
s_cmp_ge_u32 s15, 8
s_cbranch_scc1 BK47
s_sub_u32 s79, s79, 1
s_cmp_lg_u32 s79, 0
s_cbranch_scc1 SP46_l
s_branch BK47
SP48:
s_mov_b32 s79, 0x200000
SP48_l:
s_sleep 1
s_load_dword s15, s[4:5], s101 offset:512 glc
s_waitcnt lgkmcnt(0)
s_cmp_ge_u32 s15, 16
s_cbranch_scc1 BK49
s_sub_u32 s79, s79, 1
s_cmp_lg_u32 s79, 0
s_cbranch_scc1 SP48_l
s_branch BK49
SP50:
s_mov_b32 s79, 0x200000
SP50_l:
s_sleep 1
s_load_dword s15, s[4:5], s92 offset:8 glc
s_waitcnt lgkmcnt(0)
s_cmp_ge_u32 s15, s3
s_cbranch_scc1 BK51
s_sub_u32 s79, s79, 1
s_cmp_lg_u32 s79, 0
s_cbranch_scc1 SP50_l
s_branch BK51
SP52:
s_mov_b32 s79, 0x200000
SP52_l:
s_sleep 1
s_load_dword s15, s[4:5], s92 offset:12 glc
s_waitcnt lgkmcnt(0)
s_cmp_ge_u32 s15, s3
s_cbranch_scc1 BK53
s_sub_u32 s79, s79, 1
s_cmp_lg_u32 s79, 0
s_cbranch_scc1 SP52_l
s_branch BK53
FO54:
s_call_b64 s[64:65], FB0
s_branch FR55
FO56:
s_call_b64 s[64:65], FB1
s_branch FR57
SP58:
s_mov_b32 s79, 0x200000
SP58_l:
s_sleep 1
s_load_dword s15, s[4:5], s99 offset:4 glc
s_waitcnt lgkmcnt(0)
s_cmp_ge_u32 s15, 8
s_cbranch_scc1 BK59
s_sub_u32 s79, s79, 1
s_cmp_lg_u32 s79, 0
s_cbranch_scc1 SP58_l
s_branch BK59
RT60:
s_mov_b32 s79, 0x200000
RT60_l:
buffer_load_dwordx4 v[108:111], v4, s[4:7], s12 offen offset:0 sc1
buffer_load_dwordx4 v[112:115], v4, s[4:7], s12 offen offset:2048 sc1
buffer_load_dwordx4 v[116:119], v172, s[4:7], s12 offen offset:0 sc1
s_waitcnt vmcnt(0)
v_max3_u32 v168, v108, v109, v110
v_max3_u32 v168, v111, v112, v168
v_max3_u32 v168, v113, v114, v168
v_max3_u32 v168, v115, v116, v168
v_max3_u32 v168, v117, v118, v168
v_max_u32 v168, v119, v168
v_cmp_eq_u32 vcc, -1, v168
s_sub_u32 s79, s79, 1
s_nop 0
s_cbranch_vccz RB61
s_cmp_lg_u32 s79, 0
s_cbranch_scc1 RT60_l
s_branch RB61
RT62:
s_mov_b32 s79, 0x200000
RT62_l:
buffer_load_dwordx4 v[120:123], v4, s[4:7], s13 offen offset:0 sc1
buffer_load_dwordx4 v[124:127], v4, s[4:7], s13 offen offset:2048 sc1
buffer_load_dwordx4 v[128:131], v172, s[4:7], s13 offen offset:0 sc1
s_waitcnt vmcnt(0)
v_max3_u32 v168, v120, v121, v122
v_max3_u32 v168, v123, v124, v168
v_max3_u32 v168, v125, v126, v168
v_max3_u32 v168, v127, v128, v168
v_max3_u32 v168, v129, v130, v168
v_max_u32 v168, v131, v168
v_cmp_eq_u32 vcc, -1, v168
s_sub_u32 s79, s79, 1
s_nop 0
s_cbranch_vccz RB63
s_cmp_lg_u32 s79, 0
s_cbranch_scc1 RT62_l
s_branch RB63
RT64:
s_mov_b32 s79, 0x200000
RT64_l:
buffer_load_dwordx4 v[132:135], v4, s[4:7], s14 offen offset:0 sc1
buffer_load_dwordx4 v[136:139], v4, s[4:7], s14 offen offset:2048 sc1
buffer_load_dwordx4 v[140:143], v172, s[4:7], s14 offen offset:0 sc1
s_waitcnt vmcnt(0)
v_max3_u32 v168, v132, v133, v134
v_max3_u32 v168, v135, v136, v168
v_max3_u32 v168, v137, v138, v168
v_max3_u32 v168, v139, v140, v168
v_max3_u32 v168, v141, v142, v168
v_max_u32 v168, v143, v168
v_cmp_eq_u32 vcc, -1, v168
s_sub_u32 s79, s79, 1
s_nop 0
s_cbranch_vccz RB65
s_cmp_lg_u32 s79, 0
s_cbranch_scc1 RT64_l
s_branch RB65
RT66:
s_mov_b32 s79, 0x200000
RT66_l:
buffer_load_dwordx4 v[176:179], v4, s[4:7], s77 offen offset:0 sc1
buffer_load_dwordx4 v[180:183], v4, s[4:7], s77 offen offset:2048 sc1
buffer_load_dwordx4 v[184:187], v172, s[4:7], s77 offen offset:0 sc1
s_waitcnt vmcnt(0)
v_max3_u32 v168, v176, v177, v178
v_max3_u32 v168, v179, v180, v168
v_max3_u32 v168, v181, v182, v168
v_max3_u32 v168, v183, v184, v168
v_max3_u32 v168, v185, v186, v168
v_max_u32 v168, v187, v168
v_cmp_eq_u32 vcc, -1, v168
s_sub_u32 s79, s79, 1
s_nop 0
s_cbranch_vccz RB67
s_cmp_lg_u32 s79, 0
s_cbranch_scc1 RT66_l
s_branch RB67
SP68:
s_mov_b32 s79, 0x200000
SP68_l:
s_sleep 1
s_load_dword s15, s[4:5], s101 offset:4 glc
s_waitcnt lgkmcnt(0)
s_cmp_ge_u32 s15, 16
s_cbranch_scc1 BK69
s_sub_u32 s79, s79, 1
s_cmp_lg_u32 s79, 0
s_cbranch_scc1 SP68_l
s_branch BK69
SP70:
s_mov_b32 s79, 0x200000
SP70_l:
s_sleep 1
s_load_dword s15, s[4:5], s99 offset:2052 glc
s_waitcnt lgkmcnt(0)
s_cmp_ge_u32 s15, 8
s_cbranch_scc1 BK71
s_sub_u32 s79, s79, 1
s_cmp_lg_u32 s79, 0
s_cbranch_scc1 SP70_l
s_branch BK71
SP72:
s_mov_b32 s79, 0x200000
SP72_l:
s_sleep 1
s_load_dword s15, s[4:5], s99 offset:3076 glc
s_waitcnt lgkmcnt(0)
s_cmp_ge_u32 s15, 8
s_cbranch_scc1 BK73
s_sub_u32 s79, s79, 1
s_cmp_lg_u32 s79, 0
s_cbranch_scc1 SP72_l
s_branch BK73
SP74:
s_mov_b32 s79, 0x200000
SP74_l:
s_sleep 1
s_load_dword s15, s[4:5], s99 offset:12 glc
s_waitcnt lgkmcnt(0)
s_cmp_ge_u32 s15, 8
s_cbranch_scc1 BK75
s_sub_u32 s79, s79, 1
s_cmp_lg_u32 s79, 0
s_cbranch_scc1 SP74_l
s_branch BK75
main_end:
.section .rodata,"a"
.p2align 6
.amdhsa_kernel interleave_layers__sliding_block__glu_gated_geglu__prompt_kernel
  .amdhsa_next_free_vgpr 512
  .amdhsa_next_free_sgpr 102
  .amdhsa_accum_offset 256
  .amdhsa_group_segment_fixed_size 0
  .amdhsa_kernarg_size 80
  .amdhsa_user_sgpr_count 2
  .amdhsa_user_sgpr_kernarg_segment_ptr 1
  .amdhsa_system_sgpr_workgroup_id_x 1
  .amdhsa_float_denorm_mode_32 3
.end_amdhsa_kernel
```
